```python
import torch

def _softmax(x, axis=-1):
    return torch.softmax(x, dim=axis)

def _gelu(x):
    return torch.nn.functional.gelu(x, approximate='tanh')

def _silu(x):
    return torch.nn.functional.silu(x)

def _sigmoid(x):
    return torch.sigmoid(x)

def _layernorm(x, axis=-1, eps=1e-05):
    m = x.mean(dim=axis, keepdim=True)
    v = x.var(dim=axis, keepdim=True, unbiased=False)
    return (x - m) / torch.sqrt(v + eps)

def _scatter_add(tgt, idx, src, axis=0):
    return tgt.clone().index_add_(axis, idx, src)

def _segment_sum(src, seg, n):
    out = torch.zeros((n,) + src.shape[1:], dtype=src.dtype)
    return out.index_add_(0, seg, src)

def _pad(x, pw):
    flat = tuple((v for pair in reversed(pw) for v in pair))
    return torch.nn.functional.pad(x, flat)
kernel_name = 'adaLN_cond__compressed_kv_cla__geglu_ffn__prompt'

def setup_inputs():

    _w = lambda a: (lambda t: t.to(torch.bfloat16) if t.is_floating_point() else t)(torch.as_tensor(a))

    def _A_setup():
        B, H, Sq, Sk, D, M = (1, 32, 2048, 2048, 128, 512)
        Dc = 4 * D
        return {'x': _w((lambda *s: torch.randn(*s, dtype=torch.bfloat16) * 0.05)(B, Sq, M)), 'c_kv': _w((lambda *s: torch.randn(*s, dtype=torch.bfloat16) * 1.6)(B, Sk, Dc)), 'w_q': _w((lambda *s: torch.randn(*s, dtype=torch.bfloat16) * 0.8)(M, H, D) * M ** (-0.5)), 'w_uk': _w((lambda *s: torch.randn(*s, dtype=torch.bfloat16) * 0.8)(Dc, H, D) * Dc ** (-0.5)), 'w_uv': _w((lambda *s: torch.randn(*s, dtype=torch.bfloat16) * 1.6)(Dc, H, D) * Dc ** (-0.5)), 'w_o': _w((lambda *s: torch.randn(*s, dtype=torch.bfloat16) * 1.6)(H, D, M) * (H * D) ** (-0.5))}
    _A_in = _A_setup()

    def _B_setup():
        B, S, D, F = (1, 2048, 512, 1376)
        return {'x': _w((lambda *s: torch.randn(*s, dtype=torch.bfloat16) * 0.05)(B, S, D)), 'w_gate': _w((lambda *s: torch.randn(*s, dtype=torch.bfloat16) * 0.05)(D, F)), 'w_up': _w((lambda *s: torch.randn(*s, dtype=torch.bfloat16) * 0.05)(D, F)), 'w_down': _w((lambda *s: torch.randn(*s, dtype=torch.bfloat16) * 0.05)(F, D))}
    _B_in = _B_setup()
    return {'A_x': _A_in['x'], 'A_c_kv': _A_in['c_kv'], 'A_w_q': _A_in['w_q'], 'A_w_uk': _A_in['w_uk'], 'A_w_uv': _A_in['w_uv'], 'A_w_o': _A_in['w_o'], 'B_x': _B_in['x'], 'B_w_gate': _B_in['w_gate'], 'B_w_up': _B_in['w_up'], 'B_w_down': _B_in['w_down'], 'c': _w((lambda *s: torch.randn(*s, dtype=torch.bfloat16) * 0.1)(1, 512) * 8.0), 'w_mod': _w((lambda *s: torch.randn(*s, dtype=torch.bfloat16) * 0.1)(512, 6 * 512) * 512 ** (-0.5) * 8.0)}

def reference(A_x, A_c_kv, A_w_q, A_w_uk, A_w_uv, A_w_o, B_x, B_w_gate, B_w_up, B_w_down, c, w_mod):

    def _A_ref(x, c_kv, w_q, w_uk, w_uv, w_o):
        B, Sq, M = (x.shape[0], x.shape[1], x.shape[2])
        Sk = c_kv.shape[1]
        H, D = (w_q.shape[1], w_q.shape[2])
        q = torch.einsum('bqm,mhd->bhqd', x, w_q)
        k = torch.einsum('bkc,chd->bhkd', c_kv, w_uk)
        v = torch.einsum('bkc,chd->bhkd', c_kv, w_uv)
        scores = torch.einsum('bhqd,bhkd->bhqk', q, k) * D ** (-0.5)
        off = Sk - Sq
        qi = torch.arange(Sq)[:, None]
        kj = torch.arange(Sk)[None, :]
        cmask = kj <= qi + off
        scores = torch.where(cmask[None, None], scores, -1000000000.0)
        p = _softmax(scores, axis=-1)
        ctx = torch.einsum('bhqk,bhkd->bhqd', p, v)
        return torch.einsum('bhqd,hdm->bqm', ctx, w_o)

    def _B_ref(x, w_gate, w_up, w_down):
        return _gelu(x @ w_gate) * (x @ w_up) @ w_down
    x = A_x
    mod = (_silu(c) @ w_mod).reshape(c.shape[0], 6, 1, -1)
    sa, ca, ga, sb, cb, gb = (mod[:, 0].clone(), mod[:, 1].clone(), mod[:, 2].clone(), mod[:, 3].clone(), mod[:, 4].clone(), mod[:, 5].clone())
    h = _layernorm(x, axis=-1) * (1 + ca) + sa
    x = x + ga * _A_ref(h, A_c_kv, A_w_q, A_w_uk, A_w_uv, A_w_o)
    h = _layernorm(x, axis=-1) * (1 + cb) + sb
    x = x + gb * _B_ref(h, B_w_gate, B_w_up, B_w_down)
    return x
```

```asm
; @launch kernel=block_kernel grid=(256,1,1) block=(256,1,1) lds=163840
.amdgcn_target "amdgcn-amd-amdhsa--gfx950"
.text
.globl block_kernel
.p2align 8
.type block_kernel,@function
block_kernel:
    s_cmp_ge_u32 s2, 256
    s_cbranch_scc1 K1_EXIT
    s_and_b32 s3, s2, 0x81
    s_mul_i32 s3, s3, 0x4001
    s_bfe_u32 s3, s3, 0x80007
    s_and_b32 s2, s2, 0x7e
    s_or_b32 s2, s2, s3
    s_getpc_b64 s[68:69]
PC_block_kernel_1:
    s_sub_u32 s68, s68, PC_block_kernel_1-block_kernel
    s_subb_u32 s69, s69, 0
    v_lshlrev_b32 v200, 7, v0
    v_min_u32 v200, K5_END-block_kernel, v200
    global_load_dword v223, v200, s[68:69]
    v_add_u32 v200, 0x8000, v200
    v_min_u32 v200, K5_END-block_kernel, v200
    global_load_dword v223, v200, s[68:69]
    v_add_u32 v200, 0x8000, v200
    v_min_u32 v200, K5_END-block_kernel, v200
    global_load_dword v223, v200, s[68:69]
    s_load_dwordx2 s[86:87], s[0:1], 64
    s_load_dwordx2 s[8:9], s[0:1], 8
    s_load_dwordx2 s[12:13], s[0:1], 24
    s_load_dwordx2 s[28:29], s[0:1], 88
    s_load_dwordx2 s[32:33], s[0:1], 80
    s_load_dwordx2 s[16:17], s[0:1], 32
    s_load_dwordx2 s[20:21], s[0:1], 112
    s_load_dwordx2 s[24:25], s[0:1], 0
    s_load_dwordx2 s[36:37], s[0:1], 104
    s_load_dwordx2 s[4:5], s[0:1], 16
    s_load_dwordx2 s[96:97], s[0:1], 56
    s_load_dwordx2 s[92:93], s[0:1], 40
    s_load_dwordx2 s[88:89], s[0:1], 56
    s_mov_b32 s10, 0x200000
    s_mov_b32 s11, 0x20000
    s_mov_b32 s14, 0x400000
    s_mov_b32 s15, 0x20000
    s_mov_b32 s30, 0x300000
    s_mov_b32 s31, 0x20000
    s_mov_b32 s34, 0x400
    s_mov_b32 s35, 0x20000
    s_mov_b32 s18, 0x400000
    s_mov_b32 s19, 0x20000
    s_mov_b32 s22, 0x10000000
    s_mov_b32 s23, 0x20000
    s_mov_b32 s26, 0x200000
    s_mov_b32 s27, 0x20000
    s_mov_b32 s38, 0x100
    s_mov_b32 s39, 0x20000
    s_mov_b32 s6, 0x400000
    s_mov_b32 s7, 0x20000
    s_mov_b32 s98, 0x158000
    s_mov_b32 s99, 0x20000
    s_mov_b32 s94, 0x400000
    s_mov_b32 s95, 0x20000
    s_mov_b32 s90, 0x158000
    s_mov_b32 s91, 0x20000
    s_waitcnt lgkmcnt(0)
    v_mov_b32 v255, v0
    v_lshrrev_b32 v1, 6, v0
    v_and_b32 v253, 63, v0
    v_readfirstlane_b32 s40, v1
    s_and_b32 s53, s2, 7
    s_lshl_b32 s41, s53, 2
    s_bfe_u32 s48, s2, 0x20003
    s_add_u32 s41, s41, s48
    s_lshr_b32 s42, s2, 5
    s_lshl_b32 s50, s42, 2
    s_add_u32 s50, s50, s40
    s_lshl_b32 s43, s50, 16
    s_mul_i32 s44, s40, 24576
    s_add_u32 s44, s44, 65536
    s_lshl_b32 s46, s40, 12
    s_lshl_b32 s47, s41, 8
    s_lshl_b32 s45, s40, 17
    s_add_u32 s45, s45, s47
    v_lshrrev_b32 v40, 3, v253
    v_and_b32 v41, 7, v253
    v_lshrrev_b32 v42, 4, v253
    v_and_b32 v46, 15, v253
    v_lshlrev_b32 v47, 1, v42
    v_xor_b32 v47, v46, v47
    v_lshlrev_b32 v48, 13, v42
    v_lshl_add_u32 v228, v47, 4, v48
    v_add_u32 v229, 31744, v228
    v_xor_b32 v49, 128, v228
    v_add_u32 v230, 63488, v49
    v_add_u32 v231, 95232, v49
    v_xor_b32 v43, v41, v42
    v_lshlrev_b32 v44, 10, v40
    v_lshl_add_u32 v224, v43, 4, v44
    v_xor_b32 v45, 64, v224
    v_add_u32 v225, 7168, v45
    v_add_u32 v226, 14336, v224
    v_add_u32 v227, 21504, v45
    s_add_u32 s48, s53, 0
    s_and_b32 s48, s48, 7
    s_lshl_b32 s48, s48, 19
    s_add_u32 s48, s48, s45
    s_add_u32 m0, s46, 0
    s_nop 0
    buffer_load_dwordx4 v228, s[12:15], s48 offen offset:0 lds
    buffer_load_dwordx4 v229, s[12:15], s48 offen offset:1024 lds
    buffer_load_dwordx4 v230, s[12:15], s48 offen offset:2048 lds
    buffer_load_dwordx4 v231, s[12:15], s48 offen offset:3072 lds
    s_add_u32 s48, s53, 0
    s_and_b32 s48, s48, 7
    s_lshl_b32 s48, s48, 7
    s_add_u32 s48, s48, s43
    s_add_u32 m0, s44, 0
    s_nop 0
    buffer_load_dwordx4 v224, s[8:11], s48 offen offset:0 lds
    buffer_load_dwordx4 v225, s[8:11], s48 offen offset:1024 lds
    buffer_load_dwordx4 v226, s[8:11], s48 offen offset:2048 lds
    buffer_load_dwordx4 v227, s[8:11], s48 offen offset:3072 lds
    s_add_u32 m0, s44, 4096
    s_add_u32 s48, s48, 32768
    buffer_load_dwordx4 v224, s[8:11], s48 offen offset:0 lds
    buffer_load_dwordx4 v225, s[8:11], s48 offen offset:1024 lds
    buffer_load_dwordx4 v226, s[8:11], s48 offen offset:2048 lds
    buffer_load_dwordx4 v227, s[8:11], s48 offen offset:3072 lds
    s_lshr_b32 s55, s2, 3
    s_lshl_b32 s48, s55, 16
    s_lshl_b32 s49, s40, 14
    s_add_u32 s48, s48, s49
    v_lshlrev_b32 v2, 7, v253
    v_bfe_u32 v2, v253, 3, 2
    v_lshlrev_b32 v2, 13, v2
    v_lshl_add_u32 v222, v41, 7, v2
    s_lshl_b32 s55, s55, 2
    s_add_u32 s55, s55, s40
    s_lshl_b32 s55, s55, 15
    s_and_b32 s48, s2, 7
    s_lshl_b32 s48, s48, 10
    s_add_u32 s68, s55, s48
    s_add_u32 s48, s53, 1
    s_and_b32 s48, s48, 7
    s_lshl_b32 s48, s48, 19
    s_add_u32 s48, s48, s45
    s_add_u32 m0, s46, 16384
    s_nop 0
    buffer_load_dwordx4 v228, s[12:15], s48 offen offset:0 lds
    buffer_load_dwordx4 v229, s[12:15], s48 offen offset:1024 lds
    buffer_load_dwordx4 v230, s[12:15], s48 offen offset:2048 lds
    buffer_load_dwordx4 v231, s[12:15], s48 offen offset:3072 lds
    s_add_u32 s48, s53, 1
    s_and_b32 s48, s48, 7
    s_lshl_b32 s48, s48, 7
    s_add_u32 s48, s48, s43
    s_add_u32 m0, s44, 8192
    s_nop 0
    buffer_load_dwordx4 v224, s[8:11], s48 offen offset:0 lds
    buffer_load_dwordx4 v225, s[8:11], s48 offen offset:1024 lds
    buffer_load_dwordx4 v226, s[8:11], s48 offen offset:2048 lds
    buffer_load_dwordx4 v227, s[8:11], s48 offen offset:3072 lds
    s_add_u32 m0, s44, 12288
    s_add_u32 s48, s48, 32768
    buffer_load_dwordx4 v224, s[8:11], s48 offen offset:0 lds
    buffer_load_dwordx4 v225, s[8:11], s48 offen offset:1024 lds
    buffer_load_dwordx4 v226, s[8:11], s48 offen offset:2048 lds
    buffer_load_dwordx4 v227, s[8:11], s48 offen offset:3072 lds
    s_mov_b32 s52, s2
    s_mul_i32 s51, s52, 1366
    s_lshr_b32 s51, s51, 16
    s_mul_i32 s48, s51, 48
    s_sub_u32 s52, s52, s48
    s_lshl_b32 s52, s52, 2
    s_add_u32 s52, s52, s40
    v_lshrrev_b32 v2, 1, v253
    v_and_b32 v3, 1, v253
    v_mul_u32_u24 v4, 6144, v2
    v_lshl_add_u32 v184, v3, 4, v4
    s_mul_i32 s55, s51, 786432
    s_lshl_b32 s49, s52, 5
    s_add_u32 s55, s55, s49
    v_lshlrev_b32 v185, 1, v2
    s_lshl_b32 s49, s51, 8
    s_lshl_b32 s69, s2, 13
    s_lshl_b32 s48, s40, 11
    s_add_u32 s69, s69, s48
    v_lshlrev_b32 v186, 4, v253
    buffer_load_dwordx4 v[128:131], v184, s[28:31], s55 offen
    s_add_u32 s55, s55, 196608
    buffer_load_dwordx4 v[132:135], v184, s[28:31], s55 offen
    s_add_u32 s55, s55, 196608
    buffer_load_dwordx4 v[136:139], v184, s[28:31], s55 offen
    s_add_u32 s55, s55, 196608
    buffer_load_dwordx4 v[140:143], v184, s[28:31], s55 offen
    buffer_load_ushort v144, v185, s[32:35], s49 offen offset:0
    buffer_load_ushort v145, v185, s[32:35], s49 offen offset:64
    buffer_load_ushort v146, v185, s[32:35], s49 offen offset:128
    buffer_load_ushort v147, v185, s[32:35], s49 offen offset:192
    s_lshl_b32 s48, s41, 5
    s_add_u32 s50, s50, s48
    s_lshl_b32 s50, s50, 15
    s_add_u32 s50, s50, 4194304
    s_add_u32 s56, s50, 0
    s_add_u32 s57, s50, 4096
    s_add_u32 s58, s50, 8192
    s_add_u32 s59, s50, 12288
    s_add_u32 s60, s50, 16384
    s_add_u32 s61, s50, 20480
    s_add_u32 s62, s50, 24576
    s_add_u32 s63, s50, 28672
    s_lshr_b32 s54, s40, 1
    s_add_u32 s54, s54, s53
    s_and_b32 s48, s40, 1
    s_lshl_b32 s48, s48, 18
    s_add_u32 s47, s47, s48
    v_lshrrev_b32 v47, 1, v46
    v_xor_b32 v47, v42, v47
    v_lshlrev_b32 v48, 7, v46
    v_lshl_add_u32 v48, v47, 4, v48
    v_add_u32 v232, s44, v48
    v_xor_b32 v233, 64, v232
    v_lshrrev_b32 v50, 2, v46
    v_and_b32 v51, 3, v253
    v_and_b32 v52, 1, v42
    v_lshl_add_u32 v53, v42, 3, v50
    v_lshl_add_u32 v54, v52, 2, v50
    v_lshlrev_b32 v55, 8, v53
    v_lshl_add_u32 v55, v54, 5, v55
    v_lshl_add_u32 v234, v51, 3, v55
    v_xor_b32 v235, 32, v234
    v_xor_b32 v236, 64, v234
    v_xor_b32 v237, 96, v234
    v_xor_b32 v238, 128, v234
    v_xor_b32 v239, 160, v234
    v_xor_b32 v240, 192, v234
    v_xor_b32 v241, 224, v234
    v_lshrrev_b32 v56, 1, v42
    v_lshlrev_b32 v57, 9, v52
    v_lshl_add_u32 v58, v56, 10, v57
    v_lshrrev_b32 v59, 3, v46
    v_lshl_add_u32 v58, v59, 8, v58
    v_and_b32 v59, 7, v46
    v_lshl_add_u32 v242, v59, 4, v58
    v_lshl_add_u32 v58, v56, 12, v57
    v_lshl_add_u32 v243, v46, 4, v58
    s_lshl_b32 s48, s40, 1
    v_xor_b32 v60, s48, v41
    v_lshlrev_b32 v60, 4, v60
    v_lshl_add_u32 v60, v253, 7, v60
    v_add_u32 v252, 147456, v60
    s_lshr_b32 s3, s52, 6
    s_lshr_b32 s48, s51, 2
    s_or_b32 s3, s3, s48
    s_lshl_b32 s3, s3, 12
    v_min_u32 v220, 1, v255
    v_lshlrev_b32 v220, 31, v220
    v_mov_b32 v221, 1
    s_lshr_b32 s64, s2, 1
    s_and_b32 s64, s64, 0x40
    s_xor_b32 s64, s64, s2
    s_lshl_b32 s64, s64, 2
    s_add_u32 s64, s64, s40
    s_lshr_b32 s100, s2, 3
    s_lshl_b32 s100, s100, 7
    s_add_u32 s100, s100, 524288
    s_lshl_b32 s101, 1, s42
    v_mov_b32 v218, 0
    s_lshr_b32 s65, s52, 2
    s_lshl_b32 s66, s51, 4
    s_add_u32 s65, s65, s66
    s_lshl_b32 s66, s40, 6
    s_add_u32 s65, s65, s66
    s_or_b32 s66, s65, s3
    s_lshl_b32 s65, s65, 8
    s_add_u32 s65, s65, 524288
    s_cmp_lt_u32 s66, 256
    s_cselect_b32 s65, s65, 0xf0000000
    v_mov_b32 v62, 0
    v_lshlrev_b32 v63, 2, v253
    buffer_store_dword v62, v63, s[20:23], s65 offen sc1
    s_bfe_u32 s65, s2, 0x20003
    s_lshl_b32 s65, s65, 3
    s_add_u32 s65, s65, 7
    s_sub_u32 s65, s65, s42
    s_lshl_b32 s65, s65, 2
    s_bfe_u32 s66, s2, 0x20001
    s_add_u32 s65, s65, s66
    s_lshl_b32 s67, s64, 6
    s_cmp_lt_u32 s64, 192
    s_cselect_b32 s67, s67, 0xf0000000
    v_writelane_b32 v218, s67, 0
    s_lshl_b32 s66, s40, 1
    s_and_b32 s66, s66, 2
    s_lshl_b32 s67, s2, 2
    s_and_b32 s67, s67, 4
    s_or_b32 s66, s66, s67
    s_lshl_b32 s66, s66, 7
    s_lshl_b32 s67, s65, 15
    s_add_u32 s67, s67, s66
    v_writelane_b32 v218, s67, 1
    s_add_u32 s66, s66, s65
    s_lshl_b32 s66, s66, 12
    s_and_b32 s67, s66, 4096
    s_lshr_b32 s67, s67, 1
    s_sub_u32 s66, s66, s67
    s_add_u32 s66, s66, 79691776
    v_writelane_b32 v218, s66, 2
    s_cmp_ge_u32 s64, 352
    s_cselect_b32 s88, s86, s88
    s_cselect_b32 s89, s87, s89
    s_cselect_b32 s65, 352, 0
    s_cselect_b32 s66, 1024, 0
    s_sub_u32 s64, s64, s65
    s_mul_i32 s65, s64, 2979
    s_lshr_b32 s65, s65, 16
    s_mul_i32 s67, s65, 22
    s_sub_u32 s64, s64, s67
    s_lshl_b32 s67, s64, 17
    s_add_u32 s66, s66, s67
    s_lshl_b32 s67, s65, 12
    s_add_u32 s66, s66, s67
    s_add_u32 s66, s66, 83886080
    s_cmp_ge_u32 s65, 16
    s_cselect_b32 s66, 0xf0000000, s66
    v_writelane_b32 v218, s66, 3
    s_mul_i32 s65, s65, 88064
    s_lshl_b32 s64, s64, 7
    s_add_u32 s65, s65, s64
    v_writelane_b32 v218, s65, 4
    s_lshr_b32 s65, s2, 1
    s_and_b32 s65, s65, 0x40
    s_xor_b32 s65, s65, s2
    s_mul_i32 s64, s65, 1490
    s_lshr_b32 s64, s64, 16
    v_writelane_b32 v218, s64, 5
    s_mul_i32 s66, s64, 44
    s_sub_u32 s65, s65, s66
    v_writelane_b32 v218, s65, 6
    s_cmp_ge_u32 s65, 22
    s_cselect_b32 s96, s86, s96
    s_cselect_b32 s97, s87, s97
    s_cselect_b32 s66, 22, 0
    s_sub_u32 s66, s65, s66
    s_lshl_b32 s66, s66, 7
    s_mul_i32 s67, s64, 352256
    s_add_u32 s66, s66, s67
    v_writelane_b32 v218, s66, 7
    s_lshl_b32 s67, s64, 9
    s_add_u32 s67, s67, 6144
    v_writelane_b32 v218, s67, 8
    s_lshl_b32 s64, s42, 1
    s_sub_u32 s64, 14, s64
    v_writelane_b32 v218, s64, 9
    s_add_u32 s65, s64, s40
    s_sub_u32 s66, 28, s64
    s_add_u32 s66, s66, s40
    s_add_u32 s67, s65, 1
    s_cmp_lt_u32 s40, 2
    s_cselect_b32 s65, s65, s66
    v_writelane_b32 v218, s65, 10
    s_cselect_b32 s67, s67, 17
    v_writelane_b32 v218, s67, 11
    s_lshl_b32 s84, s65, 16
    s_add_u32 s84, s84, 1048576
    s_lshl_b32 s85, s65, 7
    s_add_u32 s85, s85, 524288
    s_lshl_b32 s64, s41, 20
    s_add_u32 s64, s64, 4194304
    s_add_u32 s64, s64, s46
    v_writelane_b32 v218, s64, 12
    s_lshl_b32 s64, s2, 15
    s_add_u32 s64, s64, 54525952
    v_writelane_b32 v218, s64, 13
    s_lshl_b32 s64, s41, 12
    s_add_u32 s64, s64, 37748736
    v_writelane_b32 v218, s64, 14
    s_lshl_b32 s86, s41, 7
    s_add_u32 s86, s86, 528384
    s_mov_b32 s64, 0
    s_mov_b32 s65, 12288
    s_mov_b32 s66, 24576
    s_mov_b32 s67, 36864
    v_lshlrev_b32 v60, 2, v42
    v_xor_b32 v60, v46, v60
    v_lshlrev_b32 v61, 13, v42
    v_lshl_add_u32 v216, v60, 4, v61
    v_lshl_add_u32 v60, v56, 3, v50
    v_lshlrev_b32 v60, 8, v60
    v_lshl_add_u32 v60, v50, 6, v60
    v_bfe_u32 v61, v253, 1, 1
    v_lshl_add_u32 v60, v61, 5, v60
    v_lshl_add_u32 v60, v52, 4, v60
    v_and_b32 v61, 1, v253
    v_lshl_add_u32 v217, v61, 3, v60
    s_waitcnt vmcnt(21)
    s_barrier
    ds_read_b64_tr_b16 v[192:193], v234 offset:0
    ds_read_b64_tr_b16 v[194:195], v234 offset:1024
    ds_read_b128 a[0:3], v232 offset:0
    ds_read_b128 a[4:7], v232 offset:2048
    ds_read_b128 a[8:11], v232 offset:4096
    ds_read_b128 a[12:15], v232 offset:6144
    ds_read_b64_tr_b16 v[196:197], v234 offset:8192
    ds_read_b64_tr_b16 v[198:199], v234 offset:9216
    ds_read_b128 a[16:19], v233 offset:0
    ds_read_b128 a[20:23], v233 offset:2048
    ds_read_b128 a[24:27], v233 offset:4096
    ds_read_b128 a[28:31], v233 offset:6144
    ds_read_b64_tr_b16 v[200:201], v235 offset:0
    ds_read_b64_tr_b16 v[202:203], v235 offset:1024
    ds_read_b64_tr_b16 v[204:205], v235 offset:8192
    ds_read_b64_tr_b16 v[206:207], v235 offset:9216
    s_waitcnt lgkmcnt(13)
    v_mfma_f32_16x16x32_bf16 v[0:3], v[192:195], a[0:3], 0
    ds_read_b64_tr_b16 v[208:209], v236 offset:0
    s_add_u32 s48, s53, 2
    s_waitcnt lgkmcnt(8)
    v_mfma_f32_16x16x32_bf16 v[0:3], v[196:199], a[16:19], v[0:3]
    s_and_b32 s48, s48, 7
    s_lshl_b32 s48, s48, 19
    v_mfma_f32_16x16x32_bf16 v[4:7], v[192:195], a[4:7], 0
    ds_read_b64_tr_b16 v[210:211], v236 offset:1024
    s_add_u32 s48, s48, s45
    s_waitcnt vmcnt(4)
    v_lshlrev_b32 v144, 16, v144
    s_waitcnt lgkmcnt(8)
    v_mfma_f32_16x16x32_bf16 v[4:7], v[196:199], a[20:23], v[4:7]
    s_add_u32 m0, s46, 32768
    v_mul_f32 v148, 0xbfb8aa3b, v144
    v_mfma_f32_16x16x32_bf16 v[8:11], v[192:195], a[8:11], 0
    ds_read_b64_tr_b16 v[212:213], v236 offset:8192
    v_exp_f32 v148, v148
    s_waitcnt lgkmcnt(8)
    v_mfma_f32_16x16x32_bf16 v[8:11], v[196:199], a[24:27], v[8:11]
    buffer_load_dwordx4 v228, s[12:15], s48 offen offset:0 lds
    v_add_f32 v148, 1.0, v148
    v_mfma_f32_16x16x32_bf16 v[12:15], v[192:195], a[12:15], 0
    ds_read_b64_tr_b16 v[214:215], v236 offset:9216
    v_rcp_f32 v148, v148
    s_waitcnt lgkmcnt(8)
    v_mfma_f32_16x16x32_bf16 v[12:15], v[196:199], a[28:31], v[12:15]
    buffer_load_dwordx4 v229, s[12:15], s48 offen offset:1024 lds
    v_mul_f32 v144, v144, v148
    v_cvt_pk_bf16_f32 v144, v144, v144
    s_waitcnt lgkmcnt(6)
    v_mfma_f32_16x16x32_bf16 v[16:19], v[200:203], a[0:3], 0
    ds_read_b64_tr_b16 v[192:193], v237 offset:0
    v_and_b32 v144, 0xffff0000, v144
    s_waitcnt vmcnt(5)
    v_lshlrev_b32 v145, 16, v145
    s_waitcnt lgkmcnt(5)
    v_mfma_f32_16x16x32_bf16 v[16:19], v[204:207], a[16:19], v[16:19]
    buffer_load_dwordx4 v230, s[12:15], s48 offen offset:2048 lds
    v_mul_f32 v148, 0xbfb8aa3b, v145
    v_mfma_f32_16x16x32_bf16 v[20:23], v[200:203], a[4:7], 0
    ds_read_b64_tr_b16 v[194:195], v237 offset:1024
    v_exp_f32 v148, v148
    v_mfma_f32_16x16x32_bf16 v[20:23], v[204:207], a[20:23], v[20:23]
    buffer_load_dwordx4 v231, s[12:15], s48 offen offset:3072 lds
    s_add_u32 s48, s53, 2
    v_add_f32 v148, 1.0, v148
    v_mfma_f32_16x16x32_bf16 v[24:27], v[200:203], a[8:11], 0
    ds_read_b64_tr_b16 v[196:197], v237 offset:8192
    s_and_b32 s48, s48, 7
    v_mfma_f32_16x16x32_bf16 v[24:27], v[204:207], a[24:27], v[24:27]
    s_lshl_b32 s48, s48, 7
    s_add_u32 s48, s48, s43
    v_mfma_f32_16x16x32_bf16 v[28:31], v[200:203], a[12:15], 0
    ds_read_b64_tr_b16 v[198:199], v237 offset:9216
    s_add_u32 m0, s44, 16384
    v_mfma_f32_16x16x32_bf16 v[28:31], v[204:207], a[28:31], v[28:31]
    buffer_load_dwordx4 v224, s[8:11], s48 offen offset:0 lds
    v_rcp_f32 v148, v148
    s_waitcnt lgkmcnt(6)
    v_mfma_f32_16x16x32_bf16 v[32:35], v[208:211], a[0:3], 0
    ds_read_b64_tr_b16 v[200:201], v238 offset:0
    v_mul_f32 v145, v145, v148
    v_cvt_pk_bf16_f32 v145, v145, v145
    s_waitcnt lgkmcnt(5)
    v_mfma_f32_16x16x32_bf16 v[32:35], v[212:215], a[16:19], v[32:35]
    buffer_load_dwordx4 v225, s[8:11], s48 offen offset:1024 lds
    v_and_b32 v145, 0xffff0000, v145
    s_waitcnt vmcnt(8)
    v_lshlrev_b32 v146, 16, v146
    v_mfma_f32_16x16x32_bf16 v[36:39], v[208:211], a[4:7], 0
    ds_read_b64_tr_b16 v[202:203], v238 offset:1024
    v_mul_f32 v148, 0xbfb8aa3b, v146
    v_mfma_f32_16x16x32_bf16 v[36:39], v[212:215], a[20:23], v[36:39]
    buffer_load_dwordx4 v226, s[8:11], s48 offen offset:2048 lds
    v_exp_f32 v148, v148
    v_mfma_f32_16x16x32_bf16 v[40:43], v[208:211], a[8:11], 0
    ds_read_b64_tr_b16 v[204:205], v238 offset:8192
    v_add_f32 v148, 1.0, v148
    v_mfma_f32_16x16x32_bf16 v[40:43], v[212:215], a[24:27], v[40:43]
    buffer_load_dwordx4 v227, s[8:11], s48 offen offset:3072 lds
    s_add_u32 m0, s44, 20480
    v_mfma_f32_16x16x32_bf16 v[44:47], v[208:211], a[12:15], 0
    ds_read_b64_tr_b16 v[206:207], v238 offset:9216
    s_add_u32 s48, s48, 32768
    v_mfma_f32_16x16x32_bf16 v[44:47], v[212:215], a[28:31], v[44:47]
    buffer_load_dwordx4 v224, s[8:11], s48 offen offset:0 lds
    v_rcp_f32 v148, v148
    s_waitcnt lgkmcnt(6)
    v_mfma_f32_16x16x32_bf16 v[48:51], v[192:195], a[0:3], 0
    ds_read_b64_tr_b16 v[208:209], v239 offset:0
    v_mul_f32 v146, v146, v148
    v_cvt_pk_bf16_f32 v146, v146, v146
    s_waitcnt lgkmcnt(5)
    v_mfma_f32_16x16x32_bf16 v[48:51], v[196:199], a[16:19], v[48:51]
    buffer_load_dwordx4 v225, s[8:11], s48 offen offset:1024 lds
    v_and_b32 v146, 0xffff0000, v146
    s_waitcnt vmcnt(11)
    v_lshlrev_b32 v147, 16, v147
    v_mfma_f32_16x16x32_bf16 v[52:55], v[192:195], a[4:7], 0
    ds_read_b64_tr_b16 v[210:211], v239 offset:1024
    v_mul_f32 v148, 0xbfb8aa3b, v147
    v_mfma_f32_16x16x32_bf16 v[52:55], v[196:199], a[20:23], v[52:55]
    buffer_load_dwordx4 v226, s[8:11], s48 offen offset:2048 lds
    v_exp_f32 v148, v148
    v_mfma_f32_16x16x32_bf16 v[56:59], v[192:195], a[8:11], 0
    ds_read_b64_tr_b16 v[212:213], v239 offset:8192
    v_add_f32 v148, 1.0, v148
    v_mfma_f32_16x16x32_bf16 v[56:59], v[196:199], a[24:27], v[56:59]
    buffer_load_dwordx4 v227, s[8:11], s48 offen offset:3072 lds
    s_add_u32 s48, s53, 3
    v_mfma_f32_16x16x32_bf16 v[60:63], v[192:195], a[12:15], 0
    ds_read_b64_tr_b16 v[214:215], v239 offset:9216
    s_and_b32 s48, s48, 7
    v_mfma_f32_16x16x32_bf16 v[60:63], v[196:199], a[28:31], v[60:63]
    s_lshl_b32 s48, s48, 7
    s_add_u32 s48, s48, s43
    s_waitcnt lgkmcnt(6)
    v_mfma_f32_16x16x32_bf16 v[64:67], v[200:203], a[0:3], 0
    ds_read_b64_tr_b16 v[192:193], v240 offset:0
    s_add_u32 m0, s44, 0
    s_waitcnt lgkmcnt(5)
    v_mfma_f32_16x16x32_bf16 v[64:67], v[204:207], a[16:19], v[64:67]
    buffer_load_dwordx4 v224, s[8:11], s48 offen offset:0 lds
    v_rcp_f32 v148, v148
    v_mfma_f32_16x16x32_bf16 v[68:71], v[200:203], a[4:7], 0
    ds_read_b64_tr_b16 v[194:195], v240 offset:1024
    v_mul_f32 v147, v147, v148
    v_cvt_pk_bf16_f32 v147, v147, v147
    v_mfma_f32_16x16x32_bf16 v[68:71], v[204:207], a[20:23], v[68:71]
    buffer_load_dwordx4 v225, s[8:11], s48 offen offset:1024 lds
    v_and_b32 v147, 0xffff0000, v147
    v_lshlrev_b32 v148, 16, v128
    v_mfma_f32_16x16x32_bf16 v[72:75], v[200:203], a[8:11], 0
    ds_read_b64_tr_b16 v[196:197], v240 offset:8192
    v_and_b32 v149, 0xffff0000, v128
    v_mul_f32 v152, v148, v144
    v_mfma_f32_16x16x32_bf16 v[72:75], v[204:207], a[24:27], v[72:75]
    buffer_load_dwordx4 v226, s[8:11], s48 offen offset:2048 lds
    v_mul_f32 v153, v149, v144
    v_lshlrev_b32 v148, 16, v129
    v_mfma_f32_16x16x32_bf16 v[76:79], v[200:203], a[12:15], 0
    ds_read_b64_tr_b16 v[198:199], v240 offset:9216
    v_and_b32 v149, 0xffff0000, v129
    v_mul_f32 v154, v148, v144
    v_mfma_f32_16x16x32_bf16 v[76:79], v[204:207], a[28:31], v[76:79]
    buffer_load_dwordx4 v227, s[8:11], s48 offen offset:3072 lds
    s_add_u32 m0, s44, 4096
    v_mul_f32 v155, v149, v144
    s_barrier
    s_waitcnt lgkmcnt(6)
    v_mfma_f32_16x16x32_bf16 v[80:83], v[208:211], a[0:3], 0
    ds_read_b64_tr_b16 v[200:201], v241 offset:0
    s_add_u32 s48, s48, 32768
    v_lshlrev_b32 v148, 16, v130
    s_waitcnt lgkmcnt(5)
    v_mfma_f32_16x16x32_bf16 v[80:83], v[212:215], a[16:19], v[80:83]
    ds_read_b128 a[32:35], v232 offset:8192
    v_and_b32 v149, 0xffff0000, v130
    v_mul_f32 v156, v148, v144
    v_mfma_f32_16x16x32_bf16 v[84:87], v[208:211], a[4:7], 0
    ds_read_b64_tr_b16 v[202:203], v241 offset:1024
    v_mul_f32 v157, v149, v144
    v_lshlrev_b32 v148, 16, v131
    v_mfma_f32_16x16x32_bf16 v[84:87], v[212:215], a[20:23], v[84:87]
    ds_read_b128 a[48:51], v233 offset:8192
    v_and_b32 v149, 0xffff0000, v131
    v_mul_f32 v158, v148, v144
    v_mfma_f32_16x16x32_bf16 v[88:91], v[208:211], a[8:11], 0
    ds_read_b64_tr_b16 v[204:205], v241 offset:8192
    v_mul_f32 v159, v149, v144
    v_lshlrev_b32 v148, 16, v132
    v_mfma_f32_16x16x32_bf16 v[88:91], v[212:215], a[24:27], v[88:91]
    ds_read_b128 a[36:39], v232 offset:10240
    v_and_b32 v149, 0xffff0000, v132
    v_fmac_f32 v152, v148, v145
    v_mfma_f32_16x16x32_bf16 v[92:95], v[208:211], a[12:15], 0
    ds_read_b64_tr_b16 v[206:207], v241 offset:9216
    v_fmac_f32 v153, v149, v145
    v_lshlrev_b32 v148, 16, v133
    v_mfma_f32_16x16x32_bf16 v[92:95], v[212:215], a[28:31], v[92:95]
    ds_read_b128 a[52:55], v233 offset:10240
    v_and_b32 v149, 0xffff0000, v133
    v_fmac_f32 v154, v148, v145
    s_waitcnt lgkmcnt(10)
    v_mfma_f32_16x16x32_bf16 v[96:99], v[192:195], a[0:3], 0
    ds_read_b64_tr_b16 v[208:209], v234 offset:16384
    v_fmac_f32 v155, v149, v145
    v_lshlrev_b32 v148, 16, v134
    s_waitcnt lgkmcnt(9)
    v_mfma_f32_16x16x32_bf16 v[96:99], v[196:199], a[16:19], v[96:99]
    ds_read_b128 a[40:43], v232 offset:12288
    v_and_b32 v149, 0xffff0000, v134
    v_fmac_f32 v156, v148, v145
    v_mfma_f32_16x16x32_bf16 v[100:103], v[192:195], a[4:7], 0
    ds_read_b64_tr_b16 v[210:211], v234 offset:17408
    v_fmac_f32 v157, v149, v145
    v_lshlrev_b32 v148, 16, v135
    v_mfma_f32_16x16x32_bf16 v[100:103], v[196:199], a[20:23], v[100:103]
    ds_read_b128 a[56:59], v233 offset:12288
    v_and_b32 v149, 0xffff0000, v135
    v_fmac_f32 v158, v148, v145
    v_mfma_f32_16x16x32_bf16 v[104:107], v[192:195], a[8:11], 0
    ds_read_b64_tr_b16 v[212:213], v234 offset:24576
    v_fmac_f32 v159, v149, v145
    v_lshlrev_b32 v148, 16, v136
    v_mfma_f32_16x16x32_bf16 v[104:107], v[196:199], a[24:27], v[104:107]
    ds_read_b128 a[44:47], v232 offset:14336
    v_and_b32 v149, 0xffff0000, v136
    v_fmac_f32 v152, v148, v146
    v_mfma_f32_16x16x32_bf16 v[108:111], v[192:195], a[12:15], 0
    ds_read_b64_tr_b16 v[214:215], v234 offset:25600
    v_fmac_f32 v153, v149, v146
    v_lshlrev_b32 v148, 16, v137
    v_mfma_f32_16x16x32_bf16 v[108:111], v[196:199], a[28:31], v[108:111]
    ds_read_b128 a[60:63], v233 offset:14336
    v_and_b32 v149, 0xffff0000, v137
    v_fmac_f32 v154, v148, v146
    s_waitcnt lgkmcnt(13)
    v_mfma_f32_16x16x32_bf16 v[112:115], v[200:203], a[0:3], 0
    ds_read_b64_tr_b16 v[192:193], v235 offset:16384
    v_fmac_f32 v155, v149, v146
    v_lshlrev_b32 v148, 16, v138
    s_waitcnt lgkmcnt(10)
    v_mfma_f32_16x16x32_bf16 v[112:115], v[204:207], a[16:19], v[112:115]
    buffer_load_dwordx4 v224, s[8:11], s48 offen offset:0 lds
    v_and_b32 v149, 0xffff0000, v138
    v_fmac_f32 v156, v148, v146
    v_mfma_f32_16x16x32_bf16 v[116:119], v[200:203], a[4:7], 0
    ds_read_b64_tr_b16 v[194:195], v235 offset:17408
    v_fmac_f32 v157, v149, v146
    v_lshlrev_b32 v148, 16, v139
    v_mfma_f32_16x16x32_bf16 v[116:119], v[204:207], a[20:23], v[116:119]
    buffer_load_dwordx4 v225, s[8:11], s48 offen offset:1024 lds
    v_and_b32 v149, 0xffff0000, v139
    v_fmac_f32 v158, v148, v146
    v_mfma_f32_16x16x32_bf16 v[120:123], v[200:203], a[8:11], 0
    ds_read_b64_tr_b16 v[196:197], v235 offset:24576
    v_fmac_f32 v159, v149, v146
    v_lshlrev_b32 v148, 16, v140
    v_mfma_f32_16x16x32_bf16 v[120:123], v[204:207], a[24:27], v[120:123]
    buffer_load_dwordx4 v226, s[8:11], s48 offen offset:2048 lds
    v_and_b32 v149, 0xffff0000, v140
    v_fmac_f32 v152, v148, v147
    v_mfma_f32_16x16x32_bf16 v[124:127], v[200:203], a[12:15], 0
    ds_read_b64_tr_b16 v[198:199], v235 offset:25600
    v_fmac_f32 v153, v149, v147
    v_lshlrev_b32 v148, 16, v141
    v_mfma_f32_16x16x32_bf16 v[124:127], v[204:207], a[28:31], v[124:127]
    buffer_load_dwordx4 v227, s[8:11], s48 offen offset:3072 lds
    v_and_b32 v149, 0xffff0000, v141
    v_fmac_f32 v154, v148, v147
    s_waitcnt lgkmcnt(9)
    v_mfma_f32_16x16x32_bf16 v[0:3], v[208:211], a[32:35], v[0:3]
    ds_read_b64_tr_b16 v[200:201], v236 offset:16384
    v_fmac_f32 v155, v149, v147
    v_lshlrev_b32 v148, 16, v142
    s_waitcnt lgkmcnt(6)
    v_mfma_f32_16x16x32_bf16 v[0:3], v[212:215], a[48:51], v[0:3]
    buffer_load_dwordx4 v[244:247], v186, s[24:27], s69 offen
    v_and_b32 v149, 0xffff0000, v142
    v_fmac_f32 v156, v148, v147
    v_mfma_f32_16x16x32_bf16 v[4:7], v[208:211], a[36:39], v[4:7]
    ds_read_b64_tr_b16 v[202:203], v236 offset:17408
    v_fmac_f32 v157, v149, v147
    v_lshlrev_b32 v148, 16, v143
    v_mfma_f32_16x16x32_bf16 v[4:7], v[212:215], a[52:55], v[4:7]
    buffer_load_dwordx4 v[248:251], v186, s[24:27], s69 offen offset:1024
    s_add_u32 s48, s53, 3
    v_and_b32 v149, 0xffff0000, v143
    v_mfma_f32_16x16x32_bf16 v[8:11], v[208:211], a[40:43], v[8:11]
    ds_read_b64_tr_b16 v[204:205], v236 offset:24576
    s_and_b32 s48, s48, 7
    v_fmac_f32 v158, v148, v147
    v_mfma_f32_16x16x32_bf16 v[8:11], v[212:215], a[56:59], v[8:11]
    s_lshl_b32 s48, s48, 19
    s_add_u32 s48, s48, s45
    v_fmac_f32 v159, v149, v147
    v_mfma_f32_16x16x32_bf16 v[12:15], v[208:211], a[44:47], v[12:15]
    ds_read_b64_tr_b16 v[206:207], v236 offset:25600
    s_add_u32 m0, s46, 49152
    v_and_b32 v148, 1, v253
    s_waitcnt lgkmcnt(8)
    v_mfma_f32_16x16x32_bf16 v[12:15], v[212:215], a[60:63], v[12:15]
    buffer_load_dwordx4 v228, s[12:15], s48 offen offset:0 lds
    v_lshlrev_b32 v148, 5, v148
    v_permlane32_swap_b32 v152, v156
    s_waitcnt lgkmcnt(6)
    v_mfma_f32_16x16x32_bf16 v[16:19], v[192:195], a[32:35], v[16:19]
    ds_read_b64_tr_b16 v[208:209], v237 offset:16384
    v_permlane32_swap_b32 v153, v157
    v_permlane32_swap_b32 v154, v158
    s_waitcnt lgkmcnt(5)
    v_mfma_f32_16x16x32_bf16 v[16:19], v[196:199], a[48:51], v[16:19]
    v_permlane32_swap_b32 v155, v159
    v_add_f32 v152, v152, v156
    v_add_f32 v153, v153, v157
    v_mfma_f32_16x16x32_bf16 v[20:23], v[192:195], a[36:39], v[20:23]
    ds_read_b64_tr_b16 v[210:211], v237 offset:17408
    v_add_f32 v154, v154, v158
    v_add_f32 v155, v155, v159
    v_mfma_f32_16x16x32_bf16 v[20:23], v[196:199], a[52:55], v[20:23]
    buffer_load_dwordx4 v229, s[12:15], s48 offen offset:1024 lds
    v_lshrrev_b32 v149, 4, v253
    v_lshl_add_u32 v148, v149, 3, v148
    v_mfma_f32_16x16x32_bf16 v[24:27], v[192:195], a[40:43], v[24:27]
    ds_read_b64_tr_b16 v[212:213], v237 offset:24576
    v_permlane16_swap_b32 v152, v154
    v_permlane16_swap_b32 v153, v155
    v_mfma_f32_16x16x32_bf16 v[24:27], v[196:199], a[56:59], v[24:27]
    v_add_f32 v152, v152, v154
    v_add_f32 v153, v153, v155
    s_mul_i32 s55, s51, 12288
    v_mfma_f32_16x16x32_bf16 v[28:31], v[192:195], a[44:47], v[28:31]
    ds_read_b64_tr_b16 v[214:215], v237 offset:25600
    s_lshl_b32 s49, s52, 6
    v_add_f32_dpp v152, v152, v152 row_ror:8 row_mask:0xf bank_mask:0xf
    v_mfma_f32_16x16x32_bf16 v[28:31], v[196:199], a[60:63], v[28:31]
    buffer_load_dwordx4 v230, s[12:15], s48 offen offset:2048 lds
    v_add_f32_dpp v153, v153, v153 row_ror:8 row_mask:0xf bank_mask:0xf
    s_add_u32 s55, s55, s49
    s_waitcnt lgkmcnt(6)
    v_mfma_f32_16x16x32_bf16 v[32:35], v[200:203], a[32:35], v[32:35]
    ds_read_b64_tr_b16 v[192:193], v238 offset:16384
    v_add_f32_dpp v152, v152, v152 row_ror:4 row_mask:0xf bank_mask:0xf
    v_add_f32_dpp v153, v153, v153 row_ror:4 row_mask:0xf bank_mask:0xf
    s_waitcnt lgkmcnt(5)
    v_mfma_f32_16x16x32_bf16 v[32:35], v[204:207], a[48:51], v[32:35]
    v_and_b32 v149, 14, v253
    v_add_f32_dpp v152, v152, v152 row_ror:2 row_mask:0xf bank_mask:0xf
    v_add_f32_dpp v153, v153, v153 row_ror:2 row_mask:0xf bank_mask:0xf
    v_mfma_f32_16x16x32_bf16 v[36:39], v[200:203], a[36:39], v[36:39]
    ds_read_b64_tr_b16 v[194:195], v238 offset:17408
    v_lshl_or_b32 v148, v149, 27, v148
    v_mfma_f32_16x16x32_bf16 v[36:39], v[204:207], a[52:55], v[36:39]
    buffer_load_dwordx4 v231, s[12:15], s48 offen offset:3072 lds
    s_add_u32 s48, s53, 4
    v_mfma_f32_16x16x32_bf16 v[40:43], v[200:203], a[40:43], v[40:43]
    ds_read_b64_tr_b16 v[196:197], v238 offset:24576
    s_and_b32 s48, s48, 7
    v_mfma_f32_16x16x32_bf16 v[40:43], v[204:207], a[56:59], v[40:43]
    buffer_store_dwordx2 v[152:153], v148, s[20:23], s55 offen offset:0 sc1
    s_lshl_b32 s48, s48, 7
    s_add_u32 s48, s48, s43
    v_mfma_f32_16x16x32_bf16 v[44:47], v[200:203], a[44:47], v[44:47]
    ds_read_b64_tr_b16 v[198:199], v238 offset:25600
    s_add_u32 m0, s44, 8192
    v_mfma_f32_16x16x32_bf16 v[44:47], v[204:207], a[60:63], v[44:47]
    buffer_load_dwordx4 v224, s[8:11], s48 offen offset:0 lds
    s_lshl_b32 s55, s40, 10
    s_waitcnt lgkmcnt(6)
    v_mfma_f32_16x16x32_bf16 v[48:51], v[208:211], a[32:35], v[48:51]
    ds_read_b64_tr_b16 v[200:201], v239 offset:16384
    v_lshl_add_u32 v219, v253, 4, s55
    s_waitcnt lgkmcnt(5)
    v_mfma_f32_16x16x32_bf16 v[48:51], v[212:215], a[48:51], v[48:51]
    buffer_load_dwordx4 v225, s[8:11], s48 offen offset:1024 lds
    v_mfma_f32_16x16x32_bf16 v[52:55], v[208:211], a[36:39], v[52:55]
    ds_read_b64_tr_b16 v[202:203], v239 offset:17408
    s_cmp_ge_u32 s40, 2
    s_cselect_b32 s42, 1.0, 0
    s_cselect_b32 s50, 1.0, 0x3e0293ee
    v_mfma_f32_16x16x32_bf16 v[52:55], v[212:215], a[52:55], v[52:55]
    buffer_load_dwordx4 v226, s[8:11], s48 offen offset:2048 lds
    v_mfma_f32_16x16x32_bf16 v[56:59], v[208:211], a[40:43], v[56:59]
    ds_read_b64_tr_b16 v[204:205], v239 offset:24576
    v_mfma_f32_16x16x32_bf16 v[56:59], v[212:215], a[56:59], v[56:59]
    buffer_load_dwordx4 v227, s[8:11], s48 offen offset:3072 lds
    s_add_u32 m0, s44, 12288
    v_mfma_f32_16x16x32_bf16 v[60:63], v[208:211], a[44:47], v[60:63]
    ds_read_b64_tr_b16 v[206:207], v239 offset:25600
    s_add_u32 s48, s48, 32768
    v_mfma_f32_16x16x32_bf16 v[60:63], v[212:215], a[60:63], v[60:63]
    buffer_load_dwordx4 v224, s[8:11], s48 offen offset:0 lds
    s_waitcnt lgkmcnt(6)
    v_mfma_f32_16x16x32_bf16 v[64:67], v[192:195], a[32:35], v[64:67]
    ds_read_b64_tr_b16 v[208:209], v240 offset:16384
    s_waitcnt lgkmcnt(5)
    v_mfma_f32_16x16x32_bf16 v[64:67], v[196:199], a[48:51], v[64:67]
    buffer_load_dwordx4 v225, s[8:11], s48 offen offset:1024 lds
    v_mfma_f32_16x16x32_bf16 v[68:71], v[192:195], a[36:39], v[68:71]
    ds_read_b64_tr_b16 v[210:211], v240 offset:17408
    v_mfma_f32_16x16x32_bf16 v[68:71], v[196:199], a[52:55], v[68:71]
    buffer_load_dwordx4 v226, s[8:11], s48 offen offset:2048 lds
    v_mfma_f32_16x16x32_bf16 v[72:75], v[192:195], a[40:43], v[72:75]
    ds_read_b64_tr_b16 v[212:213], v240 offset:24576
    v_mfma_f32_16x16x32_bf16 v[72:75], v[196:199], a[56:59], v[72:75]
    buffer_load_dwordx4 v227, s[8:11], s48 offen offset:3072 lds
    v_mfma_f32_16x16x32_bf16 v[76:79], v[192:195], a[44:47], v[76:79]
    ds_read_b64_tr_b16 v[214:215], v240 offset:25600
    v_mfma_f32_16x16x32_bf16 v[76:79], v[196:199], a[60:63], v[76:79]
    buffer_load_dword v223, v222, s[16:19], s68 offen
    s_waitcnt vmcnt(9)
    s_barrier
    s_waitcnt lgkmcnt(6)
    v_mfma_f32_16x16x32_bf16 v[80:83], v[200:203], a[32:35], v[80:83]
    ds_read_b64_tr_b16 v[192:193], v241 offset:16384
    s_add_u32 s48, s53, 4
    s_waitcnt lgkmcnt(5)
    v_mfma_f32_16x16x32_bf16 v[80:83], v[204:207], a[48:51], v[80:83]
    ds_read_b128 a[64:67], v232 offset:16384
    buffer_atomic_add v221, v220, s[36:39], s3 offen sc1
    s_and_b32 s48, s48, 7
    v_mfma_f32_16x16x32_bf16 v[84:87], v[200:203], a[36:39], v[84:87]
    ds_read_b64_tr_b16 v[194:195], v241 offset:17408
    s_lshl_b32 s48, s48, 19
    v_mfma_f32_16x16x32_bf16 v[84:87], v[204:207], a[52:55], v[84:87]
    ds_read_b128 a[80:83], v233 offset:16384
    s_add_u32 s48, s48, s45
    v_mfma_f32_16x16x32_bf16 v[88:91], v[200:203], a[40:43], v[88:91]
    ds_read_b64_tr_b16 v[196:197], v241 offset:24576
    s_add_u32 m0, s46, 0
    v_mfma_f32_16x16x32_bf16 v[88:91], v[204:207], a[56:59], v[88:91]
    ds_read_b128 a[68:71], v232 offset:18432
    v_mfma_f32_16x16x32_bf16 v[92:95], v[200:203], a[44:47], v[92:95]
    ds_read_b64_tr_b16 v[198:199], v241 offset:25600
    v_mfma_f32_16x16x32_bf16 v[92:95], v[204:207], a[60:63], v[92:95]
    ds_read_b128 a[84:87], v233 offset:18432
    s_waitcnt lgkmcnt(10)
    v_mfma_f32_16x16x32_bf16 v[96:99], v[208:211], a[32:35], v[96:99]
    ds_read_b64_tr_b16 v[200:201], v234 offset:32768
    s_waitcnt lgkmcnt(9)
    v_mfma_f32_16x16x32_bf16 v[96:99], v[212:215], a[48:51], v[96:99]
    ds_read_b128 a[72:75], v232 offset:20480
    v_mfma_f32_16x16x32_bf16 v[100:103], v[208:211], a[36:39], v[100:103]
    ds_read_b64_tr_b16 v[202:203], v234 offset:33792
    v_mfma_f32_16x16x32_bf16 v[100:103], v[212:215], a[52:55], v[100:103]
    ds_read_b128 a[88:91], v233 offset:20480
    v_mfma_f32_16x16x32_bf16 v[104:107], v[208:211], a[40:43], v[104:107]
    ds_read_b64_tr_b16 v[204:205], v234 offset:40960
    v_mfma_f32_16x16x32_bf16 v[104:107], v[212:215], a[56:59], v[104:107]
    ds_read_b128 a[76:79], v232 offset:22528
    v_mfma_f32_16x16x32_bf16 v[108:111], v[208:211], a[44:47], v[108:111]
    ds_read_b64_tr_b16 v[206:207], v234 offset:41984
    v_mfma_f32_16x16x32_bf16 v[108:111], v[212:215], a[60:63], v[108:111]
    ds_read_b128 a[92:95], v233 offset:22528
    s_waitcnt lgkmcnt(13)
    v_mfma_f32_16x16x32_bf16 v[112:115], v[192:195], a[32:35], v[112:115]
    ds_read_b64_tr_b16 v[208:209], v235 offset:32768
    s_waitcnt lgkmcnt(10)
    v_mfma_f32_16x16x32_bf16 v[112:115], v[196:199], a[48:51], v[112:115]
    buffer_load_dwordx4 v228, s[12:15], s48 offen offset:0 lds
    v_mfma_f32_16x16x32_bf16 v[116:119], v[192:195], a[36:39], v[116:119]
    ds_read_b64_tr_b16 v[210:211], v235 offset:33792
    v_mfma_f32_16x16x32_bf16 v[116:119], v[196:199], a[52:55], v[116:119]
    v_mfma_f32_16x16x32_bf16 v[120:123], v[192:195], a[40:43], v[120:123]
    ds_read_b64_tr_b16 v[212:213], v235 offset:40960
    v_mfma_f32_16x16x32_bf16 v[120:123], v[196:199], a[56:59], v[120:123]
    buffer_load_dwordx4 v229, s[12:15], s48 offen offset:1024 lds
    v_mfma_f32_16x16x32_bf16 v[124:127], v[192:195], a[44:47], v[124:127]
    ds_read_b64_tr_b16 v[214:215], v235 offset:41984
    v_mfma_f32_16x16x32_bf16 v[124:127], v[196:199], a[60:63], v[124:127]
    v_lshlrev_b32 v160, 16, v244
    v_and_b32 v161, 0xffff0000, v244
    s_waitcnt lgkmcnt(9)
    v_mfma_f32_16x16x32_bf16 v[0:3], v[200:203], a[64:67], v[0:3]
    ds_read_b64_tr_b16 v[192:193], v236 offset:32768
    v_lshlrev_b32 v162, 16, v245
    s_waitcnt lgkmcnt(6)
    v_mfma_f32_16x16x32_bf16 v[0:3], v[204:207], a[80:83], v[0:3]
    buffer_load_dwordx4 v230, s[12:15], s48 offen offset:2048 lds
    v_and_b32 v163, 0xffff0000, v245
    v_mfma_f32_16x16x32_bf16 v[4:7], v[200:203], a[68:71], v[4:7]
    ds_read_b64_tr_b16 v[194:195], v236 offset:33792
    v_lshlrev_b32 v164, 16, v246
    v_mfma_f32_16x16x32_bf16 v[4:7], v[204:207], a[84:87], v[4:7]
    v_and_b32 v165, 0xffff0000, v246
    v_lshlrev_b32 v166, 16, v247
    v_mfma_f32_16x16x32_bf16 v[8:11], v[200:203], a[72:75], v[8:11]
    ds_read_b64_tr_b16 v[196:197], v236 offset:40960
    v_and_b32 v167, 0xffff0000, v247
    v_mfma_f32_16x16x32_bf16 v[8:11], v[204:207], a[88:91], v[8:11]
    buffer_load_dwordx4 v231, s[12:15], s48 offen offset:3072 lds
    s_waitcnt lgkmcnt(7)
    s_add_u32 s48, s53, 5
    v_mfma_f32_16x16x32_bf16 v[12:15], v[200:203], a[76:79], v[12:15]
    ds_read_b64_tr_b16 v[198:199], v236 offset:41984
    s_and_b32 s48, s48, 7
    v_mfma_f32_16x16x32_bf16 v[12:15], v[204:207], a[92:95], v[12:15]
    s_lshl_b32 s48, s48, 7
    s_add_u32 s48, s48, s43
    s_waitcnt lgkmcnt(6)
    v_mfma_f32_16x16x32_bf16 v[16:19], v[208:211], a[64:67], v[16:19]
    ds_read_b64_tr_b16 v[200:201], v237 offset:32768
    s_add_u32 m0, s44, 16384
    s_waitcnt lgkmcnt(5)
    v_mfma_f32_16x16x32_bf16 v[16:19], v[212:215], a[80:83], v[16:19]
    buffer_load_dwordx4 v224, s[8:11], s48 offen offset:0 lds
    v_add_f32 v176, v160, v161
    v_mfma_f32_16x16x32_bf16 v[20:23], v[208:211], a[68:71], v[20:23]
    ds_read_b64_tr_b16 v[202:203], v237 offset:33792
    v_add_f32 v176, v176, v162
    v_mfma_f32_16x16x32_bf16 v[20:23], v[212:215], a[84:87], v[20:23]
    v_add_f32 v176, v176, v163
    v_add_f32 v176, v176, v164
    v_mfma_f32_16x16x32_bf16 v[24:27], v[208:211], a[72:75], v[24:27]
    ds_read_b64_tr_b16 v[204:205], v237 offset:40960
    v_add_f32 v176, v176, v165
    v_mfma_f32_16x16x32_bf16 v[24:27], v[212:215], a[88:91], v[24:27]
    buffer_load_dwordx4 v225, s[8:11], s48 offen offset:1024 lds
    v_add_f32 v176, v176, v166
    v_mfma_f32_16x16x32_bf16 v[28:31], v[208:211], a[76:79], v[28:31]
    ds_read_b64_tr_b16 v[206:207], v237 offset:41984
    v_add_f32 v176, v176, v167
    v_mfma_f32_16x16x32_bf16 v[28:31], v[212:215], a[92:95], v[28:31]
    v_lshlrev_b32 v168, 16, v248
    v_and_b32 v169, 0xffff0000, v248
    s_waitcnt lgkmcnt(6)
    v_mfma_f32_16x16x32_bf16 v[32:35], v[192:195], a[64:67], v[32:35]
    ds_read_b64_tr_b16 v[208:209], v238 offset:32768
    v_lshlrev_b32 v170, 16, v249
    s_waitcnt lgkmcnt(5)
    v_mfma_f32_16x16x32_bf16 v[32:35], v[196:199], a[80:83], v[32:35]
    buffer_load_dwordx4 v226, s[8:11], s48 offen offset:2048 lds
    v_and_b32 v171, 0xffff0000, v249
    v_mfma_f32_16x16x32_bf16 v[36:39], v[192:195], a[68:71], v[36:39]
    ds_read_b64_tr_b16 v[210:211], v238 offset:33792
    v_lshlrev_b32 v172, 16, v250
    v_mfma_f32_16x16x32_bf16 v[36:39], v[196:199], a[84:87], v[36:39]
    v_and_b32 v173, 0xffff0000, v250
    v_lshlrev_b32 v174, 16, v251
    v_mfma_f32_16x16x32_bf16 v[40:43], v[192:195], a[72:75], v[40:43]
    ds_read_b64_tr_b16 v[212:213], v238 offset:40960
    v_and_b32 v175, 0xffff0000, v251
    v_mfma_f32_16x16x32_bf16 v[40:43], v[196:199], a[88:91], v[40:43]
    buffer_load_dwordx4 v227, s[8:11], s48 offen offset:3072 lds
    s_add_u32 m0, s44, 20480
    v_mfma_f32_16x16x32_bf16 v[44:47], v[192:195], a[76:79], v[44:47]
    ds_read_b64_tr_b16 v[214:215], v238 offset:41984
    s_add_u32 s48, s48, 32768
    v_mfma_f32_16x16x32_bf16 v[44:47], v[196:199], a[92:95], v[44:47]
    v_add_f32 v177, v168, v169
    v_add_f32 v177, v177, v170
    s_waitcnt lgkmcnt(6)
    v_mfma_f32_16x16x32_bf16 v[48:51], v[200:203], a[64:67], v[48:51]
    ds_read_b64_tr_b16 v[192:193], v239 offset:32768
    v_add_f32 v177, v177, v171
    s_waitcnt lgkmcnt(5)
    v_mfma_f32_16x16x32_bf16 v[48:51], v[204:207], a[80:83], v[48:51]
    buffer_load_dwordx4 v224, s[8:11], s48 offen offset:0 lds
    v_add_f32 v177, v177, v172
    v_mfma_f32_16x16x32_bf16 v[52:55], v[200:203], a[68:71], v[52:55]
    ds_read_b64_tr_b16 v[194:195], v239 offset:33792
    v_add_f32 v177, v177, v173
    v_mfma_f32_16x16x32_bf16 v[52:55], v[204:207], a[84:87], v[52:55]
    v_add_f32 v177, v177, v174
    v_add_f32 v177, v177, v175
    v_mfma_f32_16x16x32_bf16 v[56:59], v[200:203], a[72:75], v[56:59]
    ds_read_b64_tr_b16 v[196:197], v239 offset:40960
    v_add_f32_dpp v176, v176, v176 row_ror:8 row_mask:0xf bank_mask:0xf
    v_mfma_f32_16x16x32_bf16 v[56:59], v[204:207], a[88:91], v[56:59]
    buffer_load_dwordx4 v225, s[8:11], s48 offen offset:1024 lds
    v_add_f32_dpp v177, v177, v177 row_ror:8 row_mask:0xf bank_mask:0xf
    v_mfma_f32_16x16x32_bf16 v[60:63], v[200:203], a[76:79], v[60:63]
    ds_read_b64_tr_b16 v[198:199], v239 offset:41984
    v_add_f32_dpp v176, v176, v176 row_ror:4 row_mask:0xf bank_mask:0xf
    v_mfma_f32_16x16x32_bf16 v[60:63], v[204:207], a[92:95], v[60:63]
    v_add_f32_dpp v177, v177, v177 row_ror:4 row_mask:0xf bank_mask:0xf
    v_add_f32_dpp v176, v176, v176 row_ror:2 row_mask:0xf bank_mask:0xf
    s_waitcnt lgkmcnt(6)
    v_mfma_f32_16x16x32_bf16 v[64:67], v[208:211], a[64:67], v[64:67]
    ds_read_b64_tr_b16 v[200:201], v240 offset:32768
    v_add_f32_dpp v177, v177, v177 row_ror:2 row_mask:0xf bank_mask:0xf
    s_waitcnt lgkmcnt(5)
    v_mfma_f32_16x16x32_bf16 v[64:67], v[212:215], a[80:83], v[64:67]
    buffer_load_dwordx4 v226, s[8:11], s48 offen offset:2048 lds
    v_add_f32_dpp v176, v176, v176 row_ror:1 row_mask:0xf bank_mask:0xf
    v_mfma_f32_16x16x32_bf16 v[68:71], v[208:211], a[68:71], v[68:71]
    ds_read_b64_tr_b16 v[202:203], v240 offset:33792
    v_add_f32_dpp v177, v177, v177 row_ror:1 row_mask:0xf bank_mask:0xf
    v_mfma_f32_16x16x32_bf16 v[68:71], v[212:215], a[84:87], v[68:71]
    v_mov_b32 v178, v176
    v_mov_b32 v179, v177
    v_mfma_f32_16x16x32_bf16 v[72:75], v[208:211], a[72:75], v[72:75]
    ds_read_b64_tr_b16 v[204:205], v240 offset:40960
    v_permlane16_swap_b32 v176, v178
    v_mfma_f32_16x16x32_bf16 v[72:75], v[212:215], a[88:91], v[72:75]
    buffer_load_dwordx4 v227, s[8:11], s48 offen offset:3072 lds
    v_permlane16_swap_b32 v177, v179
    v_mfma_f32_16x16x32_bf16 v[76:79], v[208:211], a[76:79], v[76:79]
    ds_read_b64_tr_b16 v[206:207], v240 offset:41984
    v_add_f32 v176, v176, v178
    v_mfma_f32_16x16x32_bf16 v[76:79], v[212:215], a[92:95], v[76:79]
    v_add_f32 v177, v177, v179
    v_mov_b32 v178, v176
    s_barrier
    s_waitcnt lgkmcnt(6)
    v_mfma_f32_16x16x32_bf16 v[80:83], v[192:195], a[64:67], v[80:83]
    ds_read_b64_tr_b16 v[208:209], v241 offset:32768
    s_add_u32 s48, s53, 5
    s_waitcnt lgkmcnt(5)
    v_mfma_f32_16x16x32_bf16 v[80:83], v[196:199], a[80:83], v[80:83]
    ds_read_b128 a[96:99], v232 offset:0
    s_and_b32 s48, s48, 7
    v_mfma_f32_16x16x32_bf16 v[84:87], v[192:195], a[68:71], v[84:87]
    ds_read_b64_tr_b16 v[210:211], v241 offset:33792
    s_lshl_b32 s48, s48, 19
    v_mfma_f32_16x16x32_bf16 v[84:87], v[196:199], a[84:87], v[84:87]
    ds_read_b128 a[112:115], v233 offset:0
    s_add_u32 s48, s48, s45
    v_mfma_f32_16x16x32_bf16 v[88:91], v[192:195], a[72:75], v[88:91]
    ds_read_b64_tr_b16 v[212:213], v241 offset:40960
    s_add_u32 m0, s46, 16384
    v_mfma_f32_16x16x32_bf16 v[88:91], v[196:199], a[88:91], v[88:91]
    ds_read_b128 a[100:103], v232 offset:2048
    v_mov_b32 v179, v177
    v_mfma_f32_16x16x32_bf16 v[92:95], v[192:195], a[76:79], v[92:95]
    ds_read_b64_tr_b16 v[214:215], v241 offset:41984
    v_permlane32_swap_b32 v176, v178
    v_mfma_f32_16x16x32_bf16 v[92:95], v[196:199], a[92:95], v[92:95]
    ds_read_b128 a[116:119], v233 offset:2048
    v_permlane32_swap_b32 v177, v179
    s_waitcnt lgkmcnt(10)
    v_mfma_f32_16x16x32_bf16 v[96:99], v[200:203], a[64:67], v[96:99]
    ds_read_b64_tr_b16 v[192:193], v234 offset:49152
    v_add_f32 v176, v176, v178
    s_waitcnt lgkmcnt(9)
    v_mfma_f32_16x16x32_bf16 v[96:99], v[204:207], a[80:83], v[96:99]
    ds_read_b128 a[104:107], v232 offset:4096
    v_add_f32 v177, v177, v179
    v_mfma_f32_16x16x32_bf16 v[100:103], v[200:203], a[68:71], v[100:103]
    ds_read_b64_tr_b16 v[194:195], v234 offset:50176
    v_mul_f32 v176, 0x3b000000, v176
    v_mfma_f32_16x16x32_bf16 v[100:103], v[204:207], a[84:87], v[100:103]
    ds_read_b128 a[120:123], v233 offset:4096
    v_sub_f32 v182, v160, v176
    v_mfma_f32_16x16x32_bf16 v[104:107], v[200:203], a[72:75], v[104:107]
    ds_read_b64_tr_b16 v[196:197], v234 offset:57344
    v_mul_f32 v180, v182, v182
    v_mfma_f32_16x16x32_bf16 v[104:107], v[204:207], a[88:91], v[104:107]
    ds_read_b128 a[108:111], v232 offset:6144
    v_sub_f32 v182, v161, v176
    v_mfma_f32_16x16x32_bf16 v[108:111], v[200:203], a[76:79], v[108:111]
    ds_read_b64_tr_b16 v[198:199], v234 offset:58368
    v_fmac_f32 v180, v182, v182
    v_mfma_f32_16x16x32_bf16 v[108:111], v[204:207], a[92:95], v[108:111]
    ds_read_b128 a[124:127], v233 offset:6144
    v_sub_f32 v182, v162, v176
    s_waitcnt lgkmcnt(13)
    v_mfma_f32_16x16x32_bf16 v[112:115], v[208:211], a[64:67], v[112:115]
    ds_read_b64_tr_b16 v[200:201], v235 offset:49152
    v_fmac_f32 v180, v182, v182
    s_waitcnt lgkmcnt(10)
    v_mfma_f32_16x16x32_bf16 v[112:115], v[212:215], a[80:83], v[112:115]
    buffer_load_dwordx4 v228, s[12:15], s48 offen offset:0 lds
    v_sub_f32 v182, v163, v176
    v_mfma_f32_16x16x32_bf16 v[116:119], v[208:211], a[68:71], v[116:119]
    ds_read_b64_tr_b16 v[202:203], v235 offset:50176
    v_fmac_f32 v180, v182, v182
    v_mfma_f32_16x16x32_bf16 v[116:119], v[212:215], a[84:87], v[116:119]
    v_sub_f32 v182, v164, v176
    v_fmac_f32 v180, v182, v182
    v_mfma_f32_16x16x32_bf16 v[120:123], v[208:211], a[72:75], v[120:123]
    ds_read_b64_tr_b16 v[204:205], v235 offset:57344
    v_sub_f32 v182, v165, v176
    v_mfma_f32_16x16x32_bf16 v[120:123], v[212:215], a[88:91], v[120:123]
    buffer_load_dwordx4 v229, s[12:15], s48 offen offset:1024 lds
    v_fmac_f32 v180, v182, v182
    v_mfma_f32_16x16x32_bf16 v[124:127], v[208:211], a[76:79], v[124:127]
    ds_read_b64_tr_b16 v[206:207], v235 offset:58368
    v_sub_f32 v182, v166, v176
    v_mfma_f32_16x16x32_bf16 v[124:127], v[212:215], a[92:95], v[124:127]
    v_fmac_f32 v180, v182, v182
    v_sub_f32 v182, v167, v176
    s_waitcnt lgkmcnt(9)
    v_mfma_f32_16x16x32_bf16 v[0:3], v[192:195], a[96:99], v[0:3]
    ds_read_b64_tr_b16 v[208:209], v236 offset:49152
    v_fmac_f32 v180, v182, v182
    s_waitcnt lgkmcnt(6)
    v_mfma_f32_16x16x32_bf16 v[0:3], v[196:199], a[112:115], v[0:3]
    buffer_load_dwordx4 v230, s[12:15], s48 offen offset:2048 lds
    v_mul_f32 v177, 0x3b000000, v177
    v_mfma_f32_16x16x32_bf16 v[4:7], v[192:195], a[100:103], v[4:7]
    ds_read_b64_tr_b16 v[210:211], v236 offset:50176
    v_sub_f32 v182, v168, v177
    v_mfma_f32_16x16x32_bf16 v[4:7], v[196:199], a[116:119], v[4:7]
    v_mul_f32 v181, v182, v182
    v_sub_f32 v182, v169, v177
    v_mfma_f32_16x16x32_bf16 v[8:11], v[192:195], a[104:107], v[8:11]
    ds_read_b64_tr_b16 v[212:213], v236 offset:57344
    v_fmac_f32 v181, v182, v182
    v_mfma_f32_16x16x32_bf16 v[8:11], v[196:199], a[120:123], v[8:11]
    buffer_load_dwordx4 v231, s[12:15], s48 offen offset:3072 lds
    s_waitcnt lgkmcnt(7)
    s_add_u32 s48, s53, 6
    v_mfma_f32_16x16x32_bf16 v[12:15], v[192:195], a[108:111], v[12:15]
    ds_read_b64_tr_b16 v[214:215], v236 offset:58368
    s_and_b32 s48, s48, 7
    v_mfma_f32_16x16x32_bf16 v[12:15], v[196:199], a[124:127], v[12:15]
    s_lshl_b32 s48, s48, 7
    s_add_u32 s48, s48, s43
    s_waitcnt lgkmcnt(6)
    v_mfma_f32_16x16x32_bf16 v[16:19], v[200:203], a[96:99], v[16:19]
    ds_read_b64_tr_b16 v[192:193], v237 offset:49152
    s_add_u32 m0, s44, 0
    s_waitcnt lgkmcnt(5)
    v_mfma_f32_16x16x32_bf16 v[16:19], v[204:207], a[112:115], v[16:19]
    buffer_load_dwordx4 v224, s[8:11], s48 offen offset:0 lds
    v_sub_f32 v182, v170, v177
    v_mfma_f32_16x16x32_bf16 v[20:23], v[200:203], a[100:103], v[20:23]
    ds_read_b64_tr_b16 v[194:195], v237 offset:50176
    v_fmac_f32 v181, v182, v182
    v_mfma_f32_16x16x32_bf16 v[20:23], v[204:207], a[116:119], v[20:23]
    v_sub_f32 v182, v171, v177
    v_fmac_f32 v181, v182, v182
    v_mfma_f32_16x16x32_bf16 v[24:27], v[200:203], a[104:107], v[24:27]
    ds_read_b64_tr_b16 v[196:197], v237 offset:57344
    v_sub_f32 v182, v172, v177
    v_mfma_f32_16x16x32_bf16 v[24:27], v[204:207], a[120:123], v[24:27]
    buffer_load_dwordx4 v225, s[8:11], s48 offen offset:1024 lds
    v_fmac_f32 v181, v182, v182
    v_mfma_f32_16x16x32_bf16 v[28:31], v[200:203], a[108:111], v[28:31]
    ds_read_b64_tr_b16 v[198:199], v237 offset:58368
    v_sub_f32 v182, v173, v177
    v_mfma_f32_16x16x32_bf16 v[28:31], v[204:207], a[124:127], v[28:31]
    v_fmac_f32 v181, v182, v182
    v_sub_f32 v182, v174, v177
    s_waitcnt lgkmcnt(6)
    v_mfma_f32_16x16x32_bf16 v[32:35], v[208:211], a[96:99], v[32:35]
    ds_read_b64_tr_b16 v[200:201], v238 offset:49152
    v_fmac_f32 v181, v182, v182
    s_waitcnt lgkmcnt(5)
    v_mfma_f32_16x16x32_bf16 v[32:35], v[212:215], a[112:115], v[32:35]
    buffer_load_dwordx4 v226, s[8:11], s48 offen offset:2048 lds
    v_sub_f32 v182, v175, v177
    v_mfma_f32_16x16x32_bf16 v[36:39], v[208:211], a[100:103], v[36:39]
    ds_read_b64_tr_b16 v[202:203], v238 offset:50176
    v_fmac_f32 v181, v182, v182
    v_mfma_f32_16x16x32_bf16 v[36:39], v[212:215], a[116:119], v[36:39]
    v_add_f32_dpp v180, v180, v180 row_ror:8 row_mask:0xf bank_mask:0xf
    v_add_f32_dpp v181, v181, v181 row_ror:8 row_mask:0xf bank_mask:0xf
    v_mfma_f32_16x16x32_bf16 v[40:43], v[208:211], a[104:107], v[40:43]
    ds_read_b64_tr_b16 v[204:205], v238 offset:57344
    v_add_f32_dpp v180, v180, v180 row_ror:4 row_mask:0xf bank_mask:0xf
    v_mfma_f32_16x16x32_bf16 v[40:43], v[212:215], a[120:123], v[40:43]
    buffer_load_dwordx4 v227, s[8:11], s48 offen offset:3072 lds
    s_add_u32 m0, s44, 4096
    v_mfma_f32_16x16x32_bf16 v[44:47], v[208:211], a[108:111], v[44:47]
    ds_read_b64_tr_b16 v[206:207], v238 offset:58368
    s_add_u32 s48, s48, 32768
    v_mfma_f32_16x16x32_bf16 v[44:47], v[212:215], a[124:127], v[44:47]
    v_add_f32_dpp v181, v181, v181 row_ror:4 row_mask:0xf bank_mask:0xf
    v_add_f32_dpp v180, v180, v180 row_ror:2 row_mask:0xf bank_mask:0xf
    s_waitcnt lgkmcnt(6)
    v_mfma_f32_16x16x32_bf16 v[48:51], v[192:195], a[96:99], v[48:51]
    ds_read_b64_tr_b16 v[208:209], v239 offset:49152
    v_add_f32_dpp v181, v181, v181 row_ror:2 row_mask:0xf bank_mask:0xf
    s_waitcnt lgkmcnt(5)
    v_mfma_f32_16x16x32_bf16 v[48:51], v[196:199], a[112:115], v[48:51]
    buffer_load_dwordx4 v224, s[8:11], s48 offen offset:0 lds
    v_add_f32_dpp v180, v180, v180 row_ror:1 row_mask:0xf bank_mask:0xf
    v_mfma_f32_16x16x32_bf16 v[52:55], v[192:195], a[100:103], v[52:55]
    ds_read_b64_tr_b16 v[210:211], v239 offset:50176
    v_add_f32_dpp v181, v181, v181 row_ror:1 row_mask:0xf bank_mask:0xf
    v_mfma_f32_16x16x32_bf16 v[52:55], v[196:199], a[116:119], v[52:55]
    v_mov_b32 v178, v180
    v_mov_b32 v179, v181
    v_mfma_f32_16x16x32_bf16 v[56:59], v[192:195], a[104:107], v[56:59]
    ds_read_b64_tr_b16 v[212:213], v239 offset:57344
    v_permlane16_swap_b32 v180, v178
    v_mfma_f32_16x16x32_bf16 v[56:59], v[196:199], a[120:123], v[56:59]
    buffer_load_dwordx4 v225, s[8:11], s48 offen offset:1024 lds
    v_permlane16_swap_b32 v181, v179
    v_mfma_f32_16x16x32_bf16 v[60:63], v[192:195], a[108:111], v[60:63]
    ds_read_b64_tr_b16 v[214:215], v239 offset:58368
    v_add_f32 v180, v180, v178
    v_mfma_f32_16x16x32_bf16 v[60:63], v[196:199], a[124:127], v[60:63]
    v_add_f32 v181, v181, v179
    v_mov_b32 v178, v180
    s_waitcnt lgkmcnt(6)
    v_mfma_f32_16x16x32_bf16 v[64:67], v[200:203], a[96:99], v[64:67]
    ds_read_b64_tr_b16 v[192:193], v240 offset:49152
    v_mov_b32 v179, v181
    s_waitcnt lgkmcnt(5)
    v_mfma_f32_16x16x32_bf16 v[64:67], v[204:207], a[112:115], v[64:67]
    buffer_load_dwordx4 v226, s[8:11], s48 offen offset:2048 lds
    v_permlane32_swap_b32 v180, v178
    v_mfma_f32_16x16x32_bf16 v[68:71], v[200:203], a[100:103], v[68:71]
    ds_read_b64_tr_b16 v[194:195], v240 offset:50176
    v_permlane32_swap_b32 v181, v179
    v_mfma_f32_16x16x32_bf16 v[68:71], v[204:207], a[116:119], v[68:71]
    v_add_f32 v180, v180, v178
    v_add_f32 v181, v181, v179
    v_mfma_f32_16x16x32_bf16 v[72:75], v[200:203], a[104:107], v[72:75]
    ds_read_b64_tr_b16 v[196:197], v240 offset:57344
    v_mul_f32 v180, 0x3b000000, v180
    v_mfma_f32_16x16x32_bf16 v[72:75], v[204:207], a[120:123], v[72:75]
    buffer_load_dwordx4 v227, s[8:11], s48 offen offset:3072 lds
    v_cvt_pk_bf16_f32 v180, v180, v180
    v_mfma_f32_16x16x32_bf16 v[76:79], v[200:203], a[108:111], v[76:79]
    ds_read_b64_tr_b16 v[198:199], v240 offset:58368
    v_and_b32 v180, 0xffff0000, v180
    v_mfma_f32_16x16x32_bf16 v[76:79], v[204:207], a[124:127], v[76:79]
    v_add_f32 v180, 0x3727c5ac, v180
    v_cvt_pk_bf16_f32 v180, v180, v180
    s_waitcnt vmcnt(20)
    s_barrier
    s_waitcnt lgkmcnt(6)
    v_mfma_f32_16x16x32_bf16 v[80:83], v[208:211], a[96:99], v[80:83]
    ds_read_b64_tr_b16 v[200:201], v241 offset:49152
    s_add_u32 s48, s53, 6
    s_waitcnt lgkmcnt(5)
    v_mfma_f32_16x16x32_bf16 v[80:83], v[212:215], a[112:115], v[80:83]
    ds_read_b128 a[128:131], v232 offset:8192
    s_and_b32 s48, s48, 7
    v_mfma_f32_16x16x32_bf16 v[84:87], v[208:211], a[100:103], v[84:87]
    ds_read_b64_tr_b16 v[202:203], v241 offset:50176
    s_lshl_b32 s48, s48, 19
    v_mfma_f32_16x16x32_bf16 v[84:87], v[212:215], a[116:119], v[84:87]
    ds_read_b128 a[144:147], v233 offset:8192
    s_add_u32 s48, s48, s45
    v_mfma_f32_16x16x32_bf16 v[88:91], v[208:211], a[104:107], v[88:91]
    ds_read_b64_tr_b16 v[204:205], v241 offset:57344
    s_add_u32 m0, s46, 32768
    v_mfma_f32_16x16x32_bf16 v[88:91], v[212:215], a[120:123], v[88:91]
    ds_read_b128 a[132:135], v232 offset:10240
    v_and_b32 v180, 0xffff0000, v180
    v_mfma_f32_16x16x32_bf16 v[92:95], v[208:211], a[108:111], v[92:95]
    ds_read_b64_tr_b16 v[206:207], v241 offset:58368
    v_mfma_f32_16x16x32_bf16 v[92:95], v[212:215], a[124:127], v[92:95]
    ds_read_b128 a[148:151], v233 offset:10240
    s_waitcnt lgkmcnt(10)
    v_mfma_f32_16x16x32_bf16 v[96:99], v[192:195], a[96:99], v[96:99]
    ds_read_b64_tr_b16 v[208:209], v234 offset:0
    s_waitcnt lgkmcnt(9)
    v_mfma_f32_16x16x32_bf16 v[96:99], v[196:199], a[112:115], v[96:99]
    ds_read_b128 a[136:139], v232 offset:12288
    v_mfma_f32_16x16x32_bf16 v[100:103], v[192:195], a[100:103], v[100:103]
    ds_read_b64_tr_b16 v[210:211], v234 offset:1024
    v_mfma_f32_16x16x32_bf16 v[100:103], v[196:199], a[116:119], v[100:103]
    ds_read_b128 a[152:155], v233 offset:12288
    v_mfma_f32_16x16x32_bf16 v[104:107], v[192:195], a[104:107], v[104:107]
    ds_read_b64_tr_b16 v[212:213], v234 offset:8192
    v_mfma_f32_16x16x32_bf16 v[104:107], v[196:199], a[120:123], v[104:107]
    ds_read_b128 a[140:143], v232 offset:14336
    v_mfma_f32_16x16x32_bf16 v[108:111], v[192:195], a[108:111], v[108:111]
    ds_read_b64_tr_b16 v[214:215], v234 offset:9216
    v_mfma_f32_16x16x32_bf16 v[108:111], v[196:199], a[124:127], v[108:111]
    ds_read_b128 a[156:159], v233 offset:14336
    s_waitcnt lgkmcnt(13)
    v_mfma_f32_16x16x32_bf16 v[112:115], v[200:203], a[96:99], v[112:115]
    ds_read_b64_tr_b16 v[192:193], v235 offset:0
    s_waitcnt lgkmcnt(10)
    v_mfma_f32_16x16x32_bf16 v[112:115], v[204:207], a[112:115], v[112:115]
    buffer_load_dwordx4 v228, s[12:15], s48 offen offset:0 lds
    v_mfma_f32_16x16x32_bf16 v[116:119], v[200:203], a[100:103], v[116:119]
    ds_read_b64_tr_b16 v[194:195], v235 offset:1024
    v_mfma_f32_16x16x32_bf16 v[116:119], v[204:207], a[116:119], v[116:119]
    v_sqrt_f32 v180, v180
    v_mfma_f32_16x16x32_bf16 v[120:123], v[200:203], a[104:107], v[120:123]
    ds_read_b64_tr_b16 v[196:197], v235 offset:8192
    v_cvt_pk_bf16_f32 v176, v176, v176
    v_mfma_f32_16x16x32_bf16 v[120:123], v[204:207], a[120:123], v[120:123]
    buffer_load_dwordx4 v229, s[12:15], s48 offen offset:1024 lds
    v_and_b32 v176, 0xffff0000, v176
    v_mfma_f32_16x16x32_bf16 v[124:127], v[200:203], a[108:111], v[124:127]
    ds_read_b64_tr_b16 v[198:199], v235 offset:9216
    v_cvt_pk_bf16_f32 v180, v180, v180
    v_mfma_f32_16x16x32_bf16 v[124:127], v[204:207], a[124:127], v[124:127]
    v_and_b32 v180, 0xffff0000, v180
    s_waitcnt lgkmcnt(9)
    v_mfma_f32_16x16x32_bf16 v[0:3], v[208:211], a[128:131], v[0:3]
    ds_read_b64_tr_b16 v[200:201], v236 offset:0
    s_waitcnt lgkmcnt(6)
    v_mfma_f32_16x16x32_bf16 v[0:3], v[212:215], a[144:147], v[0:3]
    buffer_load_dwordx4 v230, s[12:15], s48 offen offset:2048 lds
    buffer_load_dword v254, off, s[36:39], s46 sc1
    v_mfma_f32_16x16x32_bf16 v[4:7], v[208:211], a[132:135], v[4:7]
    ds_read_b64_tr_b16 v[202:203], v236 offset:1024
    v_mfma_f32_16x16x32_bf16 v[4:7], v[212:215], a[148:151], v[4:7]
    v_rcp_f32 v180, v180
    v_mfma_f32_16x16x32_bf16 v[8:11], v[208:211], a[136:139], v[8:11]
    ds_read_b64_tr_b16 v[204:205], v236 offset:8192
    v_sub_f32 v160, v160, v176
    v_mfma_f32_16x16x32_bf16 v[8:11], v[212:215], a[152:155], v[8:11]
    buffer_load_dwordx4 v231, s[12:15], s48 offen offset:3072 lds
    s_waitcnt lgkmcnt(7)
    s_add_u32 s48, s53, 7
    v_mfma_f32_16x16x32_bf16 v[12:15], v[208:211], a[140:143], v[12:15]
    ds_read_b64_tr_b16 v[206:207], v236 offset:9216
    s_and_b32 s48, s48, 7
    v_mfma_f32_16x16x32_bf16 v[12:15], v[212:215], a[156:159], v[12:15]
    s_lshl_b32 s48, s48, 7
    s_add_u32 s48, s48, s43
    s_waitcnt lgkmcnt(6)
    v_mfma_f32_16x16x32_bf16 v[16:19], v[192:195], a[128:131], v[16:19]
    ds_read_b64_tr_b16 v[208:209], v237 offset:0
    s_add_u32 m0, s44, 8192
    s_waitcnt lgkmcnt(5)
    v_mfma_f32_16x16x32_bf16 v[16:19], v[196:199], a[144:147], v[16:19]
    buffer_load_dwordx4 v224, s[8:11], s48 offen offset:0 lds
    v_sub_f32 v161, v161, v176
    v_mfma_f32_16x16x32_bf16 v[20:23], v[192:195], a[132:135], v[20:23]
    ds_read_b64_tr_b16 v[210:211], v237 offset:1024
    v_cvt_pk_bf16_f32 v182, v160, v161
    v_mfma_f32_16x16x32_bf16 v[20:23], v[196:199], a[148:151], v[20:23]
    v_lshlrev_b32 v160, 16, v182
    v_and_b32 v161, 0xffff0000, v182
    v_mfma_f32_16x16x32_bf16 v[24:27], v[192:195], a[136:139], v[24:27]
    ds_read_b64_tr_b16 v[212:213], v237 offset:8192
    v_mul_f32 v160, v160, v180
    v_mfma_f32_16x16x32_bf16 v[24:27], v[196:199], a[152:155], v[24:27]
    buffer_load_dwordx4 v225, s[8:11], s48 offen offset:1024 lds
    v_mul_f32 v161, v161, v180
    v_mfma_f32_16x16x32_bf16 v[28:31], v[192:195], a[140:143], v[28:31]
    ds_read_b64_tr_b16 v[214:215], v237 offset:9216
    v_cvt_pk_bf16_f32 v244, v160, v161
    v_mfma_f32_16x16x32_bf16 v[28:31], v[196:199], a[156:159], v[28:31]
    v_sub_f32 v162, v162, v176
    v_sub_f32 v163, v163, v176
    s_waitcnt lgkmcnt(6)
    v_mfma_f32_16x16x32_bf16 v[32:35], v[200:203], a[128:131], v[32:35]
    ds_read_b64_tr_b16 v[192:193], v238 offset:0
    v_cvt_pk_bf16_f32 v182, v162, v163
    s_waitcnt lgkmcnt(5)
    v_mfma_f32_16x16x32_bf16 v[32:35], v[204:207], a[144:147], v[32:35]
    buffer_load_dwordx4 v226, s[8:11], s48 offen offset:2048 lds
    v_lshlrev_b32 v162, 16, v182
    v_mfma_f32_16x16x32_bf16 v[36:39], v[200:203], a[132:135], v[36:39]
    ds_read_b64_tr_b16 v[194:195], v238 offset:1024
    v_and_b32 v163, 0xffff0000, v182
    v_mfma_f32_16x16x32_bf16 v[36:39], v[204:207], a[148:151], v[36:39]
    v_mul_f32 v162, v162, v180
    v_mul_f32 v163, v163, v180
    v_mfma_f32_16x16x32_bf16 v[40:43], v[200:203], a[136:139], v[40:43]
    ds_read_b64_tr_b16 v[196:197], v238 offset:8192
    v_cvt_pk_bf16_f32 v245, v162, v163
    v_mfma_f32_16x16x32_bf16 v[40:43], v[204:207], a[152:155], v[40:43]
    buffer_load_dwordx4 v227, s[8:11], s48 offen offset:3072 lds
    s_add_u32 m0, s44, 12288
    v_mfma_f32_16x16x32_bf16 v[44:47], v[200:203], a[140:143], v[44:47]
    ds_read_b64_tr_b16 v[198:199], v238 offset:9216
    s_add_u32 s48, s48, 32768
    v_mfma_f32_16x16x32_bf16 v[44:47], v[204:207], a[156:159], v[44:47]
    v_sub_f32 v164, v164, v176
    v_sub_f32 v165, v165, v176
    s_waitcnt lgkmcnt(6)
    v_mfma_f32_16x16x32_bf16 v[48:51], v[208:211], a[128:131], v[48:51]
    ds_read_b64_tr_b16 v[200:201], v239 offset:0
    v_cvt_pk_bf16_f32 v182, v164, v165
    s_waitcnt lgkmcnt(5)
    v_mfma_f32_16x16x32_bf16 v[48:51], v[212:215], a[144:147], v[48:51]
    buffer_load_dwordx4 v224, s[8:11], s48 offen offset:0 lds
    v_lshlrev_b32 v164, 16, v182
    v_mfma_f32_16x16x32_bf16 v[52:55], v[208:211], a[132:135], v[52:55]
    ds_read_b64_tr_b16 v[202:203], v239 offset:1024
    v_and_b32 v165, 0xffff0000, v182
    v_mfma_f32_16x16x32_bf16 v[52:55], v[212:215], a[148:151], v[52:55]
    v_mul_f32 v164, v164, v180
    v_mul_f32 v165, v165, v180
    v_mfma_f32_16x16x32_bf16 v[56:59], v[208:211], a[136:139], v[56:59]
    ds_read_b64_tr_b16 v[204:205], v239 offset:8192
    v_cvt_pk_bf16_f32 v246, v164, v165
    v_mfma_f32_16x16x32_bf16 v[56:59], v[212:215], a[152:155], v[56:59]
    buffer_load_dwordx4 v225, s[8:11], s48 offen offset:1024 lds
    v_sub_f32 v166, v166, v176
    v_mfma_f32_16x16x32_bf16 v[60:63], v[208:211], a[140:143], v[60:63]
    ds_read_b64_tr_b16 v[206:207], v239 offset:9216
    v_sub_f32 v167, v167, v176
    v_mfma_f32_16x16x32_bf16 v[60:63], v[212:215], a[156:159], v[60:63]
    v_cvt_pk_bf16_f32 v182, v166, v167
    v_lshlrev_b32 v166, 16, v182
    s_waitcnt lgkmcnt(6)
    v_mfma_f32_16x16x32_bf16 v[64:67], v[192:195], a[128:131], v[64:67]
    ds_read_b64_tr_b16 v[208:209], v240 offset:0
    v_and_b32 v167, 0xffff0000, v182
    s_waitcnt lgkmcnt(5)
    v_mfma_f32_16x16x32_bf16 v[64:67], v[196:199], a[144:147], v[64:67]
    buffer_load_dwordx4 v226, s[8:11], s48 offen offset:2048 lds
    v_mul_f32 v166, v166, v180
    v_mfma_f32_16x16x32_bf16 v[68:71], v[192:195], a[132:135], v[68:71]
    ds_read_b64_tr_b16 v[210:211], v240 offset:1024
    v_mul_f32 v167, v167, v180
    v_mfma_f32_16x16x32_bf16 v[68:71], v[196:199], a[148:151], v[68:71]
    v_cvt_pk_bf16_f32 v247, v166, v167
    v_mul_f32 v181, 0x3b000000, v181
    v_mfma_f32_16x16x32_bf16 v[72:75], v[192:195], a[136:139], v[72:75]
    ds_read_b64_tr_b16 v[212:213], v240 offset:8192
    v_cvt_pk_bf16_f32 v181, v181, v181
    v_mfma_f32_16x16x32_bf16 v[72:75], v[196:199], a[152:155], v[72:75]
    buffer_load_dwordx4 v227, s[8:11], s48 offen offset:3072 lds
    s_and_b32 s87, s2, 7
    s_lshl_b32 s87, s87, 7
    s_add_u32 s87, s87, 532480
    v_mfma_f32_16x16x32_bf16 v[76:79], v[192:195], a[140:143], v[76:79]
    ds_read_b64_tr_b16 v[214:215], v240 offset:9216
    v_and_b32 v181, 0xffff0000, v181
    v_mfma_f32_16x16x32_bf16 v[76:79], v[196:199], a[156:159], v[76:79]
    v_add_f32 v181, 0x3727c5ac, v181
    v_cvt_pk_bf16_f32 v181, v181, v181
    s_waitcnt vmcnt(9)
    v_readfirstlane_b32 s49, v254
    s_nop 0
    s_or_b32 s49, s49, s46
    s_cmp_ge_u32 s49, 64
    s_cbranch_scc1 K1_POLL_OK
K1_POLL:
    s_sleep 24
    buffer_load_dword v254, off, s[36:39], s46 sc1
    s_waitcnt vmcnt(0)
    v_readfirstlane_b32 s49, v254
    s_nop 0
    s_or_b32 s49, s49, s46
    s_cmp_ge_u32 s49, 64
    s_cbranch_scc1 K1_POLL_OK
    s_branch K1_POLL
K1_POLL_OK:
    s_barrier
    s_waitcnt lgkmcnt(6)
    v_mfma_f32_16x16x32_bf16 v[80:83], v[200:203], a[128:131], v[80:83]
    ds_read_b64_tr_b16 v[192:193], v241 offset:0
    s_add_u32 s48, s53, 7
    s_waitcnt lgkmcnt(5)
    v_mfma_f32_16x16x32_bf16 v[80:83], v[204:207], a[144:147], v[80:83]
    ds_read_b128 a[160:163], v232 offset:16384
    s_and_b32 s48, s48, 7
    buffer_load_dwordx4 v[128:131], v219, s[20:23], s64 offen
    v_mfma_f32_16x16x32_bf16 v[84:87], v[200:203], a[132:135], v[84:87]
    ds_read_b64_tr_b16 v[194:195], v241 offset:1024
    s_lshl_b32 s48, s48, 19
    v_mfma_f32_16x16x32_bf16 v[84:87], v[204:207], a[148:151], v[84:87]
    ds_read_b128 a[176:179], v233 offset:16384
    s_add_u32 s48, s48, s45
    buffer_load_dwordx4 v[132:135], v219, s[20:23], s65 offen
    v_mfma_f32_16x16x32_bf16 v[88:91], v[200:203], a[136:139], v[88:91]
    ds_read_b64_tr_b16 v[196:197], v241 offset:8192
    s_add_u32 m0, s46, 49152
    v_mfma_f32_16x16x32_bf16 v[88:91], v[204:207], a[152:155], v[88:91]
    ds_read_b128 a[164:167], v232 offset:18432
    buffer_load_dwordx4 v[136:139], v219, s[20:23], s66 offen
    v_mfma_f32_16x16x32_bf16 v[92:95], v[200:203], a[140:143], v[92:95]
    ds_read_b64_tr_b16 v[198:199], v241 offset:9216
    v_and_b32 v181, 0xffff0000, v181
    v_mfma_f32_16x16x32_bf16 v[92:95], v[204:207], a[156:159], v[92:95]
    ds_read_b128 a[180:183], v233 offset:18432
    buffer_load_dwordx4 v[140:143], v219, s[20:23], s67 offen
    s_waitcnt lgkmcnt(10)
    v_mfma_f32_16x16x32_bf16 v[96:99], v[208:211], a[128:131], v[96:99]
    ds_read_b64_tr_b16 v[200:201], v234 offset:16384
    s_waitcnt lgkmcnt(9)
    v_mfma_f32_16x16x32_bf16 v[96:99], v[212:215], a[144:147], v[96:99]
    ds_read_b128 a[168:171], v232 offset:20480
    buffer_atomic_add v221, v220, s[20:23], s87 offen sc1
    v_mfma_f32_16x16x32_bf16 v[100:103], v[208:211], a[132:135], v[100:103]
    ds_read_b64_tr_b16 v[202:203], v234 offset:17408
    v_mfma_f32_16x16x32_bf16 v[100:103], v[212:215], a[148:151], v[100:103]
    ds_read_b128 a[184:187], v233 offset:20480
    v_mfma_f32_16x16x32_bf16 v[104:107], v[208:211], a[136:139], v[104:107]
    ds_read_b64_tr_b16 v[204:205], v234 offset:24576
    v_mfma_f32_16x16x32_bf16 v[104:107], v[212:215], a[152:155], v[104:107]
    ds_read_b128 a[172:175], v232 offset:22528
    v_mfma_f32_16x16x32_bf16 v[108:111], v[208:211], a[140:143], v[108:111]
    ds_read_b64_tr_b16 v[206:207], v234 offset:25600
    v_mfma_f32_16x16x32_bf16 v[108:111], v[212:215], a[156:159], v[108:111]
    ds_read_b128 a[188:191], v233 offset:22528
    s_waitcnt lgkmcnt(13)
    v_mfma_f32_16x16x32_bf16 v[112:115], v[192:195], a[128:131], v[112:115]
    ds_read_b64_tr_b16 v[208:209], v235 offset:16384
    s_waitcnt lgkmcnt(10)
    v_mfma_f32_16x16x32_bf16 v[112:115], v[196:199], a[144:147], v[112:115]
    buffer_load_dwordx4 v228, s[12:15], s48 offen offset:0 lds
    v_mfma_f32_16x16x32_bf16 v[116:119], v[192:195], a[132:135], v[116:119]
    ds_read_b64_tr_b16 v[210:211], v235 offset:17408
    v_mfma_f32_16x16x32_bf16 v[116:119], v[196:199], a[148:151], v[116:119]
    v_sqrt_f32 v181, v181
    v_mfma_f32_16x16x32_bf16 v[120:123], v[192:195], a[136:139], v[120:123]
    ds_read_b64_tr_b16 v[212:213], v235 offset:24576
    v_cvt_pk_bf16_f32 v177, v177, v177
    v_mfma_f32_16x16x32_bf16 v[120:123], v[196:199], a[152:155], v[120:123]
    buffer_load_dwordx4 v229, s[12:15], s48 offen offset:1024 lds
    v_and_b32 v177, 0xffff0000, v177
    v_mfma_f32_16x16x32_bf16 v[124:127], v[192:195], a[140:143], v[124:127]
    ds_read_b64_tr_b16 v[214:215], v235 offset:25600
    v_cvt_pk_bf16_f32 v181, v181, v181
    v_mfma_f32_16x16x32_bf16 v[124:127], v[196:199], a[156:159], v[124:127]
    v_and_b32 v181, 0xffff0000, v181
    s_waitcnt lgkmcnt(9)
    v_mfma_f32_16x16x32_bf16 v[0:3], v[200:203], a[160:163], v[0:3]
    ds_read_b64_tr_b16 v[192:193], v236 offset:16384
    s_waitcnt lgkmcnt(6)
    v_mfma_f32_16x16x32_bf16 v[0:3], v[204:207], a[176:179], v[0:3]
    ds_read_b128 a[192:195], v232 offset:0
    v_mfma_f32_16x16x32_bf16 v[4:7], v[200:203], a[164:167], v[4:7]
    ds_read_b64_tr_b16 v[194:195], v236 offset:17408
    v_mfma_f32_16x16x32_bf16 v[4:7], v[204:207], a[180:183], v[4:7]
    ds_read_b128 a[208:211], v233 offset:0
    v_mfma_f32_16x16x32_bf16 v[8:11], v[200:203], a[168:171], v[8:11]
    ds_read_b64_tr_b16 v[196:197], v236 offset:24576
    v_mfma_f32_16x16x32_bf16 v[8:11], v[204:207], a[184:187], v[8:11]
    ds_read_b128 a[196:199], v232 offset:2048
    v_mfma_f32_16x16x32_bf16 v[12:15], v[200:203], a[172:175], v[12:15]
    ds_read_b64_tr_b16 v[198:199], v236 offset:25600
    s_waitcnt lgkmcnt(11)
    v_mfma_f32_16x16x32_bf16 v[12:15], v[204:207], a[188:191], v[12:15]
    ds_read_b128 a[212:215], v233 offset:2048
    s_waitcnt lgkmcnt(10)
    v_mfma_f32_16x16x32_bf16 v[16:19], v[208:211], a[160:163], v[16:19]
    ds_read_b64_tr_b16 v[200:201], v237 offset:16384
    s_waitcnt lgkmcnt(9)
    v_mfma_f32_16x16x32_bf16 v[16:19], v[212:215], a[176:179], v[16:19]
    ds_read_b128 a[200:203], v232 offset:4096
    v_mfma_f32_16x16x32_bf16 v[20:23], v[208:211], a[164:167], v[20:23]
    ds_read_b64_tr_b16 v[202:203], v237 offset:17408
    v_mfma_f32_16x16x32_bf16 v[20:23], v[212:215], a[180:183], v[20:23]
    ds_read_b128 a[216:219], v233 offset:4096
    v_mfma_f32_16x16x32_bf16 v[24:27], v[208:211], a[168:171], v[24:27]
    ds_read_b64_tr_b16 v[204:205], v237 offset:24576
    v_mfma_f32_16x16x32_bf16 v[24:27], v[212:215], a[184:187], v[24:27]
    ds_read_b128 a[204:207], v232 offset:6144
    v_mfma_f32_16x16x32_bf16 v[28:31], v[208:211], a[172:175], v[28:31]
    ds_read_b64_tr_b16 v[206:207], v237 offset:25600
    v_mfma_f32_16x16x32_bf16 v[28:31], v[212:215], a[188:191], v[28:31]
    ds_read_b128 a[220:223], v233 offset:6144
    s_waitcnt lgkmcnt(13)
    v_mfma_f32_16x16x32_bf16 v[32:35], v[192:195], a[160:163], v[32:35]
    ds_read_b64_tr_b16 v[208:209], v238 offset:16384
    s_waitcnt lgkmcnt(10)
    v_mfma_f32_16x16x32_bf16 v[32:35], v[196:199], a[176:179], v[32:35]
    buffer_load_dwordx4 v230, s[12:15], s48 offen offset:2048 lds
    v_mfma_f32_16x16x32_bf16 v[36:39], v[192:195], a[164:167], v[36:39]
    ds_read_b64_tr_b16 v[210:211], v238 offset:17408
    v_mfma_f32_16x16x32_bf16 v[36:39], v[196:199], a[180:183], v[36:39]
    v_rcp_f32 v181, v181
    v_mfma_f32_16x16x32_bf16 v[40:43], v[192:195], a[168:171], v[40:43]
    ds_read_b64_tr_b16 v[212:213], v238 offset:24576
    v_sub_f32 v168, v168, v177
    v_mfma_f32_16x16x32_bf16 v[40:43], v[196:199], a[184:187], v[40:43]
    buffer_load_dwordx4 v231, s[12:15], s48 offen offset:3072 lds
    v_lshrrev_b32 v190, 3, v253
    v_mfma_f32_16x16x32_bf16 v[44:47], v[192:195], a[172:175], v[44:47]
    ds_read_b64_tr_b16 v[214:215], v238 offset:25600
    v_and_b32 v191, 2, v190
    v_mfma_f32_16x16x32_bf16 v[44:47], v[196:199], a[188:191], v[44:47]
    v_and_b32 v187, 7, v253
    v_xor_b32 v191, v191, v187
    s_waitcnt lgkmcnt(9)
    v_mfma_f32_16x16x32_bf16 v[48:51], v[200:203], a[160:163], v[48:51]
    ds_read_b64_tr_b16 v[192:193], v239 offset:16384
    v_lshlrev_b32 v190, 13, v190
    s_waitcnt lgkmcnt(6)
    v_mfma_f32_16x16x32_bf16 v[48:51], v[204:207], a[176:179], v[48:51]
    v_lshl_add_u32 v228, v191, 4, v190
    v_xor_b32 v190, 64, v228
    v_mfma_f32_16x16x32_bf16 v[52:55], v[200:203], a[164:167], v[52:55]
    ds_read_b64_tr_b16 v[194:195], v239 offset:17408
    v_add_u32 v229, 64512, v190
    v_mfma_f32_16x16x32_bf16 v[52:55], v[204:207], a[180:183], v[52:55]
    v_add_u32 v230, 129024, v228
    v_add_u32 v231, 193536, v190
    v_mfma_f32_16x16x32_bf16 v[56:59], v[200:203], a[168:171], v[56:59]
    ds_read_b64_tr_b16 v[196:197], v239 offset:24576
    v_lshrrev_b32 v190, 4, v253
    v_mfma_f32_16x16x32_bf16 v[56:59], v[204:207], a[184:187], v[56:59]
    v_bfe_u32 v191, v253, 2, 2
    v_lshl_add_u32 v187, v190, 3, v191
    v_mfma_f32_16x16x32_bf16 v[60:63], v[200:203], a[172:175], v[60:63]
    ds_read_b64_tr_b16 v[198:199], v239 offset:25600
    v_lshlrev_b32 v187, 7, v187
    v_mfma_f32_16x16x32_bf16 v[60:63], v[204:207], a[188:191], v[60:63]
    v_bfe_u32 v191, v253, 3, 2
    v_lshl_add_u32 v187, v191, 5, v187
    s_waitcnt lgkmcnt(6)
    v_mfma_f32_16x16x32_bf16 v[64:67], v[208:211], a[160:163], v[64:67]
    ds_read_b64_tr_b16 v[200:201], v240 offset:16384
    v_and_b32 v191, 3, v253
    s_waitcnt lgkmcnt(5)
    v_mfma_f32_16x16x32_bf16 v[64:67], v[212:215], a[176:179], v[64:67]
    v_lshl_add_u32 v224, v191, 3, v187
    v_xor_b32 v225, 32, v224
    v_mfma_f32_16x16x32_bf16 v[68:71], v[208:211], a[164:167], v[68:71]
    ds_read_b64_tr_b16 v[202:203], v240 offset:17408
    v_xor_b32 v226, 64, v224
    v_mfma_f32_16x16x32_bf16 v[68:71], v[212:215], a[180:183], v[68:71]
    v_xor_b32 v227, 96, v224
    v_sub_f32 v169, v169, v177
    v_mfma_f32_16x16x32_bf16 v[72:75], v[208:211], a[168:171], v[72:75]
    ds_read_b64_tr_b16 v[204:205], v240 offset:24576
    v_cvt_pk_bf16_f32 v182, v168, v169
    v_mfma_f32_16x16x32_bf16 v[72:75], v[212:215], a[184:187], v[72:75]
    v_lshlrev_b32 v168, 16, v182
    v_and_b32 v169, 0xffff0000, v182
    v_mfma_f32_16x16x32_bf16 v[76:79], v[208:211], a[172:175], v[76:79]
    ds_read_b64_tr_b16 v[206:207], v240 offset:25600
    v_mul_f32 v168, v168, v181
    v_mfma_f32_16x16x32_bf16 v[76:79], v[212:215], a[188:191], v[76:79]
    v_mul_f32 v169, v169, v181
    v_cvt_pk_bf16_f32 v248, v168, v169
    s_waitcnt vmcnt(17)
    s_barrier
    s_waitcnt lgkmcnt(6)
    v_mfma_f32_16x16x32_bf16 v[80:83], v[192:195], a[160:163], v[80:83]
    ds_read_b64_tr_b16 v[208:209], v241 offset:16384
    s_add_u32 s48, s54, 0
    s_waitcnt lgkmcnt(5)
    v_mfma_f32_16x16x32_bf16 v[80:83], v[196:199], a[176:179], v[80:83]
    s_and_b32 s48, s48, 7
    s_lshl_b32 s48, s48, 19
    v_mfma_f32_16x16x32_bf16 v[84:87], v[192:195], a[164:167], v[84:87]
    ds_read_b64_tr_b16 v[210:211], v241 offset:17408
    s_add_u32 s48, s48, s47
    v_mfma_f32_16x16x32_bf16 v[84:87], v[196:199], a[180:183], v[84:87]
    s_add_u32 m0, s46, 0
    v_sub_f32 v170, v170, v177
    v_mfma_f32_16x16x32_bf16 v[88:91], v[192:195], a[168:171], v[88:91]
    ds_read_b64_tr_b16 v[212:213], v241 offset:24576
    v_sub_f32 v171, v171, v177
    v_mfma_f32_16x16x32_bf16 v[88:91], v[196:199], a[184:187], v[88:91]
    buffer_load_dwordx4 v228, s[16:19], s48 offen offset:0 lds
    s_waitcnt vmcnt(8)
    v_add_f32 v128, v128, v132
    v_mfma_f32_16x16x32_bf16 v[92:95], v[192:195], a[172:175], v[92:95]
    ds_read_b64_tr_b16 v[214:215], v241 offset:25600
    s_waitcnt vmcnt(6)
    v_add_f32 v136, v136, v140
    v_mfma_f32_16x16x32_bf16 v[92:95], v[196:199], a[188:191], v[92:95]
    v_add_f32 v129, v129, v133
    v_add_f32 v137, v137, v141
    s_waitcnt lgkmcnt(6)
    v_mfma_f32_16x16x32_bf16 v[96:99], v[200:203], a[160:163], v[96:99]
    ds_read_b64_tr_b16 v[192:193], v234 offset:32768
    v_add_f32 v130, v130, v134
    s_waitcnt lgkmcnt(5)
    v_mfma_f32_16x16x32_bf16 v[96:99], v[204:207], a[176:179], v[96:99]
    buffer_load_dwordx4 v229, s[16:19], s48 offen offset:1024 lds
    v_add_f32 v138, v138, v142
    v_mfma_f32_16x16x32_bf16 v[100:103], v[200:203], a[164:167], v[100:103]
    ds_read_b64_tr_b16 v[194:195], v234 offset:33792
    v_add_f32 v131, v131, v135
    v_mfma_f32_16x16x32_bf16 v[100:103], v[204:207], a[180:183], v[100:103]
    v_add_f32 v139, v139, v143
    v_add_f32 v128, v128, v136
    v_mfma_f32_16x16x32_bf16 v[104:107], v[200:203], a[168:171], v[104:107]
    ds_read_b64_tr_b16 v[196:197], v234 offset:40960
    v_add_f32 v129, v129, v137
    v_mfma_f32_16x16x32_bf16 v[104:107], v[204:207], a[184:187], v[104:107]
    buffer_load_dwordx4 v230, s[16:19], s48 offen offset:2048 lds
    v_add_f32 v130, v130, v138
    v_mfma_f32_16x16x32_bf16 v[108:111], v[200:203], a[172:175], v[108:111]
    ds_read_b64_tr_b16 v[198:199], v234 offset:41984
    v_add_f32 v131, v131, v139
    v_mfma_f32_16x16x32_bf16 v[108:111], v[204:207], a[188:191], v[108:111]
    v_cvt_pk_bf16_f32 v132, v128, v129
    v_lshlrev_b32 v128, 16, v132
    s_waitcnt lgkmcnt(6)
    v_mfma_f32_16x16x32_bf16 v[112:115], v[208:211], a[160:163], v[112:115]
    ds_read_b64_tr_b16 v[200:201], v235 offset:32768
    v_and_b32 v129, 0xffff0000, v132
    s_waitcnt lgkmcnt(5)
    v_mfma_f32_16x16x32_bf16 v[112:115], v[212:215], a[176:179], v[112:115]
    buffer_load_dwordx4 v231, s[16:19], s48 offen offset:3072 lds
    v_cvt_pk_bf16_f32 v132, v130, v131
    v_mfma_f32_16x16x32_bf16 v[116:119], v[208:211], a[164:167], v[116:119]
    ds_read_b64_tr_b16 v[202:203], v235 offset:33792
    v_lshlrev_b32 v130, 16, v132
    v_mfma_f32_16x16x32_bf16 v[116:119], v[212:215], a[180:183], v[116:119]
    v_and_b32 v131, 0xffff0000, v132
    v_add_f32 v128, s42, v128
    v_mfma_f32_16x16x32_bf16 v[120:123], v[208:211], a[168:171], v[120:123]
    ds_read_b64_tr_b16 v[204:205], v235 offset:40960
    v_add_f32 v129, s42, v129
    v_mfma_f32_16x16x32_bf16 v[120:123], v[212:215], a[184:187], v[120:123]
    v_add_f32 v130, s42, v130
    v_add_f32 v131, s42, v131
    v_mfma_f32_16x16x32_bf16 v[124:127], v[208:211], a[172:175], v[124:127]
    ds_read_b64_tr_b16 v[206:207], v235 offset:41984
    v_cvt_pk_bf16_f32 v132, v128, v129
    v_mfma_f32_16x16x32_bf16 v[124:127], v[212:215], a[188:191], v[124:127]
    v_lshlrev_b32 v128, 16, v132
    v_and_b32 v129, 0xffff0000, v132
    s_waitcnt lgkmcnt(6)
    v_mfma_f32_16x16x32_bf16 v[0:3], v[192:195], a[192:195], v[0:3]
    ds_read_b64_tr_b16 v[208:209], v236 offset:32768
    v_cvt_pk_bf16_f32 v132, v130, v131
    s_waitcnt lgkmcnt(5)
    v_mfma_f32_16x16x32_bf16 v[0:3], v[196:199], a[208:211], v[0:3]
    ds_read_b128 a[224:227], v232 offset:8192
    v_lshlrev_b32 v130, 16, v132
    v_mfma_f32_16x16x32_bf16 v[4:7], v[192:195], a[196:199], v[4:7]
    ds_read_b64_tr_b16 v[210:211], v236 offset:33792
    v_and_b32 v131, 0xffff0000, v132
    v_mfma_f32_16x16x32_bf16 v[4:7], v[196:199], a[212:215], v[4:7]
    ds_read_b128 a[240:243], v233 offset:8192
    v_mul_f32 v128, s50, v128
    v_mfma_f32_16x16x32_bf16 v[8:11], v[192:195], a[200:203], v[8:11]
    ds_read_b64_tr_b16 v[212:213], v236 offset:40960
    v_mul_f32 v129, s50, v129
    v_mfma_f32_16x16x32_bf16 v[8:11], v[196:199], a[216:219], v[8:11]
    ds_read_b128 a[228:231], v232 offset:10240
    v_mul_f32 v130, s50, v130
    v_mfma_f32_16x16x32_bf16 v[12:15], v[192:195], a[204:207], v[12:15]
    ds_read_b64_tr_b16 v[214:215], v236 offset:41984
    v_mul_f32 v131, s50, v131
    v_mfma_f32_16x16x32_bf16 v[12:15], v[196:199], a[220:223], v[12:15]
    ds_read_b128 a[244:247], v233 offset:10240
    v_add_u32 v219, 155648, v219
    s_waitcnt lgkmcnt(10)
    v_mfma_f32_16x16x32_bf16 v[16:19], v[200:203], a[192:195], v[16:19]
    ds_read_b64_tr_b16 v[192:193], v237 offset:32768
    v_cvt_pk_bf16_f32 v182, v170, v171
    s_waitcnt lgkmcnt(9)
    v_mfma_f32_16x16x32_bf16 v[16:19], v[204:207], a[208:211], v[16:19]
    ds_read_b128 a[232:235], v232 offset:12288
    v_lshlrev_b32 v170, 16, v182
    v_mfma_f32_16x16x32_bf16 v[20:23], v[200:203], a[196:199], v[20:23]
    ds_read_b64_tr_b16 v[194:195], v237 offset:33792
    v_and_b32 v171, 0xffff0000, v182
    v_mfma_f32_16x16x32_bf16 v[20:23], v[204:207], a[212:215], v[20:23]
    ds_read_b128 a[248:251], v233 offset:12288
    v_mul_f32 v170, v170, v181
    v_mfma_f32_16x16x32_bf16 v[24:27], v[200:203], a[200:203], v[24:27]
    ds_read_b64_tr_b16 v[196:197], v237 offset:40960
    v_mul_f32 v171, v171, v181
    v_mfma_f32_16x16x32_bf16 v[24:27], v[204:207], a[216:219], v[24:27]
    ds_read_b128 a[236:239], v232 offset:14336
    v_cvt_pk_bf16_f32 v249, v170, v171
    v_mfma_f32_16x16x32_bf16 v[28:31], v[200:203], a[204:207], v[28:31]
    ds_read_b64_tr_b16 v[198:199], v237 offset:41984
    v_sub_f32 v172, v172, v177
    v_mfma_f32_16x16x32_bf16 v[28:31], v[204:207], a[220:223], v[28:31]
    ds_read_b128 a[252:255], v233 offset:14336
    v_sub_f32 v173, v173, v177
    s_waitcnt lgkmcnt(13)
    v_mfma_f32_16x16x32_bf16 v[32:35], v[208:211], a[192:195], v[32:35]
    ds_read_b64_tr_b16 v[200:201], v238 offset:32768
    v_cvt_pk_bf16_f32 v182, v172, v173
    s_waitcnt lgkmcnt(10)
    v_mfma_f32_16x16x32_bf16 v[32:35], v[212:215], a[208:211], v[32:35]
    ds_write_b128 v219, v[128:131]
    v_lshlrev_b32 v219, 5, v253
    v_mfma_f32_16x16x32_bf16 v[36:39], v[208:211], a[196:199], v[36:39]
    ds_read_b64_tr_b16 v[202:203], v238 offset:33792
    v_add_u32 v219, 155648, v219
    v_mfma_f32_16x16x32_bf16 v[36:39], v[212:215], a[212:215], v[36:39]
    v_lshlrev_b32 v172, 16, v182
    v_and_b32 v173, 0xffff0000, v182
    v_mfma_f32_16x16x32_bf16 v[40:43], v[208:211], a[200:203], v[40:43]
    ds_read_b64_tr_b16 v[204:205], v238 offset:40960
    v_mul_f32 v172, v172, v181
    v_mfma_f32_16x16x32_bf16 v[40:43], v[212:215], a[216:219], v[40:43]
    v_mul_f32 v173, v173, v181
    v_cvt_pk_bf16_f32 v250, v172, v173
    v_mfma_f32_16x16x32_bf16 v[44:47], v[208:211], a[204:207], v[44:47]
    ds_read_b64_tr_b16 v[206:207], v238 offset:41984
    v_sub_f32 v174, v174, v177
    v_mfma_f32_16x16x32_bf16 v[44:47], v[212:215], a[220:223], v[44:47]
    v_sub_f32 v175, v175, v177
    v_cvt_pk_bf16_f32 v182, v174, v175
    s_waitcnt lgkmcnt(10)
    v_mfma_f32_16x16x32_bf16 v[48:51], v[192:195], a[192:195], v[48:51]
    ds_read_b64_tr_b16 v[208:209], v239 offset:32768
    v_lshlrev_b32 v174, 16, v182
    s_waitcnt lgkmcnt(7)
    v_mfma_f32_16x16x32_bf16 v[48:51], v[196:199], a[208:211], v[48:51]
    v_and_b32 v175, 0xffff0000, v182
    v_mul_f32 v174, v174, v181
    v_mfma_f32_16x16x32_bf16 v[52:55], v[192:195], a[196:199], v[52:55]
    ds_read_b64_tr_b16 v[210:211], v239 offset:33792
    v_mul_f32 v175, v175, v181
    v_mfma_f32_16x16x32_bf16 v[52:55], v[196:199], a[212:215], v[52:55]
    v_cvt_pk_bf16_f32 v251, v174, v175
    s_lshr_b32 s51, s2, 2
    v_mfma_f32_16x16x32_bf16 v[56:59], v[192:195], a[200:203], v[56:59]
    ds_read_b64_tr_b16 v[212:213], v239 offset:40960
    s_lshl_b32 s51, s51, 15
    v_mfma_f32_16x16x32_bf16 v[56:59], v[196:199], a[216:219], v[56:59]
    s_and_b32 s52, s2, 3
    s_lshl_b32 s52, s52, 7
    v_mfma_f32_16x16x32_bf16 v[60:63], v[192:195], a[204:207], v[60:63]
    ds_read_b64_tr_b16 v[214:215], v239 offset:41984
    s_add_u32 s51, s51, s52
    v_mfma_f32_16x16x32_bf16 v[60:63], v[196:199], a[220:223], v[60:63]
    s_lshl_b32 s52, s40, 13
    s_add_u32 s51, s51, s52
    s_waitcnt lgkmcnt(6)
    v_mfma_f32_16x16x32_bf16 v[64:67], v[200:203], a[192:195], v[64:67]
    ds_read_b64_tr_b16 v[192:193], v240 offset:32768
    s_add_u32 s51, s51, 1048576
    s_waitcnt lgkmcnt(5)
    v_mfma_f32_16x16x32_bf16 v[64:67], v[204:207], a[208:211], v[64:67]
    buffer_load_dword v223, v222, s[4:7], s68 offen
    v_mfma_f32_16x16x32_bf16 v[68:71], v[200:203], a[196:199], v[68:71]
    ds_read_b64_tr_b16 v[194:195], v240 offset:33792
    v_mfma_f32_16x16x32_bf16 v[68:71], v[204:207], a[212:215], v[68:71]
    v_mfma_f32_16x16x32_bf16 v[72:75], v[200:203], a[200:203], v[72:75]
    ds_read_b64_tr_b16 v[196:197], v240 offset:40960
    v_mfma_f32_16x16x32_bf16 v[72:75], v[204:207], a[216:219], v[72:75]
    v_mfma_f32_16x16x32_bf16 v[76:79], v[200:203], a[204:207], v[76:79]
    ds_read_b64_tr_b16 v[198:199], v240 offset:41984
    v_mfma_f32_16x16x32_bf16 v[76:79], v[204:207], a[220:223], v[76:79]
    s_waitcnt vmcnt(5)
    s_barrier
    s_waitcnt lgkmcnt(6)
    v_mfma_f32_16x16x32_bf16 v[80:83], v[208:211], a[192:195], v[80:83]
    ds_read_b64_tr_b16 v[200:201], v241 offset:32768
    s_add_u32 s48, s54, 2
    s_waitcnt lgkmcnt(5)
    v_mfma_f32_16x16x32_bf16 v[80:83], v[212:215], a[208:211], v[80:83]
    s_and_b32 s48, s48, 7
    s_lshl_b32 s48, s48, 19
    v_mfma_f32_16x16x32_bf16 v[84:87], v[208:211], a[196:199], v[84:87]
    ds_read_b64_tr_b16 v[202:203], v241 offset:33792
    s_add_u32 s48, s48, s47
    v_mfma_f32_16x16x32_bf16 v[84:87], v[212:215], a[212:215], v[84:87]
    ds_read_b128 v[176:179], v219 offset:0
    s_add_u32 m0, s46, 16384
    v_mfma_f32_16x16x32_bf16 v[88:91], v[208:211], a[200:203], v[88:91]
    ds_read_b64_tr_b16 v[204:205], v241 offset:40960
    v_mfma_f32_16x16x32_bf16 v[88:91], v[212:215], a[216:219], v[88:91]
    buffer_load_dwordx4 v228, s[16:19], s48 offen offset:0 lds
    v_mfma_f32_16x16x32_bf16 v[92:95], v[208:211], a[204:207], v[92:95]
    ds_read_b64_tr_b16 v[206:207], v241 offset:41984
    v_mfma_f32_16x16x32_bf16 v[92:95], v[212:215], a[220:223], v[92:95]
    ds_read_b128 v[180:183], v219 offset:16
    s_waitcnt lgkmcnt(8)
    v_mfma_f32_16x16x32_bf16 v[96:99], v[192:195], a[192:195], v[96:99]
    ds_read_b64_tr_b16 v[208:209], v234 offset:49152
    s_waitcnt lgkmcnt(7)
    v_mfma_f32_16x16x32_bf16 v[96:99], v[196:199], a[208:211], v[96:99]
    buffer_load_dwordx4 v229, s[16:19], s48 offen offset:1024 lds
    v_mfma_f32_16x16x32_bf16 v[100:103], v[192:195], a[196:199], v[100:103]
    ds_read_b64_tr_b16 v[210:211], v234 offset:50176
    v_mfma_f32_16x16x32_bf16 v[100:103], v[196:199], a[212:215], v[100:103]
    ds_read_b128 v[184:187], v219 offset:2048
    v_mfma_f32_16x16x32_bf16 v[104:107], v[192:195], a[200:203], v[104:107]
    ds_read_b64_tr_b16 v[212:213], v234 offset:57344
    v_mfma_f32_16x16x32_bf16 v[104:107], v[196:199], a[216:219], v[104:107]
    buffer_load_dwordx4 v230, s[16:19], s48 offen offset:2048 lds
    v_mfma_f32_16x16x32_bf16 v[108:111], v[192:195], a[204:207], v[108:111]
    ds_read_b64_tr_b16 v[214:215], v234 offset:58368
    v_mfma_f32_16x16x32_bf16 v[108:111], v[196:199], a[220:223], v[108:111]
    ds_read_b128 v[188:191], v219 offset:2064
    v_lshlrev_b32 v232, 16, v244
    s_waitcnt lgkmcnt(10)
    v_mfma_f32_16x16x32_bf16 v[112:115], v[200:203], a[192:195], v[112:115]
    ds_read_b64_tr_b16 v[192:193], v235 offset:49152
    v_and_b32 v233, 0xffff0000, v244
    s_waitcnt lgkmcnt(8)
    v_mfma_f32_16x16x32_bf16 v[112:115], v[204:207], a[208:211], v[112:115]
    buffer_load_dwordx4 v231, s[16:19], s48 offen offset:3072 lds
    s_add_u32 s48, s54, 6
    v_mfma_f32_16x16x32_bf16 v[116:119], v[200:203], a[196:199], v[116:119]
    ds_read_b64_tr_b16 v[194:195], v235 offset:50176
    s_and_b32 s48, s48, 7
    v_mfma_f32_16x16x32_bf16 v[116:119], v[204:207], a[212:215], v[116:119]
    s_lshl_b32 s48, s48, 19
    s_add_u32 s48, s48, s47
    v_mfma_f32_16x16x32_bf16 v[120:123], v[200:203], a[200:203], v[120:123]
    ds_read_b64_tr_b16 v[196:197], v235 offset:57344
    s_add_u32 m0, s46, 65536
    v_mfma_f32_16x16x32_bf16 v[120:123], v[204:207], a[216:219], v[120:123]
    buffer_load_dwordx4 v228, s[16:19], s48 offen offset:0 lds
    s_waitcnt lgkmcnt(6)
    v_mul_f32 v232, v232, v184
    v_mfma_f32_16x16x32_bf16 v[124:127], v[200:203], a[204:207], v[124:127]
    ds_read_b64_tr_b16 v[198:199], v235 offset:58368
    v_mul_f32 v233, v233, v185
    v_mfma_f32_16x16x32_bf16 v[124:127], v[204:207], a[220:223], v[124:127]
    v_cvt_pk_bf16_f32 v219, v232, v233
    v_lshlrev_b32 v232, 16, v219
    v_mfma_f32_16x16x32_bf16 v[0:3], v[208:211], a[224:227], v[0:3]
    ds_read_b64_tr_b16 v[200:201], v236 offset:49152
    v_and_b32 v233, 0xffff0000, v219
    s_waitcnt lgkmcnt(6)
    v_mfma_f32_16x16x32_bf16 v[0:3], v[212:215], a[240:243], v[0:3]
    buffer_load_dwordx4 v229, s[16:19], s48 offen offset:1024 lds
    v_fmamk_f32 v232, v232, 0x3e0293ee, v176
    v_mfma_f32_16x16x32_bf16 v[4:7], v[208:211], a[228:231], v[4:7]
    ds_read_b64_tr_b16 v[202:203], v236 offset:50176
    v_fmamk_f32 v233, v233, 0x3e0293ee, v177
    v_mfma_f32_16x16x32_bf16 v[4:7], v[212:215], a[244:247], v[4:7]
    v_cvt_pk_bf16_f32 v244, v232, v233
    v_lshlrev_b32 v232, 16, v245
    v_mfma_f32_16x16x32_bf16 v[8:11], v[208:211], a[232:235], v[8:11]
    ds_read_b64_tr_b16 v[204:205], v236 offset:57344
    v_and_b32 v233, 0xffff0000, v245
    v_mfma_f32_16x16x32_bf16 v[8:11], v[212:215], a[248:251], v[8:11]
    buffer_load_dwordx4 v230, s[16:19], s48 offen offset:2048 lds
    v_mul_f32 v232, v232, v186
    v_mfma_f32_16x16x32_bf16 v[12:15], v[208:211], a[236:239], v[12:15]
    ds_read_b64_tr_b16 v[206:207], v236 offset:58368
    v_mul_f32 v233, v233, v187
    v_mfma_f32_16x16x32_bf16 v[12:15], v[212:215], a[252:255], v[12:15]
    v_cvt_pk_bf16_f32 v219, v232, v233
    v_lshlrev_b32 v232, 16, v219
    s_waitcnt lgkmcnt(6)
    v_mfma_f32_16x16x32_bf16 v[16:19], v[192:195], a[224:227], v[16:19]
    ds_read_b64_tr_b16 v[208:209], v237 offset:49152
    v_and_b32 v233, 0xffff0000, v219
    s_waitcnt lgkmcnt(5)
    v_mfma_f32_16x16x32_bf16 v[16:19], v[196:199], a[240:243], v[16:19]
    buffer_load_dwordx4 v231, s[16:19], s48 offen offset:3072 lds
    s_add_u32 s48, s54, 0
    v_mfma_f32_16x16x32_bf16 v[20:23], v[192:195], a[228:231], v[20:23]
    ds_read_b64_tr_b16 v[210:211], v237 offset:50176
    s_and_b32 s48, s48, 7
    v_mfma_f32_16x16x32_bf16 v[20:23], v[196:199], a[244:247], v[20:23]
    s_lshl_b32 s48, s48, 19
    s_add_u32 s48, s48, s47
    v_mfma_f32_16x16x32_bf16 v[24:27], v[192:195], a[232:235], v[24:27]
    ds_read_b64_tr_b16 v[212:213], v237 offset:57344
    s_add_u32 s48, s48, 128
    v_mfma_f32_16x16x32_bf16 v[24:27], v[196:199], a[248:251], v[24:27]
    s_add_u32 m0, s46, 81920
    v_fmamk_f32 v232, v232, 0x3e0293ee, v178
    v_mfma_f32_16x16x32_bf16 v[28:31], v[192:195], a[236:239], v[28:31]
    ds_read_b64_tr_b16 v[214:215], v237 offset:58368
    v_fmamk_f32 v233, v233, 0x3e0293ee, v179
    v_mfma_f32_16x16x32_bf16 v[28:31], v[196:199], a[252:255], v[28:31]
    buffer_load_dwordx4 v228, s[16:19], s48 offen offset:0 lds
    v_cvt_pk_bf16_f32 v245, v232, v233
    s_waitcnt lgkmcnt(6)
    v_mfma_f32_16x16x32_bf16 v[32:35], v[200:203], a[224:227], v[32:35]
    ds_read_b64_tr_b16 v[192:193], v238 offset:49152
    v_lshlrev_b32 v232, 16, v246
    s_waitcnt lgkmcnt(5)
    v_mfma_f32_16x16x32_bf16 v[32:35], v[204:207], a[240:243], v[32:35]
    v_and_b32 v233, 0xffff0000, v246
    v_mul_f32 v232, v232, v188
    v_mfma_f32_16x16x32_bf16 v[36:39], v[200:203], a[228:231], v[36:39]
    ds_read_b64_tr_b16 v[194:195], v238 offset:50176
    v_mul_f32 v233, v233, v189
    v_mfma_f32_16x16x32_bf16 v[36:39], v[204:207], a[244:247], v[36:39]
    buffer_load_dwordx4 v229, s[16:19], s48 offen offset:1024 lds
    v_cvt_pk_bf16_f32 v219, v232, v233
    v_mfma_f32_16x16x32_bf16 v[40:43], v[200:203], a[232:235], v[40:43]
    ds_read_b64_tr_b16 v[196:197], v238 offset:57344
    v_lshlrev_b32 v232, 16, v219
    v_mfma_f32_16x16x32_bf16 v[40:43], v[204:207], a[248:251], v[40:43]
    v_and_b32 v233, 0xffff0000, v219
    v_fmamk_f32 v232, v232, 0x3e0293ee, v180
    v_mfma_f32_16x16x32_bf16 v[44:47], v[200:203], a[236:239], v[44:47]
    ds_read_b64_tr_b16 v[198:199], v238 offset:58368
    v_fmamk_f32 v233, v233, 0x3e0293ee, v181
    v_mfma_f32_16x16x32_bf16 v[44:47], v[204:207], a[252:255], v[44:47]
    buffer_load_dwordx4 v230, s[16:19], s48 offen offset:2048 lds
    v_cvt_pk_bf16_f32 v246, v232, v233
    s_waitcnt lgkmcnt(6)
    v_mfma_f32_16x16x32_bf16 v[48:51], v[208:211], a[224:227], v[48:51]
    ds_read_b64_tr_b16 v[200:201], v239 offset:49152
    v_lshlrev_b32 v232, 16, v247
    s_waitcnt lgkmcnt(5)
    v_mfma_f32_16x16x32_bf16 v[48:51], v[212:215], a[240:243], v[48:51]
    v_and_b32 v233, 0xffff0000, v247
    v_mul_f32 v232, v232, v190
    v_mfma_f32_16x16x32_bf16 v[52:55], v[208:211], a[228:231], v[52:55]
    ds_read_b64_tr_b16 v[202:203], v239 offset:50176
    v_mul_f32 v233, v233, v191
    v_mfma_f32_16x16x32_bf16 v[52:55], v[212:215], a[244:247], v[52:55]
    buffer_load_dwordx4 v231, s[16:19], s48 offen offset:3072 lds
    s_add_u32 s48, s54, 2
    v_mfma_f32_16x16x32_bf16 v[56:59], v[208:211], a[232:235], v[56:59]
    ds_read_b64_tr_b16 v[204:205], v239 offset:57344
    s_and_b32 s48, s48, 7
    v_mfma_f32_16x16x32_bf16 v[56:59], v[212:215], a[248:251], v[56:59]
    s_lshl_b32 s48, s48, 19
    s_add_u32 s48, s48, s47
    v_mfma_f32_16x16x32_bf16 v[60:63], v[208:211], a[236:239], v[60:63]
    ds_read_b64_tr_b16 v[206:207], v239 offset:58368
    s_add_u32 s48, s48, 128
    v_mfma_f32_16x16x32_bf16 v[60:63], v[212:215], a[252:255], v[60:63]
    s_add_u32 m0, s46, 98304
    v_cvt_pk_bf16_f32 v219, v232, v233
    s_waitcnt lgkmcnt(6)
    v_mfma_f32_16x16x32_bf16 v[64:67], v[192:195], a[224:227], v[64:67]
    ds_read_b64_tr_b16 v[208:209], v240 offset:49152
    v_lshlrev_b32 v232, 16, v219
    s_waitcnt lgkmcnt(5)
    v_mfma_f32_16x16x32_bf16 v[64:67], v[196:199], a[240:243], v[64:67]
    buffer_load_dwordx4 v228, s[16:19], s48 offen offset:0 lds
    v_and_b32 v233, 0xffff0000, v219
    v_mfma_f32_16x16x32_bf16 v[68:71], v[192:195], a[228:231], v[68:71]
    ds_read_b64_tr_b16 v[210:211], v240 offset:50176
    v_fmamk_f32 v232, v232, 0x3e0293ee, v182
    v_mfma_f32_16x16x32_bf16 v[68:71], v[196:199], a[244:247], v[68:71]
    v_fmamk_f32 v233, v233, 0x3e0293ee, v183
    v_cvt_pk_bf16_f32 v247, v232, v233
    v_mfma_f32_16x16x32_bf16 v[72:75], v[192:195], a[232:235], v[72:75]
    ds_read_b64_tr_b16 v[212:213], v240 offset:57344
    v_mfma_f32_16x16x32_bf16 v[72:75], v[196:199], a[248:251], v[72:75]
    buffer_load_dwordx4 v229, s[16:19], s48 offen offset:1024 lds
    v_mfma_f32_16x16x32_bf16 v[76:79], v[192:195], a[236:239], v[76:79]
    ds_read_b64_tr_b16 v[214:215], v240 offset:58368
    v_mfma_f32_16x16x32_bf16 v[76:79], v[196:199], a[252:255], v[76:79]
    ds_write_b128 v252, v[244:247]
    v_xor_b32 v252, 16, v252
    s_waitcnt vmcnt(15) lgkmcnt(0)
    s_barrier
    v_mfma_f32_16x16x32_bf16 v[80:83], v[200:203], a[224:227], v[80:83]
    ds_read_b64_tr_b16 v[192:193], v241 offset:49152
    v_lshlrev_b32 v232, 16, v248
    v_mfma_f32_16x16x32_bf16 v[80:83], v[204:207], a[240:243], v[80:83]
    buffer_load_dwordx4 v230, s[16:19], s48 offen offset:2048 lds
    v_and_b32 v233, 0xffff0000, v248
    v_mfma_f32_16x16x32_bf16 v[84:87], v[200:203], a[228:231], v[84:87]
    ds_read_b64_tr_b16 v[194:195], v241 offset:50176
    v_mul_f32 v232, v232, v184
    v_mfma_f32_16x16x32_bf16 v[84:87], v[204:207], a[244:247], v[84:87]
    v_mul_f32 v233, v233, v185
    v_cvt_pk_bf16_f32 v219, v232, v233
    v_mfma_f32_16x16x32_bf16 v[88:91], v[200:203], a[232:235], v[88:91]
    ds_read_b64_tr_b16 v[196:197], v241 offset:57344
    v_lshlrev_b32 v232, 16, v219
    v_mfma_f32_16x16x32_bf16 v[88:91], v[204:207], a[248:251], v[88:91]
    buffer_load_dwordx4 v231, s[16:19], s48 offen offset:3072 lds
    s_add_u32 s48, s54, 4
    v_mfma_f32_16x16x32_bf16 v[92:95], v[200:203], a[236:239], v[92:95]
    ds_read_b64_tr_b16 v[198:199], v241 offset:58368
    s_and_b32 s48, s48, 7
    v_mfma_f32_16x16x32_bf16 v[92:95], v[204:207], a[252:255], v[92:95]
    s_lshl_b32 s48, s48, 19
    s_add_u32 s48, s48, s47
    v_mfma_f32_16x16x32_bf16 v[96:99], v[208:211], a[224:227], v[96:99]
    ds_read_b64_tr_b16 v[200:201], v224 offset:0
    s_add_u32 m0, s46, 32768
    v_mfma_f32_16x16x32_bf16 v[96:99], v[212:215], a[240:243], v[96:99]
    buffer_load_dwordx4 v228, s[16:19], s48 offen offset:0 lds
    v_and_b32 v233, 0xffff0000, v219
    v_mfma_f32_16x16x32_bf16 v[100:103], v[208:211], a[228:231], v[100:103]
    ds_read_b64_tr_b16 v[202:203], v224 offset:512
    v_fmamk_f32 v232, v232, 0x3e0293ee, v176
    v_mfma_f32_16x16x32_bf16 v[100:103], v[212:215], a[244:247], v[100:103]
    v_fmamk_f32 v233, v233, 0x3e0293ee, v177
    v_cvt_pk_bf16_f32 v248, v232, v233
    v_mfma_f32_16x16x32_bf16 v[104:107], v[208:211], a[232:235], v[104:107]
    ds_read_b64_tr_b16 v[204:205], v224 offset:4096
    v_lshlrev_b32 v232, 16, v249
    v_mfma_f32_16x16x32_bf16 v[104:107], v[212:215], a[248:251], v[104:107]
    buffer_load_dwordx4 v229, s[16:19], s48 offen offset:1024 lds
    v_and_b32 v233, 0xffff0000, v249
    v_mfma_f32_16x16x32_bf16 v[108:111], v[208:211], a[236:239], v[108:111]
    ds_read_b64_tr_b16 v[206:207], v224 offset:4608
    v_mul_f32 v232, v232, v186
    v_mfma_f32_16x16x32_bf16 v[108:111], v[212:215], a[252:255], v[108:111]
    v_mul_f32 v233, v233, v187
    v_cvt_pk_bf16_f32 v219, v232, v233
    s_waitcnt lgkmcnt(6)
    v_mfma_f32_16x16x32_bf16 v[112:115], v[192:195], a[224:227], v[112:115]
    ds_read_b64_tr_b16 v[208:209], v225 offset:0
    v_lshlrev_b32 v232, 16, v219
    s_waitcnt lgkmcnt(5)
    v_mfma_f32_16x16x32_bf16 v[112:115], v[196:199], a[240:243], v[112:115]
    buffer_load_dwordx4 v230, s[16:19], s48 offen offset:2048 lds
    v_and_b32 v233, 0xffff0000, v219
    v_mfma_f32_16x16x32_bf16 v[116:119], v[192:195], a[228:231], v[116:119]
    ds_read_b64_tr_b16 v[210:211], v225 offset:512
    v_fmamk_f32 v232, v232, 0x3e0293ee, v178
    v_mfma_f32_16x16x32_bf16 v[116:119], v[196:199], a[244:247], v[116:119]
    v_fmamk_f32 v233, v233, 0x3e0293ee, v179
    v_cvt_pk_bf16_f32 v249, v232, v233
    v_mfma_f32_16x16x32_bf16 v[120:123], v[192:195], a[232:235], v[120:123]
    ds_read_b64_tr_b16 v[212:213], v225 offset:4096
    v_lshlrev_b32 v232, 16, v250
    v_mfma_f32_16x16x32_bf16 v[120:123], v[196:199], a[248:251], v[120:123]
    buffer_load_dwordx4 v231, s[16:19], s48 offen offset:3072 lds
    s_add_u32 s48, s54, 4
    v_mfma_f32_16x16x32_bf16 v[124:127], v[192:195], a[236:239], v[124:127]
    ds_read_b64_tr_b16 v[214:215], v225 offset:4608
    s_and_b32 s48, s48, 7
    v_mfma_f32_16x16x32_bf16 v[124:127], v[196:199], a[252:255], v[124:127]
    s_lshl_b32 s48, s48, 19
    s_add_u32 s48, s48, s47
    s_waitcnt lgkmcnt(6)
    v_mfma_f32_16x16x32_bf16 v[128:131], a[0:3], v[200:203], 0
    ds_read_b64_tr_b16 v[192:193], v226 offset:0
    s_add_u32 s48, s48, 128
    s_waitcnt lgkmcnt(5)
    v_mfma_f32_16x16x32_bf16 v[128:131], a[16:19], v[204:207], v[128:131]
    s_add_u32 m0, s46, 114688
    v_and_b32 v233, 0xffff0000, v250
    v_mfma_f32_16x16x32_bf16 v[132:135], a[4:7], v[200:203], 0
    ds_read_b64_tr_b16 v[194:195], v226 offset:512
    v_add_u32 v234, 0x10000, v224
    v_mfma_f32_16x16x32_bf16 v[132:135], a[20:23], v[204:207], v[132:135]
    buffer_load_dwordx4 v228, s[16:19], s48 offen offset:0 lds
    v_add_u32 v235, 0x10000, v225
    v_mfma_f32_16x16x32_bf16 v[136:139], a[8:11], v[200:203], 0
    ds_read_b64_tr_b16 v[196:197], v226 offset:4096
    v_add_u32 v236, 0x10000, v226
    v_mfma_f32_16x16x32_bf16 v[136:139], a[24:27], v[204:207], v[136:139]
    v_add_u32 v237, 0x10000, v227
    v_mul_f32 v232, v232, v188
    v_mfma_f32_16x16x32_bf16 v[140:143], a[12:15], v[200:203], 0
    ds_read_b64_tr_b16 v[198:199], v226 offset:4608
    v_mul_f32 v233, v233, v189
    v_mfma_f32_16x16x32_bf16 v[140:143], a[28:31], v[204:207], v[140:143]
    buffer_load_dwordx4 v229, s[16:19], s48 offen offset:1024 lds
    v_cvt_pk_bf16_f32 v219, v232, v233
    s_waitcnt lgkmcnt(6)
    v_mfma_f32_16x16x32_bf16 v[144:147], a[0:3], v[208:211], 0
    ds_read_b64_tr_b16 v[200:201], v227 offset:0
    v_lshlrev_b32 v232, 16, v219
    s_waitcnt lgkmcnt(5)
    v_mfma_f32_16x16x32_bf16 v[144:147], a[16:19], v[212:215], v[144:147]
    v_and_b32 v233, 0xffff0000, v219
    v_fmamk_f32 v232, v232, 0x3e0293ee, v180
    v_mfma_f32_16x16x32_bf16 v[148:151], a[4:7], v[208:211], 0
    ds_read_b64_tr_b16 v[202:203], v227 offset:512
    v_fmamk_f32 v233, v233, 0x3e0293ee, v181
    v_mfma_f32_16x16x32_bf16 v[148:151], a[20:23], v[212:215], v[148:151]
    buffer_load_dwordx4 v230, s[16:19], s48 offen offset:2048 lds
    v_cvt_pk_bf16_f32 v250, v232, v233
    v_mfma_f32_16x16x32_bf16 v[152:155], a[8:11], v[208:211], 0
    ds_read_b64_tr_b16 v[204:205], v227 offset:4096
    v_lshlrev_b32 v232, 16, v251
    v_mfma_f32_16x16x32_bf16 v[152:155], a[24:27], v[212:215], v[152:155]
    v_and_b32 v233, 0xffff0000, v251
    v_mul_f32 v232, v232, v190
    v_mfma_f32_16x16x32_bf16 v[156:159], a[12:15], v[208:211], 0
    ds_read_b64_tr_b16 v[206:207], v227 offset:4608
    v_mul_f32 v233, v233, v191
    v_mfma_f32_16x16x32_bf16 v[156:159], a[28:31], v[212:215], v[156:159]
    buffer_load_dwordx4 v231, s[16:19], s48 offen offset:3072 lds
    v_cvt_pk_bf16_f32 v219, v232, v233
    s_waitcnt lgkmcnt(6)
    v_mfma_f32_16x16x32_bf16 v[160:163], a[0:3], v[192:195], 0
    ds_read_b64_tr_b16 v[208:209], v224 offset:8192
    v_lshlrev_b32 v232, 16, v219
    s_waitcnt lgkmcnt(5)
    v_mfma_f32_16x16x32_bf16 v[160:163], a[16:19], v[196:199], v[160:163]
    v_and_b32 v233, 0xffff0000, v219
    v_fmamk_f32 v232, v232, 0x3e0293ee, v182
    v_mfma_f32_16x16x32_bf16 v[164:167], a[4:7], v[192:195], 0
    ds_read_b64_tr_b16 v[210:211], v224 offset:8704
    v_fmamk_f32 v233, v233, 0x3e0293ee, v183
    v_mfma_f32_16x16x32_bf16 v[164:167], a[20:23], v[196:199], v[164:167]
    v_cvt_pk_bf16_f32 v251, v232, v233
    v_mfma_f32_16x16x32_bf16 v[168:171], a[8:11], v[192:195], 0
    ds_read_b64_tr_b16 v[212:213], v224 offset:12288
    v_mfma_f32_16x16x32_bf16 v[168:171], a[24:27], v[196:199], v[168:171]
    ds_write_b128 v252, v[248:251]
    v_mfma_f32_16x16x32_bf16 v[172:175], a[12:15], v[192:195], 0
    ds_read_b64_tr_b16 v[214:215], v224 offset:12800
    v_lshrrev_b32 v232, 3, v253
    v_mfma_f32_16x16x32_bf16 v[172:175], a[28:31], v[196:199], v[172:175]
    v_and_b32 v233, 7, v253
    v_xor_b32 v219, v232, v233
    s_waitcnt lgkmcnt(7)
    v_mfma_f32_16x16x32_bf16 v[176:179], a[0:3], v[200:203], 0
    ds_read_b64_tr_b16 v[192:193], v225 offset:8192
    v_lshlrev_b32 v219, 4, v219
    s_waitcnt lgkmcnt(6)
    v_mfma_f32_16x16x32_bf16 v[176:179], a[16:19], v[204:207], v[176:179]
    v_lshl_add_u32 v219, v232, 7, v219
    s_lshl_b32 s52, s40, 11
    v_mfma_f32_16x16x32_bf16 v[180:183], a[4:7], v[200:203], 0
    ds_read_b64_tr_b16 v[194:195], v225 offset:8704
    s_add_u32 s52, s52, 147456
    v_mfma_f32_16x16x32_bf16 v[180:183], a[20:23], v[204:207], v[180:183]
    v_add_u32 v219, s52, v219
    v_lshlrev_b32 v233, 4, v233
    v_mfma_f32_16x16x32_bf16 v[184:187], a[8:11], v[200:203], 0
    ds_read_b64_tr_b16 v[196:197], v225 offset:12288
    v_lshl_add_u32 v252, v232, 9, v233
    v_mfma_f32_16x16x32_bf16 v[184:187], a[24:27], v[204:207], v[184:187]
    s_add_u32 s52, s51, 4096
    v_mfma_f32_16x16x32_bf16 v[188:191], a[12:15], v[200:203], 0
    ds_read_b64_tr_b16 v[198:199], v225 offset:12800
    v_mfma_f32_16x16x32_bf16 v[188:191], a[28:31], v[204:207], v[188:191]
    s_waitcnt lgkmcnt(7)
    v_mfma_f32_16x16x32_bf16 v[128:131], a[32:35], v[208:211], v[128:131]
    ds_read_b64_tr_b16 v[200:201], v226 offset:8192
    s_waitcnt lgkmcnt(5)
    v_mfma_f32_16x16x32_bf16 v[128:131], a[48:51], v[212:215], v[128:131]
    v_mfma_f32_16x16x32_bf16 v[132:135], a[36:39], v[208:211], v[132:135]
    ds_read_b64_tr_b16 v[202:203], v226 offset:8704
    v_mfma_f32_16x16x32_bf16 v[132:135], a[52:55], v[212:215], v[132:135]
    v_mfma_f32_16x16x32_bf16 v[136:139], a[40:43], v[208:211], v[136:139]
    ds_read_b64_tr_b16 v[204:205], v226 offset:12288
    v_mfma_f32_16x16x32_bf16 v[136:139], a[56:59], v[212:215], v[136:139]
    v_mfma_f32_16x16x32_bf16 v[140:143], a[44:47], v[208:211], v[140:143]
    ds_read_b64_tr_b16 v[206:207], v226 offset:12800
    v_mfma_f32_16x16x32_bf16 v[140:143], a[60:63], v[212:215], v[140:143]
    s_waitcnt vmcnt(20)
    s_barrier
    s_waitcnt lgkmcnt(6)
    v_mfma_f32_16x16x32_bf16 v[144:147], a[32:35], v[192:195], v[144:147]
    ds_read_b64_tr_b16 v[208:209], v227 offset:8192
    s_add_u32 s48, s54, 6
    s_waitcnt lgkmcnt(5)
    v_mfma_f32_16x16x32_bf16 v[144:147], a[48:51], v[196:199], v[144:147]
    s_and_b32 s48, s48, 7
    s_lshl_b32 s48, s48, 19
    v_mfma_f32_16x16x32_bf16 v[148:151], a[36:39], v[192:195], v[148:151]
    ds_read_b64_tr_b16 v[210:211], v227 offset:8704
    s_add_u32 s48, s48, s47
    v_mfma_f32_16x16x32_bf16 v[148:151], a[52:55], v[196:199], v[148:151]
    s_add_u32 s48, s48, 128
    s_add_u32 m0, s46, 49152
    v_mfma_f32_16x16x32_bf16 v[152:155], a[40:43], v[192:195], v[152:155]
    ds_read_b64_tr_b16 v[212:213], v227 offset:12288
    v_mfma_f32_16x16x32_bf16 v[152:155], a[56:59], v[196:199], v[152:155]
    buffer_load_dwordx4 v228, s[16:19], s48 offen offset:0 lds
    v_mfma_f32_16x16x32_bf16 v[156:159], a[44:47], v[192:195], v[156:159]
    ds_read_b64_tr_b16 v[214:215], v227 offset:12800
    v_mfma_f32_16x16x32_bf16 v[156:159], a[60:63], v[196:199], v[156:159]
    ds_read_b128 v[244:247], v219 offset:0
    s_waitcnt lgkmcnt(7)
    v_mfma_f32_16x16x32_bf16 v[160:163], a[32:35], v[200:203], v[160:163]
    ds_read_b64_tr_b16 v[192:193], v224 offset:16384
    s_waitcnt lgkmcnt(6)
    v_mfma_f32_16x16x32_bf16 v[160:163], a[48:51], v[204:207], v[160:163]
    buffer_load_dwordx4 v229, s[16:19], s48 offen offset:1024 lds
    v_mfma_f32_16x16x32_bf16 v[164:167], a[36:39], v[200:203], v[164:167]
    ds_read_b64_tr_b16 v[194:195], v224 offset:16896
    v_mfma_f32_16x16x32_bf16 v[164:167], a[52:55], v[204:207], v[164:167]
    ds_read_b128 v[248:251], v219 offset:1024
    v_mfma_f32_16x16x32_bf16 v[168:171], a[40:43], v[200:203], v[168:171]
    ds_read_b64_tr_b16 v[196:197], v224 offset:20480
    v_mfma_f32_16x16x32_bf16 v[168:171], a[56:59], v[204:207], v[168:171]
    buffer_load_dwordx4 v230, s[16:19], s48 offen offset:2048 lds
    v_mfma_f32_16x16x32_bf16 v[172:175], a[44:47], v[200:203], v[172:175]
    ds_read_b64_tr_b16 v[198:199], v224 offset:20992
    v_mfma_f32_16x16x32_bf16 v[172:175], a[60:63], v[204:207], v[172:175]
    s_waitcnt lgkmcnt(8)
    v_mfma_f32_16x16x32_bf16 v[176:179], a[32:35], v[208:211], v[176:179]
    ds_read_b64_tr_b16 v[200:201], v225 offset:16384
    s_waitcnt lgkmcnt(7)
    v_mfma_f32_16x16x32_bf16 v[176:179], a[48:51], v[212:215], v[176:179]
    buffer_load_dwordx4 v231, s[16:19], s48 offen offset:3072 lds
    v_mfma_f32_16x16x32_bf16 v[180:183], a[36:39], v[208:211], v[180:183]
    ds_read_b64_tr_b16 v[202:203], v225 offset:16896
    v_mfma_f32_16x16x32_bf16 v[180:183], a[52:55], v[212:215], v[180:183]
    v_mfma_f32_16x16x32_bf16 v[184:187], a[40:43], v[208:211], v[184:187]
    ds_read_b64_tr_b16 v[204:205], v225 offset:20480
    v_mfma_f32_16x16x32_bf16 v[184:187], a[56:59], v[212:215], v[184:187]
    s_waitcnt lgkmcnt(8)
    buffer_store_dwordx4 v[244:247], v252, s[20:23], s51 offen sc1
    v_mfma_f32_16x16x32_bf16 v[188:191], a[44:47], v[208:211], v[188:191]
    ds_read_b64_tr_b16 v[206:207], v225 offset:20992
    v_mfma_f32_16x16x32_bf16 v[188:191], a[60:63], v[212:215], v[188:191]
    s_waitcnt lgkmcnt(7)
    v_mfma_f32_16x16x32_bf16 v[128:131], a[64:67], v[192:195], v[128:131]
    ds_read_b64_tr_b16 v[208:209], v226 offset:16384
    s_waitcnt lgkmcnt(5)
    v_mfma_f32_16x16x32_bf16 v[128:131], a[80:83], v[196:199], v[128:131]
    buffer_store_dwordx4 v[248:251], v252, s[20:23], s52 offen sc1
    v_mfma_f32_16x16x32_bf16 v[132:135], a[68:71], v[192:195], v[132:135]
    ds_read_b64_tr_b16 v[210:211], v226 offset:16896
    v_cvt_pk_bf16_f32 v0, v0, v1
    v_mfma_f32_16x16x32_bf16 v[132:135], a[84:87], v[196:199], v[132:135]
    v_cvt_pk_bf16_f32 v1, v2, v3
    v_cvt_pk_bf16_f32 v2, v16, v17
    v_mfma_f32_16x16x32_bf16 v[136:139], a[72:75], v[192:195], v[136:139]
    ds_read_b64_tr_b16 v[212:213], v226 offset:20480
    v_cvt_pk_bf16_f32 v3, v18, v19
    v_mfma_f32_16x16x32_bf16 v[136:139], a[88:91], v[196:199], v[136:139]
    buffer_store_dwordx4 v[0:3], v242, s[20:23], s56 offen offset:0 sc1
    v_lshlrev_b32 v229, 4, v253
    v_mfma_f32_16x16x32_bf16 v[140:143], a[76:79], v[192:195], v[140:143]
    ds_read_b64_tr_b16 v[214:215], v226 offset:20992
    v_mov_b32 v231, v216
    v_mfma_f32_16x16x32_bf16 v[140:143], a[92:95], v[196:199], v[140:143]
    v_mov_b32 v248, v217
    v_xor_b32 v249, 64, v217
    s_waitcnt lgkmcnt(6)
    v_mfma_f32_16x16x32_bf16 v[144:147], a[64:67], v[200:203], v[144:147]
    ds_read_b64_tr_b16 v[192:193], v227 offset:16384
    v_xor_b32 v250, 128, v217
    s_waitcnt lgkmcnt(5)
    v_mfma_f32_16x16x32_bf16 v[144:147], a[80:83], v[204:207], v[144:147]
    v_xor_b32 v251, 192, v217
    v_mfma_f32_16x16x32_bf16 v[148:151], a[68:71], v[200:203], v[148:151]
    ds_read_b64_tr_b16 v[194:195], v227 offset:16896
    v_mfma_f32_16x16x32_bf16 v[148:151], a[84:87], v[204:207], v[148:151]
    v_mfma_f32_16x16x32_bf16 v[152:155], a[72:75], v[200:203], v[152:155]
    ds_read_b64_tr_b16 v[196:197], v227 offset:20480
    v_mfma_f32_16x16x32_bf16 v[152:155], a[88:91], v[204:207], v[152:155]
    v_cvt_pk_bf16_f32 v4, v4, v5
    v_cvt_pk_bf16_f32 v5, v6, v7
    v_mfma_f32_16x16x32_bf16 v[156:159], a[76:79], v[200:203], v[156:159]
    ds_read_b64_tr_b16 v[198:199], v227 offset:20992
    v_cvt_pk_bf16_f32 v6, v20, v21
    v_mfma_f32_16x16x32_bf16 v[156:159], a[92:95], v[204:207], v[156:159]
    v_cvt_pk_bf16_f32 v7, v22, v23
    s_waitcnt lgkmcnt(6)
    v_mfma_f32_16x16x32_bf16 v[160:163], a[64:67], v[208:211], v[160:163]
    ds_read_b64_tr_b16 v[200:201], v224 offset:24576
    s_waitcnt lgkmcnt(5)
    v_mfma_f32_16x16x32_bf16 v[160:163], a[80:83], v[212:215], v[160:163]
    buffer_store_dwordx4 v[4:7], v242, s[20:23], s56 offen offset:128 sc1
    v_mfma_f32_16x16x32_bf16 v[164:167], a[68:71], v[208:211], v[164:167]
    ds_read_b64_tr_b16 v[202:203], v224 offset:25088
    v_mfma_f32_16x16x32_bf16 v[164:167], a[84:87], v[212:215], v[164:167]
    v_mfma_f32_16x16x32_bf16 v[168:171], a[72:75], v[208:211], v[168:171]
    ds_read_b64_tr_b16 v[204:205], v224 offset:28672
    v_mfma_f32_16x16x32_bf16 v[168:171], a[88:91], v[212:215], v[168:171]
    v_mfma_f32_16x16x32_bf16 v[172:175], a[76:79], v[208:211], v[172:175]
    ds_read_b64_tr_b16 v[206:207], v224 offset:29184
    v_mfma_f32_16x16x32_bf16 v[172:175], a[92:95], v[212:215], v[172:175]
    s_waitcnt lgkmcnt(6)
    v_mfma_f32_16x16x32_bf16 v[176:179], a[64:67], v[192:195], v[176:179]
    ds_read_b64_tr_b16 v[208:209], v225 offset:24576
    v_cvt_pk_bf16_f32 v8, v8, v9
    s_waitcnt lgkmcnt(5)
    v_mfma_f32_16x16x32_bf16 v[176:179], a[80:83], v[196:199], v[176:179]
    v_cvt_pk_bf16_f32 v9, v10, v11
    v_cvt_pk_bf16_f32 v10, v24, v25
    v_mfma_f32_16x16x32_bf16 v[180:183], a[68:71], v[192:195], v[180:183]
    ds_read_b64_tr_b16 v[210:211], v225 offset:25088
    v_cvt_pk_bf16_f32 v11, v26, v27
    v_mfma_f32_16x16x32_bf16 v[180:183], a[84:87], v[196:199], v[180:183]
    buffer_store_dwordx4 v[8:11], v242, s[20:23], s58 offen offset:0 sc1
    v_mfma_f32_16x16x32_bf16 v[184:187], a[72:75], v[192:195], v[184:187]
    ds_read_b64_tr_b16 v[212:213], v225 offset:28672
    v_mfma_f32_16x16x32_bf16 v[184:187], a[88:91], v[196:199], v[184:187]
    v_mfma_f32_16x16x32_bf16 v[188:191], a[76:79], v[192:195], v[188:191]
    ds_read_b64_tr_b16 v[214:215], v225 offset:29184
    v_mfma_f32_16x16x32_bf16 v[188:191], a[92:95], v[196:199], v[188:191]
    s_waitcnt lgkmcnt(6)
    v_mfma_f32_16x16x32_bf16 v[128:131], a[96:99], v[200:203], v[128:131]
    ds_read_b64_tr_b16 v[192:193], v226 offset:24576
    s_waitcnt lgkmcnt(5)
    v_mfma_f32_16x16x32_bf16 v[128:131], a[112:115], v[204:207], v[128:131]
    v_mfma_f32_16x16x32_bf16 v[132:135], a[100:103], v[200:203], v[132:135]
    ds_read_b64_tr_b16 v[194:195], v226 offset:25088
    v_mfma_f32_16x16x32_bf16 v[132:135], a[116:119], v[204:207], v[132:135]
    v_cvt_pk_bf16_f32 v12, v12, v13
    v_cvt_pk_bf16_f32 v13, v14, v15
    v_mfma_f32_16x16x32_bf16 v[136:139], a[104:107], v[200:203], v[136:139]
    ds_read_b64_tr_b16 v[196:197], v226 offset:28672
    v_cvt_pk_bf16_f32 v14, v28, v29
    v_mfma_f32_16x16x32_bf16 v[136:139], a[120:123], v[204:207], v[136:139]
    v_cvt_pk_bf16_f32 v15, v30, v31
    v_mfma_f32_16x16x32_bf16 v[140:143], a[108:111], v[200:203], v[140:143]
    ds_read_b64_tr_b16 v[198:199], v226 offset:29184
    v_mfma_f32_16x16x32_bf16 v[140:143], a[124:127], v[204:207], v[140:143]
    buffer_store_dwordx4 v[12:15], v242, s[20:23], s58 offen offset:128 sc1
    s_waitcnt vmcnt(14)
    s_barrier
    s_waitcnt lgkmcnt(6)
    v_mfma_f32_16x16x32_bf16 v[144:147], a[96:99], v[208:211], v[144:147]
    ds_read_b64_tr_b16 v[200:201], v227 offset:24576
    s_add_u32 m0, s46, 0
    s_waitcnt lgkmcnt(5)
    v_mfma_f32_16x16x32_bf16 v[144:147], a[112:115], v[212:215], v[144:147]
    s_add_u32 s8, s45, 0
    v_mfma_f32_16x16x32_bf16 v[148:151], a[100:103], v[208:211], v[148:151]
    ds_read_b64_tr_b16 v[202:203], v227 offset:25088
    v_mfma_f32_16x16x32_bf16 v[148:151], a[116:119], v[212:215], v[148:151]
    buffer_load_dwordx4 v231, s[4:7], s8 offen offset:0 lds
    s_add_u32 s8, s8, 31744
    v_mfma_f32_16x16x32_bf16 v[152:155], a[104:107], v[208:211], v[152:155]
    ds_read_b64_tr_b16 v[204:205], v227 offset:28672
    v_mfma_f32_16x16x32_bf16 v[152:155], a[120:123], v[212:215], v[152:155]
    v_mfma_f32_16x16x32_bf16 v[156:159], a[108:111], v[208:211], v[156:159]
    ds_read_b64_tr_b16 v[206:207], v227 offset:29184
    v_cvt_pk_bf16_f32 v32, v32, v33
    v_mfma_f32_16x16x32_bf16 v[156:159], a[124:127], v[212:215], v[156:159]
    v_cvt_pk_bf16_f32 v33, v34, v35
    v_cvt_pk_bf16_f32 v34, v48, v49
    s_waitcnt lgkmcnt(6)
    v_mfma_f32_16x16x32_bf16 v[160:163], a[96:99], v[192:195], v[160:163]
    ds_read_b64_tr_b16 v[208:209], v224 offset:32768
    v_cvt_pk_bf16_f32 v35, v50, v51
    s_waitcnt lgkmcnt(5)
    v_mfma_f32_16x16x32_bf16 v[160:163], a[112:115], v[196:199], v[160:163]
    buffer_store_dwordx4 v[32:35], v242, s[20:23], s56 offen offset:2048 sc1
    v_mfma_f32_16x16x32_bf16 v[164:167], a[100:103], v[192:195], v[164:167]
    ds_read_b64_tr_b16 v[210:211], v224 offset:33280
    v_mfma_f32_16x16x32_bf16 v[164:167], a[116:119], v[196:199], v[164:167]
    buffer_load_dwordx4 v231, s[4:7], s8 offen offset:1024 lds
    s_add_u32 s8, s8, 31744
    v_mfma_f32_16x16x32_bf16 v[168:171], a[104:107], v[192:195], v[168:171]
    ds_read_b64_tr_b16 v[212:213], v224 offset:36864
    v_mfma_f32_16x16x32_bf16 v[168:171], a[120:123], v[196:199], v[168:171]
    v_mfma_f32_16x16x32_bf16 v[172:175], a[108:111], v[192:195], v[172:175]
    ds_read_b64_tr_b16 v[214:215], v224 offset:37376
    v_mfma_f32_16x16x32_bf16 v[172:175], a[124:127], v[196:199], v[172:175]
    buffer_load_dwordx4 v231, s[4:7], s8 offen offset:2048 lds
    s_add_u32 s8, s8, 31744
    s_waitcnt lgkmcnt(6)
    v_mfma_f32_16x16x32_bf16 v[176:179], a[96:99], v[200:203], v[176:179]
    ds_read_b64_tr_b16 v[192:193], v225 offset:32768
    s_waitcnt lgkmcnt(5)
    v_mfma_f32_16x16x32_bf16 v[176:179], a[112:115], v[204:207], v[176:179]
    v_cvt_pk_bf16_f32 v36, v36, v37
    v_cvt_pk_bf16_f32 v37, v38, v39
    v_mfma_f32_16x16x32_bf16 v[180:183], a[100:103], v[200:203], v[180:183]
    ds_read_b64_tr_b16 v[194:195], v225 offset:33280
    v_cvt_pk_bf16_f32 v38, v52, v53
    v_mfma_f32_16x16x32_bf16 v[180:183], a[116:119], v[204:207], v[180:183]
    buffer_load_dwordx4 v231, s[4:7], s8 offen offset:3072 lds
    v_cvt_pk_bf16_f32 v39, v54, v55
    v_mfma_f32_16x16x32_bf16 v[184:187], a[104:107], v[200:203], v[184:187]
    ds_read_b64_tr_b16 v[196:197], v225 offset:36864
    v_mfma_f32_16x16x32_bf16 v[184:187], a[120:123], v[204:207], v[184:187]
    buffer_store_dwordx4 v[36:39], v242, s[20:23], s56 offen offset:2176 sc1
    v_mfma_f32_16x16x32_bf16 v[188:191], a[108:111], v[200:203], v[188:191]
    ds_read_b64_tr_b16 v[198:199], v225 offset:37376
    v_mfma_f32_16x16x32_bf16 v[188:191], a[124:127], v[204:207], v[188:191]
    s_waitcnt lgkmcnt(6)
    v_mfma_f32_16x16x32_bf16 v[128:131], a[128:131], v[208:211], v[128:131]
    ds_read_b64_tr_b16 v[200:201], v226 offset:32768
    s_waitcnt lgkmcnt(5)
    v_mfma_f32_16x16x32_bf16 v[128:131], a[144:147], v[212:215], v[128:131]
    v_mfma_f32_16x16x32_bf16 v[132:135], a[132:135], v[208:211], v[132:135]
    ds_read_b64_tr_b16 v[202:203], v226 offset:33280
    v_mfma_f32_16x16x32_bf16 v[132:135], a[148:151], v[212:215], v[132:135]
    v_mfma_f32_16x16x32_bf16 v[136:139], a[136:139], v[208:211], v[136:139]
    ds_read_b64_tr_b16 v[204:205], v226 offset:36864
    v_cvt_pk_bf16_f32 v40, v40, v41
    v_mfma_f32_16x16x32_bf16 v[136:139], a[152:155], v[212:215], v[136:139]
    v_cvt_pk_bf16_f32 v41, v42, v43
    v_cvt_pk_bf16_f32 v42, v56, v57
    v_mfma_f32_16x16x32_bf16 v[140:143], a[140:143], v[208:211], v[140:143]
    ds_read_b64_tr_b16 v[206:207], v226 offset:37376
    v_cvt_pk_bf16_f32 v43, v58, v59
    v_mfma_f32_16x16x32_bf16 v[140:143], a[156:159], v[212:215], v[140:143]
    buffer_store_dwordx4 v[40:43], v242, s[20:23], s58 offen offset:2048 sc1
    s_waitcnt lgkmcnt(6)
    v_mfma_f32_16x16x32_bf16 v[144:147], a[128:131], v[192:195], v[144:147]
    ds_read_b64_tr_b16 v[208:209], v227 offset:32768
    s_waitcnt lgkmcnt(5)
    v_mfma_f32_16x16x32_bf16 v[144:147], a[144:147], v[196:199], v[144:147]
    v_mfma_f32_16x16x32_bf16 v[148:151], a[132:135], v[192:195], v[148:151]
    ds_read_b64_tr_b16 v[210:211], v227 offset:33280
    v_mfma_f32_16x16x32_bf16 v[148:151], a[148:151], v[196:199], v[148:151]
    v_mfma_f32_16x16x32_bf16 v[152:155], a[136:139], v[192:195], v[152:155]
    ds_read_b64_tr_b16 v[212:213], v227 offset:36864
    v_mfma_f32_16x16x32_bf16 v[152:155], a[152:155], v[196:199], v[152:155]
    v_mfma_f32_16x16x32_bf16 v[156:159], a[140:143], v[192:195], v[156:159]
    ds_read_b64_tr_b16 v[214:215], v227 offset:37376
    v_mfma_f32_16x16x32_bf16 v[156:159], a[156:159], v[196:199], v[156:159]
    v_cvt_pk_bf16_f32 v44, v44, v45
    v_cvt_pk_bf16_f32 v45, v46, v47
    s_waitcnt lgkmcnt(6)
    v_mfma_f32_16x16x32_bf16 v[160:163], a[128:131], v[200:203], v[160:163]
    ds_read_b64_tr_b16 v[192:193], v224 offset:40960
    v_cvt_pk_bf16_f32 v46, v60, v61
    s_waitcnt lgkmcnt(5)
    v_mfma_f32_16x16x32_bf16 v[160:163], a[144:147], v[204:207], v[160:163]
    v_cvt_pk_bf16_f32 v47, v62, v63
    v_mfma_f32_16x16x32_bf16 v[164:167], a[132:135], v[200:203], v[164:167]
    ds_read_b64_tr_b16 v[194:195], v224 offset:41472
    v_mfma_f32_16x16x32_bf16 v[164:167], a[148:151], v[204:207], v[164:167]
    buffer_store_dwordx4 v[44:47], v242, s[20:23], s58 offen offset:2176 sc1
    v_mfma_f32_16x16x32_bf16 v[168:171], a[136:139], v[200:203], v[168:171]
    ds_read_b64_tr_b16 v[196:197], v224 offset:45056
    v_mfma_f32_16x16x32_bf16 v[168:171], a[152:155], v[204:207], v[168:171]
    v_mfma_f32_16x16x32_bf16 v[172:175], a[140:143], v[200:203], v[172:175]
    ds_read_b64_tr_b16 v[198:199], v224 offset:45568
    v_mfma_f32_16x16x32_bf16 v[172:175], a[156:159], v[204:207], v[172:175]
    s_waitcnt lgkmcnt(6)
    v_mfma_f32_16x16x32_bf16 v[176:179], a[128:131], v[208:211], v[176:179]
    ds_read_b64_tr_b16 v[200:201], v225 offset:40960
    s_waitcnt lgkmcnt(5)
    v_mfma_f32_16x16x32_bf16 v[176:179], a[144:147], v[212:215], v[176:179]
    v_mfma_f32_16x16x32_bf16 v[180:183], a[132:135], v[208:211], v[180:183]
    ds_read_b64_tr_b16 v[202:203], v225 offset:41472
    v_cvt_pk_bf16_f32 v64, v64, v65
    v_mfma_f32_16x16x32_bf16 v[180:183], a[148:151], v[212:215], v[180:183]
    v_cvt_pk_bf16_f32 v65, v66, v67
    v_cvt_pk_bf16_f32 v66, v80, v81
    v_mfma_f32_16x16x32_bf16 v[184:187], a[136:139], v[208:211], v[184:187]
    ds_read_b64_tr_b16 v[204:205], v225 offset:45056
    v_cvt_pk_bf16_f32 v67, v82, v83
    v_mfma_f32_16x16x32_bf16 v[184:187], a[152:155], v[212:215], v[184:187]
    buffer_store_dwordx4 v[64:67], v242, s[20:23], s57 offen offset:0 sc1
    v_mfma_f32_16x16x32_bf16 v[188:191], a[140:143], v[208:211], v[188:191]
    ds_read_b64_tr_b16 v[206:207], v225 offset:45568
    v_mfma_f32_16x16x32_bf16 v[188:191], a[156:159], v[212:215], v[188:191]
    s_waitcnt lgkmcnt(6)
    v_mfma_f32_16x16x32_bf16 v[128:131], a[160:163], v[192:195], v[128:131]
    ds_read_b64_tr_b16 v[208:209], v226 offset:40960
    s_waitcnt lgkmcnt(5)
    v_mfma_f32_16x16x32_bf16 v[128:131], a[176:179], v[196:199], v[128:131]
    v_mfma_f32_16x16x32_bf16 v[132:135], a[164:167], v[192:195], v[132:135]
    ds_read_b64_tr_b16 v[210:211], v226 offset:41472
    v_mfma_f32_16x16x32_bf16 v[132:135], a[180:183], v[196:199], v[132:135]
    v_mfma_f32_16x16x32_bf16 v[136:139], a[168:171], v[192:195], v[136:139]
    ds_read_b64_tr_b16 v[212:213], v226 offset:45056
    v_mfma_f32_16x16x32_bf16 v[136:139], a[184:187], v[196:199], v[136:139]
    v_cvt_pk_bf16_f32 v68, v68, v69
    v_cvt_pk_bf16_f32 v69, v70, v71
    v_mfma_f32_16x16x32_bf16 v[140:143], a[172:175], v[192:195], v[140:143]
    ds_read_b64_tr_b16 v[214:215], v226 offset:45568
    v_cvt_pk_bf16_f32 v70, v84, v85
    v_mfma_f32_16x16x32_bf16 v[140:143], a[188:191], v[196:199], v[140:143]
    v_cvt_pk_bf16_f32 v71, v86, v87
    s_waitcnt vmcnt(13)
    s_barrier
    s_waitcnt lgkmcnt(6)
    v_mfma_f32_16x16x32_bf16 v[144:147], a[160:163], v[200:203], v[144:147]
    ds_read_b64_tr_b16 v[192:193], v227 offset:40960
    s_add_u32 m0, s46, 16384
    s_waitcnt lgkmcnt(5)
    v_mfma_f32_16x16x32_bf16 v[144:147], a[176:179], v[204:207], v[144:147]
    buffer_atomic_add v221, v220, s[20:23], s100 offen sc1
    s_add_u32 s8, s45, 524288
    v_mfma_f32_16x16x32_bf16 v[148:151], a[164:167], v[200:203], v[148:151]
    ds_read_b64_tr_b16 v[194:195], v227 offset:41472
    v_mfma_f32_16x16x32_bf16 v[148:151], a[180:183], v[204:207], v[148:151]
    buffer_store_dwordx4 v[68:71], v242, s[20:23], s57 offen offset:128 sc1
    v_mfma_f32_16x16x32_bf16 v[152:155], a[168:171], v[200:203], v[152:155]
    ds_read_b64_tr_b16 v[196:197], v227 offset:45056
    v_mfma_f32_16x16x32_bf16 v[152:155], a[184:187], v[204:207], v[152:155]
    buffer_load_dwordx4 v231, s[4:7], s8 offen offset:0 lds
    s_add_u32 s8, s8, 31744
    v_mfma_f32_16x16x32_bf16 v[156:159], a[172:175], v[200:203], v[156:159]
    ds_read_b64_tr_b16 v[198:199], v227 offset:45568
    v_mfma_f32_16x16x32_bf16 v[156:159], a[188:191], v[204:207], v[156:159]
    s_waitcnt lgkmcnt(6)
    v_mfma_f32_16x16x32_bf16 v[160:163], a[160:163], v[208:211], v[160:163]
    ds_read_b64_tr_b16 v[200:201], v234 offset:0
    v_cvt_pk_bf16_f32 v72, v72, v73
    s_waitcnt lgkmcnt(5)
    v_mfma_f32_16x16x32_bf16 v[160:163], a[176:179], v[212:215], v[160:163]
    v_cvt_pk_bf16_f32 v73, v74, v75
    v_cvt_pk_bf16_f32 v74, v88, v89
    v_mfma_f32_16x16x32_bf16 v[164:167], a[164:167], v[208:211], v[164:167]
    ds_read_b64_tr_b16 v[202:203], v234 offset:512
    v_cvt_pk_bf16_f32 v75, v90, v91
    v_mfma_f32_16x16x32_bf16 v[164:167], a[180:183], v[212:215], v[164:167]
    buffer_store_dwordx4 v[72:75], v242, s[20:23], s59 offen offset:0 sc1
    v_mfma_f32_16x16x32_bf16 v[168:171], a[168:171], v[208:211], v[168:171]
    ds_read_b64_tr_b16 v[204:205], v234 offset:4096
    v_mfma_f32_16x16x32_bf16 v[168:171], a[184:187], v[212:215], v[168:171]
    buffer_load_dwordx4 v231, s[4:7], s8 offen offset:1024 lds
    s_add_u32 s8, s8, 31744
    v_mfma_f32_16x16x32_bf16 v[172:175], a[172:175], v[208:211], v[172:175]
    ds_read_b64_tr_b16 v[206:207], v234 offset:4608
    v_mfma_f32_16x16x32_bf16 v[172:175], a[188:191], v[212:215], v[172:175]
    s_waitcnt lgkmcnt(6)
    v_mfma_f32_16x16x32_bf16 v[176:179], a[160:163], v[192:195], v[176:179]
    ds_read_b64_tr_b16 v[208:209], v235 offset:0
    s_waitcnt lgkmcnt(5)
    v_mfma_f32_16x16x32_bf16 v[176:179], a[176:179], v[196:199], v[176:179]
    buffer_load_dwordx4 v231, s[4:7], s8 offen offset:2048 lds
    s_add_u32 s8, s8, 31744
    v_mfma_f32_16x16x32_bf16 v[180:183], a[164:167], v[192:195], v[180:183]
    ds_read_b64_tr_b16 v[210:211], v235 offset:512
    v_mfma_f32_16x16x32_bf16 v[180:183], a[180:183], v[196:199], v[180:183]
    v_cvt_pk_bf16_f32 v76, v76, v77
    v_cvt_pk_bf16_f32 v77, v78, v79
    v_mfma_f32_16x16x32_bf16 v[184:187], a[168:171], v[192:195], v[184:187]
    ds_read_b64_tr_b16 v[212:213], v235 offset:4096
    v_cvt_pk_bf16_f32 v78, v92, v93
    v_mfma_f32_16x16x32_bf16 v[184:187], a[184:187], v[196:199], v[184:187]
    buffer_load_dwordx4 v231, s[4:7], s8 offen offset:3072 lds
    v_cvt_pk_bf16_f32 v79, v94, v95
    v_mfma_f32_16x16x32_bf16 v[188:191], a[172:175], v[192:195], v[188:191]
    ds_read_b64_tr_b16 v[214:215], v235 offset:4608
    v_mfma_f32_16x16x32_bf16 v[188:191], a[188:191], v[196:199], v[188:191]
    buffer_store_dwordx4 v[76:79], v242, s[20:23], s59 offen offset:128 sc1
    s_waitcnt lgkmcnt(6)
    v_mfma_f32_16x16x32_bf16 v[128:131], a[192:195], v[200:203], v[128:131]
    ds_read_b64_tr_b16 v[192:193], v236 offset:0
    s_waitcnt lgkmcnt(5)
    v_mfma_f32_16x16x32_bf16 v[128:131], a[208:211], v[204:207], v[128:131]
    v_mfma_f32_16x16x32_bf16 v[132:135], a[196:199], v[200:203], v[132:135]
    ds_read_b64_tr_b16 v[194:195], v236 offset:512
    v_mfma_f32_16x16x32_bf16 v[132:135], a[212:215], v[204:207], v[132:135]
    v_mfma_f32_16x16x32_bf16 v[136:139], a[200:203], v[200:203], v[136:139]
    ds_read_b64_tr_b16 v[196:197], v236 offset:4096
    v_mfma_f32_16x16x32_bf16 v[136:139], a[216:219], v[204:207], v[136:139]
    v_mfma_f32_16x16x32_bf16 v[140:143], a[204:207], v[200:203], v[140:143]
    ds_read_b64_tr_b16 v[198:199], v236 offset:4608
    v_cvt_pk_bf16_f32 v96, v96, v97
    v_mfma_f32_16x16x32_bf16 v[140:143], a[220:223], v[204:207], v[140:143]
    v_cvt_pk_bf16_f32 v97, v98, v99
    v_cvt_pk_bf16_f32 v98, v112, v113
    s_waitcnt lgkmcnt(6)
    v_mfma_f32_16x16x32_bf16 v[144:147], a[192:195], v[208:211], v[144:147]
    ds_read_b64_tr_b16 v[200:201], v237 offset:0
    v_cvt_pk_bf16_f32 v99, v114, v115
    s_waitcnt lgkmcnt(5)
    v_mfma_f32_16x16x32_bf16 v[144:147], a[208:211], v[212:215], v[144:147]
    buffer_store_dwordx4 v[96:99], v242, s[20:23], s57 offen offset:2048 sc1
    v_mfma_f32_16x16x32_bf16 v[148:151], a[196:199], v[208:211], v[148:151]
    ds_read_b64_tr_b16 v[202:203], v237 offset:512
    v_mfma_f32_16x16x32_bf16 v[148:151], a[212:215], v[212:215], v[148:151]
    v_mfma_f32_16x16x32_bf16 v[152:155], a[200:203], v[208:211], v[152:155]
    ds_read_b64_tr_b16 v[204:205], v237 offset:4096
    v_mfma_f32_16x16x32_bf16 v[152:155], a[216:219], v[212:215], v[152:155]
    v_mfma_f32_16x16x32_bf16 v[156:159], a[204:207], v[208:211], v[156:159]
    ds_read_b64_tr_b16 v[206:207], v237 offset:4608
    v_mfma_f32_16x16x32_bf16 v[156:159], a[220:223], v[212:215], v[156:159]
    s_waitcnt lgkmcnt(6)
    v_mfma_f32_16x16x32_bf16 v[160:163], a[192:195], v[192:195], v[160:163]
    ds_read_b64_tr_b16 v[208:209], v234 offset:8192
    s_waitcnt lgkmcnt(5)
    v_mfma_f32_16x16x32_bf16 v[160:163], a[208:211], v[196:199], v[160:163]
    v_cvt_pk_bf16_f32 v100, v100, v101
    v_cvt_pk_bf16_f32 v101, v102, v103
    v_mfma_f32_16x16x32_bf16 v[164:167], a[196:199], v[192:195], v[164:167]
    ds_read_b64_tr_b16 v[210:211], v234 offset:8704
    v_cvt_pk_bf16_f32 v102, v116, v117
    v_mfma_f32_16x16x32_bf16 v[164:167], a[212:215], v[196:199], v[164:167]
    v_cvt_pk_bf16_f32 v103, v118, v119
    v_mfma_f32_16x16x32_bf16 v[168:171], a[200:203], v[192:195], v[168:171]
    ds_read_b64_tr_b16 v[212:213], v234 offset:12288
    v_mfma_f32_16x16x32_bf16 v[168:171], a[216:219], v[196:199], v[168:171]
    buffer_store_dwordx4 v[100:103], v242, s[20:23], s57 offen offset:2176 sc1
    v_mfma_f32_16x16x32_bf16 v[172:175], a[204:207], v[192:195], v[172:175]
    ds_read_b64_tr_b16 v[214:215], v234 offset:12800
    v_mfma_f32_16x16x32_bf16 v[172:175], a[220:223], v[196:199], v[172:175]
    s_waitcnt lgkmcnt(6)
    v_mfma_f32_16x16x32_bf16 v[176:179], a[192:195], v[200:203], v[176:179]
    ds_read_b64_tr_b16 v[192:193], v235 offset:8192
    s_waitcnt lgkmcnt(5)
    v_mfma_f32_16x16x32_bf16 v[176:179], a[208:211], v[204:207], v[176:179]
    v_mfma_f32_16x16x32_bf16 v[180:183], a[196:199], v[200:203], v[180:183]
    ds_read_b64_tr_b16 v[194:195], v235 offset:8704
    v_mfma_f32_16x16x32_bf16 v[180:183], a[212:215], v[204:207], v[180:183]
    v_mfma_f32_16x16x32_bf16 v[184:187], a[200:203], v[200:203], v[184:187]
    ds_read_b64_tr_b16 v[196:197], v235 offset:12288
    v_cvt_pk_bf16_f32 v104, v104, v105
    v_mfma_f32_16x16x32_bf16 v[184:187], a[216:219], v[204:207], v[184:187]
    v_cvt_pk_bf16_f32 v105, v106, v107
    v_cvt_pk_bf16_f32 v106, v120, v121
    v_mfma_f32_16x16x32_bf16 v[188:191], a[204:207], v[200:203], v[188:191]
    ds_read_b64_tr_b16 v[198:199], v235 offset:12800
    v_cvt_pk_bf16_f32 v107, v122, v123
    v_mfma_f32_16x16x32_bf16 v[188:191], a[220:223], v[204:207], v[188:191]
    buffer_store_dwordx4 v[104:107], v242, s[20:23], s59 offen offset:2048 sc1
    s_waitcnt lgkmcnt(6)
    v_mfma_f32_16x16x32_bf16 v[128:131], a[224:227], v[208:211], v[128:131]
    ds_read_b64_tr_b16 v[200:201], v236 offset:8192
    s_waitcnt lgkmcnt(5)
    v_mfma_f32_16x16x32_bf16 v[128:131], a[240:243], v[212:215], v[128:131]
    v_mfma_f32_16x16x32_bf16 v[132:135], a[228:231], v[208:211], v[132:135]
    ds_read_b64_tr_b16 v[202:203], v236 offset:8704
    v_mfma_f32_16x16x32_bf16 v[132:135], a[244:247], v[212:215], v[132:135]
    v_mfma_f32_16x16x32_bf16 v[136:139], a[232:235], v[208:211], v[136:139]
    ds_read_b64_tr_b16 v[204:205], v236 offset:12288
    v_mfma_f32_16x16x32_bf16 v[136:139], a[248:251], v[212:215], v[136:139]
    v_mfma_f32_16x16x32_bf16 v[140:143], a[236:239], v[208:211], v[140:143]
    ds_read_b64_tr_b16 v[206:207], v236 offset:12800
    v_mfma_f32_16x16x32_bf16 v[140:143], a[252:255], v[212:215], v[140:143]
    v_cvt_pk_bf16_f32 v108, v108, v109
    v_cvt_pk_bf16_f32 v109, v110, v111
    s_barrier
    s_waitcnt lgkmcnt(6)
    v_mfma_f32_16x16x32_bf16 v[144:147], a[224:227], v[192:195], v[144:147]
    ds_read_b64_tr_b16 v[208:209], v237 offset:8192
    v_cvt_pk_bf16_f32 v110, v124, v125
    s_waitcnt lgkmcnt(5)
    v_mfma_f32_16x16x32_bf16 v[144:147], a[240:243], v[196:199], v[144:147]
    v_cvt_pk_bf16_f32 v111, v126, v127
    s_add_u32 m0, s46, 32768
    v_mfma_f32_16x16x32_bf16 v[148:151], a[228:231], v[192:195], v[148:151]
    ds_read_b64_tr_b16 v[210:211], v237 offset:8704
    s_add_u32 s8, s45, 1048576
    v_mfma_f32_16x16x32_bf16 v[148:151], a[244:247], v[196:199], v[148:151]
    buffer_store_dwordx4 v[108:111], v242, s[20:23], s59 offen offset:2176 sc1
    v_mfma_f32_16x16x32_bf16 v[152:155], a[232:235], v[192:195], v[152:155]
    ds_read_b64_tr_b16 v[212:213], v237 offset:12288
    v_mfma_f32_16x16x32_bf16 v[152:155], a[248:251], v[196:199], v[152:155]
    buffer_load_dwordx4 v231, s[4:7], s8 offen offset:0 lds
    s_add_u32 s8, s8, 31744
    v_mfma_f32_16x16x32_bf16 v[156:159], a[236:239], v[192:195], v[156:159]
    ds_read_b64_tr_b16 v[214:215], v237 offset:12800
    v_mfma_f32_16x16x32_bf16 v[156:159], a[252:255], v[196:199], v[156:159]
    s_waitcnt lgkmcnt(6)
    v_mfma_f32_16x16x32_bf16 v[160:163], a[224:227], v[200:203], v[160:163]
    ds_read_b64_tr_b16 v[192:193], v234 offset:16384
    s_waitcnt lgkmcnt(5)
    v_mfma_f32_16x16x32_bf16 v[160:163], a[240:243], v[204:207], v[160:163]
    buffer_load_dwordx4 v231, s[4:7], s8 offen offset:1024 lds
    s_add_u32 s8, s8, 31744
    v_mfma_f32_16x16x32_bf16 v[164:167], a[228:231], v[200:203], v[164:167]
    ds_read_b64_tr_b16 v[194:195], v234 offset:16896
    v_mfma_f32_16x16x32_bf16 v[164:167], a[244:247], v[204:207], v[164:167]
    v_mfma_f32_16x16x32_bf16 v[168:171], a[232:235], v[200:203], v[168:171]
    ds_read_b64_tr_b16 v[196:197], v234 offset:20480
    v_mfma_f32_16x16x32_bf16 v[168:171], a[248:251], v[204:207], v[168:171]
    buffer_load_dwordx4 v231, s[4:7], s8 offen offset:2048 lds
    s_add_u32 s8, s8, 31744
    v_mfma_f32_16x16x32_bf16 v[172:175], a[236:239], v[200:203], v[172:175]
    ds_read_b64_tr_b16 v[198:199], v234 offset:20992
    v_mfma_f32_16x16x32_bf16 v[172:175], a[252:255], v[204:207], v[172:175]
    s_waitcnt lgkmcnt(6)
    v_mfma_f32_16x16x32_bf16 v[176:179], a[224:227], v[208:211], v[176:179]
    ds_read_b64_tr_b16 v[200:201], v235 offset:16384
    s_waitcnt lgkmcnt(5)
    v_mfma_f32_16x16x32_bf16 v[176:179], a[240:243], v[212:215], v[176:179]
    buffer_load_dwordx4 v231, s[4:7], s8 offen offset:3072 lds
    v_mfma_f32_16x16x32_bf16 v[180:183], a[228:231], v[208:211], v[180:183]
    ds_read_b64_tr_b16 v[202:203], v235 offset:16896
    v_mfma_f32_16x16x32_bf16 v[180:183], a[244:247], v[212:215], v[180:183]
    v_mfma_f32_16x16x32_bf16 v[184:187], a[232:235], v[208:211], v[184:187]
    ds_read_b64_tr_b16 v[204:205], v235 offset:20480
    v_mfma_f32_16x16x32_bf16 v[184:187], a[248:251], v[212:215], v[184:187]
    v_mfma_f32_16x16x32_bf16 v[188:191], a[236:239], v[208:211], v[188:191]
    ds_read_b64_tr_b16 v[206:207], v235 offset:20992
    v_mfma_f32_16x16x32_bf16 v[188:191], a[252:255], v[212:215], v[188:191]
    s_waitcnt lgkmcnt(6)
    v_mfma_f32_16x16x32_bf16 v[0:3], a[0:3], v[192:195], 0
    ds_read_b64_tr_b16 v[208:209], v236 offset:16384
    s_waitcnt lgkmcnt(5)
    v_mfma_f32_16x16x32_bf16 v[0:3], a[16:19], v[196:199], v[0:3]
    v_mfma_f32_16x16x32_bf16 v[4:7], a[4:7], v[192:195], 0
    ds_read_b64_tr_b16 v[210:211], v236 offset:16896
    v_mfma_f32_16x16x32_bf16 v[4:7], a[20:23], v[196:199], v[4:7]
    v_mfma_f32_16x16x32_bf16 v[8:11], a[8:11], v[192:195], 0
    ds_read_b64_tr_b16 v[212:213], v236 offset:20480
    v_mfma_f32_16x16x32_bf16 v[8:11], a[24:27], v[196:199], v[8:11]
    v_mfma_f32_16x16x32_bf16 v[12:15], a[12:15], v[192:195], 0
    ds_read_b64_tr_b16 v[214:215], v236 offset:20992
    v_cvt_pk_bf16_f32 v128, v128, v129
    v_mfma_f32_16x16x32_bf16 v[12:15], a[28:31], v[196:199], v[12:15]
    v_cvt_pk_bf16_f32 v129, v130, v131
    v_cvt_pk_bf16_f32 v130, v132, v133
    s_waitcnt lgkmcnt(6)
    v_mfma_f32_16x16x32_bf16 v[16:19], a[0:3], v[200:203], 0
    ds_read_b64_tr_b16 v[192:193], v237 offset:16384
    v_cvt_pk_bf16_f32 v131, v134, v135
    s_waitcnt lgkmcnt(5)
    v_mfma_f32_16x16x32_bf16 v[16:19], a[16:19], v[204:207], v[16:19]
    buffer_store_dwordx4 v[128:131], v243, s[20:23], s60 offen offset:0 sc1
    v_mfma_f32_16x16x32_bf16 v[20:23], a[4:7], v[200:203], 0
    ds_read_b64_tr_b16 v[194:195], v237 offset:16896
    v_mfma_f32_16x16x32_bf16 v[20:23], a[20:23], v[204:207], v[20:23]
    v_mfma_f32_16x16x32_bf16 v[24:27], a[8:11], v[200:203], 0
    ds_read_b64_tr_b16 v[196:197], v237 offset:20480
    v_cvt_pk_bf16_f32 v136, v136, v137
    v_mfma_f32_16x16x32_bf16 v[24:27], a[24:27], v[204:207], v[24:27]
    v_cvt_pk_bf16_f32 v137, v138, v139
    v_cvt_pk_bf16_f32 v138, v140, v141
    v_mfma_f32_16x16x32_bf16 v[28:31], a[12:15], v[200:203], 0
    ds_read_b64_tr_b16 v[198:199], v237 offset:20992
    v_cvt_pk_bf16_f32 v139, v142, v143
    v_mfma_f32_16x16x32_bf16 v[28:31], a[28:31], v[204:207], v[28:31]
    buffer_store_dwordx4 v[136:139], v243, s[20:23], s62 offen offset:0 sc1
    s_waitcnt lgkmcnt(6)
    v_mfma_f32_16x16x32_bf16 v[32:35], a[0:3], v[208:211], 0
    ds_read_b64_tr_b16 v[200:201], v234 offset:24576
    s_waitcnt lgkmcnt(5)
    v_mfma_f32_16x16x32_bf16 v[32:35], a[16:19], v[212:215], v[32:35]
    v_mfma_f32_16x16x32_bf16 v[36:39], a[4:7], v[208:211], 0
    ds_read_b64_tr_b16 v[202:203], v234 offset:25088
    v_cvt_pk_bf16_f32 v144, v144, v145
    v_mfma_f32_16x16x32_bf16 v[36:39], a[20:23], v[212:215], v[36:39]
    v_cvt_pk_bf16_f32 v145, v146, v147
    v_cvt_pk_bf16_f32 v146, v148, v149
    v_mfma_f32_16x16x32_bf16 v[40:43], a[8:11], v[208:211], 0
    ds_read_b64_tr_b16 v[204:205], v234 offset:28672
    v_cvt_pk_bf16_f32 v147, v150, v151
    v_mfma_f32_16x16x32_bf16 v[40:43], a[24:27], v[212:215], v[40:43]
    buffer_store_dwordx4 v[144:147], v243, s[20:23], s60 offen offset:256 sc1
    v_mfma_f32_16x16x32_bf16 v[44:47], a[12:15], v[208:211], 0
    ds_read_b64_tr_b16 v[206:207], v234 offset:29184
    v_mfma_f32_16x16x32_bf16 v[44:47], a[28:31], v[212:215], v[44:47]
    s_waitcnt lgkmcnt(6)
    v_mfma_f32_16x16x32_bf16 v[48:51], a[0:3], v[192:195], 0
    ds_read_b64_tr_b16 v[208:209], v235 offset:24576
    v_cvt_pk_bf16_f32 v152, v152, v153
    s_waitcnt lgkmcnt(5)
    v_mfma_f32_16x16x32_bf16 v[48:51], a[16:19], v[196:199], v[48:51]
    v_cvt_pk_bf16_f32 v153, v154, v155
    v_cvt_pk_bf16_f32 v154, v156, v157
    v_mfma_f32_16x16x32_bf16 v[52:55], a[4:7], v[192:195], 0
    ds_read_b64_tr_b16 v[210:211], v235 offset:25088
    v_cvt_pk_bf16_f32 v155, v158, v159
    v_mfma_f32_16x16x32_bf16 v[52:55], a[20:23], v[196:199], v[52:55]
    buffer_store_dwordx4 v[152:155], v243, s[20:23], s62 offen offset:256 sc1
    v_mfma_f32_16x16x32_bf16 v[56:59], a[8:11], v[192:195], 0
    ds_read_b64_tr_b16 v[212:213], v235 offset:28672
    v_mfma_f32_16x16x32_bf16 v[56:59], a[24:27], v[196:199], v[56:59]
    v_mfma_f32_16x16x32_bf16 v[60:63], a[12:15], v[192:195], 0
    ds_read_b64_tr_b16 v[214:215], v235 offset:29184
    v_cvt_pk_bf16_f32 v160, v160, v161
    v_mfma_f32_16x16x32_bf16 v[60:63], a[28:31], v[196:199], v[60:63]
    buffer_load_dword v254, off, s[20:23], s85 sc1
    v_cvt_pk_bf16_f32 v161, v162, v163
    s_waitcnt lgkmcnt(6)
    v_mfma_f32_16x16x32_bf16 v[0:3], a[32:35], v[200:203], v[0:3]
    ds_read_b64_tr_b16 v[192:193], v236 offset:24576
    v_cvt_pk_bf16_f32 v162, v164, v165
    s_waitcnt lgkmcnt(5)
    v_mfma_f32_16x16x32_bf16 v[0:3], a[48:51], v[204:207], v[0:3]
    v_cvt_pk_bf16_f32 v163, v166, v167
    v_mfma_f32_16x16x32_bf16 v[4:7], a[36:39], v[200:203], v[4:7]
    ds_read_b64_tr_b16 v[194:195], v236 offset:25088
    v_mfma_f32_16x16x32_bf16 v[4:7], a[52:55], v[204:207], v[4:7]
    buffer_store_dwordx4 v[160:163], v243, s[20:23], s60 offen offset:1024 sc1
    v_mfma_f32_16x16x32_bf16 v[8:11], a[40:43], v[200:203], v[8:11]
    ds_read_b64_tr_b16 v[196:197], v236 offset:28672
    v_mfma_f32_16x16x32_bf16 v[8:11], a[56:59], v[204:207], v[8:11]
    v_mfma_f32_16x16x32_bf16 v[12:15], a[44:47], v[200:203], v[12:15]
    ds_read_b64_tr_b16 v[198:199], v236 offset:29184
    v_cvt_pk_bf16_f32 v168, v168, v169
    v_mfma_f32_16x16x32_bf16 v[12:15], a[60:63], v[204:207], v[12:15]
    v_cvt_pk_bf16_f32 v169, v170, v171
    v_cvt_pk_bf16_f32 v170, v172, v173
    s_barrier
    s_waitcnt lgkmcnt(6)
    v_mfma_f32_16x16x32_bf16 v[16:19], a[32:35], v[208:211], v[16:19]
    ds_read_b64_tr_b16 v[200:201], v237 offset:24576
    v_cvt_pk_bf16_f32 v171, v174, v175
    s_waitcnt lgkmcnt(5)
    v_mfma_f32_16x16x32_bf16 v[16:19], a[48:51], v[212:215], v[16:19]
    buffer_store_dwordx4 v[168:171], v243, s[20:23], s62 offen offset:1024 sc1
    v_mfma_f32_16x16x32_bf16 v[20:23], a[36:39], v[208:211], v[20:23]
    ds_read_b64_tr_b16 v[202:203], v237 offset:25088
    v_mfma_f32_16x16x32_bf16 v[20:23], a[52:55], v[212:215], v[20:23]
    v_mfma_f32_16x16x32_bf16 v[24:27], a[40:43], v[208:211], v[24:27]
    ds_read_b64_tr_b16 v[204:205], v237 offset:28672
    v_cvt_pk_bf16_f32 v176, v176, v177
    v_mfma_f32_16x16x32_bf16 v[24:27], a[56:59], v[212:215], v[24:27]
    v_cvt_pk_bf16_f32 v177, v178, v179
    v_cvt_pk_bf16_f32 v178, v180, v181
    v_mfma_f32_16x16x32_bf16 v[28:31], a[44:47], v[208:211], v[28:31]
    ds_read_b64_tr_b16 v[206:207], v237 offset:29184
    v_cvt_pk_bf16_f32 v179, v182, v183
    v_mfma_f32_16x16x32_bf16 v[28:31], a[60:63], v[212:215], v[28:31]
    buffer_store_dwordx4 v[176:179], v243, s[20:23], s60 offen offset:1280 sc1
    s_waitcnt lgkmcnt(6)
    v_mfma_f32_16x16x32_bf16 v[32:35], a[32:35], v[192:195], v[32:35]
    ds_read_b64_tr_b16 v[208:209], v234 offset:32768
    s_waitcnt lgkmcnt(5)
    v_mfma_f32_16x16x32_bf16 v[32:35], a[48:51], v[196:199], v[32:35]
    v_mfma_f32_16x16x32_bf16 v[36:39], a[36:39], v[192:195], v[36:39]
    ds_read_b64_tr_b16 v[210:211], v234 offset:33280
    v_cvt_pk_bf16_f32 v184, v184, v185
    v_mfma_f32_16x16x32_bf16 v[36:39], a[52:55], v[196:199], v[36:39]
    v_cvt_pk_bf16_f32 v185, v186, v187
    v_cvt_pk_bf16_f32 v186, v188, v189
    v_mfma_f32_16x16x32_bf16 v[40:43], a[40:43], v[192:195], v[40:43]
    ds_read_b64_tr_b16 v[212:213], v234 offset:36864
    v_cvt_pk_bf16_f32 v187, v190, v191
    v_mfma_f32_16x16x32_bf16 v[40:43], a[56:59], v[196:199], v[40:43]
    buffer_store_dwordx4 v[184:187], v243, s[20:23], s62 offen offset:1280 sc1
    v_mfma_f32_16x16x32_bf16 v[44:47], a[44:47], v[192:195], v[44:47]
    ds_read_b64_tr_b16 v[214:215], v234 offset:37376
    v_mfma_f32_16x16x32_bf16 v[44:47], a[60:63], v[196:199], v[44:47]
    s_waitcnt lgkmcnt(6)
    v_mfma_f32_16x16x32_bf16 v[48:51], a[32:35], v[200:203], v[48:51]
    ds_read_b64_tr_b16 v[192:193], v235 offset:32768
    s_waitcnt lgkmcnt(5)
    v_mfma_f32_16x16x32_bf16 v[48:51], a[48:51], v[204:207], v[48:51]
    v_mfma_f32_16x16x32_bf16 v[52:55], a[36:39], v[200:203], v[52:55]
    ds_read_b64_tr_b16 v[194:195], v235 offset:33280
    v_mfma_f32_16x16x32_bf16 v[52:55], a[52:55], v[204:207], v[52:55]
    v_mfma_f32_16x16x32_bf16 v[56:59], a[40:43], v[200:203], v[56:59]
    ds_read_b64_tr_b16 v[196:197], v235 offset:36864
    v_mfma_f32_16x16x32_bf16 v[56:59], a[56:59], v[204:207], v[56:59]
    v_mfma_f32_16x16x32_bf16 v[60:63], a[44:47], v[200:203], v[60:63]
    ds_read_b64_tr_b16 v[198:199], v235 offset:37376
    v_mfma_f32_16x16x32_bf16 v[60:63], a[60:63], v[204:207], v[60:63]
    s_waitcnt lgkmcnt(6)
    v_mfma_f32_16x16x32_bf16 v[0:3], a[64:67], v[208:211], v[0:3]
    ds_read_b64_tr_b16 v[200:201], v236 offset:32768
    s_waitcnt lgkmcnt(5)
    v_mfma_f32_16x16x32_bf16 v[0:3], a[80:83], v[212:215], v[0:3]
    v_mfma_f32_16x16x32_bf16 v[4:7], a[68:71], v[208:211], v[4:7]
    ds_read_b64_tr_b16 v[202:203], v236 offset:33280
    v_mfma_f32_16x16x32_bf16 v[4:7], a[84:87], v[212:215], v[4:7]
    v_mfma_f32_16x16x32_bf16 v[8:11], a[72:75], v[208:211], v[8:11]
    ds_read_b64_tr_b16 v[204:205], v236 offset:36864
    v_mfma_f32_16x16x32_bf16 v[8:11], a[88:91], v[212:215], v[8:11]
    v_mfma_f32_16x16x32_bf16 v[12:15], a[76:79], v[208:211], v[12:15]
    ds_read_b64_tr_b16 v[206:207], v236 offset:37376
    v_mfma_f32_16x16x32_bf16 v[12:15], a[92:95], v[212:215], v[12:15]
    s_waitcnt lgkmcnt(6)
    v_mfma_f32_16x16x32_bf16 v[16:19], a[64:67], v[192:195], v[16:19]
    ds_read_b64_tr_b16 v[208:209], v237 offset:32768
    s_waitcnt lgkmcnt(5)
    v_mfma_f32_16x16x32_bf16 v[16:19], a[80:83], v[196:199], v[16:19]
    v_mfma_f32_16x16x32_bf16 v[20:23], a[68:71], v[192:195], v[20:23]
    ds_read_b64_tr_b16 v[210:211], v237 offset:33280
    v_mfma_f32_16x16x32_bf16 v[20:23], a[84:87], v[196:199], v[20:23]
    v_mfma_f32_16x16x32_bf16 v[24:27], a[72:75], v[192:195], v[24:27]
    ds_read_b64_tr_b16 v[212:213], v237 offset:36864
    v_mfma_f32_16x16x32_bf16 v[24:27], a[88:91], v[196:199], v[24:27]
    v_mfma_f32_16x16x32_bf16 v[28:31], a[76:79], v[192:195], v[28:31]
    ds_read_b64_tr_b16 v[214:215], v237 offset:37376
    v_mfma_f32_16x16x32_bf16 v[28:31], a[92:95], v[196:199], v[28:31]
    s_waitcnt lgkmcnt(6)
    v_mfma_f32_16x16x32_bf16 v[32:35], a[64:67], v[200:203], v[32:35]
    ds_read_b64_tr_b16 v[192:193], v234 offset:40960
    s_waitcnt lgkmcnt(5)
    v_mfma_f32_16x16x32_bf16 v[32:35], a[80:83], v[204:207], v[32:35]
    v_mfma_f32_16x16x32_bf16 v[36:39], a[68:71], v[200:203], v[36:39]
    ds_read_b64_tr_b16 v[194:195], v234 offset:41472
    v_mfma_f32_16x16x32_bf16 v[36:39], a[84:87], v[204:207], v[36:39]
    v_mfma_f32_16x16x32_bf16 v[40:43], a[72:75], v[200:203], v[40:43]
    ds_read_b64_tr_b16 v[196:197], v234 offset:45056
    v_mfma_f32_16x16x32_bf16 v[40:43], a[88:91], v[204:207], v[40:43]
    v_mfma_f32_16x16x32_bf16 v[44:47], a[76:79], v[200:203], v[44:47]
    ds_read_b64_tr_b16 v[198:199], v234 offset:45568
    v_mfma_f32_16x16x32_bf16 v[44:47], a[92:95], v[204:207], v[44:47]
    s_waitcnt lgkmcnt(6)
    v_mfma_f32_16x16x32_bf16 v[48:51], a[64:67], v[208:211], v[48:51]
    ds_read_b64_tr_b16 v[200:201], v235 offset:40960
    s_waitcnt lgkmcnt(5)
    v_mfma_f32_16x16x32_bf16 v[48:51], a[80:83], v[212:215], v[48:51]
    v_mfma_f32_16x16x32_bf16 v[52:55], a[68:71], v[208:211], v[52:55]
    ds_read_b64_tr_b16 v[202:203], v235 offset:41472
    v_mfma_f32_16x16x32_bf16 v[52:55], a[84:87], v[212:215], v[52:55]
    v_mfma_f32_16x16x32_bf16 v[56:59], a[72:75], v[208:211], v[56:59]
    ds_read_b64_tr_b16 v[204:205], v235 offset:45056
    v_mfma_f32_16x16x32_bf16 v[56:59], a[88:91], v[212:215], v[56:59]
    v_mfma_f32_16x16x32_bf16 v[60:63], a[76:79], v[208:211], v[60:63]
    ds_read_b64_tr_b16 v[206:207], v235 offset:45568
    v_mfma_f32_16x16x32_bf16 v[60:63], a[92:95], v[212:215], v[60:63]
    s_waitcnt vmcnt(4)
    v_cmp_gt_u32 vcc, 8, v254
    s_nop 0
    s_cbranch_vccz K1_PH_OK
K1_PH:
    s_sleep 24
    buffer_load_dword v254, off, s[20:23], s85 sc1
    s_waitcnt vmcnt(0)
    v_cmp_gt_u32 vcc, 8, v254
    s_nop 0
    s_cbranch_vccz K1_PH_OK
    s_branch K1_PH
K1_PH_OK:
    s_waitcnt lgkmcnt(6)
    v_mfma_f32_16x16x32_bf16 v[0:3], a[96:99], v[192:195], v[0:3]
    ds_read_b64_tr_b16 v[208:209], v236 offset:40960
    s_add_u32 s9, s84, 0
    s_waitcnt lgkmcnt(5)
    v_mfma_f32_16x16x32_bf16 v[0:3], a[112:115], v[196:199], v[0:3]
    buffer_load_dwordx4 a[0:3], v229, s[20:23], s9 offen offset:0
    v_mfma_f32_16x16x32_bf16 v[4:7], a[100:103], v[192:195], v[4:7]
    ds_read_b64_tr_b16 v[210:211], v236 offset:41472
    v_mfma_f32_16x16x32_bf16 v[4:7], a[116:119], v[196:199], v[4:7]
    v_mfma_f32_16x16x32_bf16 v[8:11], a[104:107], v[192:195], v[8:11]
    ds_read_b64_tr_b16 v[212:213], v236 offset:45056
    v_mfma_f32_16x16x32_bf16 v[8:11], a[120:123], v[196:199], v[8:11]
    buffer_load_dwordx4 a[8:11], v229, s[20:23], s9 offen offset:1024
    v_mfma_f32_16x16x32_bf16 v[12:15], a[108:111], v[192:195], v[12:15]
    ds_read_b64_tr_b16 v[214:215], v236 offset:45568
    v_mfma_f32_16x16x32_bf16 v[12:15], a[124:127], v[196:199], v[12:15]
    s_barrier
    s_waitcnt lgkmcnt(6)
    v_mfma_f32_16x16x32_bf16 v[16:19], a[96:99], v[200:203], v[16:19]
    ds_read_b64_tr_b16 v[192:193], v237 offset:40960
    s_waitcnt lgkmcnt(5)
    v_mfma_f32_16x16x32_bf16 v[16:19], a[112:115], v[204:207], v[16:19]
    buffer_load_dwordx4 a[16:19], v229, s[20:23], s9 offen offset:2048
    v_mfma_f32_16x16x32_bf16 v[20:23], a[100:103], v[200:203], v[20:23]
    ds_read_b64_tr_b16 v[194:195], v237 offset:41472
    v_mfma_f32_16x16x32_bf16 v[20:23], a[116:119], v[204:207], v[20:23]
    v_mfma_f32_16x16x32_bf16 v[24:27], a[104:107], v[200:203], v[24:27]
    ds_read_b64_tr_b16 v[196:197], v237 offset:45056
    v_mfma_f32_16x16x32_bf16 v[24:27], a[120:123], v[204:207], v[24:27]
    buffer_load_dwordx4 a[24:27], v229, s[20:23], s9 offen offset:3072
    s_add_u32 s9, s84, 32768
    v_mfma_f32_16x16x32_bf16 v[28:31], a[108:111], v[200:203], v[28:31]
    ds_read_b64_tr_b16 v[198:199], v237 offset:45568
    v_mfma_f32_16x16x32_bf16 v[28:31], a[124:127], v[204:207], v[28:31]
    s_waitcnt lgkmcnt(6)
    v_mfma_f32_16x16x32_bf16 v[32:35], a[96:99], v[208:211], v[32:35]
    ds_read_b64_tr_b16 v[200:201], v234 offset:49152
    s_waitcnt lgkmcnt(5)
    v_mfma_f32_16x16x32_bf16 v[32:35], a[112:115], v[212:215], v[32:35]
    buffer_load_dwordx4 a[4:7], v229, s[20:23], s9 offen offset:0
    v_mfma_f32_16x16x32_bf16 v[36:39], a[100:103], v[208:211], v[36:39]
    ds_read_b64_tr_b16 v[202:203], v234 offset:49664
    v_mfma_f32_16x16x32_bf16 v[36:39], a[116:119], v[212:215], v[36:39]
    v_mfma_f32_16x16x32_bf16 v[40:43], a[104:107], v[208:211], v[40:43]
    ds_read_b64_tr_b16 v[204:205], v234 offset:53248
    v_mfma_f32_16x16x32_bf16 v[40:43], a[120:123], v[212:215], v[40:43]
    buffer_load_dwordx4 a[12:15], v229, s[20:23], s9 offen offset:1024
    v_mfma_f32_16x16x32_bf16 v[44:47], a[108:111], v[208:211], v[44:47]
    ds_read_b64_tr_b16 v[206:207], v234 offset:53760
    v_mfma_f32_16x16x32_bf16 v[44:47], a[124:127], v[212:215], v[44:47]
    s_waitcnt lgkmcnt(6)
    v_mfma_f32_16x16x32_bf16 v[48:51], a[96:99], v[192:195], v[48:51]
    ds_read_b64_tr_b16 v[208:209], v235 offset:49152
    s_waitcnt lgkmcnt(5)
    v_mfma_f32_16x16x32_bf16 v[48:51], a[112:115], v[196:199], v[48:51]
    buffer_load_dwordx4 a[20:23], v229, s[20:23], s9 offen offset:2048
    v_mfma_f32_16x16x32_bf16 v[52:55], a[100:103], v[192:195], v[52:55]
    ds_read_b64_tr_b16 v[210:211], v235 offset:49664
    v_mfma_f32_16x16x32_bf16 v[52:55], a[116:119], v[196:199], v[52:55]
    v_mfma_f32_16x16x32_bf16 v[56:59], a[104:107], v[192:195], v[56:59]
    ds_read_b64_tr_b16 v[212:213], v235 offset:53248
    v_mfma_f32_16x16x32_bf16 v[56:59], a[120:123], v[196:199], v[56:59]
    buffer_load_dwordx4 a[28:31], v229, s[20:23], s9 offen offset:3072
    s_add_u32 s9, s84, 4096
    v_mfma_f32_16x16x32_bf16 v[60:63], a[108:111], v[192:195], v[60:63]
    ds_read_b64_tr_b16 v[214:215], v235 offset:53760
    v_mfma_f32_16x16x32_bf16 v[60:63], a[124:127], v[196:199], v[60:63]
    buffer_load_dwordx4 a[32:35], v229, s[20:23], s9 offen offset:0
    s_waitcnt lgkmcnt(6)
    v_mfma_f32_16x16x32_bf16 v[0:3], a[128:131], v[200:203], v[0:3]
    ds_read_b64_tr_b16 v[192:193], v236 offset:49152
    s_waitcnt lgkmcnt(5)
    v_mfma_f32_16x16x32_bf16 v[0:3], a[144:147], v[204:207], v[0:3]
    v_mfma_f32_16x16x32_bf16 v[4:7], a[132:135], v[200:203], v[4:7]
    ds_read_b64_tr_b16 v[194:195], v236 offset:49664
    v_mfma_f32_16x16x32_bf16 v[4:7], a[148:151], v[204:207], v[4:7]
    buffer_load_dwordx4 a[40:43], v229, s[20:23], s9 offen offset:1024
    v_mfma_f32_16x16x32_bf16 v[8:11], a[136:139], v[200:203], v[8:11]
    ds_read_b64_tr_b16 v[196:197], v236 offset:53248
    v_mfma_f32_16x16x32_bf16 v[8:11], a[152:155], v[204:207], v[8:11]
    v_mfma_f32_16x16x32_bf16 v[12:15], a[140:143], v[200:203], v[12:15]
    ds_read_b64_tr_b16 v[198:199], v236 offset:53760
    v_mfma_f32_16x16x32_bf16 v[12:15], a[156:159], v[204:207], v[12:15]
    buffer_load_dwordx4 a[48:51], v229, s[20:23], s9 offen offset:2048
    s_waitcnt lgkmcnt(6)
    v_mfma_f32_16x16x32_bf16 v[16:19], a[128:131], v[208:211], v[16:19]
    ds_read_b64_tr_b16 v[200:201], v237 offset:49152
    s_waitcnt lgkmcnt(5)
    v_mfma_f32_16x16x32_bf16 v[16:19], a[144:147], v[212:215], v[16:19]
    v_mfma_f32_16x16x32_bf16 v[20:23], a[132:135], v[208:211], v[20:23]
    ds_read_b64_tr_b16 v[202:203], v237 offset:49664
    v_mfma_f32_16x16x32_bf16 v[20:23], a[148:151], v[212:215], v[20:23]
    buffer_load_dwordx4 a[56:59], v229, s[20:23], s9 offen offset:3072
    s_add_u32 s9, s84, 36864
    v_mfma_f32_16x16x32_bf16 v[24:27], a[136:139], v[208:211], v[24:27]
    ds_read_b64_tr_b16 v[204:205], v237 offset:53248
    v_mfma_f32_16x16x32_bf16 v[24:27], a[152:155], v[212:215], v[24:27]
    v_mfma_f32_16x16x32_bf16 v[28:31], a[140:143], v[208:211], v[28:31]
    ds_read_b64_tr_b16 v[206:207], v237 offset:53760
    v_mfma_f32_16x16x32_bf16 v[28:31], a[156:159], v[212:215], v[28:31]
    buffer_load_dwordx4 a[36:39], v229, s[20:23], s9 offen offset:0
    s_waitcnt lgkmcnt(6)
    v_mfma_f32_16x16x32_bf16 v[32:35], a[128:131], v[192:195], v[32:35]
    ds_read_b64_tr_b16 v[208:209], v234 offset:57344
    s_waitcnt lgkmcnt(5)
    v_mfma_f32_16x16x32_bf16 v[32:35], a[144:147], v[196:199], v[32:35]
    v_mfma_f32_16x16x32_bf16 v[36:39], a[132:135], v[192:195], v[36:39]
    ds_read_b64_tr_b16 v[210:211], v234 offset:57856
    v_mfma_f32_16x16x32_bf16 v[36:39], a[148:151], v[196:199], v[36:39]
    buffer_load_dwordx4 a[44:47], v229, s[20:23], s9 offen offset:1024
    v_mfma_f32_16x16x32_bf16 v[40:43], a[136:139], v[192:195], v[40:43]
    ds_read_b64_tr_b16 v[212:213], v234 offset:61440
    v_mfma_f32_16x16x32_bf16 v[40:43], a[152:155], v[196:199], v[40:43]
    v_mfma_f32_16x16x32_bf16 v[44:47], a[140:143], v[192:195], v[44:47]
    ds_read_b64_tr_b16 v[214:215], v234 offset:61952
    v_mfma_f32_16x16x32_bf16 v[44:47], a[156:159], v[196:199], v[44:47]
    buffer_load_dwordx4 a[52:55], v229, s[20:23], s9 offen offset:2048
    s_waitcnt lgkmcnt(6)
    v_mfma_f32_16x16x32_bf16 v[48:51], a[128:131], v[200:203], v[48:51]
    ds_read_b64_tr_b16 v[192:193], v235 offset:57344
    s_waitcnt lgkmcnt(5)
    v_mfma_f32_16x16x32_bf16 v[48:51], a[144:147], v[204:207], v[48:51]
    v_mfma_f32_16x16x32_bf16 v[52:55], a[132:135], v[200:203], v[52:55]
    ds_read_b64_tr_b16 v[194:195], v235 offset:57856
    v_mfma_f32_16x16x32_bf16 v[52:55], a[148:151], v[204:207], v[52:55]
    buffer_load_dwordx4 a[60:63], v229, s[20:23], s9 offen offset:3072
    s_add_u32 s9, s84, 8192
    v_mfma_f32_16x16x32_bf16 v[56:59], a[136:139], v[200:203], v[56:59]
    ds_read_b64_tr_b16 v[196:197], v235 offset:61440
    v_mfma_f32_16x16x32_bf16 v[56:59], a[152:155], v[204:207], v[56:59]
    buffer_load_dwordx4 a[64:67], v229, s[20:23], s9 offen offset:0
    v_mfma_f32_16x16x32_bf16 v[60:63], a[140:143], v[200:203], v[60:63]
    ds_read_b64_tr_b16 v[198:199], v235 offset:61952
    v_mfma_f32_16x16x32_bf16 v[60:63], a[156:159], v[204:207], v[60:63]
    s_waitcnt lgkmcnt(6)
    v_mfma_f32_16x16x32_bf16 v[0:3], a[160:163], v[208:211], v[0:3]
    ds_read_b64_tr_b16 v[200:201], v236 offset:57344
    s_waitcnt lgkmcnt(5)
    v_mfma_f32_16x16x32_bf16 v[0:3], a[176:179], v[212:215], v[0:3]
    buffer_load_dwordx4 a[72:75], v229, s[20:23], s9 offen offset:1024
    v_mfma_f32_16x16x32_bf16 v[4:7], a[164:167], v[208:211], v[4:7]
    ds_read_b64_tr_b16 v[202:203], v236 offset:57856
    v_mfma_f32_16x16x32_bf16 v[4:7], a[180:183], v[212:215], v[4:7]
    v_mfma_f32_16x16x32_bf16 v[8:11], a[168:171], v[208:211], v[8:11]
    ds_read_b64_tr_b16 v[204:205], v236 offset:61440
    v_mfma_f32_16x16x32_bf16 v[8:11], a[184:187], v[212:215], v[8:11]
    buffer_load_dwordx4 a[80:83], v229, s[20:23], s9 offen offset:2048
    v_mfma_f32_16x16x32_bf16 v[12:15], a[172:175], v[208:211], v[12:15]
    ds_read_b64_tr_b16 v[206:207], v236 offset:61952
    v_mfma_f32_16x16x32_bf16 v[12:15], a[188:191], v[212:215], v[12:15]
    s_barrier
    s_waitcnt lgkmcnt(6)
    v_mfma_f32_16x16x32_bf16 v[16:19], a[160:163], v[192:195], v[16:19]
    ds_read_b64_tr_b16 v[208:209], v237 offset:57344
    s_waitcnt lgkmcnt(5)
    v_mfma_f32_16x16x32_bf16 v[16:19], a[176:179], v[196:199], v[16:19]
    buffer_load_dwordx4 a[88:91], v229, s[20:23], s9 offen offset:3072
    s_add_u32 s9, s84, 40960
    v_mfma_f32_16x16x32_bf16 v[20:23], a[164:167], v[192:195], v[20:23]
    ds_read_b64_tr_b16 v[210:211], v237 offset:57856
    v_mfma_f32_16x16x32_bf16 v[20:23], a[180:183], v[196:199], v[20:23]
    v_mfma_f32_16x16x32_bf16 v[24:27], a[168:171], v[192:195], v[24:27]
    ds_read_b64_tr_b16 v[212:213], v237 offset:61440
    v_mfma_f32_16x16x32_bf16 v[24:27], a[184:187], v[196:199], v[24:27]
    buffer_load_dwordx4 a[68:71], v229, s[20:23], s9 offen offset:0
    v_mfma_f32_16x16x32_bf16 v[28:31], a[172:175], v[192:195], v[28:31]
    ds_read_b64_tr_b16 v[214:215], v237 offset:61952
    v_mfma_f32_16x16x32_bf16 v[28:31], a[188:191], v[196:199], v[28:31]
    s_waitcnt lgkmcnt(6)
    v_mfma_f32_16x16x32_bf16 v[32:35], a[160:163], v[200:203], v[32:35]
    ds_read_b64_tr_b16 v[192:193], v224 offset:49152
    s_waitcnt lgkmcnt(5)
    v_mfma_f32_16x16x32_bf16 v[32:35], a[176:179], v[204:207], v[32:35]
    buffer_load_dwordx4 a[76:79], v229, s[20:23], s9 offen offset:1024
    v_mfma_f32_16x16x32_bf16 v[36:39], a[164:167], v[200:203], v[36:39]
    ds_read_b64_tr_b16 v[194:195], v224 offset:49664
    v_mfma_f32_16x16x32_bf16 v[36:39], a[180:183], v[204:207], v[36:39]
    v_mfma_f32_16x16x32_bf16 v[40:43], a[168:171], v[200:203], v[40:43]
    ds_read_b64_tr_b16 v[196:197], v224 offset:53248
    v_mfma_f32_16x16x32_bf16 v[40:43], a[184:187], v[204:207], v[40:43]
    buffer_load_dwordx4 a[84:87], v229, s[20:23], s9 offen offset:2048
    v_mfma_f32_16x16x32_bf16 v[44:47], a[172:175], v[200:203], v[44:47]
    ds_read_b64_tr_b16 v[198:199], v224 offset:53760
    v_mfma_f32_16x16x32_bf16 v[44:47], a[188:191], v[204:207], v[44:47]
    s_waitcnt lgkmcnt(6)
    v_mfma_f32_16x16x32_bf16 v[48:51], a[160:163], v[208:211], v[48:51]
    ds_read_b64_tr_b16 v[200:201], v225 offset:49152
    s_waitcnt lgkmcnt(5)
    v_mfma_f32_16x16x32_bf16 v[48:51], a[176:179], v[212:215], v[48:51]
    buffer_load_dwordx4 a[92:95], v229, s[20:23], s9 offen offset:3072
    s_add_u32 s9, s84, 12288
    v_mfma_f32_16x16x32_bf16 v[52:55], a[164:167], v[208:211], v[52:55]
    ds_read_b64_tr_b16 v[202:203], v225 offset:49664
    v_mfma_f32_16x16x32_bf16 v[52:55], a[180:183], v[212:215], v[52:55]
    buffer_load_dwordx4 a[96:99], v229, s[20:23], s9 offen offset:0
    v_mfma_f32_16x16x32_bf16 v[56:59], a[168:171], v[208:211], v[56:59]
    ds_read_b64_tr_b16 v[204:205], v225 offset:53248
    v_mfma_f32_16x16x32_bf16 v[56:59], a[184:187], v[212:215], v[56:59]
    v_mfma_f32_16x16x32_bf16 v[60:63], a[172:175], v[208:211], v[60:63]
    ds_read_b64_tr_b16 v[206:207], v225 offset:53760
    v_mfma_f32_16x16x32_bf16 v[60:63], a[188:191], v[212:215], v[60:63]
    buffer_load_dwordx4 a[104:107], v229, s[20:23], s9 offen offset:1024
    s_waitcnt lgkmcnt(6)
    v_mfma_f32_16x16x32_bf16 v[0:3], a[192:195], v[192:195], v[0:3]
    ds_read_b64_tr_b16 v[208:209], v226 offset:49152
    s_waitcnt lgkmcnt(5)
    v_mfma_f32_16x16x32_bf16 v[0:3], a[208:211], v[196:199], v[0:3]
    v_mfma_f32_16x16x32_bf16 v[4:7], a[196:199], v[192:195], v[4:7]
    ds_read_b64_tr_b16 v[210:211], v226 offset:49664
    v_mfma_f32_16x16x32_bf16 v[4:7], a[212:215], v[196:199], v[4:7]
    buffer_load_dwordx4 a[112:115], v229, s[20:23], s9 offen offset:2048
    v_mfma_f32_16x16x32_bf16 v[8:11], a[200:203], v[192:195], v[8:11]
    ds_read_b64_tr_b16 v[212:213], v226 offset:53248
    v_mfma_f32_16x16x32_bf16 v[8:11], a[216:219], v[196:199], v[8:11]
    v_mfma_f32_16x16x32_bf16 v[12:15], a[204:207], v[192:195], v[12:15]
    ds_read_b64_tr_b16 v[214:215], v226 offset:53760
    v_mfma_f32_16x16x32_bf16 v[12:15], a[220:223], v[196:199], v[12:15]
    buffer_load_dwordx4 a[120:123], v229, s[20:23], s9 offen offset:3072
    s_add_u32 s9, s84, 45056
    s_waitcnt lgkmcnt(6)
    v_mfma_f32_16x16x32_bf16 v[16:19], a[192:195], v[200:203], v[16:19]
    ds_read_b64_tr_b16 v[192:193], v227 offset:49152
    s_waitcnt lgkmcnt(5)
    v_mfma_f32_16x16x32_bf16 v[16:19], a[208:211], v[204:207], v[16:19]
    v_mfma_f32_16x16x32_bf16 v[20:23], a[196:199], v[200:203], v[20:23]
    ds_read_b64_tr_b16 v[194:195], v227 offset:49664
    v_mfma_f32_16x16x32_bf16 v[20:23], a[212:215], v[204:207], v[20:23]
    buffer_load_dwordx4 a[100:103], v229, s[20:23], s9 offen offset:0
    v_mfma_f32_16x16x32_bf16 v[24:27], a[200:203], v[200:203], v[24:27]
    ds_read_b64_tr_b16 v[196:197], v227 offset:53248
    v_mfma_f32_16x16x32_bf16 v[24:27], a[216:219], v[204:207], v[24:27]
    v_mfma_f32_16x16x32_bf16 v[28:31], a[204:207], v[200:203], v[28:31]
    ds_read_b64_tr_b16 v[198:199], v227 offset:53760
    v_mfma_f32_16x16x32_bf16 v[28:31], a[220:223], v[204:207], v[28:31]
    buffer_load_dwordx4 a[108:111], v229, s[20:23], s9 offen offset:1024
    s_waitcnt lgkmcnt(6)
    v_mfma_f32_16x16x32_bf16 v[32:35], a[192:195], v[208:211], v[32:35]
    ds_read_b64_tr_b16 v[200:201], v224 offset:57344
    s_waitcnt lgkmcnt(5)
    v_mfma_f32_16x16x32_bf16 v[32:35], a[208:211], v[212:215], v[32:35]
    v_mfma_f32_16x16x32_bf16 v[36:39], a[196:199], v[208:211], v[36:39]
    ds_read_b64_tr_b16 v[202:203], v224 offset:57856
    v_mfma_f32_16x16x32_bf16 v[36:39], a[212:215], v[212:215], v[36:39]
    buffer_load_dwordx4 a[116:119], v229, s[20:23], s9 offen offset:2048
    v_mfma_f32_16x16x32_bf16 v[40:43], a[200:203], v[208:211], v[40:43]
    ds_read_b64_tr_b16 v[204:205], v224 offset:61440
    v_mfma_f32_16x16x32_bf16 v[40:43], a[216:219], v[212:215], v[40:43]
    v_mfma_f32_16x16x32_bf16 v[44:47], a[204:207], v[208:211], v[44:47]
    ds_read_b64_tr_b16 v[206:207], v224 offset:61952
    v_mfma_f32_16x16x32_bf16 v[44:47], a[220:223], v[212:215], v[44:47]
    buffer_load_dwordx4 a[124:127], v229, s[20:23], s9 offen offset:3072
    s_waitcnt lgkmcnt(6)
    v_mfma_f32_16x16x32_bf16 v[48:51], a[192:195], v[192:195], v[48:51]
    ds_read_b64_tr_b16 v[208:209], v225 offset:57344
    s_waitcnt lgkmcnt(5)
    v_mfma_f32_16x16x32_bf16 v[48:51], a[208:211], v[196:199], v[48:51]
    v_mfma_f32_16x16x32_bf16 v[52:55], a[196:199], v[192:195], v[52:55]
    ds_read_b64_tr_b16 v[210:211], v225 offset:57856
    v_mfma_f32_16x16x32_bf16 v[52:55], a[212:215], v[196:199], v[52:55]
    v_mfma_f32_16x16x32_bf16 v[56:59], a[200:203], v[192:195], v[56:59]
    ds_read_b64_tr_b16 v[212:213], v225 offset:61440
    v_mfma_f32_16x16x32_bf16 v[56:59], a[216:219], v[196:199], v[56:59]
    v_mfma_f32_16x16x32_bf16 v[60:63], a[204:207], v[192:195], v[60:63]
    ds_read_b64_tr_b16 v[214:215], v225 offset:61952
    v_mfma_f32_16x16x32_bf16 v[60:63], a[220:223], v[196:199], v[60:63]
    s_waitcnt lgkmcnt(6)
    v_mfma_f32_16x16x32_bf16 v[0:3], a[224:227], v[200:203], v[0:3]
    ds_read_b64_tr_b16 v[192:193], v226 offset:57344
    s_waitcnt lgkmcnt(5)
    v_mfma_f32_16x16x32_bf16 v[0:3], a[240:243], v[204:207], v[0:3]
    v_mfma_f32_16x16x32_bf16 v[4:7], a[228:231], v[200:203], v[4:7]
    ds_read_b64_tr_b16 v[194:195], v226 offset:57856
    v_mfma_f32_16x16x32_bf16 v[4:7], a[244:247], v[204:207], v[4:7]
    v_mfma_f32_16x16x32_bf16 v[8:11], a[232:235], v[200:203], v[8:11]
    ds_read_b64_tr_b16 v[196:197], v226 offset:61440
    v_mfma_f32_16x16x32_bf16 v[8:11], a[248:251], v[204:207], v[8:11]
    v_mfma_f32_16x16x32_bf16 v[12:15], a[236:239], v[200:203], v[12:15]
    ds_read_b64_tr_b16 v[198:199], v226 offset:61952
    v_mfma_f32_16x16x32_bf16 v[12:15], a[252:255], v[204:207], v[12:15]
    s_waitcnt lgkmcnt(6)
    v_mfma_f32_16x16x32_bf16 v[16:19], a[224:227], v[208:211], v[16:19]
    ds_read_b64_tr_b16 v[200:201], v227 offset:57344
    s_waitcnt lgkmcnt(5)
    v_mfma_f32_16x16x32_bf16 v[16:19], a[240:243], v[212:215], v[16:19]
    v_mfma_f32_16x16x32_bf16 v[20:23], a[228:231], v[208:211], v[20:23]
    ds_read_b64_tr_b16 v[202:203], v227 offset:57856
    v_mfma_f32_16x16x32_bf16 v[20:23], a[244:247], v[212:215], v[20:23]
    v_cvt_pk_bf16_f32 v0, v0, v1
    v_cvt_pk_bf16_f32 v1, v2, v3
    v_mfma_f32_16x16x32_bf16 v[24:27], a[232:235], v[208:211], v[24:27]
    ds_read_b64_tr_b16 v[204:205], v227 offset:61440
    v_cvt_pk_bf16_f32 v2, v4, v5
    v_mfma_f32_16x16x32_bf16 v[24:27], a[248:251], v[212:215], v[24:27]
    v_cvt_pk_bf16_f32 v3, v6, v7
    v_mfma_f32_16x16x32_bf16 v[28:31], a[236:239], v[208:211], v[28:31]
    ds_read_b64_tr_b16 v[206:207], v227 offset:61952
    v_mfma_f32_16x16x32_bf16 v[28:31], a[252:255], v[212:215], v[28:31]
    buffer_store_dwordx4 v[0:3], v243, s[20:23], s60 offen offset:2048 sc1
    v_cvt_pk_bf16_f32 v8, v8, v9
    s_waitcnt lgkmcnt(6)
    v_mfma_f32_16x16x32_bf16 v[32:35], a[224:227], v[192:195], v[32:35]
    ds_read_b64_tr_b16 v[128:129], v248 offset:0
    v_cvt_pk_bf16_f32 v9, v10, v11
    v_cvt_pk_bf16_f32 v10, v12, v13
    s_waitcnt lgkmcnt(5)
    v_mfma_f32_16x16x32_bf16 v[32:35], a[240:243], v[196:199], v[32:35]
    ds_read_b64_tr_b16 v[130:131], v248 offset:1024
    v_cvt_pk_bf16_f32 v11, v14, v15
    v_mfma_f32_16x16x32_bf16 v[36:39], a[228:231], v[192:195], v[36:39]
    buffer_store_dwordx4 v[8:11], v243, s[20:23], s62 offen offset:2048 sc1
    ds_read_b64_tr_b16 v[132:133], v249 offset:0
    v_mfma_f32_16x16x32_bf16 v[36:39], a[244:247], v[196:199], v[36:39]
    ds_read_b64_tr_b16 v[134:135], v249 offset:1024
    v_cvt_pk_bf16_f32 v16, v16, v17
    v_cvt_pk_bf16_f32 v17, v18, v19
    v_mfma_f32_16x16x32_bf16 v[40:43], a[232:235], v[192:195], v[40:43]
    ds_read_b64_tr_b16 v[136:137], v250 offset:0
    v_cvt_pk_bf16_f32 v18, v20, v21
    v_cvt_pk_bf16_f32 v19, v22, v23
    v_mfma_f32_16x16x32_bf16 v[40:43], a[248:251], v[196:199], v[40:43]
    buffer_store_dwordx4 v[16:19], v243, s[20:23], s60 offen offset:2304 sc1
    ds_read_b64_tr_b16 v[138:139], v250 offset:1024
    v_cvt_pk_bf16_f32 v24, v24, v25
    v_mfma_f32_16x16x32_bf16 v[44:47], a[236:239], v[192:195], v[44:47]
    ds_read_b64_tr_b16 v[140:141], v251 offset:0
    v_cvt_pk_bf16_f32 v25, v26, v27
    v_cvt_pk_bf16_f32 v26, v28, v29
    v_mfma_f32_16x16x32_bf16 v[44:47], a[252:255], v[196:199], v[44:47]
    ds_read_b64_tr_b16 v[142:143], v251 offset:1024
    v_cvt_pk_bf16_f32 v27, v30, v31
    s_waitcnt lgkmcnt(10)
    v_mfma_f32_16x16x32_bf16 v[48:51], a[224:227], v[200:203], v[48:51]
    buffer_store_dwordx4 v[24:27], v243, s[20:23], s62 offen offset:2304 sc1
    ds_read_b64_tr_b16 v[144:145], v248 offset:4096
    s_waitcnt lgkmcnt(9)
    v_mfma_f32_16x16x32_bf16 v[48:51], a[240:243], v[204:207], v[48:51]
    ds_read_b64_tr_b16 v[146:147], v248 offset:5120
    v_mfma_f32_16x16x32_bf16 v[52:55], a[228:231], v[200:203], v[52:55]
    ds_read_b64_tr_b16 v[148:149], v249 offset:4096
    v_mfma_f32_16x16x32_bf16 v[52:55], a[244:247], v[204:207], v[52:55]
    ds_read_b64_tr_b16 v[150:151], v249 offset:5120
    v_cvt_pk_bf16_f32 v32, v32, v33
    v_cvt_pk_bf16_f32 v33, v34, v35
    v_mfma_f32_16x16x32_bf16 v[56:59], a[232:235], v[200:203], v[56:59]
    ds_read_b64_tr_b16 v[152:153], v250 offset:4096
    v_cvt_pk_bf16_f32 v34, v36, v37
    v_cvt_pk_bf16_f32 v35, v38, v39
    v_mfma_f32_16x16x32_bf16 v[56:59], a[248:251], v[204:207], v[56:59]
    buffer_store_dwordx4 v[32:35], v243, s[20:23], s60 offen offset:3072 sc1
    ds_read_b64_tr_b16 v[154:155], v250 offset:5120
    v_cvt_pk_bf16_f32 v40, v40, v41
    v_mfma_f32_16x16x32_bf16 v[60:63], a[236:239], v[200:203], v[60:63]
    ds_read_b64_tr_b16 v[156:157], v251 offset:4096
    v_cvt_pk_bf16_f32 v41, v42, v43
    v_cvt_pk_bf16_f32 v42, v44, v45
    v_mfma_f32_16x16x32_bf16 v[60:63], a[252:255], v[204:207], v[60:63]
    ds_read_b64_tr_b16 v[158:159], v251 offset:5120
    v_cvt_pk_bf16_f32 v43, v46, v47
    buffer_store_dwordx4 v[40:43], v243, s[20:23], s62 offen offset:3072 sc1
    s_waitcnt vmcnt(37) lgkmcnt(14)
    v_mfma_f32_32x32x16_bf16 v[0:15], v[128:131], a[0:3], 0
    ds_read_b64_tr_b16 v[232:233], v248 offset:8192
    v_cvt_pk_bf16_f32 v48, v48, v49
    v_cvt_pk_bf16_f32 v49, v50, v51
    v_cvt_pk_bf16_f32 v50, v52, v53
    v_cvt_pk_bf16_f32 v51, v54, v55
    buffer_store_dwordx4 v[48:51], v243, s[20:23], s60 offen offset:3328 sc1
    v_cvt_pk_bf16_f32 v56, v56, v57
    s_waitcnt vmcnt(34)
    v_mfma_f32_32x32x16_bf16 v[64:79], v[128:131], a[4:7], 0
    ds_read_b64_tr_b16 v[234:235], v248 offset:9216
    v_cvt_pk_bf16_f32 v57, v58, v59
    v_cvt_pk_bf16_f32 v58, v60, v61
    v_cvt_pk_bf16_f32 v59, v62, v63
    buffer_store_dwordx4 v[56:59], v243, s[20:23], s62 offen offset:3328 sc1
    s_waitcnt lgkmcnt(14)
    v_mfma_f32_32x32x16_bf16 v[16:31], v[132:135], a[0:3], 0
    ds_read_b64_tr_b16 v[236:237], v249 offset:8192
    v_mfma_f32_32x32x16_bf16 v[80:95], v[132:135], a[4:7], 0
    ds_read_b64_tr_b16 v[238:239], v249 offset:9216
    s_waitcnt lgkmcnt(14)
    v_mfma_f32_32x32x16_bf16 v[32:47], v[136:139], a[0:3], 0
    ds_read_b64_tr_b16 v[240:241], v250 offset:8192
    v_mfma_f32_32x32x16_bf16 v[96:111], v[136:139], a[4:7], 0
    ds_read_b64_tr_b16 v[242:243], v250 offset:9216
    s_waitcnt lgkmcnt(14)
    v_mfma_f32_32x32x16_bf16 v[48:63], v[140:143], a[0:3], 0
    ds_read_b64_tr_b16 v[244:245], v251 offset:8192
    v_readlane_b32 s66, v218, 0
    v_readlane_b32 s48, v218, 1
    v_readlane_b32 s49, v218, 2
    v_mfma_f32_32x32x16_bf16 v[112:127], v[140:143], a[4:7], 0
    ds_read_b64_tr_b16 v[246:247], v251 offset:9216
    v_readlane_b32 s51, v218, 3
    v_readlane_b32 s50, v218, 4
    v_readlane_b32 s52, v218, 5
    s_waitcnt lgkmcnt(14)
    v_mfma_f32_32x32x16_bf16 v[0:15], v[144:147], a[8:11], v[0:15]
    ds_read_b64_tr_b16 v[128:129], v248 offset:12288
    s_cmp_eq_u32 s40, 1
    s_cselect_b32 s62, s86, 0xf0000000
    s_cselect_b32 s63, 0, 0xff
    v_readlane_b32 s53, v218, 6
    v_readlane_b32 s54, v218, 7
    v_readlane_b32 s55, v218, 8
    s_waitcnt vmcnt(34)
    v_mfma_f32_32x32x16_bf16 v[64:79], v[144:147], a[12:15], v[64:79]
    ds_read_b64_tr_b16 v[130:131], v248 offset:13312
    v_readlane_b32 s41, v218, 9
    v_readlane_b32 s47, v218, 10
    v_readlane_b32 s43, v218, 11
    s_waitcnt lgkmcnt(14)
    v_mfma_f32_32x32x16_bf16 v[16:31], v[148:151], a[8:11], v[16:31]
    ds_read_b64_tr_b16 v[132:133], v249 offset:12288
    v_readlane_b32 s44, v218, 12
    v_readlane_b32 s68, v218, 13
    v_readlane_b32 s69, v218, 14
    v_mfma_f32_32x32x16_bf16 v[80:95], v[148:151], a[12:15], v[80:95]
    ds_read_b64_tr_b16 v[134:135], v249 offset:13312
    v_and_b32 v161, 15, v253
    v_lshrrev_b32 v162, 5, v253
    v_bfe_u32 v163, v253, 4, 1
    s_waitcnt lgkmcnt(14)
    v_mfma_f32_32x32x16_bf16 v[32:47], v[152:155], a[8:11], v[32:47]
    ds_read_b64_tr_b16 v[136:137], v250 offset:12288
    v_lshlrev_b32 v163, 17, v163
    v_lshl_add_u32 v163, v162, 8, v163
    v_lshl_add_u32 v230, v161, 4, v163
    v_mfma_f32_32x32x16_bf16 v[96:111], v[152:155], a[12:15], v[96:111]
    ds_read_b64_tr_b16 v[138:139], v250 offset:13312
    v_and_b32 v163, 31, v253
    v_lshlrev_b32 v162, 2, v162
    v_sub_u32 v163, v163, v162
    s_waitcnt lgkmcnt(14)
    v_mfma_f32_32x32x16_bf16 v[48:63], v[156:159], a[8:11], v[48:63]
    ds_read_b64_tr_b16 v[140:141], v251 offset:12288
    v_cmp_gt_i32 s[10:11], 0, v163
    v_cmp_gt_i32 s[12:13], 1, v163
    v_cmp_gt_i32 s[14:15], 2, v163
    v_mfma_f32_32x32x16_bf16 v[112:127], v[156:159], a[12:15], v[112:127]
    ds_read_b64_tr_b16 v[142:143], v251 offset:13312
    v_cmp_gt_i32 s[16:17], 3, v163
    v_cmp_gt_i32 s[18:19], 16, v163
    v_cmp_gt_i32 s[24:25], 17, v163
    s_barrier
    s_waitcnt lgkmcnt(14)
    v_mfma_f32_32x32x16_bf16 v[0:15], v[232:235], a[16:19], v[0:15]
    ds_read_b64_tr_b16 v[144:145], v248 offset:16384
    v_cmp_gt_i32 s[26:27], 18, v163
    v_cmp_gt_i32 s[28:29], 19, v163
    v_cmp_gt_i32 s[30:31], 8, v163
    s_waitcnt vmcnt(33)
    v_mfma_f32_32x32x16_bf16 v[64:79], v[232:235], a[20:23], v[64:79]
    ds_read_b64_tr_b16 v[146:147], v248 offset:17408
    s_add_u32 m0, s46, 49152
    s_add_u32 s8, s45, 1572864
    buffer_load_dwordx4 v231, s[4:7], s8 offen offset:0 lds
    v_cmp_gt_i32 s[32:33], 9, v163
    v_cmp_gt_i32 s[34:35], 10, v163
    v_cmp_gt_i32 s[36:37], 11, v163
    s_waitcnt lgkmcnt(14)
    v_mfma_f32_32x32x16_bf16 v[16:31], v[236:239], a[16:19], v[16:31]
    ds_read_b64_tr_b16 v[148:149], v249 offset:16384
    v_cmp_gt_i32 s[38:39], 24, v163
    v_cmp_gt_i32 s[56:57], 25, v163
    v_cmp_gt_i32 s[58:59], 26, v163
    v_mfma_f32_32x32x16_bf16 v[80:95], v[236:239], a[20:23], v[80:95]
    ds_read_b64_tr_b16 v[150:151], v249 offset:17408
    s_add_u32 s8, s8, 31744
    buffer_load_dwordx4 v231, s[4:7], s8 offen offset:1024 lds
    v_cmp_gt_i32 s[60:61], 27, v163
    s_mov_b32 s3, 0xff800000
    v_lshrrev_b32 v163, 3, v253
    s_waitcnt lgkmcnt(14)
    v_mfma_f32_32x32x16_bf16 v[32:47], v[240:243], a[16:19], v[32:47]
    ds_read_b64_tr_b16 v[152:153], v250 offset:16384
    v_and_b32 v161, 7, v253
    v_lshlrev_b32 v161, 4, v161
    v_lshl_add_u32 v254, v163, 10, v161
    v_mfma_f32_32x32x16_bf16 v[96:111], v[240:243], a[20:23], v[96:111]
    ds_read_b64_tr_b16 v[154:155], v250 offset:17408
    s_add_u32 s8, s8, 31744
    buffer_load_dwordx4 v231, s[4:7], s8 offen offset:2048 lds
    v_mul_u32_u24 v163, 2752, v163
    v_add_u32 v252, v163, v161
    v_lshrrev_b32 v200, 3, v255
    s_waitcnt lgkmcnt(14)
    v_mfma_f32_32x32x16_bf16 v[48:63], v[244:247], a[16:19], v[48:63]
    ds_read_b64_tr_b16 v[156:157], v251 offset:16384
    v_and_b32 v201, 7, v255
    v_mul_u32_u24 v202, 11008, v200
    v_lshl_add_u32 v202, v201, 4, v202
    v_mfma_f32_32x32x16_bf16 v[112:127], v[244:247], a[20:23], v[112:127]
    ds_read_b64_tr_b16 v[158:159], v251 offset:17408
    s_add_u32 s8, s8, 31744
    buffer_load_dwordx4 v231, s[4:7], s8 offen offset:3072 lds
    v_lshlrev_b32 v200, 4, v200
    v_lshrrev_b32 v206, 4, v253
    v_mul_u32_u24 v206, 12288, v206
    s_waitcnt lgkmcnt(14)
    v_mfma_f32_32x32x16_bf16 v[0:15], v[128:131], a[24:27], v[0:15]
    ds_read_b64_tr_b16 v[232:233], v248 offset:20480
    v_and_b32 v207, 15, v253
    v_lshl_add_u32 v206, v207, 2, v206
    v_lshlrev_b32 v207, 2, v207
    s_waitcnt vmcnt(36)
    v_mfma_f32_32x32x16_bf16 v[64:79], v[128:131], a[28:31], v[64:79]
    ds_read_b64_tr_b16 v[234:235], v248 offset:21504
    v_lshlrev_b32 v203, 22, v255
    v_and_b32 v203, 0xe0000000, v203
    s_waitcnt lgkmcnt(14)
    v_mfma_f32_32x32x16_bf16 v[16:31], v[132:135], a[24:27], v[16:31]
    ds_read_b64_tr_b16 v[236:237], v249 offset:20480
    v_mfma_f32_32x32x16_bf16 v[80:95], v[132:135], a[28:31], v[80:95]
    ds_read_b64_tr_b16 v[238:239], v249 offset:21504
    s_cmp_eq_u32 s40, 2
    s_mov_b32 s64, 532480
    s_cselect_b32 s64, s64, 0xf0000000
    s_waitcnt lgkmcnt(14)
    v_mfma_f32_32x32x16_bf16 v[32:47], v[136:139], a[24:27], v[32:47]
    ds_read_b64_tr_b16 v[240:241], v250 offset:20480
    v_and_b32 v165, 7, v253
    v_lshlrev_b32 v165, 7, v165
    v_mfma_f32_32x32x16_bf16 v[96:111], v[136:139], a[28:31], v[96:111]
    ds_read_b64_tr_b16 v[242:243], v250 offset:21504
    buffer_load_dword v164, v165, s[20:23], s64 offen sc1
    s_waitcnt lgkmcnt(14)
    v_mfma_f32_32x32x16_bf16 v[48:63], v[140:143], a[24:27], v[48:63]
    ds_read_b64_tr_b16 v[244:245], v251 offset:20480
    v_mfma_f32_32x32x16_bf16 v[112:127], v[140:143], a[28:31], v[112:127]
    ds_read_b64_tr_b16 v[246:247], v251 offset:21504
    s_waitcnt vmcnt(36) lgkmcnt(14)
    v_mfma_f32_32x32x16_bf16 v[0:15], v[144:147], a[32:35], v[0:15]
    ds_read_b64_tr_b16 v[128:129], v248 offset:24576
    s_waitcnt vmcnt(32)
    v_mfma_f32_32x32x16_bf16 v[64:79], v[144:147], a[36:39], v[64:79]
    ds_read_b64_tr_b16 v[130:131], v248 offset:25600
    s_add_u32 m0, s46, 65536
    s_add_u32 s8, s45, 2097152
    buffer_load_dwordx4 v231, s[4:7], s8 offen offset:0 lds
    s_waitcnt lgkmcnt(14)
    v_mfma_f32_32x32x16_bf16 v[16:31], v[148:151], a[32:35], v[16:31]
    ds_read_b64_tr_b16 v[132:133], v249 offset:24576
    v_mfma_f32_32x32x16_bf16 v[80:95], v[148:151], a[36:39], v[80:95]
    ds_read_b64_tr_b16 v[134:135], v249 offset:25600
    s_add_u32 s8, s8, 31744
    buffer_load_dwordx4 v231, s[4:7], s8 offen offset:1024 lds
    s_waitcnt lgkmcnt(14)
    v_mfma_f32_32x32x16_bf16 v[32:47], v[152:155], a[32:35], v[32:47]
    ds_read_b64_tr_b16 v[136:137], v250 offset:24576
    v_mfma_f32_32x32x16_bf16 v[96:111], v[152:155], a[36:39], v[96:111]
    ds_read_b64_tr_b16 v[138:139], v250 offset:25600
    s_add_u32 s8, s8, 31744
    buffer_load_dwordx4 v231, s[4:7], s8 offen offset:2048 lds
    s_waitcnt lgkmcnt(14)
    v_mfma_f32_32x32x16_bf16 v[48:63], v[156:159], a[32:35], v[48:63]
    ds_read_b64_tr_b16 v[140:141], v251 offset:24576
    v_mfma_f32_32x32x16_bf16 v[112:127], v[156:159], a[36:39], v[112:127]
    ds_read_b64_tr_b16 v[142:143], v251 offset:25600
    s_add_u32 s8, s8, 31744
    buffer_load_dwordx4 v231, s[4:7], s8 offen offset:3072 lds
    s_waitcnt lgkmcnt(14)
    v_mfma_f32_32x32x16_bf16 v[0:15], v[232:235], a[40:43], v[0:15]
    ds_read_b64_tr_b16 v[144:145], v248 offset:28672
    s_waitcnt vmcnt(35)
    v_mfma_f32_32x32x16_bf16 v[64:79], v[232:235], a[44:47], v[64:79]
    ds_read_b64_tr_b16 v[146:147], v248 offset:29696
    s_add_u32 s9, s84, 16384
    buffer_load_dwordx4 a[128:131], v229, s[20:23], s9 offen offset:0
    s_waitcnt lgkmcnt(14)
    v_mfma_f32_32x32x16_bf16 v[16:31], v[236:239], a[40:43], v[16:31]
    ds_read_b64_tr_b16 v[148:149], v249 offset:28672
    v_mfma_f32_32x32x16_bf16 v[80:95], v[236:239], a[44:47], v[80:95]
    ds_read_b64_tr_b16 v[150:151], v249 offset:29696
    buffer_load_dwordx4 a[136:139], v229, s[20:23], s9 offen offset:1024
    s_waitcnt lgkmcnt(14)
    v_mfma_f32_32x32x16_bf16 v[32:47], v[240:243], a[40:43], v[32:47]
    ds_read_b64_tr_b16 v[152:153], v250 offset:28672
    v_mfma_f32_32x32x16_bf16 v[96:111], v[240:243], a[44:47], v[96:111]
    ds_read_b64_tr_b16 v[154:155], v250 offset:29696
    buffer_load_dwordx4 a[144:147], v229, s[20:23], s9 offen offset:2048
    s_waitcnt lgkmcnt(14)
    v_mfma_f32_32x32x16_bf16 v[48:63], v[244:247], a[40:43], v[48:63]
    ds_read_b64_tr_b16 v[156:157], v251 offset:28672
    v_mov_b32 v221, s101
    v_mfma_f32_32x32x16_bf16 v[112:127], v[244:247], a[44:47], v[112:127]
    ds_read_b64_tr_b16 v[158:159], v251 offset:29696
    buffer_load_dwordx4 a[152:155], v229, s[20:23], s9 offen offset:3072
    s_waitcnt vmcnt(13)
    s_barrier
    s_waitcnt lgkmcnt(14)
    v_mfma_f32_32x32x16_bf16 v[0:15], v[128:131], a[48:51], v[0:15]
    ds_read_b64_tr_b16 v[232:233], v248 offset:32768
    buffer_atomic_add v221, v220, s[20:23], s86 offen sc1
    v_mfma_f32_32x32x16_bf16 v[64:79], v[128:131], a[52:55], v[64:79]
    ds_read_b64_tr_b16 v[234:235], v248 offset:33792
    s_add_u32 s9, s84, 49152
    buffer_load_dwordx4 a[132:135], v229, s[20:23], s9 offen offset:0
    s_mov_b32 s100, 0xff800000
    s_mov_b32 s101, 0xff800000
    s_waitcnt lgkmcnt(14)
    v_mfma_f32_32x32x16_bf16 v[16:31], v[132:135], a[48:51], v[16:31]
    ds_read_b64_tr_b16 v[236:237], v249 offset:32768
    v_mfma_f32_32x32x16_bf16 v[80:95], v[132:135], a[52:55], v[80:95]
    ds_read_b64_tr_b16 v[238:239], v249 offset:33792
    buffer_load_dwordx4 a[140:143], v229, s[20:23], s9 offen offset:1024
    s_waitcnt lgkmcnt(14)
    v_mfma_f32_32x32x16_bf16 v[32:47], v[136:139], a[48:51], v[32:47]
    ds_read_b64_tr_b16 v[240:241], v250 offset:32768
    v_mfma_f32_32x32x16_bf16 v[96:111], v[136:139], a[52:55], v[96:111]
    ds_read_b64_tr_b16 v[242:243], v250 offset:33792
    buffer_load_dwordx4 a[148:151], v229, s[20:23], s9 offen offset:2048
    s_waitcnt lgkmcnt(14)
    v_mfma_f32_32x32x16_bf16 v[48:63], v[140:143], a[48:51], v[48:63]
    ds_read_b64_tr_b16 v[244:245], v251 offset:32768
    v_mfma_f32_32x32x16_bf16 v[112:127], v[140:143], a[52:55], v[112:127]
    ds_read_b64_tr_b16 v[246:247], v251 offset:33792
    buffer_load_dwordx4 a[156:159], v229, s[20:23], s9 offen offset:3072
    s_waitcnt lgkmcnt(14)
    v_mfma_f32_32x32x16_bf16 v[0:15], v[144:147], a[56:59], v[0:15]
    ds_read_b64_tr_b16 v[128:129], v248 offset:36864
    v_mfma_f32_32x32x16_bf16 v[64:79], v[144:147], a[60:63], v[64:79]
    ds_read_b64_tr_b16 v[130:131], v248 offset:37888
    s_waitcnt lgkmcnt(14)
    v_mfma_f32_32x32x16_bf16 v[16:31], v[148:151], a[56:59], v[16:31]
    ds_read_b64_tr_b16 v[132:133], v249 offset:36864
    v_mfma_f32_32x32x16_bf16 v[80:95], v[148:151], a[60:63], v[80:95]
    ds_read_b64_tr_b16 v[134:135], v249 offset:37888
    s_waitcnt lgkmcnt(14)
    v_mfma_f32_32x32x16_bf16 v[32:47], v[152:155], a[56:59], v[32:47]
    ds_read_b64_tr_b16 v[136:137], v250 offset:36864
    v_mfma_f32_32x32x16_bf16 v[96:111], v[152:155], a[60:63], v[96:111]
    ds_read_b64_tr_b16 v[138:139], v250 offset:37888
    s_waitcnt lgkmcnt(14)
    v_mfma_f32_32x32x16_bf16 v[48:63], v[156:159], a[56:59], v[48:63]
    ds_read_b64_tr_b16 v[140:141], v251 offset:36864
    v_mfma_f32_32x32x16_bf16 v[112:127], v[156:159], a[60:63], v[112:127]
    ds_read_b64_tr_b16 v[142:143], v251 offset:37888
    s_waitcnt lgkmcnt(14)
    v_mfma_f32_32x32x16_bf16 v[0:15], v[232:235], a[64:67], v[0:15]
    ds_read_b64_tr_b16 v[144:145], v248 offset:40960
    v_mfma_f32_32x32x16_bf16 v[64:79], v[232:235], a[68:71], v[64:79]
    ds_read_b64_tr_b16 v[146:147], v248 offset:41984
    s_add_u32 m0, s46, 81920
    s_add_u32 s8, s45, 2621440
    buffer_load_dwordx4 v231, s[4:7], s8 offen offset:0 lds
    s_waitcnt lgkmcnt(14)
    v_mfma_f32_32x32x16_bf16 v[16:31], v[236:239], a[64:67], v[16:31]
    ds_read_b64_tr_b16 v[148:149], v249 offset:40960
    v_mfma_f32_32x32x16_bf16 v[80:95], v[236:239], a[68:71], v[80:95]
    ds_read_b64_tr_b16 v[150:151], v249 offset:41984
    s_add_u32 s8, s8, 31744
    buffer_load_dwordx4 v231, s[4:7], s8 offen offset:1024 lds
    s_waitcnt lgkmcnt(14)
    v_mfma_f32_32x32x16_bf16 v[32:47], v[240:243], a[64:67], v[32:47]
    ds_read_b64_tr_b16 v[152:153], v250 offset:40960
    v_mfma_f32_32x32x16_bf16 v[96:111], v[240:243], a[68:71], v[96:111]
    ds_read_b64_tr_b16 v[154:155], v250 offset:41984
    s_add_u32 s8, s8, 31744
    buffer_load_dwordx4 v231, s[4:7], s8 offen offset:2048 lds
    s_waitcnt lgkmcnt(14)
    v_mfma_f32_32x32x16_bf16 v[48:63], v[244:247], a[64:67], v[48:63]
    ds_read_b64_tr_b16 v[156:157], v251 offset:40960
    v_mfma_f32_32x32x16_bf16 v[112:127], v[244:247], a[68:71], v[112:127]
    ds_read_b64_tr_b16 v[158:159], v251 offset:41984
    s_add_u32 s8, s8, 31744
    buffer_load_dwordx4 v231, s[4:7], s8 offen offset:3072 lds
    s_waitcnt lgkmcnt(14)
    v_mfma_f32_32x32x16_bf16 v[0:15], v[128:131], a[72:75], v[0:15]
    ds_read_b64_tr_b16 v[232:233], v248 offset:45056
    v_mfma_f32_32x32x16_bf16 v[64:79], v[128:131], a[76:79], v[64:79]
    ds_read_b64_tr_b16 v[234:235], v248 offset:46080
    s_add_u32 s9, s84, 20480
    buffer_load_dwordx4 a[160:163], v229, s[20:23], s9 offen offset:0
    s_waitcnt lgkmcnt(14)
    v_mfma_f32_32x32x16_bf16 v[16:31], v[132:135], a[72:75], v[16:31]
    ds_read_b64_tr_b16 v[236:237], v249 offset:45056
    v_mfma_f32_32x32x16_bf16 v[80:95], v[132:135], a[76:79], v[80:95]
    ds_read_b64_tr_b16 v[238:239], v249 offset:46080
    buffer_load_dwordx4 a[168:171], v229, s[20:23], s9 offen offset:1024
    s_waitcnt lgkmcnt(14)
    v_mfma_f32_32x32x16_bf16 v[32:47], v[136:139], a[72:75], v[32:47]
    ds_read_b64_tr_b16 v[240:241], v250 offset:45056
    v_mfma_f32_32x32x16_bf16 v[96:111], v[136:139], a[76:79], v[96:111]
    ds_read_b64_tr_b16 v[242:243], v250 offset:46080
    buffer_load_dwordx4 a[176:179], v229, s[20:23], s9 offen offset:2048
    s_waitcnt lgkmcnt(14)
    v_mfma_f32_32x32x16_bf16 v[48:63], v[140:143], a[72:75], v[48:63]
    ds_read_b64_tr_b16 v[244:245], v251 offset:45056
    v_mfma_f32_32x32x16_bf16 v[112:127], v[140:143], a[76:79], v[112:127]
    ds_read_b64_tr_b16 v[246:247], v251 offset:46080
    buffer_load_dwordx4 a[184:187], v229, s[20:23], s9 offen offset:3072
    s_cmp_lg_u32 s40, 2
    s_cbranch_scc1 K2_PD_OK
    s_waitcnt vmcnt(21)
    v_cmp_gt_u32 vcc, 32, v164
    s_nop 0
    s_cbranch_vccz K2_PD_OK
K2_PD:
    s_sleep 8
    buffer_load_dword v164, v165, s[20:23], s64 offen sc1
    s_waitcnt vmcnt(0)
    v_cmp_gt_u32 vcc, 32, v164
    s_nop 0
    s_cbranch_vccz K2_PD_OK
    s_branch K2_PD
K2_PD_OK:
    s_waitcnt vmcnt(22)
    s_barrier
    s_waitcnt lgkmcnt(14)
    v_mfma_f32_32x32x16_bf16 v[0:15], v[144:147], a[80:83], v[0:15]
    ds_read_b64_tr_b16 v[128:129], v248 offset:49152
    v_mfma_f32_32x32x16_bf16 v[64:79], v[144:147], a[84:87], v[64:79]
    ds_read_b64_tr_b16 v[130:131], v248 offset:50176
    s_add_u32 s9, s84, 53248
    buffer_load_dwordx4 a[164:167], v229, s[20:23], s9 offen offset:0
    s_waitcnt lgkmcnt(14)
    v_mfma_f32_32x32x16_bf16 v[16:31], v[148:151], a[80:83], v[16:31]
    ds_read_b64_tr_b16 v[132:133], v249 offset:49152
    v_mfma_f32_32x32x16_bf16 v[80:95], v[148:151], a[84:87], v[80:95]
    ds_read_b64_tr_b16 v[134:135], v249 offset:50176
    buffer_load_dwordx4 a[172:175], v229, s[20:23], s9 offen offset:1024
    s_waitcnt lgkmcnt(14)
    v_mfma_f32_32x32x16_bf16 v[32:47], v[152:155], a[80:83], v[32:47]
    ds_read_b64_tr_b16 v[136:137], v250 offset:49152
    v_mfma_f32_32x32x16_bf16 v[96:111], v[152:155], a[84:87], v[96:111]
    ds_read_b64_tr_b16 v[138:139], v250 offset:50176
    buffer_load_dwordx4 a[180:183], v229, s[20:23], s9 offen offset:2048
    s_waitcnt lgkmcnt(14)
    v_mfma_f32_32x32x16_bf16 v[48:63], v[156:159], a[80:83], v[48:63]
    ds_read_b64_tr_b16 v[140:141], v251 offset:49152
    v_mfma_f32_32x32x16_bf16 v[112:127], v[156:159], a[84:87], v[112:127]
    ds_read_b64_tr_b16 v[142:143], v251 offset:50176
    buffer_load_dwordx4 a[188:191], v229, s[20:23], s9 offen offset:3072
    s_waitcnt lgkmcnt(14)
    v_mfma_f32_32x32x16_bf16 v[0:15], v[232:235], a[88:91], v[0:15]
    ds_read_b64_tr_b16 v[144:145], v248 offset:53248
    v_mfma_f32_32x32x16_bf16 v[64:79], v[232:235], a[92:95], v[64:79]
    ds_read_b64_tr_b16 v[146:147], v248 offset:54272
    s_waitcnt lgkmcnt(14)
    v_mfma_f32_32x32x16_bf16 v[16:31], v[236:239], a[88:91], v[16:31]
    ds_read_b64_tr_b16 v[148:149], v249 offset:53248
    v_mfma_f32_32x32x16_bf16 v[80:95], v[236:239], a[92:95], v[80:95]
    ds_read_b64_tr_b16 v[150:151], v249 offset:54272
    s_waitcnt lgkmcnt(14)
    v_mfma_f32_32x32x16_bf16 v[32:47], v[240:243], a[88:91], v[32:47]
    ds_read_b64_tr_b16 v[152:153], v250 offset:53248
    v_mfma_f32_32x32x16_bf16 v[96:111], v[240:243], a[92:95], v[96:111]
    ds_read_b64_tr_b16 v[154:155], v250 offset:54272
    s_waitcnt lgkmcnt(14)
    v_mfma_f32_32x32x16_bf16 v[48:63], v[244:247], a[88:91], v[48:63]
    ds_read_b64_tr_b16 v[156:157], v251 offset:53248
    v_mfma_f32_32x32x16_bf16 v[112:127], v[244:247], a[92:95], v[112:127]
    ds_read_b64_tr_b16 v[158:159], v251 offset:54272
    s_waitcnt lgkmcnt(14)
    v_mfma_f32_32x32x16_bf16 v[0:15], v[128:131], a[96:99], v[0:15]
    ds_read_b64_tr_b16 v[232:233], v248 offset:57344
    v_mfma_f32_32x32x16_bf16 v[64:79], v[128:131], a[100:103], v[64:79]
    ds_read_b64_tr_b16 v[234:235], v248 offset:58368
    s_add_u32 m0, s46, 98304
    s_add_u32 s8, s45, 3145728
    buffer_load_dwordx4 v231, s[4:7], s8 offen offset:0 lds
    s_waitcnt lgkmcnt(14)
    v_mfma_f32_32x32x16_bf16 v[16:31], v[132:135], a[96:99], v[16:31]
    ds_read_b64_tr_b16 v[236:237], v249 offset:57344
    buffer_load_dwordx4 v[160:163], v202, s[96:99], s54 offen
    v_mfma_f32_32x32x16_bf16 v[80:95], v[132:135], a[100:103], v[80:95]
    ds_read_b64_tr_b16 v[238:239], v249 offset:58368
    s_add_u32 s8, s8, 31744
    buffer_load_dwordx4 v231, s[4:7], s8 offen offset:1024 lds
    s_waitcnt lgkmcnt(14)
    v_mfma_f32_32x32x16_bf16 v[32:47], v[136:139], a[96:99], v[32:47]
    ds_read_b64_tr_b16 v[240:241], v250 offset:57344
    s_add_u32 s54, s54, 2752
    buffer_load_dwordx4 v[164:167], v202, s[96:99], s54 offen
    v_mfma_f32_32x32x16_bf16 v[96:111], v[136:139], a[100:103], v[96:111]
    ds_read_b64_tr_b16 v[242:243], v250 offset:58368
    s_add_u32 s8, s8, 31744
    buffer_load_dwordx4 v231, s[4:7], s8 offen offset:2048 lds
    s_waitcnt lgkmcnt(14)
    v_mfma_f32_32x32x16_bf16 v[48:63], v[140:143], a[96:99], v[48:63]
    ds_read_b64_tr_b16 v[244:245], v251 offset:57344
    s_add_u32 s54, s54, 2752
    buffer_load_dwordx4 v[168:171], v202, s[96:99], s54 offen
    v_mfma_f32_32x32x16_bf16 v[112:127], v[140:143], a[100:103], v[112:127]
    ds_read_b64_tr_b16 v[246:247], v251 offset:58368
    s_add_u32 s8, s8, 31744
    buffer_load_dwordx4 v231, s[4:7], s8 offen offset:3072 lds
    s_waitcnt lgkmcnt(14)
    v_mfma_f32_32x32x16_bf16 v[0:15], v[144:147], a[104:107], v[0:15]
    ds_read_b64_tr_b16 v[128:129], v248 offset:61440
    s_add_u32 s54, s54, 2752
    buffer_load_dwordx4 v[172:175], v202, s[96:99], s54 offen
    v_mfma_f32_32x32x16_bf16 v[64:79], v[144:147], a[108:111], v[64:79]
    ds_read_b64_tr_b16 v[130:131], v248 offset:62464
    s_add_u32 s9, s84, 24576
    buffer_load_dwordx4 a[192:195], v229, s[20:23], s9 offen offset:0
    s_waitcnt lgkmcnt(14)
    v_mfma_f32_32x32x16_bf16 v[16:31], v[148:151], a[104:107], v[16:31]
    ds_read_b64_tr_b16 v[132:133], v249 offset:61440
    s_add_u32 s54, s54, 2752
    buffer_load_dwordx4 v[176:179], v200, s[20:23], s55 offen
    v_mfma_f32_32x32x16_bf16 v[80:95], v[148:151], a[108:111], v[80:95]
    ds_read_b64_tr_b16 v[134:135], v249 offset:62464
    buffer_load_dwordx4 a[200:203], v229, s[20:23], s9 offen offset:1024
    s_waitcnt lgkmcnt(14)
    v_mfma_f32_32x32x16_bf16 v[32:47], v[152:155], a[104:107], v[32:47]
    ds_read_b64_tr_b16 v[136:137], v250 offset:61440
    buffer_load_dwordx4 v[180:183], v200, s[20:23], s55 offen offset:2048
    v_mfma_f32_32x32x16_bf16 v[96:111], v[152:155], a[108:111], v[96:111]
    ds_read_b64_tr_b16 v[138:139], v250 offset:62464
    buffer_load_dwordx4 a[208:211], v229, s[20:23], s9 offen offset:2048
    s_waitcnt lgkmcnt(14)
    v_mfma_f32_32x32x16_bf16 v[48:63], v[156:159], a[104:107], v[48:63]
    ds_read_b64_tr_b16 v[140:141], v251 offset:61440
    s_add_u32 s55, s55, 12288
    buffer_load_dwordx4 v[184:187], v200, s[20:23], s55 offen
    v_mfma_f32_32x32x16_bf16 v[112:127], v[156:159], a[108:111], v[112:127]
    ds_read_b64_tr_b16 v[142:143], v251 offset:62464
    v_add_u32 v248, 0x10000, v248
    v_add_u32 v249, 0x10000, v249
    v_add_u32 v250, 0x10000, v250
    v_add_u32 v251, 0x10000, v251
    buffer_load_dwordx4 a[216:219], v229, s[20:23], s9 offen offset:3072
    s_waitcnt vmcnt(36)
    s_barrier
    s_waitcnt lgkmcnt(14)
    v_mfma_f32_32x32x16_bf16 v[0:15], v[232:235], a[112:115], v[0:15]
    ds_read_b64_tr_b16 v[144:145], v248 offset:0
    buffer_load_dwordx4 v[188:191], v200, s[20:23], s55 offen offset:2048
    v_mfma_f32_32x32x16_bf16 v[64:79], v[232:235], a[116:119], v[64:79]
    ds_read_b64_tr_b16 v[146:147], v248 offset:1024
    s_add_u32 s9, s84, 57344
    buffer_load_dwordx4 a[196:199], v229, s[20:23], s9 offen offset:0
    s_waitcnt lgkmcnt(14)
    v_mfma_f32_32x32x16_bf16 v[16:31], v[236:239], a[112:115], v[16:31]
    ds_read_b64_tr_b16 v[148:149], v249 offset:0
    s_add_u32 s55, s55, 12288
    buffer_load_dwordx4 v[208:211], v200, s[20:23], s55 offen
    v_mfma_f32_32x32x16_bf16 v[80:95], v[236:239], a[116:119], v[80:95]
    ds_read_b64_tr_b16 v[150:151], v249 offset:1024
    buffer_load_dwordx4 a[204:207], v229, s[20:23], s9 offen offset:1024
    s_waitcnt lgkmcnt(14)
    v_mfma_f32_32x32x16_bf16 v[32:47], v[240:243], a[112:115], v[32:47]
    ds_read_b64_tr_b16 v[152:153], v250 offset:0
    buffer_load_dword v226, off, s[20:23], s62 sc1
    buffer_load_dwordx4 v[212:215], v200, s[20:23], s55 offen offset:2048
    v_mfma_f32_32x32x16_bf16 v[96:111], v[240:243], a[116:119], v[96:111]
    ds_read_b64_tr_b16 v[154:155], v250 offset:1024
    buffer_load_dwordx4 a[212:215], v229, s[20:23], s9 offen offset:2048
    s_waitcnt lgkmcnt(14)
    v_mfma_f32_32x32x16_bf16 v[48:63], v[244:247], a[112:115], v[48:63]
    ds_read_b64_tr_b16 v[156:157], v251 offset:0
    s_add_u32 s55, s55, 12288
    buffer_load_dwordx4 v[216:219], v200, s[20:23], s55 offen
    v_mfma_f32_32x32x16_bf16 v[112:127], v[244:247], a[116:119], v[112:127]
    ds_read_b64_tr_b16 v[158:159], v251 offset:1024
    buffer_load_dwordx4 a[220:223], v229, s[20:23], s9 offen offset:3072
    s_waitcnt lgkmcnt(14)
    v_mfma_f32_32x32x16_bf16 v[0:15], v[128:131], a[120:123], v[0:15]
    ds_read_b64_tr_b16 v[232:233], v248 offset:4096
    buffer_load_dwordx4 v[220:223], v200, s[20:23], s55 offen offset:2048
    v_mfma_f32_32x32x16_bf16 v[64:79], v[128:131], a[124:127], v[64:79]
    ds_read_b64_tr_b16 v[234:235], v248 offset:5120
    s_waitcnt lgkmcnt(14)
    v_mfma_f32_32x32x16_bf16 v[16:31], v[132:135], a[120:123], v[16:31]
    ds_read_b64_tr_b16 v[236:237], v249 offset:4096
    s_add_u32 s55, s55, 12288
    buffer_load_dword v206, v206, s[20:23], s66 offen offset:0
    v_mfma_f32_32x32x16_bf16 v[80:95], v[132:135], a[124:127], v[80:95]
    ds_read_b64_tr_b16 v[238:239], v249 offset:5120
    s_waitcnt lgkmcnt(14)
    v_mfma_f32_32x32x16_bf16 v[32:47], v[136:139], a[120:123], v[32:47]
    ds_read_b64_tr_b16 v[240:241], v250 offset:4096
    v_mfma_f32_32x32x16_bf16 v[96:111], v[136:139], a[124:127], v[96:111]
    ds_read_b64_tr_b16 v[242:243], v250 offset:5120
    s_waitcnt lgkmcnt(14)
    v_mfma_f32_32x32x16_bf16 v[48:63], v[140:143], a[120:123], v[48:63]
    ds_read_b64_tr_b16 v[244:245], v251 offset:4096
    v_mfma_f32_32x32x16_bf16 v[112:127], v[140:143], a[124:127], v[112:127]
    ds_read_b64_tr_b16 v[246:247], v251 offset:5120
    s_waitcnt vmcnt(46) lgkmcnt(14)
    v_mfma_f32_32x32x16_bf16 v[0:15], v[144:147], a[128:131], v[0:15]
    ds_read_b64_tr_b16 v[128:129], v248 offset:8192
    s_waitcnt vmcnt(41)
    v_mfma_f32_32x32x16_bf16 v[64:79], v[144:147], a[132:135], v[64:79]
    ds_read_b64_tr_b16 v[130:131], v248 offset:9216
    s_add_u32 m0, s46, 114688
    s_add_u32 s8, s45, 3670016
    buffer_load_dwordx4 v231, s[4:7], s8 offen offset:0 lds
    s_waitcnt lgkmcnt(14)
    v_mfma_f32_32x32x16_bf16 v[16:31], v[148:151], a[128:131], v[16:31]
    ds_read_b64_tr_b16 v[132:133], v249 offset:8192
    v_mfma_f32_32x32x16_bf16 v[80:95], v[148:151], a[132:135], v[80:95]
    ds_read_b64_tr_b16 v[134:135], v249 offset:9216
    s_add_u32 s8, s8, 31744
    buffer_load_dwordx4 v231, s[4:7], s8 offen offset:1024 lds
    s_waitcnt lgkmcnt(14)
    v_mfma_f32_32x32x16_bf16 v[32:47], v[152:155], a[128:131], v[32:47]
    ds_read_b64_tr_b16 v[136:137], v250 offset:8192
    v_mfma_f32_32x32x16_bf16 v[96:111], v[152:155], a[132:135], v[96:111]
    ds_read_b64_tr_b16 v[138:139], v250 offset:9216
    s_add_u32 s8, s8, 31744
    buffer_load_dwordx4 v231, s[4:7], s8 offen offset:2048 lds
    s_waitcnt lgkmcnt(14)
    v_mfma_f32_32x32x16_bf16 v[48:63], v[156:159], a[128:131], v[48:63]
    ds_read_b64_tr_b16 v[140:141], v251 offset:8192
    v_mfma_f32_32x32x16_bf16 v[112:127], v[156:159], a[132:135], v[112:127]
    ds_read_b64_tr_b16 v[142:143], v251 offset:9216
    s_add_u32 s8, s8, 31744
    buffer_load_dwordx4 v231, s[4:7], s8 offen offset:3072 lds
    s_waitcnt lgkmcnt(14)
    v_mfma_f32_32x32x16_bf16 v[0:15], v[232:235], a[136:139], v[0:15]
    ds_read_b64_tr_b16 v[144:145], v248 offset:12288
    s_waitcnt vmcnt(44)
    v_mfma_f32_32x32x16_bf16 v[64:79], v[232:235], a[140:143], v[64:79]
    ds_read_b64_tr_b16 v[146:147], v248 offset:13312
    s_add_u32 s9, s84, 28672
    buffer_load_dwordx4 a[224:227], v229, s[20:23], s9 offen offset:0
    s_waitcnt lgkmcnt(14)
    v_mfma_f32_32x32x16_bf16 v[16:31], v[236:239], a[136:139], v[16:31]
    ds_read_b64_tr_b16 v[148:149], v249 offset:12288
    v_mfma_f32_32x32x16_bf16 v[80:95], v[236:239], a[140:143], v[80:95]
    ds_read_b64_tr_b16 v[150:151], v249 offset:13312
    buffer_load_dwordx4 a[232:235], v229, s[20:23], s9 offen offset:1024
    s_waitcnt lgkmcnt(14)
    v_mfma_f32_32x32x16_bf16 v[32:47], v[240:243], a[136:139], v[32:47]
    ds_read_b64_tr_b16 v[152:153], v250 offset:12288
    v_mfma_f32_32x32x16_bf16 v[96:111], v[240:243], a[140:143], v[96:111]
    ds_read_b64_tr_b16 v[154:155], v250 offset:13312
    buffer_load_dwordx4 a[240:243], v229, s[20:23], s9 offen offset:2048
    s_waitcnt lgkmcnt(14)
    v_mfma_f32_32x32x16_bf16 v[48:63], v[244:247], a[136:139], v[48:63]
    ds_read_b64_tr_b16 v[156:157], v251 offset:12288
    v_mfma_f32_32x32x16_bf16 v[112:127], v[244:247], a[140:143], v[112:127]
    ds_read_b64_tr_b16 v[158:159], v251 offset:13312
    buffer_load_dwordx4 a[248:251], v229, s[20:23], s9 offen offset:3072
    s_waitcnt vmcnt(14)
    v_readfirstlane_b32 s42, v226
    s_nop 0
    s_or_b32 s42, s42, s63
    s_and_b32 s42, s42, 1
    s_cbranch_scc1 K2_PK_OK
K2_PK:
    s_sleep 24
    buffer_load_dword v226, off, s[20:23], s62 sc1
    s_waitcnt vmcnt(0)
    v_readfirstlane_b32 s42, v226
    s_nop 0
    s_or_b32 s42, s42, s63
    s_and_b32 s42, s42, 1
    s_cbranch_scc1 K2_PK_OK
    s_branch K2_PK
K2_PK_OK:
    s_barrier
    s_waitcnt lgkmcnt(14)
    v_mfma_f32_32x32x16_bf16 v[0:15], v[128:131], a[144:147], v[0:15]
    ds_read_b64_tr_b16 v[232:233], v248 offset:16384
    v_mfma_f32_32x32x16_bf16 v[64:79], v[128:131], a[148:151], v[64:79]
    ds_read_b64_tr_b16 v[234:235], v248 offset:17408
    s_add_u32 s9, s84, 61440
    buffer_load_dwordx4 a[228:231], v229, s[20:23], s9 offen offset:0
    s_waitcnt lgkmcnt(14)
    v_mfma_f32_32x32x16_bf16 v[16:31], v[132:135], a[144:147], v[16:31]
    ds_read_b64_tr_b16 v[236:237], v249 offset:16384
    v_mfma_f32_32x32x16_bf16 v[80:95], v[132:135], a[148:151], v[80:95]
    ds_read_b64_tr_b16 v[238:239], v249 offset:17408
    buffer_load_dwordx4 a[236:239], v229, s[20:23], s9 offen offset:1024
    s_waitcnt lgkmcnt(14)
    v_mfma_f32_32x32x16_bf16 v[32:47], v[136:139], a[144:147], v[32:47]
    ds_read_b64_tr_b16 v[240:241], v250 offset:16384
    v_mfma_f32_32x32x16_bf16 v[96:111], v[136:139], a[148:151], v[96:111]
    ds_read_b64_tr_b16 v[242:243], v250 offset:17408
    buffer_load_dwordx4 a[244:247], v229, s[20:23], s9 offen offset:2048
    s_waitcnt lgkmcnt(14)
    v_mfma_f32_32x32x16_bf16 v[48:63], v[140:143], a[144:147], v[48:63]
    ds_read_b64_tr_b16 v[244:245], v251 offset:16384
    v_mfma_f32_32x32x16_bf16 v[112:127], v[140:143], a[148:151], v[112:127]
    ds_read_b64_tr_b16 v[246:247], v251 offset:17408
    buffer_load_dwordx4 a[252:255], v229, s[20:23], s9 offen offset:3072
    s_waitcnt lgkmcnt(14)
    v_mfma_f32_32x32x16_bf16 v[0:15], v[144:147], a[152:155], v[0:15]
    ds_read_b64_tr_b16 v[128:129], v248 offset:20480
    v_add_f32 v176, v176, v184
    s_waitcnt vmcnt(15)
    v_add_f32 v208, v208, v216
    v_add_f32 v176, v176, v208
    v_cvt_pk_bf16_f32 v176, v176, v176
    v_and_b32 v176, 0xffff0000, v176
    v_mfma_f32_32x32x16_bf16 v[64:79], v[144:147], a[156:159], v[64:79]
    ds_read_b64_tr_b16 v[130:131], v248 offset:21504
    s_add_u32 m0, s46, 131072
    s_nop 0
    buffer_load_dwordx4 v229, s[20:23], s44 offen offset:0 lds
    v_add_f32 v177, v177, v185
    v_add_f32 v209, v209, v217
    v_add_f32 v177, v177, v209
    v_cvt_pk_bf16_f32 v177, v177, v177
    v_and_b32 v177, 0xffff0000, v177
    s_waitcnt lgkmcnt(14)
    v_mfma_f32_32x32x16_bf16 v[16:31], v[148:151], a[152:155], v[16:31]
    ds_read_b64_tr_b16 v[132:133], v249 offset:20480
    v_add_f32 v178, v178, v186
    v_add_f32 v210, v210, v218
    v_add_f32 v178, v178, v210
    v_cvt_pk_bf16_f32 v178, v178, v178
    v_and_b32 v178, 0xffff0000, v178
    v_mfma_f32_32x32x16_bf16 v[80:95], v[148:151], a[156:159], v[80:95]
    ds_read_b64_tr_b16 v[134:135], v249 offset:21504
    buffer_load_dwordx4 v229, s[20:23], s44 offen offset:1024 lds
    v_add_f32 v179, v179, v187
    v_add_f32 v211, v211, v219
    v_add_f32 v179, v179, v211
    v_cvt_pk_bf16_f32 v179, v179, v179
    v_and_b32 v179, 0xffff0000, v179
    s_waitcnt lgkmcnt(14)
    v_mfma_f32_32x32x16_bf16 v[32:47], v[152:155], a[152:155], v[32:47]
    ds_read_b64_tr_b16 v[136:137], v250 offset:20480
    v_add_f32 v180, v180, v188
    s_waitcnt vmcnt(15)
    v_add_f32 v212, v212, v220
    v_add_f32 v180, v180, v212
    v_cvt_pk_bf16_f32 v180, v180, v180
    v_and_b32 v180, 0xffff0000, v180
    v_mfma_f32_32x32x16_bf16 v[96:111], v[152:155], a[156:159], v[96:111]
    ds_read_b64_tr_b16 v[138:139], v250 offset:21504
    buffer_load_dwordx4 v229, s[20:23], s44 offen offset:2048 lds
    v_add_f32 v181, v181, v189
    v_add_f32 v213, v213, v221
    v_add_f32 v181, v181, v213
    v_cvt_pk_bf16_f32 v181, v181, v181
    v_and_b32 v181, 0xffff0000, v181
    s_waitcnt lgkmcnt(14)
    v_mfma_f32_32x32x16_bf16 v[48:63], v[156:159], a[152:155], v[48:63]
    ds_read_b64_tr_b16 v[140:141], v251 offset:20480
    v_add_f32 v182, v182, v190
    v_add_f32 v214, v214, v222
    v_add_f32 v182, v182, v214
    v_cvt_pk_bf16_f32 v182, v182, v182
    v_and_b32 v182, 0xffff0000, v182
    v_mfma_f32_32x32x16_bf16 v[112:127], v[156:159], a[156:159], v[112:127]
    ds_read_b64_tr_b16 v[142:143], v251 offset:21504
    buffer_load_dwordx4 v229, s[20:23], s44 offen offset:3072 lds
    v_add_f32 v183, v183, v191
    v_add_f32 v215, v215, v223
    v_add_f32 v183, v183, v215
    v_cvt_pk_bf16_f32 v183, v183, v183
    v_and_b32 v183, 0xffff0000, v183
    s_waitcnt lgkmcnt(14)
    v_mfma_f32_32x32x16_bf16 v[0:15], v[232:235], a[160:163], v[0:15]
    ds_read_b64_tr_b16 v[144:145], v248 offset:24576
    v_add_u32 v228, 0x20000, v229
    s_waitcnt vmcnt(16)
    v_mov_b32 v204, v206
    s_add_u32 s66, s66, 131072
    s_nop 0
    v_permlane16_swap_b32 v206, v204
    v_mfma_f32_32x32x16_bf16 v[64:79], v[232:235], a[164:167], v[64:79]
    ds_read_b64_tr_b16 v[146:147], v248 offset:25600
    s_add_u32 s8, s44, 16384
    s_mov_b32 m0, s46
    s_nop 0
    buffer_load_dwordx4 v229, s[20:23], s8 offen offset:0 lds
    v_add_f32 v206, v206, v204
    v_mov_b32 v204, v206
    s_nop 1
    v_permlane32_swap_b32 v206, v204
    v_add_f32 v206, v206, v204
    s_waitcnt lgkmcnt(14)
    v_mfma_f32_32x32x16_bf16 v[16:31], v[236:239], a[160:163], v[16:31]
    ds_read_b64_tr_b16 v[148:149], v249 offset:24576
    v_cvt_pk_bf16_f32 v206, v206, v206
    v_and_b32 v206, 0xffff0000, v206
    buffer_store_dword v206, v207, s[20:23], s66 offen sc1
    v_add_f32 v180, 1.0, v180
    v_cvt_pk_bf16_f32 v180, v180, v180
    v_mfma_f32_32x32x16_bf16 v[80:95], v[236:239], a[164:167], v[80:95]
    ds_read_b64_tr_b16 v[150:151], v249 offset:25600
    buffer_load_dwordx4 v229, s[20:23], s8 offen offset:1024 lds
    v_and_b32 v180, 0xffff0000, v180
    v_add_f32 v181, 1.0, v181
    v_cvt_pk_bf16_f32 v181, v181, v181
    v_and_b32 v181, 0xffff0000, v181
    v_add_f32 v182, 1.0, v182
    s_waitcnt lgkmcnt(14)
    v_mfma_f32_32x32x16_bf16 v[32:47], v[240:243], a[160:163], v[32:47]
    ds_read_b64_tr_b16 v[152:153], v250 offset:24576
    v_cvt_pk_bf16_f32 v182, v182, v182
    v_and_b32 v182, 0xffff0000, v182
    v_add_f32 v183, 1.0, v183
    v_cvt_pk_bf16_f32 v183, v183, v183
    v_and_b32 v183, 0xffff0000, v183
    v_mfma_f32_32x32x16_bf16 v[96:111], v[240:243], a[164:167], v[96:111]
    ds_read_b64_tr_b16 v[154:155], v250 offset:25600
    buffer_load_dwordx4 v229, s[20:23], s8 offen offset:2048 lds
    v_lshlrev_b32 v204, 16, v160
    v_and_b32 v205, 0xffff0000, v160
    v_mul_f32 v184, v204, v180
    v_mul_f32 v185, v205, v180
    v_mul_f32 v192, v204, v176
    s_waitcnt lgkmcnt(14)
    v_mfma_f32_32x32x16_bf16 v[48:63], v[244:247], a[160:163], v[48:63]
    ds_read_b64_tr_b16 v[156:157], v251 offset:24576
    v_mul_f32 v193, v205, v176
    v_lshlrev_b32 v204, 16, v161
    v_and_b32 v205, 0xffff0000, v161
    v_mul_f32 v186, v204, v180
    v_mul_f32 v187, v205, v180
    v_mfma_f32_32x32x16_bf16 v[112:127], v[244:247], a[164:167], v[112:127]
    ds_read_b64_tr_b16 v[158:159], v251 offset:25600
    buffer_load_dwordx4 v229, s[20:23], s8 offen offset:3072 lds
    v_mul_f32 v194, v204, v176
    v_mul_f32 v195, v205, v176
    v_lshlrev_b32 v204, 16, v162
    v_and_b32 v205, 0xffff0000, v162
    v_mul_f32 v188, v204, v180
    s_waitcnt lgkmcnt(14)
    v_mfma_f32_32x32x16_bf16 v[0:15], v[128:131], a[168:171], v[0:15]
    ds_read_b64_tr_b16 v[232:233], v248 offset:28672
    v_mul_f32 v189, v205, v180
    v_mul_f32 v196, v204, v176
    v_mul_f32 v197, v205, v176
    v_lshlrev_b32 v204, 16, v163
    v_and_b32 v205, 0xffff0000, v163
    v_mfma_f32_32x32x16_bf16 v[64:79], v[128:131], a[172:175], v[64:79]
    ds_read_b64_tr_b16 v[234:235], v248 offset:29696
    s_add_u32 s8, s44, 32768
    s_add_u32 m0, s46, 16384
    s_nop 0
    buffer_load_dwordx4 v229, s[20:23], s8 offen offset:0 lds
    v_mul_f32 v190, v204, v180
    v_mul_f32 v191, v205, v180
    v_mul_f32 v198, v204, v176
    v_mul_f32 v199, v205, v176
    v_lshlrev_b32 v204, 16, v164
    s_waitcnt lgkmcnt(14)
    v_mfma_f32_32x32x16_bf16 v[16:31], v[132:135], a[168:171], v[16:31]
    ds_read_b64_tr_b16 v[236:237], v249 offset:28672
    v_and_b32 v205, 0xffff0000, v164
    v_fmac_f32 v184, v204, v181
    v_fmac_f32 v185, v205, v181
    v_fmac_f32 v192, v204, v177
    v_fmac_f32 v193, v205, v177
    v_mfma_f32_32x32x16_bf16 v[80:95], v[132:135], a[172:175], v[80:95]
    ds_read_b64_tr_b16 v[238:239], v249 offset:29696
    buffer_load_dwordx4 v229, s[20:23], s8 offen offset:1024 lds
    v_lshlrev_b32 v204, 16, v165
    v_and_b32 v205, 0xffff0000, v165
    v_fmac_f32 v186, v204, v181
    v_fmac_f32 v187, v205, v181
    v_fmac_f32 v194, v204, v177
    s_waitcnt lgkmcnt(14)
    v_mfma_f32_32x32x16_bf16 v[32:47], v[136:139], a[168:171], v[32:47]
    ds_read_b64_tr_b16 v[240:241], v250 offset:28672
    v_fmac_f32 v195, v205, v177
    v_lshlrev_b32 v204, 16, v166
    v_and_b32 v205, 0xffff0000, v166
    v_fmac_f32 v188, v204, v181
    v_fmac_f32 v189, v205, v181
    v_mfma_f32_32x32x16_bf16 v[96:111], v[136:139], a[172:175], v[96:111]
    ds_read_b64_tr_b16 v[242:243], v250 offset:29696
    buffer_load_dwordx4 v229, s[20:23], s8 offen offset:2048 lds
    v_fmac_f32 v196, v204, v177
    v_fmac_f32 v197, v205, v177
    v_lshlrev_b32 v204, 16, v167
    v_and_b32 v205, 0xffff0000, v167
    v_fmac_f32 v190, v204, v181
    s_waitcnt lgkmcnt(14)
    v_mfma_f32_32x32x16_bf16 v[48:63], v[140:143], a[168:171], v[48:63]
    ds_read_b64_tr_b16 v[244:245], v251 offset:28672
    v_fmac_f32 v191, v205, v181
    v_fmac_f32 v198, v204, v177
    v_fmac_f32 v199, v205, v177
    v_lshlrev_b32 v204, 16, v168
    v_and_b32 v205, 0xffff0000, v168
    v_mfma_f32_32x32x16_bf16 v[112:127], v[140:143], a[172:175], v[112:127]
    ds_read_b64_tr_b16 v[246:247], v251 offset:29696
    buffer_load_dwordx4 v229, s[20:23], s8 offen offset:3072 lds
    v_fmac_f32 v184, v204, v182
    v_fmac_f32 v185, v205, v182
    v_fmac_f32 v192, v204, v178
    v_fmac_f32 v193, v205, v178
    v_lshlrev_b32 v204, 16, v169
    s_barrier
    s_waitcnt lgkmcnt(14)
    v_mfma_f32_32x32x16_bf16 v[0:15], v[144:147], a[176:179], v[0:15]
    ds_read_b64_tr_b16 v[128:129], v248 offset:32768
    v_and_b32 v205, 0xffff0000, v169
    v_fmac_f32 v186, v204, v182
    v_fmac_f32 v187, v205, v182
    v_fmac_f32 v194, v204, v178
    v_fmac_f32 v195, v205, v178
    v_mfma_f32_32x32x16_bf16 v[64:79], v[144:147], a[180:183], v[64:79]
    ds_read_b64_tr_b16 v[130:131], v248 offset:33792
    v_lshlrev_b32 v204, 16, v170
    v_and_b32 v205, 0xffff0000, v170
    v_fmac_f32 v188, v204, v182
    v_fmac_f32 v189, v205, v182
    v_fmac_f32 v196, v204, v178
    s_waitcnt lgkmcnt(14)
    v_mfma_f32_32x32x16_bf16 v[16:31], v[148:151], a[176:179], v[16:31]
    ds_read_b64_tr_b16 v[132:133], v249 offset:32768
    v_fmac_f32 v197, v205, v178
    v_lshlrev_b32 v204, 16, v171
    v_and_b32 v205, 0xffff0000, v171
    v_fmac_f32 v190, v204, v182
    v_fmac_f32 v191, v205, v182
    v_mfma_f32_32x32x16_bf16 v[80:95], v[148:151], a[180:183], v[80:95]
    ds_read_b64_tr_b16 v[134:135], v249 offset:33792
    s_add_u32 m0, s46, 65536
    s_nop 0
    buffer_load_dwordx4 v252, s[88:91], s50 offen offset:0 lds
    v_fmac_f32 v198, v204, v178
    v_fmac_f32 v199, v205, v178
    v_lshlrev_b32 v204, 16, v172
    v_and_b32 v205, 0xffff0000, v172
    v_fmac_f32 v184, v204, v183
    s_waitcnt lgkmcnt(14)
    v_mfma_f32_32x32x16_bf16 v[32:47], v[152:155], a[176:179], v[32:47]
    ds_read_b64_tr_b16 v[136:137], v250 offset:32768
    v_fmac_f32 v185, v205, v183
    v_fmac_f32 v192, v204, v179
    v_fmac_f32 v193, v205, v179
    v_lshlrev_b32 v204, 16, v173
    v_and_b32 v205, 0xffff0000, v173
    v_mfma_f32_32x32x16_bf16 v[96:111], v[152:155], a[180:183], v[96:111]
    ds_read_b64_tr_b16 v[138:139], v250 offset:33792
    s_add_u32 s50, s50, 20992
    buffer_load_dwordx4 v252, s[88:91], s50 offen offset:1024 lds
    v_fmac_f32 v186, v204, v183
    v_fmac_f32 v187, v205, v183
    v_fmac_f32 v194, v204, v179
    v_fmac_f32 v195, v205, v179
    v_lshlrev_b32 v204, 16, v174
    s_waitcnt lgkmcnt(14)
    v_mfma_f32_32x32x16_bf16 v[48:63], v[156:159], a[176:179], v[48:63]
    ds_read_b64_tr_b16 v[140:141], v251 offset:32768
    v_and_b32 v205, 0xffff0000, v174
    v_fmac_f32 v188, v204, v183
    v_fmac_f32 v189, v205, v183
    v_fmac_f32 v196, v204, v179
    v_fmac_f32 v197, v205, v179
    v_mfma_f32_32x32x16_bf16 v[112:127], v[156:159], a[180:183], v[112:127]
    ds_read_b64_tr_b16 v[142:143], v251 offset:33792
    s_add_u32 s50, s50, 20992
    buffer_load_dwordx4 v252, s[88:91], s50 offen offset:2048 lds
    v_lshlrev_b32 v204, 16, v175
    v_and_b32 v205, 0xffff0000, v175
    v_fmac_f32 v190, v204, v183
    v_fmac_f32 v191, v205, v183
    v_fmac_f32 v198, v204, v179
    s_waitcnt lgkmcnt(14)
    v_mfma_f32_32x32x16_bf16 v[0:15], v[232:235], a[184:187], v[0:15]
    ds_read_b64_tr_b16 v[144:145], v248 offset:36864
    v_fmac_f32 v199, v205, v179
    v_permlane32_swap_b32 v184, v188
    v_permlane32_swap_b32 v185, v189
    v_permlane32_swap_b32 v186, v190
    v_permlane32_swap_b32 v187, v191
    v_mfma_f32_32x32x16_bf16 v[64:79], v[232:235], a[188:191], v[64:79]
    ds_read_b64_tr_b16 v[146:147], v248 offset:37888
    s_add_u32 s50, s50, 20992
    buffer_load_dwordx4 v252, s[88:91], s50 offen offset:3072 lds
    v_add_f32 v184, v184, v188
    v_add_f32 v185, v185, v189
    v_add_f32 v186, v186, v190
    v_add_f32 v187, v187, v191
    v_permlane32_swap_b32 v192, v196
    s_waitcnt lgkmcnt(14)
    v_mfma_f32_32x32x16_bf16 v[16:31], v[236:239], a[184:187], v[16:31]
    ds_read_b64_tr_b16 v[148:149], v249 offset:36864
    v_permlane32_swap_b32 v193, v197
    v_permlane32_swap_b32 v194, v198
    v_permlane32_swap_b32 v195, v199
    v_add_f32 v192, v192, v196
    v_add_f32 v193, v193, v197
    v_mfma_f32_32x32x16_bf16 v[80:95], v[236:239], a[188:191], v[80:95]
    ds_read_b64_tr_b16 v[150:151], v249 offset:37888
    v_add_f32 v194, v194, v198
    v_add_f32 v195, v195, v199
    v_permlane16_swap_b32 v184, v186
    v_permlane16_swap_b32 v185, v187
    v_permlane16_swap_b32 v192, v194
    s_waitcnt lgkmcnt(14)
    v_mfma_f32_32x32x16_bf16 v[32:47], v[240:243], a[184:187], v[32:47]
    ds_read_b64_tr_b16 v[152:153], v250 offset:36864
    v_permlane16_swap_b32 v193, v195
    v_add_f32 v184, v184, v186
    v_add_f32 v185, v185, v187
    v_add_f32 v192, v192, v194
    v_add_f32 v193, v193, v195
    v_mfma_f32_32x32x16_bf16 v[96:111], v[240:243], a[188:191], v[96:111]
    ds_read_b64_tr_b16 v[154:155], v250 offset:37888
    v_lshlrev_b32 v201, 5, v201
    v_lshrrev_b32 v204, 4, v253
    v_lshl_add_u32 v201, v204, 3, v201
    s_lshl_b32 s54, s40, 9
    s_add_u32 s54, s54, 151552
    s_waitcnt lgkmcnt(14)
    v_mfma_f32_32x32x16_bf16 v[48:63], v[244:247], a[184:187], v[48:63]
    ds_read_b64_tr_b16 v[156:157], v251 offset:36864
    v_add_u32 v201, s54, v201
    v_add_f32_dpp v184, v184, v184 row_ror:8 row_mask:0xf bank_mask:0xf
    v_add_f32_dpp v185, v185, v185 row_ror:8 row_mask:0xf bank_mask:0xf
    v_add_f32_dpp v192, v192, v192 row_ror:8 row_mask:0xf bank_mask:0xf
    v_add_f32_dpp v193, v193, v193 row_ror:8 row_mask:0xf bank_mask:0xf
    v_mfma_f32_32x32x16_bf16 v[112:127], v[244:247], a[188:191], v[112:127]
    ds_read_b64_tr_b16 v[158:159], v251 offset:37888
    ds_write_b64 v201, v[184:185] offset:0
    ds_write_b64 v201, v[192:193] offset:256
    s_waitcnt lgkmcnt(15)
    v_mfma_f32_32x32x16_bf16 v[0:15], v[128:131], a[192:195], v[0:15]
    ds_read_b64_tr_b16 v[232:233], v248 offset:40960
    v_mfma_f32_32x32x16_bf16 v[64:79], v[128:131], a[196:199], v[64:79]
    ds_read_b64_tr_b16 v[234:235], v248 offset:41984
    s_waitcnt lgkmcnt(15)
    v_mfma_f32_32x32x16_bf16 v[16:31], v[132:135], a[192:195], v[16:31]
    ds_read_b64_tr_b16 v[236:237], v249 offset:40960
    v_accvgpr_write_b32 a128, 0
    v_accvgpr_write_b32 a129, 0
    v_accvgpr_write_b32 a130, 0
    v_accvgpr_write_b32 a131, 0
    v_accvgpr_write_b32 a132, 0
    v_mfma_f32_32x32x16_bf16 v[80:95], v[132:135], a[196:199], v[80:95]
    ds_read_b64_tr_b16 v[238:239], v249 offset:41984
    v_accvgpr_write_b32 a133, 0
    v_accvgpr_write_b32 a134, 0
    v_accvgpr_write_b32 a135, 0
    v_accvgpr_write_b32 a136, 0
    v_accvgpr_write_b32 a137, 0
    s_waitcnt lgkmcnt(15)
    v_mfma_f32_32x32x16_bf16 v[32:47], v[136:139], a[192:195], v[32:47]
    ds_read_b64_tr_b16 v[240:241], v250 offset:40960
    v_accvgpr_write_b32 a138, 0
    v_accvgpr_write_b32 a139, 0
    v_accvgpr_write_b32 a140, 0
    v_accvgpr_write_b32 a141, 0
    v_accvgpr_write_b32 a142, 0
    v_mfma_f32_32x32x16_bf16 v[96:111], v[136:139], a[196:199], v[96:111]
    ds_read_b64_tr_b16 v[242:243], v250 offset:41984
    v_accvgpr_write_b32 a143, 0
    v_accvgpr_write_b32 a144, 0
    v_accvgpr_write_b32 a145, 0
    v_accvgpr_write_b32 a146, 0
    v_accvgpr_write_b32 a147, 0
    s_waitcnt lgkmcnt(15)
    v_mfma_f32_32x32x16_bf16 v[48:63], v[140:143], a[192:195], v[48:63]
    ds_read_b64_tr_b16 v[244:245], v251 offset:40960
    v_accvgpr_write_b32 a148, 0
    v_accvgpr_write_b32 a149, 0
    v_accvgpr_write_b32 a150, 0
    v_accvgpr_write_b32 a151, 0
    v_accvgpr_write_b32 a152, 0
    v_mfma_f32_32x32x16_bf16 v[112:127], v[140:143], a[196:199], v[112:127]
    ds_read_b64_tr_b16 v[246:247], v251 offset:41984
    v_accvgpr_write_b32 a153, 0
    v_accvgpr_write_b32 a154, 0
    v_accvgpr_write_b32 a155, 0
    v_accvgpr_write_b32 a156, 0
    v_accvgpr_write_b32 a157, 0
    s_waitcnt lgkmcnt(15)
    v_mfma_f32_32x32x16_bf16 v[0:15], v[144:147], a[200:203], v[0:15]
    ds_read_b64_tr_b16 v[128:129], v248 offset:45056
    v_accvgpr_write_b32 a158, 0
    v_accvgpr_write_b32 a159, 0
    v_accvgpr_write_b32 a160, 0
    v_accvgpr_write_b32 a161, 0
    v_accvgpr_write_b32 a162, 0
    v_mfma_f32_32x32x16_bf16 v[64:79], v[144:147], a[204:207], v[64:79]
    ds_read_b64_tr_b16 v[130:131], v248 offset:46080
    v_accvgpr_write_b32 a163, 0
    v_accvgpr_write_b32 a164, 0
    v_accvgpr_write_b32 a165, 0
    v_accvgpr_write_b32 a166, 0
    v_accvgpr_write_b32 a167, 0
    s_waitcnt lgkmcnt(15)
    v_mfma_f32_32x32x16_bf16 v[16:31], v[148:151], a[200:203], v[16:31]
    ds_read_b64_tr_b16 v[132:133], v249 offset:45056
    v_accvgpr_write_b32 a168, 0
    v_accvgpr_write_b32 a169, 0
    v_accvgpr_write_b32 a170, 0
    v_accvgpr_write_b32 a171, 0
    v_accvgpr_write_b32 a172, 0
    v_mfma_f32_32x32x16_bf16 v[80:95], v[148:151], a[204:207], v[80:95]
    ds_read_b64_tr_b16 v[134:135], v249 offset:46080
    v_accvgpr_write_b32 a173, 0
    v_accvgpr_write_b32 a174, 0
    v_accvgpr_write_b32 a175, 0
    v_accvgpr_write_b32 a176, 0
    v_accvgpr_write_b32 a177, 0
    s_waitcnt lgkmcnt(15)
    v_mfma_f32_32x32x16_bf16 v[32:47], v[152:155], a[200:203], v[32:47]
    ds_read_b64_tr_b16 v[136:137], v250 offset:45056
    v_accvgpr_write_b32 a178, 0
    v_accvgpr_write_b32 a179, 0
    v_accvgpr_write_b32 a180, 0
    v_accvgpr_write_b32 a181, 0
    v_accvgpr_write_b32 a182, 0
    v_mfma_f32_32x32x16_bf16 v[96:111], v[152:155], a[204:207], v[96:111]
    ds_read_b64_tr_b16 v[138:139], v250 offset:46080
    v_accvgpr_write_b32 a183, 0
    v_accvgpr_write_b32 a184, 0
    v_accvgpr_write_b32 a185, 0
    v_accvgpr_write_b32 a186, 0
    v_accvgpr_write_b32 a187, 0
    s_waitcnt lgkmcnt(15)
    v_mfma_f32_32x32x16_bf16 v[48:63], v[156:159], a[200:203], v[48:63]
    ds_read_b64_tr_b16 v[140:141], v251 offset:45056
    v_accvgpr_write_b32 a188, 0
    v_accvgpr_write_b32 a189, 0
    v_accvgpr_write_b32 a190, 0
    v_accvgpr_write_b32 a191, 0
    v_mfma_f32_32x32x16_bf16 v[112:127], v[156:159], a[204:207], v[112:127]
    ds_read_b64_tr_b16 v[142:143], v251 offset:46080
    s_waitcnt lgkmcnt(15)
    s_waitcnt vmcnt(13)
    s_barrier
    s_waitcnt lgkmcnt(14)
    v_mfma_f32_32x32x16_bf16 v[0:15], v[232:235], a[208:211], v[0:15]
    ds_read_b64_tr_b16 v[144:145], v248 offset:49152
    ds_read_b128 a[64:67], v228 offset:0
    v_mfma_f32_32x32x16_bf16 v[64:79], v[232:235], a[212:215], v[64:79]
    ds_read_b64_tr_b16 v[146:147], v248 offset:50176
    s_lshl_b32 s54, s40, 8
    s_and_b32 s54, s54, 256
    s_add_u32 s54, s54, 151552
    v_lshl_add_u32 v201, v253, 2, s54
    ds_read_b32 v160, v201 offset:0
    s_waitcnt lgkmcnt(15)
    v_mfma_f32_32x32x16_bf16 v[16:31], v[236:239], a[208:211], v[16:31]
    ds_read_b64_tr_b16 v[148:149], v249 offset:49152
    ds_read_b128 a[68:71], v228 offset:1024
    ds_read_b32 v161, v201 offset:512
    ds_read_b32 v162, v201 offset:1024
    ds_read_b32 v163, v201 offset:1536
    s_lshl_b32 s54, s52, 1
    s_add_u32 s54, s54, s40
    v_mfma_f32_32x32x16_bf16 v[80:95], v[236:239], a[212:215], v[80:95]
    ds_read_b64_tr_b16 v[150:151], v249 offset:50176
    s_mul_i32 s54, s54, 11264
    s_lshl_b32 s55, s53, 8
    s_add_u32 s54, s54, s55
    s_add_u32 s54, s54, 262144
    v_lshl_add_u32 v203, v253, 2, v203
    s_waitcnt lgkmcnt(15)
    v_mfma_f32_32x32x16_bf16 v[32:47], v[240:243], a[208:211], v[32:47]
    ds_read_b64_tr_b16 v[152:153], v250 offset:49152
    ds_read_b128 a[72:75], v228 offset:2048
    v_mfma_f32_32x32x16_bf16 v[96:111], v[240:243], a[212:215], v[96:111]
    ds_read_b64_tr_b16 v[154:155], v250 offset:50176
    v_mfma_f32_32x32x16_bf16 v[48:63], v[244:247], a[208:211], v[48:63]
    ds_read_b64_tr_b16 v[156:157], v251 offset:49152
    ds_read_b128 a[76:79], v228 offset:3072
    v_mfma_f32_32x32x16_bf16 v[112:127], v[244:247], a[212:215], v[112:127]
    ds_read_b64_tr_b16 v[158:159], v251 offset:50176
    s_waitcnt lgkmcnt(9)
    v_add_f32 v160, v160, v161
    s_waitcnt lgkmcnt(7)
    v_add_f32 v162, v162, v163
    v_add_f32 v160, v160, v162
    buffer_store_dword v160, v203, s[20:23], s54 offen sc1
    v_mfma_f32_32x32x16_bf16 v[0:15], v[128:131], a[216:219], v[0:15]
    ds_read_b64_tr_b16 v[232:233], v248 offset:53248
    ds_read_b128 a[80:83], v228 offset:4096
    v_mov_b32 v192, 0
    v_mov_b32 v193, 0
    v_mov_b32 v194, 0
    v_mov_b32 v195, 0
    v_mov_b32 v196, 0
    v_mfma_f32_32x32x16_bf16 v[64:79], v[128:131], a[220:223], v[64:79]
    ds_read_b64_tr_b16 v[234:235], v248 offset:54272
    v_mov_b32 v197, 0
    v_mov_b32 v198, 0
    v_mov_b32 v199, 0
    v_mov_b32 v200, 0
    v_mov_b32 v201, 0
    v_mfma_f32_32x32x16_bf16 v[16:31], v[132:135], a[216:219], v[16:31]
    ds_read_b64_tr_b16 v[236:237], v249 offset:53248
    ds_read_b128 a[84:87], v228 offset:5120
    v_mov_b32 v202, 0
    v_mov_b32 v203, 0
    v_mov_b32 v204, 0
    v_mov_b32 v205, 0
    v_mov_b32 v206, 0
    v_mfma_f32_32x32x16_bf16 v[80:95], v[132:135], a[220:223], v[80:95]
    ds_read_b64_tr_b16 v[238:239], v249 offset:54272
    v_mov_b32 v207, 0
    v_mov_b32 v208, 0
    v_mov_b32 v209, 0
    v_mov_b32 v210, 0
    v_mov_b32 v211, 0
    v_mfma_f32_32x32x16_bf16 v[32:47], v[136:139], a[216:219], v[32:47]
    ds_read_b64_tr_b16 v[240:241], v250 offset:53248
    ds_read_b128 a[88:91], v228 offset:6144
    v_mov_b32 v212, 0
    v_mov_b32 v213, 0
    v_mov_b32 v214, 0
    v_mov_b32 v215, 0
    v_mov_b32 v216, 0
    v_mfma_f32_32x32x16_bf16 v[96:111], v[136:139], a[220:223], v[96:111]
    ds_read_b64_tr_b16 v[242:243], v250 offset:54272
    v_mov_b32 v217, 0
    v_mov_b32 v218, 0
    v_mov_b32 v219, 0
    v_mov_b32 v220, 0
    v_mov_b32 v221, 0
    v_mfma_f32_32x32x16_bf16 v[48:63], v[140:143], a[216:219], v[48:63]
    ds_read_b64_tr_b16 v[244:245], v251 offset:53248
    ds_read_b128 a[92:95], v228 offset:7168
    v_mov_b32 v222, 0
    v_mov_b32 v223, 0
    v_mov_b64 v[160:161], 0
    v_mov_b64 v[162:163], 0
    v_mov_b64 v[164:165], 0
    v_mfma_f32_32x32x16_bf16 v[112:127], v[140:143], a[220:223], v[112:127]
    ds_read_b64_tr_b16 v[246:247], v251 offset:54272
    v_mov_b64 v[166:167], 0
    v_mov_b64 v[168:169], 0
    v_mov_b64 v[170:171], 0
    v_mov_b32 v172, 0
    v_mov_b32 v173, 0xff800000
    v_mfma_f32_32x32x16_bf16 v[0:15], v[144:147], a[224:227], v[0:15]
    ds_read_b64_tr_b16 v[128:129], v248 offset:57344
    ds_read_b128 a[96:99], v228 offset:8192
    buffer_load_dword v226, off, s[20:23], s62 sc1
    v_lshrrev_b32 v255, 5, v253
    v_bfe_u32 v252, v253, 2, 3
    v_lshl_add_u32 v224, v255, 4, v252
    v_lshlrev_b32 v224, 7, v224
    v_bfe_u32 v252, v253, 2, 2
    v_mfma_f32_32x32x16_bf16 v[64:79], v[144:147], a[228:231], v[64:79]
    ds_read_b64_tr_b16 v[130:131], v248 offset:58368
    s_add_u32 s8, s44, 49152
    s_add_u32 m0, s46, 32768
    s_nop 0
    buffer_load_dwordx4 v229, s[20:23], s8 offen offset:0 lds
    v_lshl_add_u32 v225, v255, 3, v252
    v_lshlrev_b32 v225, 7, v225
    v_bfe_u32 v252, v253, 4, 1
    v_lshl_add_u32 v225, v252, 5, v225
    v_and_b32 v252, 3, v253
    s_waitcnt lgkmcnt(15)
    v_mfma_f32_32x32x16_bf16 v[16:31], v[148:151], a[224:227], v[16:31]
    ds_read_b64_tr_b16 v[132:133], v249 offset:57344
    ds_read_b128 a[100:103], v228 offset:9216
    s_add_u32 s87, s46, 65536
    v_lshl_add_u32 v252, v252, 3, s87
    v_add_u32 v224, v224, v252
    v_add_u32 v225, v225, v252
    v_mov_b64 v[174:175], s[100:101]
    v_mfma_f32_32x32x16_bf16 v[80:95], v[148:151], a[228:231], v[80:95]
    ds_read_b64_tr_b16 v[134:135], v249 offset:58368
    buffer_load_dwordx4 v229, s[20:23], s8 offen offset:1024 lds
    v_mov_b64 v[176:177], s[100:101]
    v_mov_b64 v[178:179], s[100:101]
    v_mov_b64 v[180:181], s[100:101]
    v_mov_b64 v[182:183], s[100:101]
    v_mov_b64 v[184:185], s[100:101]
    v_mfma_f32_32x32x16_bf16 v[32:47], v[152:155], a[224:227], v[32:47]
    ds_read_b64_tr_b16 v[136:137], v250 offset:57344
    ds_read_b128 a[104:107], v228 offset:10240
    v_mov_b64 v[186:187], s[100:101]
    v_mov_b64 v[188:189], s[100:101]
    v_mov_b64 v[190:191], s[100:101]
    v_mfma_f32_32x32x16_bf16 v[96:111], v[152:155], a[228:231], v[96:111]
    ds_read_b64_tr_b16 v[138:139], v250 offset:58368
    buffer_load_dwordx4 v229, s[20:23], s8 offen offset:2048 lds
    v_mfma_f32_32x32x16_bf16 v[48:63], v[156:159], a[224:227], v[48:63]
    ds_read_b64_tr_b16 v[140:141], v251 offset:57344
    ds_read_b128 a[108:111], v228 offset:11264
    v_mfma_f32_32x32x16_bf16 v[112:127], v[156:159], a[228:231], v[112:127]
    ds_read_b64_tr_b16 v[142:143], v251 offset:58368
    buffer_load_dwordx4 v229, s[20:23], s8 offen offset:3072 lds
    s_waitcnt lgkmcnt(15)
    v_mfma_f32_32x32x16_bf16 v[0:15], v[232:235], a[232:235], v[0:15]
    ds_read_b64_tr_b16 v[144:145], v248 offset:61440
    ds_read_b128 a[112:115], v228 offset:12288
    v_mfma_f32_32x32x16_bf16 v[64:79], v[232:235], a[236:239], v[64:79]
    ds_read_b64_tr_b16 v[146:147], v248 offset:62464
    s_add_u32 s8, s44, 65536
    s_add_u32 m0, s46, 49152
    s_nop 0
    buffer_load_dwordx4 v229, s[20:23], s8 offen offset:0 lds
    v_mfma_f32_32x32x16_bf16 v[16:31], v[236:239], a[232:235], v[16:31]
    ds_read_b64_tr_b16 v[148:149], v249 offset:61440
    ds_read_b128 a[116:119], v228 offset:13312
    v_mfma_f32_32x32x16_bf16 v[80:95], v[236:239], a[236:239], v[80:95]
    ds_read_b64_tr_b16 v[150:151], v249 offset:62464
    buffer_load_dwordx4 v229, s[20:23], s8 offen offset:1024 lds
    v_mfma_f32_32x32x16_bf16 v[32:47], v[240:243], a[232:235], v[32:47]
    ds_read_b64_tr_b16 v[152:153], v250 offset:61440
    ds_read_b128 a[120:123], v228 offset:14336
    v_mfma_f32_32x32x16_bf16 v[96:111], v[240:243], a[236:239], v[96:111]
    ds_read_b64_tr_b16 v[154:155], v250 offset:62464
    buffer_load_dwordx4 v229, s[20:23], s8 offen offset:2048 lds
    s_waitcnt lgkmcnt(15)
    v_mfma_f32_32x32x16_bf16 v[48:63], v[244:247], a[232:235], v[48:63]
    ds_read_b64_tr_b16 v[156:157], v251 offset:61440
    ds_read_b128 a[124:127], v228 offset:15360
    v_mfma_f32_32x32x16_bf16 v[112:127], v[244:247], a[236:239], v[112:127]
    ds_read_b64_tr_b16 v[158:159], v251 offset:62464
    buffer_load_dwordx4 v229, s[20:23], s8 offen offset:3072 lds
    s_waitcnt vmcnt(10)
    v_mfma_f32_32x32x16_bf16 v[0:15], v[128:131], a[240:243], v[0:15]
    ds_read_b64_tr_b16 a[212:213], v225 offset:0
    v_mfma_f32_32x32x16_bf16 v[64:79], v[128:131], a[244:247], v[64:79]
    ds_read_b64_tr_b16 a[214:215], v225 offset:512
    v_mfma_f32_32x32x16_bf16 v[16:31], v[132:135], a[240:243], v[16:31]
    ds_read_b64_tr_b16 a[216:217], v225 offset:2048
    v_mfma_f32_32x32x16_bf16 v[80:95], v[132:135], a[244:247], v[80:95]
    ds_read_b64_tr_b16 a[218:219], v225 offset:2560
    s_waitcnt lgkmcnt(15)
    v_mfma_f32_32x32x16_bf16 v[32:47], v[136:139], a[240:243], v[32:47]
    ds_read_b64_tr_b16 a[220:221], v225 offset:64
    v_mfma_f32_32x32x16_bf16 v[96:111], v[136:139], a[244:247], v[96:111]
    ds_read_b64_tr_b16 a[222:223], v225 offset:576
    v_mfma_f32_32x32x16_bf16 v[48:63], v[140:143], a[240:243], v[48:63]
    ds_read_b64_tr_b16 a[224:225], v225 offset:2112
    v_mfma_f32_32x32x16_bf16 v[112:127], v[140:143], a[244:247], v[112:127]
    ds_read_b64_tr_b16 a[226:227], v225 offset:2624
    s_waitcnt lgkmcnt(15)
    v_mfma_f32_32x32x16_bf16 v[0:15], v[144:147], a[248:251], v[0:15]
    s_waitcnt lgkmcnt(6)
    buffer_store_dwordx4 a[212:215], v229, s[20:23], s51 offen offset:0 sc1
    v_mfma_f32_32x32x16_bf16 v[64:79], v[144:147], a[252:255], v[64:79]
    v_mfma_f32_32x32x16_bf16 v[16:31], v[148:151], a[248:251], v[16:31]
    s_waitcnt lgkmcnt(4)
    buffer_store_dwordx4 a[216:219], v229, s[20:23], s51 offen offset:2048 sc1
    v_mfma_f32_32x32x16_bf16 v[80:95], v[148:151], a[252:255], v[80:95]
    v_mfma_f32_32x32x16_bf16 v[32:47], v[152:155], a[248:251], v[32:47]
    s_add_u32 s51, s51, 65536
    s_waitcnt lgkmcnt(2)
    buffer_store_dwordx4 a[220:223], v229, s[20:23], s51 offen offset:0 sc1
    v_mfma_f32_32x32x16_bf16 v[96:111], v[152:155], a[252:255], v[96:111]
    v_mfma_f32_32x32x16_bf16 v[48:63], v[156:159], a[248:251], v[48:63]
    s_waitcnt lgkmcnt(0)
    buffer_store_dwordx4 a[224:227], v229, s[20:23], s51 offen offset:2048 sc1
    v_mfma_f32_32x32x16_bf16 v[112:127], v[156:159], a[252:255], v[112:127]
    s_lshl_b32 s8, s40, 14
    s_and_b32 s8, s8, 0x4000
    s_add_u32 s8, s8, s68
    s_cmp_ge_u32 s40, 2
    s_cselect_b32 s8, s8, 0xf0000000
    v_cvt_pk_bf16_f32 v232, v0, v1
    v_cvt_pk_bf16_f32 v233, v2, v3
    v_cvt_pk_bf16_f32 v234, v4, v5
    v_cvt_pk_bf16_f32 v235, v6, v7
    v_accvgpr_write_b32 a0, v232
    v_accvgpr_write_b32 a1, v233
    v_accvgpr_write_b32 a2, v234
    v_accvgpr_write_b32 a3, v235
    buffer_store_dwordx4 v[232:235], v229, s[20:23], s8 offen offset:0
    v_cvt_pk_bf16_f32 v236, v8, v9
    v_cvt_pk_bf16_f32 v237, v10, v11
    v_cvt_pk_bf16_f32 v238, v12, v13
    v_cvt_pk_bf16_f32 v239, v14, v15
    v_accvgpr_write_b32 a4, v236
    v_accvgpr_write_b32 a5, v237
    v_accvgpr_write_b32 a6, v238
    v_accvgpr_write_b32 a7, v239
    buffer_store_dwordx4 v[236:239], v229, s[20:23], s8 offen offset:1024
    v_cvt_pk_bf16_f32 v240, v16, v17
    v_cvt_pk_bf16_f32 v241, v18, v19
    v_cvt_pk_bf16_f32 v242, v20, v21
    v_cvt_pk_bf16_f32 v243, v22, v23
    v_accvgpr_write_b32 a8, v240
    v_accvgpr_write_b32 a9, v241
    v_accvgpr_write_b32 a10, v242
    v_accvgpr_write_b32 a11, v243
    buffer_store_dwordx4 v[240:243], v229, s[20:23], s8 offen offset:2048
    v_cvt_pk_bf16_f32 v244, v24, v25
    v_cvt_pk_bf16_f32 v245, v26, v27
    v_cvt_pk_bf16_f32 v246, v28, v29
    v_cvt_pk_bf16_f32 v247, v30, v31
    v_accvgpr_write_b32 a12, v244
    v_accvgpr_write_b32 a13, v245
    v_accvgpr_write_b32 a14, v246
    v_accvgpr_write_b32 a15, v247
    buffer_store_dwordx4 v[244:247], v229, s[20:23], s8 offen offset:3072
    s_add_u32 s8, s8, 4096
    v_cvt_pk_bf16_f32 v232, v32, v33
    v_cvt_pk_bf16_f32 v233, v34, v35
    v_cvt_pk_bf16_f32 v234, v36, v37
    v_cvt_pk_bf16_f32 v235, v38, v39
    v_accvgpr_write_b32 a16, v232
    v_accvgpr_write_b32 a17, v233
    v_accvgpr_write_b32 a18, v234
    v_accvgpr_write_b32 a19, v235
    buffer_store_dwordx4 v[232:235], v229, s[20:23], s8 offen offset:0
    v_cvt_pk_bf16_f32 v236, v40, v41
    v_cvt_pk_bf16_f32 v237, v42, v43
    v_cvt_pk_bf16_f32 v238, v44, v45
    v_cvt_pk_bf16_f32 v239, v46, v47
    v_accvgpr_write_b32 a20, v236
    v_accvgpr_write_b32 a21, v237
    v_accvgpr_write_b32 a22, v238
    v_accvgpr_write_b32 a23, v239
    buffer_store_dwordx4 v[236:239], v229, s[20:23], s8 offen offset:1024
    v_cvt_pk_bf16_f32 v240, v48, v49
    v_cvt_pk_bf16_f32 v241, v50, v51
    v_cvt_pk_bf16_f32 v242, v52, v53
    v_cvt_pk_bf16_f32 v243, v54, v55
    v_accvgpr_write_b32 a24, v240
    v_accvgpr_write_b32 a25, v241
    v_accvgpr_write_b32 a26, v242
    v_accvgpr_write_b32 a27, v243
    buffer_store_dwordx4 v[240:243], v229, s[20:23], s8 offen offset:2048
    v_cvt_pk_bf16_f32 v244, v56, v57
    v_cvt_pk_bf16_f32 v245, v58, v59
    v_cvt_pk_bf16_f32 v246, v60, v61
    v_cvt_pk_bf16_f32 v247, v62, v63
    v_accvgpr_write_b32 a28, v244
    v_accvgpr_write_b32 a29, v245
    v_accvgpr_write_b32 a30, v246
    v_accvgpr_write_b32 a31, v247
    buffer_store_dwordx4 v[244:247], v229, s[20:23], s8 offen offset:3072
    s_add_u32 s8, s8, 4096
    v_accvgpr_write_b32 a192, 0
    v_accvgpr_write_b32 a193, 0
    v_accvgpr_write_b32 a194, 0
    v_accvgpr_write_b32 a195, 0
    s_nop 1
    v_mfma_f32_32x32x16_bf16 v[0:15], a[192:195], a[192:195], 0
    v_mfma_f32_32x32x16_bf16 v[16:31], a[192:195], a[192:195], 0
    v_mfma_f32_32x32x16_bf16 v[32:47], a[192:195], a[192:195], 0
    v_mfma_f32_32x32x16_bf16 v[48:63], a[192:195], a[192:195], 0
    v_cvt_pk_bf16_f32 v232, v64, v65
    v_cvt_pk_bf16_f32 v233, v66, v67
    v_cvt_pk_bf16_f32 v234, v68, v69
    v_cvt_pk_bf16_f32 v235, v70, v71
    v_accvgpr_write_b32 a32, v232
    v_accvgpr_write_b32 a33, v233
    v_accvgpr_write_b32 a34, v234
    v_accvgpr_write_b32 a35, v235
    buffer_store_dwordx4 v[232:235], v229, s[20:23], s8 offen offset:0
    v_cvt_pk_bf16_f32 v236, v72, v73
    v_cvt_pk_bf16_f32 v237, v74, v75
    v_cvt_pk_bf16_f32 v238, v76, v77
    v_cvt_pk_bf16_f32 v239, v78, v79
    v_accvgpr_write_b32 a36, v236
    v_accvgpr_write_b32 a37, v237
    v_accvgpr_write_b32 a38, v238
    v_accvgpr_write_b32 a39, v239
    buffer_store_dwordx4 v[236:239], v229, s[20:23], s8 offen offset:1024
    v_cvt_pk_bf16_f32 v240, v80, v81
    v_cvt_pk_bf16_f32 v241, v82, v83
    v_cvt_pk_bf16_f32 v242, v84, v85
    v_cvt_pk_bf16_f32 v243, v86, v87
    v_accvgpr_write_b32 a40, v240
    v_accvgpr_write_b32 a41, v241
    v_accvgpr_write_b32 a42, v242
    v_accvgpr_write_b32 a43, v243
    buffer_store_dwordx4 v[240:243], v229, s[20:23], s8 offen offset:2048
    v_cvt_pk_bf16_f32 v244, v88, v89
    v_cvt_pk_bf16_f32 v245, v90, v91
    v_cvt_pk_bf16_f32 v246, v92, v93
    v_cvt_pk_bf16_f32 v247, v94, v95
    v_accvgpr_write_b32 a44, v244
    v_accvgpr_write_b32 a45, v245
    v_accvgpr_write_b32 a46, v246
    v_accvgpr_write_b32 a47, v247
    buffer_store_dwordx4 v[244:247], v229, s[20:23], s8 offen offset:3072
    s_add_u32 s8, s8, 4096
    v_cvt_pk_bf16_f32 v232, v96, v97
    v_cvt_pk_bf16_f32 v233, v98, v99
    v_cvt_pk_bf16_f32 v234, v100, v101
    v_cvt_pk_bf16_f32 v235, v102, v103
    v_accvgpr_write_b32 a48, v232
    v_accvgpr_write_b32 a49, v233
    v_accvgpr_write_b32 a50, v234
    v_accvgpr_write_b32 a51, v235
    buffer_store_dwordx4 v[232:235], v229, s[20:23], s8 offen offset:0
    v_cvt_pk_bf16_f32 v236, v104, v105
    v_cvt_pk_bf16_f32 v237, v106, v107
    v_cvt_pk_bf16_f32 v238, v108, v109
    v_cvt_pk_bf16_f32 v239, v110, v111
    v_accvgpr_write_b32 a52, v236
    v_accvgpr_write_b32 a53, v237
    v_accvgpr_write_b32 a54, v238
    v_accvgpr_write_b32 a55, v239
    buffer_store_dwordx4 v[236:239], v229, s[20:23], s8 offen offset:1024
    v_cvt_pk_bf16_f32 v240, v112, v113
    v_cvt_pk_bf16_f32 v241, v114, v115
    v_cvt_pk_bf16_f32 v242, v116, v117
    v_cvt_pk_bf16_f32 v243, v118, v119
    v_accvgpr_write_b32 a56, v240
    v_accvgpr_write_b32 a57, v241
    v_accvgpr_write_b32 a58, v242
    v_accvgpr_write_b32 a59, v243
    buffer_store_dwordx4 v[240:243], v229, s[20:23], s8 offen offset:2048
    v_cvt_pk_bf16_f32 v244, v120, v121
    v_cvt_pk_bf16_f32 v245, v122, v123
    v_cvt_pk_bf16_f32 v246, v124, v125
    v_cvt_pk_bf16_f32 v247, v126, v127
    v_accvgpr_write_b32 a60, v244
    v_accvgpr_write_b32 a61, v245
    v_accvgpr_write_b32 a62, v246
    v_accvgpr_write_b32 a63, v247
    buffer_store_dwordx4 v[244:247], v229, s[20:23], s8 offen offset:3072
    s_add_u32 s8, s8, 4096
    v_mfma_f32_32x32x16_bf16 v[64:79], a[192:195], a[192:195], 0
    v_mfma_f32_32x32x16_bf16 v[80:95], a[192:195], a[192:195], 0
    v_mfma_f32_32x32x16_bf16 v[96:111], a[192:195], a[192:195], 0
    v_mfma_f32_32x32x16_bf16 v[112:127], a[192:195], a[192:195], 0
    s_lshl_b32 s51, s46, 1
    s_add_u32 s51, s51, 114688
    s_add_u32 s8, s46, 49152
    v_add_u32 v250, s8, v224
    v_mov_b32 v251, v254
    v_min_u32 v248, 1, v253
    v_lshlrev_b32 v248, 31, v248
    v_mov_b32 v249, 1
    s_and_b32 s97, s2, 6
    s_lshl_b32 s97, s97, 11
    s_add_u32 s97, s97, 557056
    s_add_u32 s96, s43, 1
    s_cmp_ge_u32 s40, 2
    s_cselect_b32 s50, s41, 99
    v_mov_b32 v224, 0
    v_mov_b32 v225, 0
    s_waitcnt vmcnt(28)
    v_readfirstlane_b32 s42, v226
    s_nop 0
    s_or_b32 s42, s42, s63
    s_cmp_eq_u32 s42, 0xff
    s_cbranch_scc1 K2_PA_OK
K2_PA:
    s_sleep 4
    buffer_load_dword v226, off, s[20:23], s62 sc1
    s_waitcnt vmcnt(0)
    v_readfirstlane_b32 s42, v226
    s_nop 0
    s_or_b32 s42, s42, s63
    s_cmp_eq_u32 s42, 0xff
    s_cbranch_scc1 K2_PA_OK
    s_branch K2_PA
K2_PA_OK:
    v_mov_b32 v228, v229
    s_bfe_u32 s98, s2, 0x20003
    s_lshl_b32 s98, s98, 1
    s_lshr_b32 s99, s40, 1
    s_add_u32 s98, s98, s99
    s_lshl_b32 s98, s98, 19
    s_and_b32 s99, s2, 6
    s_lshl_b32 s99, s99, 16
    s_add_u32 s98, s98, s99
    s_and_b32 s99, s46, 4096
    s_add_u32 s98, s98, s99
    s_add_u32 s99, s98, 79740928
    s_add_u32 s98, s98, 79208448
    s_cmp_eq_u32 s40, 3
    s_cselect_b32 s62, 13, 99
    s_mov_b32 s63, 537600
    v_and_b32 v252, 3, v253
    v_lshlrev_b32 v252, 7, v252
    s_load_dwordx2 s[88:89], s[0:1], 72
    s_and_b32 s86, s40, 1
    s_mov_b32 s8, s2
    s_lshl_b32 s8, s8, 1
    s_add_u32 s8, s8, s86
    s_lshr_b32 s9, s8, 3
    s_and_b32 s8, s8, 7
    s_lshl_b32 s87, s9, 15
    s_lshl_b32 s86, s8, 7
    s_add_u32 s87, s87, s86
    s_mul_i32 s86, s8, 48
    s_add_u32 s86, s86, s9
    s_lshl_b32 s86, s86, 12
    s_add_u32 s86, s86, 88080384
    s_cmp_lt_u32 s9, 48
    s_cselect_b32 s86, s86, 0xf0000000
    s_add_u32 s45, s44, 81920
    s_add_u32 s84, s44, 1064960
    s_mov_b32 s42, -1
    s_mov_b32 s67, s46
    s_add_u32 s42, s42, 1
    s_xor_b32 s67, s67, 0x8000
    s_lshl_b32 s8, s42, 15
    s_sub_u32 s54, s84, s8
    s_cmp_ge_u32 s42, s41
    s_cselect_b32 s54, s54, 0xf0000000
    s_cmp_lt_u32 s42, 16
    s_cselect_b32 s54, s54, s99
    s_sub_u32 s55, s54, 49152
    s_mov_b32 s65, s47
    s_mov_b32 s64, 0xff800000
    s_mov_b32 s66, 1
    s_waitcnt lgkmcnt(0)
    s_barrier
    s_mov_b32 s85, 0
K2_TOP:
    s_add_u32 m0, s67, 65536
    v_mfma_f32_32x32x16_bf16 v[128:143], a[64:67], a[0:3], v[192:207]
    buffer_load_dwordx4 v229, s[20:23], s54 offen offset:0 lds
    v_add_f32 v225, v225, v171
    v_cvt_pk_bf16_f32 v169, v170, v171
    v_exp_f32 v173, v173
    v_mfma_f32_32x32x16_bf16 v[128:143], a[68:71], a[4:7], v[128:143]
    v_add_f32 v225, v225, v172
    v_exp_f32 v174, v174
    v_add_f32 v225, v225, v173
    v_cvt_pk_bf16_f32 v170, v172, v173
    v_mfma_f32_32x32x16_bf16 v[128:143], a[72:75], a[8:11], v[128:143]
    buffer_load_dwordx4 v229, s[20:23], s54 offen offset:1024 lds
    v_exp_f32 v175, v175
    v_add_f32 v225, v225, v174
    v_mfma_f32_32x32x16_bf16 v[128:143], a[76:79], a[12:15], v[128:143]
    v_exp_f32 v176, v176
    v_add_f32 v225, v225, v175
    v_cvt_pk_bf16_f32 v171, v174, v175
    v_exp_f32 v177, v177
    v_mfma_f32_32x32x16_bf16 v[128:143], a[80:83], a[16:19], v[128:143]
    buffer_load_dwordx4 v229, s[20:23], s54 offen offset:2048 lds
    v_add_f32 v225, v225, v176
    v_exp_f32 v178, v178
    v_add_f32 v225, v225, v177
    v_mfma_f32_32x32x16_bf16 v[128:143], a[84:87], a[20:23], v[128:143]
    v_cvt_pk_bf16_f32 v176, v176, v177
    v_exp_f32 v179, v179
    v_add_f32 v225, v225, v178
    v_exp_f32 v180, v180
    v_mfma_f32_32x32x16_bf16 v[128:143], a[88:91], a[24:27], v[128:143]
    buffer_load_dwordx4 v229, s[20:23], s54 offen offset:3072 lds
    v_add_f32 v225, v225, v179
    v_cvt_pk_bf16_f32 v177, v178, v179
    v_exp_f32 v181, v181
    v_mfma_f32_32x32x16_bf16 v[128:143], a[92:95], a[28:31], v[128:143]
    s_add_u32 m0, s67, 81920
    v_add_f32 v225, v225, v180
    v_exp_f32 v182, v182
    v_add_f32 v225, v225, v181
    v_mfma_f32_32x32x16_bf16 v[144:159], a[96:99], a[0:3], v[192:207]
    buffer_load_dwordx4 v229, s[20:23], s55 offen offset:0 lds
    v_cvt_pk_bf16_f32 v178, v180, v181
    v_exp_f32 v183, v183
    v_add_f32 v225, v225, v182
    v_mfma_f32_32x32x16_bf16 v[144:159], a[100:103], a[4:7], v[144:159]
    v_exp_f32 v184, v184
    v_add_f32 v225, v225, v183
    v_cvt_pk_bf16_f32 v179, v182, v183
    v_mfma_f32_32x32x16_bf16 v[144:159], a[104:107], a[8:11], v[144:159]
    buffer_load_dwordx4 v229, s[20:23], s55 offen offset:1024 lds
    v_exp_f32 v185, v185
    v_add_f32 v225, v225, v184
    v_mfma_f32_32x32x16_bf16 v[144:159], a[108:111], a[12:15], v[144:159]
    v_max3_f32 v226, v128, v129, v130
    v_exp_f32 v186, v186
    v_add_f32 v225, v225, v185
    v_cvt_pk_bf16_f32 v184, v184, v185
    v_mfma_f32_32x32x16_bf16 v[144:159], a[112:115], a[16:19], v[144:159]
    buffer_load_dwordx4 v229, s[20:23], s55 offen offset:2048 lds
    v_max3_f32 v226, v226, v131, v132
    v_exp_f32 v187, v187
    v_add_f32 v225, v225, v186
    v_mfma_f32_32x32x16_bf16 v[144:159], a[116:119], a[20:23], v[144:159]
    v_max3_f32 v226, v226, v133, v134
    v_exp_f32 v188, v188
    v_add_f32 v225, v225, v187
    v_cvt_pk_bf16_f32 v185, v186, v187
    v_mfma_f32_32x32x16_bf16 v[144:159], a[120:123], a[24:27], v[144:159]
    buffer_load_dwordx4 v229, s[20:23], s55 offen offset:3072 lds
    v_max3_f32 v226, v226, v135, v136
    v_exp_f32 v189, v189
    v_add_f32 v225, v225, v188
    v_mfma_f32_32x32x16_bf16 v[144:159], a[124:127], a[28:31], v[144:159]
    v_max3_f32 v226, v226, v137, v138
    v_exp_f32 v190, v190
    v_add_f32 v225, v225, v189
    v_cvt_pk_bf16_f32 v186, v188, v189
    v_mfma_f32_32x32x16_bf16 v[64:79], a[128:131], v[160:163], v[64:79]
    ds_read_b128 a[128:131], v228 offset:0
    v_max3_f32 v226, v226, v139, v140
    v_exp_f32 v191, v191
    v_add_f32 v225, v225, v190
    v_add_f32 v225, v225, v191
    v_mfma_f32_32x32x16_bf16 v[80:95], a[132:135], v[160:163], v[80:95]
    ds_read_b128 a[132:135], v228 offset:1024
    v_max3_f32 v226, v226, v141, v142
    v_cvt_pk_bf16_f32 v187, v190, v191
    v_mfma_f32_32x32x16_bf16 v[96:111], a[136:139], v[160:163], v[96:111]
    ds_read_b128 a[136:139], v228 offset:2048
    v_max3_f32 v226, v226, v143, v144
    v_max3_f32 v226, v226, v145, v146
    v_max3_f32 v226, v226, v147, v148
    v_max3_f32 v226, v226, v149, v150
    v_max3_f32 v226, v226, v151, v152
    v_mfma_f32_32x32x16_bf16 v[112:127], a[140:143], v[160:163], v[112:127]
    ds_read_b128 a[140:143], v228 offset:3072
    v_max3_f32 v226, v226, v153, v154
    v_max3_f32 v226, v226, v155, v156
    v_max3_f32 v226, v226, v157, v158
    v_max_f32 v226, v226, v159
    v_cmp_lt_f32 vcc, s64, v226
    s_nop 0
    s_cbranch_vccnz K2_SLOWX
K2_BACKX:
    v_mfma_f32_32x32x16_bf16 v[64:79], a[144:147], v[168:171], v[64:79]
    ds_read_b128 a[144:147], v228 offset:4096
    v_exp_f32 v128, v128
    v_exp_f32 v129, v129
    v_add_f32 v224, v224, v128
    v_mfma_f32_32x32x16_bf16 v[80:95], a[148:151], v[168:171], v[80:95]
    ds_read_b128 a[148:151], v228 offset:5120
    v_exp_f32 v130, v130
    v_add_f32 v224, v224, v129
    v_cvt_pk_bf16_f32 v128, v128, v129
    v_mfma_f32_32x32x16_bf16 v[96:111], a[152:155], v[168:171], v[96:111]
    ds_read_b128 a[152:155], v228 offset:6144
    v_exp_f32 v131, v131
    v_add_f32 v224, v224, v130
    v_mfma_f32_32x32x16_bf16 v[112:127], a[156:159], v[168:171], v[112:127]
    ds_read_b128 a[156:159], v228 offset:7168
    v_exp_f32 v132, v132
    v_add_f32 v224, v224, v131
    v_cvt_pk_bf16_f32 v129, v130, v131
    v_mfma_f32_32x32x16_bf16 v[64:79], a[160:163], v[176:179], v[64:79]
    ds_read_b128 a[160:163], v228 offset:8192
    s_lshl_b32 s8, s42, 15
    v_exp_f32 v133, v133
    v_add_f32 v224, v224, v132
    v_mfma_f32_32x32x16_bf16 v[80:95], a[164:167], v[176:179], v[80:95]
    ds_read_b128 a[164:167], v228 offset:9216
    v_exp_f32 v134, v134
    v_add_f32 v224, v224, v133
    v_cvt_pk_bf16_f32 v130, v132, v133
    v_mfma_f32_32x32x16_bf16 v[96:111], a[168:171], v[176:179], v[96:111]
    ds_read_b128 a[168:171], v228 offset:10240
    v_exp_f32 v135, v135
    v_add_f32 v224, v224, v134
    v_exp_f32 v136, v136
    v_mfma_f32_32x32x16_bf16 v[112:127], a[172:175], v[176:179], v[112:127]
    ds_read_b128 a[172:175], v228 offset:11264
    v_add_f32 v224, v224, v135
    v_cvt_pk_bf16_f32 v131, v134, v135
    v_exp_f32 v137, v137
    v_mfma_f32_32x32x16_bf16 v[64:79], a[176:179], v[184:187], v[64:79]
    ds_read_b128 a[176:179], v228 offset:12288
    v_add_f32 v224, v224, v136
    v_exp_f32 v138, v138
    v_add_f32 v224, v224, v137
    v_mfma_f32_32x32x16_bf16 v[80:95], a[180:183], v[184:187], v[80:95]
    ds_read_b128 a[180:183], v228 offset:13312
    v_cvt_pk_bf16_f32 v136, v136, v137
    v_exp_f32 v139, v139
    v_add_f32 v224, v224, v138
    v_mfma_f32_32x32x16_bf16 v[96:111], a[184:187], v[184:187], v[96:111]
    ds_read_b128 a[184:187], v228 offset:14336
    v_exp_f32 v140, v140
    v_add_f32 v224, v224, v139
    v_mfma_f32_32x32x16_bf16 v[112:127], a[188:191], v[184:187], v[112:127]
    ds_read_b128 a[188:191], v228 offset:15360
    v_cvt_pk_bf16_f32 v137, v138, v139
    v_exp_f32 v141, v141
    v_add_f32 v224, v224, v140
    v_mfma_f32_32x32x16_bf16 v[160:175], a[64:67], a[32:35], v[208:223]
    ds_read_b128 a[64:67], v228 offset:16384
    s_cmp_lt_u32 s42, 15
    v_exp_f32 v142, v142
    v_add_f32 v224, v224, v141
    v_cvt_pk_bf16_f32 v138, v140, v141
    v_mfma_f32_32x32x16_bf16 v[160:175], a[68:71], a[36:39], v[160:175]
    ds_read_b128 a[68:71], v228 offset:17408
    s_cselect_b32 s52, s45, s98
    v_exp_f32 v143, v143
    v_add_f32 v224, v224, v142
    v_mfma_f32_32x32x16_bf16 v[160:175], a[72:75], a[40:43], v[160:175]
    ds_read_b128 a[72:75], v228 offset:18432
    v_exp_f32 v144, v144
    v_add_f32 v224, v224, v143
    v_cvt_pk_bf16_f32 v139, v142, v143
    v_mfma_f32_32x32x16_bf16 v[160:175], a[76:79], a[44:47], v[160:175]
    ds_read_b128 a[76:79], v228 offset:19456
    v_exp_f32 v145, v145
    v_add_f32 v224, v224, v144
    v_exp_f32 v146, v146
    v_mfma_f32_32x32x16_bf16 v[160:175], a[80:83], a[48:51], v[160:175]
    ds_read_b128 a[80:83], v228 offset:20480
    s_add_u32 s52, s52, s8
    v_add_f32 v224, v224, v145
    v_cvt_pk_bf16_f32 v144, v144, v145
    v_exp_f32 v147, v147
    v_mfma_f32_32x32x16_bf16 v[160:175], a[84:87], a[52:55], v[160:175]
    ds_read_b128 a[84:87], v228 offset:21504
    v_add_f32 v224, v224, v146
    v_exp_f32 v148, v148
    v_add_f32 v224, v224, v147
    v_mfma_f32_32x32x16_bf16 v[160:175], a[88:91], a[56:59], v[160:175]
    ds_read_b128 a[88:91], v228 offset:22528
    v_cvt_pk_bf16_f32 v145, v146, v147
    v_exp_f32 v149, v149
    v_mfma_f32_32x32x16_bf16 v[160:175], a[92:95], a[60:63], v[160:175]
    ds_read_b128 a[92:95], v228 offset:23552
    v_add_f32 v224, v224, v148
    v_exp_f32 v150, v150
    v_add_f32 v224, v224, v149
    v_mfma_f32_32x32x16_bf16 v[176:191], a[96:99], a[32:35], v[208:223]
    ds_read_b128 a[96:99], v228 offset:24576
    s_add_u32 s53, s52, 16384
    v_cvt_pk_bf16_f32 v146, v148, v149
    v_exp_f32 v151, v151
    v_add_f32 v224, v224, v150
    v_mfma_f32_32x32x16_bf16 v[176:191], a[100:103], a[36:39], v[176:191]
    ds_read_b128 a[100:103], v228 offset:25600
    v_exp_f32 v152, v152
    v_add_f32 v224, v224, v151
    v_cvt_pk_bf16_f32 v147, v150, v151
    v_mfma_f32_32x32x16_bf16 v[176:191], a[104:107], a[40:43], v[176:191]
    ds_read_b128 a[104:107], v228 offset:26624
    v_exp_f32 v153, v153
    v_add_f32 v224, v224, v152
    v_mfma_f32_32x32x16_bf16 v[176:191], a[108:111], a[44:47], v[176:191]
    ds_read_b128 a[108:111], v228 offset:27648
    v_max3_f32 v227, v160, v161, v162
    v_exp_f32 v154, v154
    v_add_f32 v224, v224, v153
    v_cvt_pk_bf16_f32 v152, v152, v153
    v_mfma_f32_32x32x16_bf16 v[176:191], a[112:115], a[48:51], v[176:191]
    ds_read_b128 a[112:115], v228 offset:28672
    v_max3_f32 v227, v227, v163, v164
    v_exp_f32 v155, v155
    v_add_f32 v224, v224, v154
    v_mfma_f32_32x32x16_bf16 v[176:191], a[116:119], a[52:55], v[176:191]
    ds_read_b128 a[116:119], v228 offset:29696
    v_max3_f32 v227, v227, v165, v166
    v_exp_f32 v156, v156
    v_add_f32 v224, v224, v155
    v_cvt_pk_bf16_f32 v153, v154, v155
    v_mfma_f32_32x32x16_bf16 v[176:191], a[120:123], a[56:59], v[176:191]
    ds_read_b128 a[120:123], v228 offset:30720
    v_max3_f32 v227, v227, v167, v168
    v_exp_f32 v157, v157
    v_add_f32 v224, v224, v156
    v_mfma_f32_32x32x16_bf16 v[176:191], a[124:127], a[60:63], v[176:191]
    ds_read_b128 a[124:127], v228 offset:31744
    v_max3_f32 v227, v227, v169, v170
    v_exp_f32 v158, v158
    v_add_f32 v224, v224, v157
    s_waitcnt lgkmcnt(15)
    v_mfma_f32_32x32x16_bf16 v[0:15], a[128:131], v[128:131], v[0:15]
    s_xor_b32 m0, s67, 0x8000
    v_max3_f32 v227, v227, v171, v172
    v_cvt_pk_bf16_f32 v154, v156, v157
    v_exp_f32 v159, v159
    v_add_f32 v224, v224, v158
    v_mfma_f32_32x32x16_bf16 v[16:31], a[132:135], v[128:131], v[16:31]
    v_max3_f32 v227, v227, v173, v174
    v_xor_b32 v228, 0x8000, v228
    v_add_f32 v224, v224, v159
    s_waitcnt lgkmcnt(0)
    s_waitcnt vmcnt(0)
    s_barrier
    v_mfma_f32_32x32x16_bf16 v[32:47], a[136:139], v[128:131], v[32:47]
    buffer_load_dwordx4 v229, s[20:23], s52 offen offset:0 lds
    v_max3_f32 v227, v227, v175, v176
    v_max3_f32 v227, v227, v177, v178
    v_max3_f32 v227, v227, v179, v180
    v_max3_f32 v227, v227, v181, v182
    v_max3_f32 v227, v227, v183, v184
    v_mfma_f32_32x32x16_bf16 v[48:63], a[140:143], v[128:131], v[48:63]
    v_max3_f32 v227, v227, v185, v186
    v_max3_f32 v227, v227, v187, v188
    v_max3_f32 v227, v227, v189, v190
    v_max_f32 v227, v227, v191
    v_cmp_lt_f32 vcc, s64, v227
    s_nop 0
    s_cbranch_vccnz K2_SLOWY
K2_BACKY:
    v_mfma_f32_32x32x16_bf16 v[0:15], a[144:147], v[136:139], v[0:15]
    buffer_load_dwordx4 v229, s[20:23], s52 offen offset:1024 lds
    v_cvt_pk_bf16_f32 v155, v158, v159
    v_exp_f32 v160, v160
    v_mfma_f32_32x32x16_bf16 v[16:31], a[148:151], v[136:139], v[16:31]
    s_add_u32 s42, s42, 1
    v_exp_f32 v161, v161
    v_add_f32 v225, v225, v160
    v_exp_f32 v162, v162
    v_mfma_f32_32x32x16_bf16 v[32:47], a[152:155], v[136:139], v[32:47]
    buffer_load_dwordx4 v229, s[20:23], s52 offen offset:2048 lds
    v_add_f32 v225, v225, v161
    v_cvt_pk_bf16_f32 v160, v160, v161
    v_exp_f32 v163, v163
    v_mfma_f32_32x32x16_bf16 v[48:63], a[156:159], v[136:139], v[48:63]
    s_cmp_ge_u32 s42, s85
    s_cselect_b32 s64, s3, 0x41000000
    v_add_f32 v225, v225, v162
    v_exp_f32 v164, v164
    v_add_f32 v225, v225, v163
    v_mfma_f32_32x32x16_bf16 v[0:15], a[160:163], v[144:147], v[0:15]
    buffer_load_dwordx4 v229, s[20:23], s52 offen offset:3072 lds
    v_cvt_pk_bf16_f32 v161, v162, v163
    v_exp_f32 v165, v165
    v_add_f32 v225, v225, v164
    v_mfma_f32_32x32x16_bf16 v[16:31], a[164:167], v[144:147], v[16:31]
    s_add_u32 m0, m0, 16384
    s_xor_b32 s67, s67, 0x8000
    s_lshl_b32 s8, s42, 15
    v_exp_f32 v166, v166
    v_add_f32 v225, v225, v165
    v_mfma_f32_32x32x16_bf16 v[32:47], a[168:171], v[144:147], v[32:47]
    buffer_load_dwordx4 v229, s[20:23], s53 offen offset:0 lds
    v_cvt_pk_bf16_f32 v162, v164, v165
    v_exp_f32 v167, v167
    v_add_f32 v225, v225, v166
    v_mfma_f32_32x32x16_bf16 v[48:63], a[172:175], v[144:147], v[48:63]
    s_sub_u32 s54, s84, s8
    s_cmp_ge_u32 s42, s41
    s_cselect_b32 s54, s54, 0xf0000000
    v_exp_f32 v168, v168
    v_add_f32 v225, v225, v167
    v_mfma_f32_32x32x16_bf16 v[0:15], a[176:179], v[152:155], v[0:15]
    buffer_load_dwordx4 v229, s[20:23], s53 offen offset:1024 lds
    v_cvt_pk_bf16_f32 v163, v166, v167
    v_exp_f32 v169, v169
    v_add_f32 v225, v225, v168
    v_mfma_f32_32x32x16_bf16 v[16:31], a[180:183], v[152:155], v[16:31]
    s_cmp_lt_u32 s42, 16
    s_cselect_b32 s54, s54, s99
    s_sub_u32 s55, s54, 49152
    v_exp_f32 v170, v170
    v_add_f32 v225, v225, v169
    v_mfma_f32_32x32x16_bf16 v[32:47], a[184:187], v[152:155], v[32:47]
    buffer_load_dwordx4 v229, s[20:23], s53 offen offset:2048 lds
    v_cvt_pk_bf16_f32 v168, v168, v169
    v_exp_f32 v171, v171
    v_add_f32 v225, v225, v170
    v_mfma_f32_32x32x16_bf16 v[48:63], a[188:191], v[152:155], v[48:63]
    buffer_load_dwordx4 v229, s[20:23], s53 offen offset:3072 lds
    v_exp_f32 v172, v172
    s_cmp_lg_u32 s42, s43
    s_cbranch_scc1 K2_TOP
    s_lshl_b32 s52, s47, 19
    s_add_u32 s52, s52, s69
    s_add_u32 s53, s52, 262144
    v_mov_b32 v245, 0
    v_mov_b32 v247, 0
    s_cmp_eq_u32 s42, 17
    s_cbranch_scc1 K2_FINAL
    v_or_b32 v228, 0x10000, v228
    s_add_u32 m0, s67, 65536
    s_nop 0
    buffer_load_dwordx4 v229, s[20:23], s54 offen offset:0 lds
    v_mfma_f32_32x32x16_bf16 v[64:79], a[128:131], v[160:163], v[64:79]
    v_add_f32 v225, v225, v171
    v_cvt_pk_bf16_f32 v169, v170, v171
    v_exp_f32 v173, v173
    v_mov_b32 v244, v224
    buffer_load_dwordx4 v229, s[20:23], s54 offen offset:1024 lds
    s_nop 1
    v_mfma_f32_32x32x16_bf16 v[80:95], a[132:135], v[160:163], v[80:95]
    v_add_f32 v225, v225, v172
    v_exp_f32 v174, v174
    buffer_load_dwordx4 v229, s[20:23], s54 offen offset:2048 lds
    v_add_f32 v225, v225, v173
    v_permlane32_swap_b32 v244, v224
    v_add_f32 v244, v244, v224
    v_mfma_f32_32x32x16_bf16 v[96:111], a[136:139], v[160:163], v[96:111]
    buffer_load_dwordx4 v229, s[20:23], s54 offen offset:3072 lds
    v_cvt_pk_bf16_f32 v170, v172, v173
    v_exp_f32 v175, v175
    v_add_f32 v225, v225, v174
    v_rcp_f32 v244, v244
    s_nop 0
    v_pk_mul_f32 v[0:1], v[0:1], v[244:245] op_sel_hi:[1,0]
    s_add_u32 m0, s67, 81920
    s_nop 0
    buffer_load_dwordx4 v229, s[20:23], s55 offen offset:0 lds
    v_mfma_f32_32x32x16_bf16 v[112:127], a[140:143], v[160:163], v[112:127]
    v_exp_f32 v176, v176
    v_add_f32 v225, v225, v175
    v_cvt_pk_bf16_f32 v171, v174, v175
    buffer_load_dwordx4 v229, s[20:23], s55 offen offset:1024 lds
    v_pk_mul_f32 v[2:3], v[2:3], v[244:245] op_sel_hi:[1,0]
    v_pk_mul_f32 v[4:5], v[4:5], v[244:245] op_sel_hi:[1,0]
    v_mfma_f32_32x32x16_bf16 v[64:79], a[144:147], v[168:171], v[64:79]
    v_exp_f32 v177, v177
    buffer_load_dwordx4 v229, s[20:23], s55 offen offset:2048 lds
    v_add_f32 v225, v225, v176
    v_exp_f32 v178, v178
    v_add_f32 v225, v225, v177
    v_cvt_pk_bf16_f32 v176, v176, v177
    v_mfma_f32_32x32x16_bf16 v[80:95], a[148:151], v[168:171], v[80:95]
    buffer_load_dwordx4 v229, s[20:23], s55 offen offset:3072 lds
    v_exp_f32 v179, v179
    v_add_f32 v225, v225, v178
    v_exp_f32 v180, v180
    v_add_f32 v225, v225, v179
    s_xor_b32 s9, s40, 1
    s_lshl_b32 s9, s9, 14
    s_add_u32 s9, s9, s68
    buffer_load_dwordx4 a[0:3], v229, s[20:23], s9 offen offset:0
    v_cvt_pk_bf16_f32 v177, v178, v179
    v_mfma_f32_32x32x16_bf16 v[96:111], a[152:155], v[168:171], v[96:111]
    v_exp_f32 v181, v181
    v_add_f32 v225, v225, v180
    buffer_load_dwordx4 a[4:7], v229, s[20:23], s9 offen offset:1024
    v_exp_f32 v182, v182
    v_add_f32 v225, v225, v181
    v_cvt_pk_bf16_f32 v178, v180, v181
    v_mfma_f32_32x32x16_bf16 v[112:127], a[156:159], v[168:171], v[112:127]
    v_exp_f32 v183, v183
    buffer_load_dwordx4 a[8:11], v229, s[20:23], s9 offen offset:2048
    v_add_f32 v225, v225, v182
    v_exp_f32 v184, v184
    v_add_f32 v225, v225, v183
    v_cvt_pk_bf16_f32 v179, v182, v183
    buffer_load_dwordx4 a[12:15], v229, s[20:23], s9 offen offset:3072
    s_nop 0
    v_mfma_f32_32x32x16_bf16 v[64:79], a[160:163], v[176:179], v[64:79]
    v_exp_f32 v185, v185
    v_add_f32 v225, v225, v184
    v_exp_f32 v186, v186
    s_add_u32 s9, s9, 4096
    buffer_load_dwordx4 a[16:19], v229, s[20:23], s9 offen offset:0
    v_add_f32 v225, v225, v185
    v_cvt_pk_bf16_f32 v184, v184, v185
    v_mfma_f32_32x32x16_bf16 v[80:95], a[164:167], v[176:179], v[80:95]
    v_exp_f32 v187, v187
    v_add_f32 v225, v225, v186
    buffer_load_dwordx4 a[20:23], v229, s[20:23], s9 offen offset:1024
    v_exp_f32 v188, v188
    v_add_f32 v225, v225, v187
    v_cvt_pk_bf16_f32 v185, v186, v187
    v_mfma_f32_32x32x16_bf16 v[96:111], a[168:171], v[176:179], v[96:111]
    buffer_load_dwordx4 a[24:27], v229, s[20:23], s9 offen offset:2048
    v_exp_f32 v189, v189
    v_add_f32 v225, v225, v188
    v_exp_f32 v190, v190
    v_add_f32 v225, v225, v189
    buffer_load_dwordx4 a[28:31], v229, s[20:23], s9 offen offset:3072
    v_cvt_pk_bf16_f32 v186, v188, v189
    v_mfma_f32_32x32x16_bf16 v[112:127], a[172:175], v[176:179], v[112:127]
    v_exp_f32 v191, v191
    v_add_f32 v225, v225, v190
    v_add_f32 v225, v225, v191
    s_add_u32 s9, s9, 4096
    buffer_load_dwordx4 a[32:35], v229, s[20:23], s9 offen offset:0
    v_cvt_pk_bf16_f32 v187, v190, v191
    v_pk_mul_f32 v[6:7], v[6:7], v[244:245] op_sel_hi:[1,0]
    s_nop 0
    v_mfma_f32_32x32x16_bf16 v[64:79], a[176:179], v[184:187], v[64:79]
    v_pk_mul_f32 v[8:9], v[8:9], v[244:245] op_sel_hi:[1,0]
    buffer_load_dwordx4 a[36:39], v229, s[20:23], s9 offen offset:1024
    v_pk_mul_f32 v[10:11], v[10:11], v[244:245] op_sel_hi:[1,0]
    v_pk_mul_f32 v[12:13], v[12:13], v[244:245] op_sel_hi:[1,0]
    v_pk_mul_f32 v[14:15], v[14:15], v[244:245] op_sel_hi:[1,0]
    v_pk_mul_f32 v[16:17], v[16:17], v[244:245] op_sel_hi:[1,0]
    buffer_load_dwordx4 a[40:43], v229, s[20:23], s9 offen offset:2048
    v_mfma_f32_32x32x16_bf16 v[80:95], a[180:183], v[184:187], v[80:95]
    v_pk_mul_f32 v[18:19], v[18:19], v[244:245] op_sel_hi:[1,0]
    v_pk_mul_f32 v[20:21], v[20:21], v[244:245] op_sel_hi:[1,0]
    v_pk_mul_f32 v[22:23], v[22:23], v[244:245] op_sel_hi:[1,0]
    v_pk_mul_f32 v[24:25], v[24:25], v[244:245] op_sel_hi:[1,0]
    buffer_load_dwordx4 a[44:47], v229, s[20:23], s9 offen offset:3072
    v_pk_mul_f32 v[26:27], v[26:27], v[244:245] op_sel_hi:[1,0]
    v_mfma_f32_32x32x16_bf16 v[96:111], a[184:187], v[184:187], v[96:111]
    v_pk_mul_f32 v[28:29], v[28:29], v[244:245] op_sel_hi:[1,0]
    v_pk_mul_f32 v[30:31], v[30:31], v[244:245] op_sel_hi:[1,0]
    s_add_u32 s9, s9, 4096
    buffer_load_dwordx4 a[48:51], v229, s[20:23], s9 offen offset:0
    v_pk_mul_f32 v[32:33], v[32:33], v[244:245] op_sel_hi:[1,0]
    v_pk_mul_f32 v[34:35], v[34:35], v[244:245] op_sel_hi:[1,0]
    v_pk_mul_f32 v[36:37], v[36:37], v[244:245] op_sel_hi:[1,0]
    v_mfma_f32_32x32x16_bf16 v[112:127], a[188:191], v[184:187], v[112:127]
    buffer_load_dwordx4 a[52:55], v229, s[20:23], s9 offen offset:1024
    v_pk_mul_f32 v[38:39], v[38:39], v[244:245] op_sel_hi:[1,0]
    v_pk_mul_f32 v[40:41], v[40:41], v[244:245] op_sel_hi:[1,0]
    v_pk_mul_f32 v[42:43], v[42:43], v[244:245] op_sel_hi:[1,0]
    v_pk_mul_f32 v[44:45], v[44:45], v[244:245] op_sel_hi:[1,0]
    v_pk_mul_f32 v[46:47], v[46:47], v[244:245] op_sel_hi:[1,0]
    buffer_load_dwordx4 a[56:59], v229, s[20:23], s9 offen offset:2048
    v_pk_mul_f32 v[48:49], v[48:49], v[244:245] op_sel_hi:[1,0]
    v_pk_mul_f32 v[50:51], v[50:51], v[244:245] op_sel_hi:[1,0]
    v_pk_mul_f32 v[52:53], v[52:53], v[244:245] op_sel_hi:[1,0]
    v_pk_mul_f32 v[54:55], v[54:55], v[244:245] op_sel_hi:[1,0]
    buffer_load_dwordx4 a[60:63], v229, s[20:23], s9 offen offset:3072
    v_pk_mul_f32 v[56:57], v[56:57], v[244:245] op_sel_hi:[1,0]
    v_pk_mul_f32 v[58:59], v[58:59], v[244:245] op_sel_hi:[1,0]
    v_pk_mul_f32 v[60:61], v[60:61], v[244:245] op_sel_hi:[1,0]
    v_pk_mul_f32 v[62:63], v[62:63], v[244:245] op_sel_hi:[1,0]
    s_add_u32 s9, s9, 4096
    ds_read_b128 a[64:67], v228 offset:16384
    v_cvt_pk_bf16_f32 v0, v0, v1
    v_cvt_pk_bf16_f32 v1, v2, v3
    v_cvt_pk_bf16_f32 v2, v4, v5
    v_cvt_pk_bf16_f32 v3, v6, v7
    buffer_store_dwordx4 v[0:3], v230, s[20:23], s52 offen offset:0 sc1
    v_cvt_pk_bf16_f32 v8, v8, v9
    v_cvt_pk_bf16_f32 v9, v10, v11
    v_cvt_pk_bf16_f32 v10, v12, v13
    ds_read_b128 a[68:71], v228 offset:17408
    v_cvt_pk_bf16_f32 v11, v14, v15
    buffer_store_dwordx4 v[8:11], v230, s[20:23], s52 offen offset:512 sc1
    v_cvt_pk_bf16_f32 v16, v16, v17
    v_cvt_pk_bf16_f32 v17, v18, v19
    v_cvt_pk_bf16_f32 v18, v20, v21
    v_cvt_pk_bf16_f32 v19, v22, v23
    buffer_store_dwordx4 v[16:19], v230, s[20:23], s52 offen offset:1024 sc1
    ds_read_b128 a[72:75], v228 offset:18432
    v_cvt_pk_bf16_f32 v24, v24, v25
    v_cvt_pk_bf16_f32 v25, v26, v27
    v_cvt_pk_bf16_f32 v26, v28, v29
    v_cvt_pk_bf16_f32 v27, v30, v31
    buffer_store_dwordx4 v[24:27], v230, s[20:23], s52 offen offset:1536 sc1
    v_cvt_pk_bf16_f32 v32, v32, v33
    v_cvt_pk_bf16_f32 v33, v34, v35
    ds_read_b128 a[76:79], v228 offset:19456
    v_cvt_pk_bf16_f32 v34, v36, v37
    v_cvt_pk_bf16_f32 v35, v38, v39
    buffer_store_dwordx4 v[32:35], v230, s[20:23], s52 offen offset:2048 sc1
    v_cvt_pk_bf16_f32 v40, v40, v41
    v_cvt_pk_bf16_f32 v41, v42, v43
    v_cvt_pk_bf16_f32 v42, v44, v45
    v_cvt_pk_bf16_f32 v43, v46, v47
    buffer_store_dwordx4 v[40:43], v230, s[20:23], s52 offen offset:2560 sc1
    ds_read_b128 a[80:83], v228 offset:20480
    v_cvt_pk_bf16_f32 v48, v48, v49
    v_cvt_pk_bf16_f32 v49, v50, v51
    v_cvt_pk_bf16_f32 v50, v52, v53
    v_cvt_pk_bf16_f32 v51, v54, v55
    buffer_store_dwordx4 v[48:51], v230, s[20:23], s52 offen offset:3072 sc1
    v_cvt_pk_bf16_f32 v56, v56, v57
    v_cvt_pk_bf16_f32 v57, v58, v59
    ds_read_b128 a[84:87], v228 offset:21504
    v_cvt_pk_bf16_f32 v58, v60, v61
    v_cvt_pk_bf16_f32 v59, v62, v63
    buffer_store_dwordx4 v[56:59], v230, s[20:23], s52 offen offset:3584 sc1
    v_mov_b32 v246, v225
    s_nop 1
    v_permlane32_swap_b32 v246, v225
    v_add_f32 v246, v246, v225
    ds_read_b128 a[88:91], v228 offset:22528
    v_rcp_f32 v246, v246
    s_nop 0
    v_pk_mul_f32 v[64:65], v[64:65], v[246:247] op_sel_hi:[1,0]
    v_pk_mul_f32 v[66:67], v[66:67], v[246:247] op_sel_hi:[1,0]
    v_pk_mul_f32 v[68:69], v[68:69], v[246:247] op_sel_hi:[1,0]
    v_pk_mul_f32 v[70:71], v[70:71], v[246:247] op_sel_hi:[1,0]
    v_cvt_pk_bf16_f32 v64, v64, v65
    v_cvt_pk_bf16_f32 v65, v66, v67
    v_cvt_pk_bf16_f32 v66, v68, v69
    ds_read_b128 a[92:95], v228 offset:23552
    v_cvt_pk_bf16_f32 v67, v70, v71
    buffer_store_dwordx4 v[64:67], v230, s[20:23], s53 offen offset:0 sc1
    v_pk_mul_f32 v[72:73], v[72:73], v[246:247] op_sel_hi:[1,0]
    v_pk_mul_f32 v[74:75], v[74:75], v[246:247] op_sel_hi:[1,0]
    v_pk_mul_f32 v[76:77], v[76:77], v[246:247] op_sel_hi:[1,0]
    v_pk_mul_f32 v[78:79], v[78:79], v[246:247] op_sel_hi:[1,0]
    v_cvt_pk_bf16_f32 v72, v72, v73
    ds_read_b128 a[96:99], v228 offset:24576
    v_cvt_pk_bf16_f32 v73, v74, v75
    v_cvt_pk_bf16_f32 v74, v76, v77
    v_cvt_pk_bf16_f32 v75, v78, v79
    buffer_store_dwordx4 v[72:75], v230, s[20:23], s53 offen offset:512 sc1
    v_pk_mul_f32 v[80:81], v[80:81], v[246:247] op_sel_hi:[1,0]
    v_pk_mul_f32 v[82:83], v[82:83], v[246:247] op_sel_hi:[1,0]
    v_pk_mul_f32 v[84:85], v[84:85], v[246:247] op_sel_hi:[1,0]
    ds_read_b128 a[100:103], v228 offset:25600
    v_pk_mul_f32 v[86:87], v[86:87], v[246:247] op_sel_hi:[1,0]
    v_cvt_pk_bf16_f32 v80, v80, v81
    v_cvt_pk_bf16_f32 v81, v82, v83
    v_cvt_pk_bf16_f32 v82, v84, v85
    v_cvt_pk_bf16_f32 v83, v86, v87
    buffer_store_dwordx4 v[80:83], v230, s[20:23], s53 offen offset:1024 sc1
    v_pk_mul_f32 v[88:89], v[88:89], v[246:247] op_sel_hi:[1,0]
    v_pk_mul_f32 v[90:91], v[90:91], v[246:247] op_sel_hi:[1,0]
    ds_read_b128 a[104:107], v228 offset:26624
    v_pk_mul_f32 v[92:93], v[92:93], v[246:247] op_sel_hi:[1,0]
    v_pk_mul_f32 v[94:95], v[94:95], v[246:247] op_sel_hi:[1,0]
    v_cvt_pk_bf16_f32 v88, v88, v89
    v_cvt_pk_bf16_f32 v89, v90, v91
    v_cvt_pk_bf16_f32 v90, v92, v93
    v_cvt_pk_bf16_f32 v91, v94, v95
    buffer_store_dwordx4 v[88:91], v230, s[20:23], s53 offen offset:1536 sc1
    ds_read_b128 a[108:111], v228 offset:27648
    v_pk_mul_f32 v[96:97], v[96:97], v[246:247] op_sel_hi:[1,0]
    v_pk_mul_f32 v[98:99], v[98:99], v[246:247] op_sel_hi:[1,0]
    v_pk_mul_f32 v[100:101], v[100:101], v[246:247] op_sel_hi:[1,0]
    v_pk_mul_f32 v[102:103], v[102:103], v[246:247] op_sel_hi:[1,0]
    v_cvt_pk_bf16_f32 v96, v96, v97
    v_cvt_pk_bf16_f32 v97, v98, v99
    v_cvt_pk_bf16_f32 v98, v100, v101
    ds_read_b128 a[112:115], v228 offset:28672
    v_cvt_pk_bf16_f32 v99, v102, v103
    buffer_store_dwordx4 v[96:99], v230, s[20:23], s53 offen offset:2048 sc1
    v_pk_mul_f32 v[104:105], v[104:105], v[246:247] op_sel_hi:[1,0]
    v_pk_mul_f32 v[106:107], v[106:107], v[246:247] op_sel_hi:[1,0]
    v_pk_mul_f32 v[108:109], v[108:109], v[246:247] op_sel_hi:[1,0]
    v_pk_mul_f32 v[110:111], v[110:111], v[246:247] op_sel_hi:[1,0]
    v_cvt_pk_bf16_f32 v104, v104, v105
    v_cvt_pk_bf16_f32 v105, v106, v107
    ds_read_b128 a[116:119], v228 offset:29696
    v_cvt_pk_bf16_f32 v106, v108, v109
    v_cvt_pk_bf16_f32 v107, v110, v111
    buffer_store_dwordx4 v[104:107], v230, s[20:23], s53 offen offset:2560 sc1
    v_pk_mul_f32 v[112:113], v[112:113], v[246:247] op_sel_hi:[1,0]
    v_pk_mul_f32 v[114:115], v[114:115], v[246:247] op_sel_hi:[1,0]
    v_pk_mul_f32 v[116:117], v[116:117], v[246:247] op_sel_hi:[1,0]
    v_pk_mul_f32 v[118:119], v[118:119], v[246:247] op_sel_hi:[1,0]
    ds_read_b128 a[120:123], v228 offset:30720
    v_cvt_pk_bf16_f32 v112, v112, v113
    v_cvt_pk_bf16_f32 v113, v114, v115
    v_cvt_pk_bf16_f32 v114, v116, v117
    v_cvt_pk_bf16_f32 v115, v118, v119
    buffer_store_dwordx4 v[112:115], v230, s[20:23], s53 offen offset:3072 sc1
    v_pk_mul_f32 v[120:121], v[120:121], v[246:247] op_sel_hi:[1,0]
    v_pk_mul_f32 v[122:123], v[122:123], v[246:247] op_sel_hi:[1,0]
    ds_read_b128 a[124:127], v228 offset:31744
    v_pk_mul_f32 v[124:125], v[124:125], v[246:247] op_sel_hi:[1,0]
    v_pk_mul_f32 v[126:127], v[126:127], v[246:247] op_sel_hi:[1,0]
    v_cvt_pk_bf16_f32 v120, v120, v121
    v_cvt_pk_bf16_f32 v121, v122, v123
    v_cvt_pk_bf16_f32 v122, v124, v125
    v_cvt_pk_bf16_f32 v123, v126, v127
    buffer_store_dwordx4 v[120:123], v230, s[20:23], s53 offen offset:3584 sc1
    s_lshl_b32 s8, s42, 15
    s_cmp_lt_u32 s42, 15
    s_cselect_b32 s52, s45, s98
    s_add_u32 s52, s52, s8
    s_add_u32 s53, s52, 16384
    s_xor_b32 s8, s40, 3
    s_lshl_b32 s8, s8, 9
    s_add_u32 s8, s8, 147456
    v_lshrrev_b32 v226, 1, v229
    v_add_u32 v226, s8, v226
    v_mfma_f32_32x32x16_bf16 v[0:15], a[192:195], a[192:195], 0
    v_mfma_f32_32x32x16_bf16 v[16:31], a[192:195], a[192:195], 0
    v_mfma_f32_32x32x16_bf16 v[32:47], a[192:195], a[192:195], 0
    v_mfma_f32_32x32x16_bf16 v[48:63], a[192:195], a[192:195], 0
    v_mfma_f32_32x32x16_bf16 v[64:79], a[192:195], a[192:195], 0
    v_mfma_f32_32x32x16_bf16 v[80:95], a[192:195], a[192:195], 0
    v_mfma_f32_32x32x16_bf16 v[96:111], a[192:195], a[192:195], 0
    v_mfma_f32_32x32x16_bf16 v[112:127], a[192:195], a[192:195], 0
    s_waitcnt vmcnt(16)
    s_waitcnt lgkmcnt(0)
    s_barrier
    ds_read2_b32 v[192:193], v226 offset0:0 offset1:0
    ds_read2_b32 v[208:209], v226 offset0:1 offset1:1
    s_xor_b32 m0, s67, 0x8000
    s_nop 0
    buffer_load_dwordx4 v229, s[20:23], s52 offen offset:0 lds
    v_mov_b64 v[160:161], 0
    v_mov_b64 v[162:163], 0
    v_mov_b64 v[164:165], 0
    v_mov_b64 v[166:167], 0
    v_mov_b64 v[168:169], 0
    buffer_load_dwordx4 v229, s[20:23], s52 offen offset:1024 lds
    v_mov_b64 v[170:171], 0
    v_mov_b32 v172, 0
    v_mov_b32 v173, 0xff800000
    v_mov_b64 v[174:175], s[100:101]
    buffer_load_dwordx4 v229, s[20:23], s52 offen offset:2048 lds
    v_mov_b64 v[176:177], s[100:101]
    v_mov_b64 v[178:179], s[100:101]
    v_mov_b64 v[180:181], s[100:101]
    v_mov_b64 v[182:183], s[100:101]
    buffer_load_dwordx4 v229, s[20:23], s52 offen offset:3072 lds
    v_mov_b64 v[184:185], s[100:101]
    v_mov_b64 v[186:187], s[100:101]
    v_mov_b64 v[188:189], s[100:101]
    v_mov_b64 v[190:191], s[100:101]
    s_add_u32 m0, m0, 16384
    s_nop 0
    buffer_load_dwordx4 v229, s[20:23], s53 offen offset:0 lds
    v_mov_b64 v[224:225], 0
    v_xor_b32 v228, 0x8000, v228
    s_waitcnt lgkmcnt(1)
    v_mov_b64 v[194:195], v[192:193]
    v_mov_b64 v[196:197], v[192:193]
    buffer_load_dwordx4 v229, s[20:23], s53 offen offset:1024 lds
    v_mov_b64 v[198:199], v[192:193]
    v_mov_b64 v[200:201], v[192:193]
    v_mov_b64 v[202:203], v[192:193]
    v_mov_b64 v[204:205], v[192:193]
    buffer_load_dwordx4 v229, s[20:23], s53 offen offset:2048 lds
    v_mov_b64 v[206:207], v[192:193]
    s_waitcnt lgkmcnt(0)
    v_mov_b64 v[210:211], v[208:209]
    v_mov_b64 v[212:213], v[208:209]
    v_mov_b64 v[214:215], v[208:209]
    buffer_load_dwordx4 v229, s[20:23], s53 offen offset:3072 lds
    v_mov_b64 v[216:217], v[208:209]
    v_mov_b64 v[218:219], v[208:209]
    v_mov_b64 v[220:221], v[208:209]
    v_mov_b64 v[222:223], v[208:209]
    s_add_u32 s42, s42, 1
    s_xor_b32 s67, s67, 0x8000
    s_lshl_b32 s8, s42, 15
    s_sub_u32 s54, s84, s8
    s_cmp_ge_u32 s42, s41
    s_cselect_b32 s54, s54, 0xf0000000
    s_cmp_lt_u32 s42, 16
    s_cselect_b32 s54, s54, s99
    s_sub_u32 s55, s54, 49152
    s_sub_u32 s47, 31, s47
    s_mov_b32 s65, s42
    s_mov_b32 s64, 0xff800000
    s_mov_b32 s43, 17
    s_cmp_lg_u32 s42, 17
    s_cbranch_scc1 K2_TOP
    s_lshl_b32 s52, s47, 19
    s_add_u32 s52, s52, s69
    s_add_u32 s53, s52, 262144
K2_FINAL:
    v_add_u32 v198, s46, v229
    ds_read_b128 a[16:19], v198 offset:32768
    ds_read_b128 a[20:23], v198 offset:33792
    ds_read_b128 a[24:27], v198 offset:34816
    ds_read_b128 a[28:31], v198 offset:35840
    ds_read_b128 a[48:51], v198 offset:49152
    ds_read_b128 a[52:55], v198 offset:50176
    ds_read_b128 a[56:59], v198 offset:51200
    ds_read_b128 a[60:63], v198 offset:52224
    v_add_u32 v199, 0x10000, v198
    v_add_u32 v228, 0x8000, v198
    v_xor_b32 v196, 0x3000, v228
    s_add_u32 s8, s46, 149504
    v_add_u32 v226, s8, v229
    v_xor_b32 v227, 0x3000, v226
    s_bfe_u32 s13, s2, 0x20001
    s_and_b32 s16, s2, 1
    s_add_u32 s10, s41, s16
    s_lshl_b32 s29, s10, 7
    s_add_u32 s29, s29, s97
    s_bfe_u32 s11, s2, 0x20003
    s_lshl_b32 s11, s11, 1
    s_lshr_b32 s16, s40, 1
    s_add_u32 s11, s11, s16
    s_lshl_b32 s12, s11, 19
    s_lshl_b32 s16, s13, 17
    s_add_u32 s12, s12, s16
    s_and_b32 s16, s40, 1
    s_lshl_b32 s16, s16, 12
    s_add_u32 s12, s12, s16
    s_add_u32 s12, s12, 79691776
    s_cmp_eq_u32 s40, 1
    s_mov_b32 s18, 524288
    s_cselect_b32 s18, s18, 0xf0000000
    s_cselect_b32 s19, 32, 0
    s_cmp_eq_u32 s40, 3
    s_cselect_b32 s31, 32, 0
    v_and_b32 v250, 7, v253
    v_add_u32 v250, 104, v250
    v_lshlrev_b32 v250, 7, v250
    s_getpc_b64 s[98:99]
K2_PC:
    s_add_u32 s98, s98, K2_DONE-K2_PC
    s_addc_u32 s99, s99, 0
    s_lshl_b32 s16, s40, 13
    v_lshl_add_u32 v252, v229, 3, s16
    v_min_u32 v252, K5_END-K2_DONE, v252
    global_load_dword v252, v252, s[98:99]
    s_add_u32 s17, s97, 1920
    s_cmp_eq_u32 s96, 17
    s_cselect_b32 s17, s17, 0x70000000
    s_lshl_b32 s16, s10, 20
    s_sub_u32 s39, 16252928, s16
    s_lshr_b32 s16, s16, 1
    s_lshl_b32 s38, s13, 15
    s_add_u32 s16, s16, s38
    s_add_u32 s16, s16, s46
    s_add_u32 s16, s16, 37748736
    s_add_u32 s8, s13, 0
    s_and_b32 s8, s8, 3
    s_lshl_b32 s8, s8, 17
    s_add_u32 s8, s8, s16
    s_add_u32 s9, s13, 1
    s_and_b32 s9, s9, 3
    s_lshl_b32 s9, s9, 17
    s_add_u32 s9, s9, s16
    s_add_u32 s14, s13, 2
    s_and_b32 s14, s14, 3
    s_lshl_b32 s14, s14, 17
    s_add_u32 s14, s14, s16
    s_add_u32 s15, s13, 3
    s_and_b32 s15, s15, 3
    s_lshl_b32 s15, s15, 17
    s_add_u32 s15, s15, s16
    s_cmp_ge_u32 s40, 2
    s_cbranch_scc1 K2_M23
    ds_read_b128 a[0:3], v199 offset:49152
    v_mfma_f32_32x32x16_bf16 v[64:79], a[128:131], v[160:163], v[64:79]
    v_add_f32 v225, v225, v171
    v_cvt_pk_bf16_f32 v169, v170, v171
    v_exp_f32 v173, v173
    v_mfma_f32_32x32x16_bf16 v[80:95], a[132:135], v[160:163], v[80:95]
    s_add_u32 s16, s12, 16384
    buffer_load_dwordx4 a[32:35], v229, s[20:23], s16 offen offset:0
    ds_write_b128 v228, v[0:3] offset:0
    v_add_f32 v225, v225, v172
    v_exp_f32 v174, v174
    v_add_f32 v225, v225, v173
    v_mfma_f32_32x32x16_bf16 v[96:111], a[136:139], v[160:163], v[96:111]
    ds_read_b128 a[4:7], v199 offset:50176
    ds_write_b128 v228, v[4:7] offset:1024
    v_cvt_pk_bf16_f32 v170, v172, v173
    v_exp_f32 v175, v175
    v_add_f32 v225, v225, v174
    v_mfma_f32_32x32x16_bf16 v[112:127], a[140:143], v[160:163], v[112:127]
    buffer_load_dwordx4 a[36:39], v229, s[20:23], s16 offen offset:1024
    ds_write_b128 v228, v[8:11] offset:2048
    v_exp_f32 v176, v176
    v_add_f32 v225, v225, v175
    v_cvt_pk_bf16_f32 v171, v174, v175
    s_nop 1
    v_mfma_f32_32x32x16_bf16 v[64:79], a[144:147], v[168:171], v[64:79]
    ds_read_b128 a[8:11], v199 offset:51200
    ds_write_b128 v228, v[12:15] offset:3072
    v_exp_f32 v177, v177
    v_add_f32 v225, v225, v176
    v_exp_f32 v178, v178
    v_add_f32 v225, v225, v177
    s_add_u32 s16, s12, 18432
    ds_write_b128 v228, v[16:19] offset:16384
    buffer_load_dwordx4 a[40:43], v229, s[20:23], s16 offen offset:0
    v_cvt_pk_bf16_f32 v176, v176, v177
    v_mfma_f32_32x32x16_bf16 v[80:95], a[148:151], v[168:171], v[80:95]
    v_exp_f32 v179, v179
    v_add_f32 v225, v225, v178
    ds_write_b128 v228, v[20:23] offset:17408
    v_exp_f32 v180, v180
    ds_read_b128 a[12:15], v199 offset:52224
    v_add_f32 v225, v225, v179
    v_cvt_pk_bf16_f32 v177, v178, v179
    v_mfma_f32_32x32x16_bf16 v[96:111], a[152:155], v[168:171], v[96:111]
    ds_write_b128 v228, v[24:27] offset:18432
    v_exp_f32 v181, v181
    buffer_load_dwordx4 a[44:47], v229, s[20:23], s16 offen offset:1024
    v_add_f32 v225, v225, v180
    v_exp_f32 v182, v182
    v_add_f32 v225, v225, v181
    ds_write_b128 v228, v[28:31] offset:19456
    v_cvt_pk_bf16_f32 v178, v180, v181
    ds_read_b128 a[96:99], v199 offset:32768
    v_mfma_f32_32x32x16_bf16 v[112:127], a[156:159], v[168:171], v[112:127]
    v_exp_f32 v183, v183
    v_add_f32 v225, v225, v182
    ds_write_b128 v228, v[32:35] offset:32768
    v_exp_f32 v184, v184
    s_add_u32 s16, s12, 32768
    buffer_load_dwordx4 a[64:67], v229, s[20:23], s16 offen offset:0
    v_add_f32 v225, v225, v183
    v_cvt_pk_bf16_f32 v179, v182, v183
    ds_write_b128 v228, v[36:39] offset:33792
    s_nop 0
    v_mfma_f32_32x32x16_bf16 v[64:79], a[160:163], v[176:179], v[64:79]
    v_exp_f32 v185, v185
    ds_read_b128 a[100:103], v199 offset:33792
    v_add_f32 v225, v225, v184
    v_exp_f32 v186, v186
    ds_write_b128 v228, v[40:43] offset:34816
    v_add_f32 v225, v225, v185
    v_cvt_pk_bf16_f32 v184, v184, v185
    v_mfma_f32_32x32x16_bf16 v[80:95], a[164:167], v[176:179], v[80:95]
    buffer_load_dwordx4 a[68:71], v229, s[20:23], s16 offen offset:1024
    v_exp_f32 v187, v187
    ds_write_b128 v228, v[44:47] offset:35840
    v_add_f32 v225, v225, v186
    v_exp_f32 v188, v188
    v_add_f32 v225, v225, v187
    ds_read_b128 a[104:107], v199 offset:34816
    v_cvt_pk_bf16_f32 v185, v186, v187
    ds_write_b128 v228, v[48:51] offset:49152
    v_mfma_f32_32x32x16_bf16 v[96:111], a[168:171], v[176:179], v[96:111]
    v_exp_f32 v189, v189
    v_add_f32 v225, v225, v188
    s_add_u32 s16, s12, 34816
    buffer_load_dwordx4 a[72:75], v229, s[20:23], s16 offen offset:0
    ds_write_b128 v228, v[52:55] offset:50176
    v_exp_f32 v190, v190
    v_add_f32 v225, v225, v189
    v_cvt_pk_bf16_f32 v186, v188, v189
    v_mfma_f32_32x32x16_bf16 v[112:127], a[172:175], v[176:179], v[112:127]
    ds_read_b128 a[108:111], v199 offset:35840
    ds_write_b128 v228, v[56:59] offset:51200
    v_exp_f32 v191, v191
    v_add_f32 v225, v225, v190
    v_add_f32 v225, v225, v191
    v_cvt_pk_bf16_f32 v187, v190, v191
    buffer_load_dwordx4 a[76:79], v229, s[20:23], s16 offen offset:1024
    ds_write_b128 v228, v[60:63] offset:52224
    v_mfma_f32_32x32x16_bf16 v[64:79], a[176:179], v[184:187], v[64:79]
    v_mfma_f32_32x32x16_bf16 v[80:95], a[180:183], v[184:187], v[80:95]
    v_mfma_f32_32x32x16_bf16 v[96:111], a[184:187], v[184:187], v[96:111]
    v_mfma_f32_32x32x16_bf16 v[112:127], a[188:191], v[184:187], v[112:127]
    v_mov_b32 v193, v224
    ds_write_b64 v226, v[192:193]
    s_waitcnt vmcnt(17)
    buffer_atomic_add v249, v248, s[20:23], s17 offen sc1
    s_waitcnt lgkmcnt(0)
    s_barrier
    ds_read_b64 v[232:233], v227
    ds_read_b128 v[0:3], v196 offset:0
    ds_read_b128 v[4:7], v196 offset:1024
    ds_read_b128 v[8:11], v196 offset:2048
    ds_read_b128 v[12:15], v196 offset:3072
    ds_read_b128 v[16:19], v196 offset:16384
    ds_read_b128 v[20:23], v196 offset:17408
    ds_read_b128 v[24:27], v196 offset:18432
    ds_read_b128 v[28:31], v196 offset:19456
    ds_read_b128 v[32:35], v196 offset:32768
    ds_read_b128 v[36:39], v196 offset:33792
    ds_read_b128 v[40:43], v196 offset:34816
    ds_read_b128 v[44:47], v196 offset:35840
    ds_read_b128 v[48:51], v196 offset:49152
    ds_read_b128 v[52:55], v196 offset:50176
    ds_read_b128 v[56:59], v196 offset:51200
    ds_read_b128 v[60:63], v196 offset:52224
    s_waitcnt lgkmcnt(15)
    v_min_f32 v234, v208, v232
    v_sub_f32 v244, v234, v208
    v_sub_f32 v246, v234, v232
    v_exp_f32 v244, v244
    v_exp_f32 v246, v246
    v_mul_f32 v225, v225, v244
    v_fmac_f32 v225, v233, v246
    v_mov_b32 v236, v225
    s_nop 1
    v_permlane32_swap_b32 v236, v225
    v_add_f32 v236, v236, v225
    v_rcp_f32 v236, v236
    s_nop 0
    v_mul_f32 v244, v244, v236
    v_mul_f32 v246, v246, v236
    v_pk_mul_f32 v[64:65], v[64:65], v[244:245] op_sel_hi:[1,0]
    s_nop 0
    v_pk_fma_f32 v[64:65], v[0:1], v[246:247], v[64:65] op_sel_hi:[1,0,1]
    v_pk_mul_f32 v[66:67], v[66:67], v[244:245] op_sel_hi:[1,0]
    s_nop 0
    v_pk_fma_f32 v[66:67], v[2:3], v[246:247], v[66:67] op_sel_hi:[1,0,1]
    v_pk_mul_f32 v[68:69], v[68:69], v[244:245] op_sel_hi:[1,0]
    s_waitcnt lgkmcnt(14)
    v_pk_fma_f32 v[68:69], v[4:5], v[246:247], v[68:69] op_sel_hi:[1,0,1]
    v_pk_mul_f32 v[70:71], v[70:71], v[244:245] op_sel_hi:[1,0]
    s_nop 0
    v_pk_fma_f32 v[70:71], v[6:7], v[246:247], v[70:71] op_sel_hi:[1,0,1]
    v_cvt_pk_bf16_f32 v64, v64, v65
    v_cvt_pk_bf16_f32 v65, v66, v67
    buffer_load_dword v197, off, s[20:23], s29 sc1
    v_cvt_pk_bf16_f32 v66, v68, v69
    v_cvt_pk_bf16_f32 v67, v70, v71
    buffer_store_dwordx4 v[64:67], v230, s[20:23], s53 offen offset:0 sc1
    v_pk_mul_f32 v[72:73], v[72:73], v[244:245] op_sel_hi:[1,0]
    s_waitcnt lgkmcnt(13)
    v_pk_fma_f32 v[72:73], v[8:9], v[246:247], v[72:73] op_sel_hi:[1,0,1]
    v_pk_mul_f32 v[74:75], v[74:75], v[244:245] op_sel_hi:[1,0]
    s_nop 0
    v_pk_fma_f32 v[74:75], v[10:11], v[246:247], v[74:75] op_sel_hi:[1,0,1]
    v_pk_mul_f32 v[76:77], v[76:77], v[244:245] op_sel_hi:[1,0]
    s_waitcnt lgkmcnt(12)
    v_pk_fma_f32 v[76:77], v[12:13], v[246:247], v[76:77] op_sel_hi:[1,0,1]
    v_pk_mul_f32 v[78:79], v[78:79], v[244:245] op_sel_hi:[1,0]
    s_nop 0
    v_pk_fma_f32 v[78:79], v[14:15], v[246:247], v[78:79] op_sel_hi:[1,0,1]
    v_cvt_pk_bf16_f32 v72, v72, v73
    v_cvt_pk_bf16_f32 v73, v74, v75
    v_cvt_pk_bf16_f32 v74, v76, v77
    v_cvt_pk_bf16_f32 v75, v78, v79
    buffer_store_dwordx4 v[72:75], v230, s[20:23], s53 offen offset:512 sc1
    v_pk_mul_f32 v[80:81], v[80:81], v[244:245] op_sel_hi:[1,0]
    s_waitcnt lgkmcnt(11)
    v_pk_fma_f32 v[80:81], v[16:17], v[246:247], v[80:81] op_sel_hi:[1,0,1]
    v_pk_mul_f32 v[82:83], v[82:83], v[244:245] op_sel_hi:[1,0]
    s_nop 0
    v_pk_fma_f32 v[82:83], v[18:19], v[246:247], v[82:83] op_sel_hi:[1,0,1]
    v_pk_mul_f32 v[84:85], v[84:85], v[244:245] op_sel_hi:[1,0]
    s_waitcnt lgkmcnt(10)
    v_pk_fma_f32 v[84:85], v[20:21], v[246:247], v[84:85] op_sel_hi:[1,0,1]
    v_pk_mul_f32 v[86:87], v[86:87], v[244:245] op_sel_hi:[1,0]
    s_nop 0
    v_pk_fma_f32 v[86:87], v[22:23], v[246:247], v[86:87] op_sel_hi:[1,0,1]
    v_cvt_pk_bf16_f32 v80, v80, v81
    v_cvt_pk_bf16_f32 v81, v82, v83
    v_cvt_pk_bf16_f32 v82, v84, v85
    v_cvt_pk_bf16_f32 v83, v86, v87
    buffer_store_dwordx4 v[80:83], v230, s[20:23], s53 offen offset:1024 sc1
    v_pk_mul_f32 v[88:89], v[88:89], v[244:245] op_sel_hi:[1,0]
    s_waitcnt lgkmcnt(9)
    v_pk_fma_f32 v[88:89], v[24:25], v[246:247], v[88:89] op_sel_hi:[1,0,1]
    v_pk_mul_f32 v[90:91], v[90:91], v[244:245] op_sel_hi:[1,0]
    s_nop 0
    v_pk_fma_f32 v[90:91], v[26:27], v[246:247], v[90:91] op_sel_hi:[1,0,1]
    v_pk_mul_f32 v[92:93], v[92:93], v[244:245] op_sel_hi:[1,0]
    s_waitcnt lgkmcnt(8)
    v_pk_fma_f32 v[92:93], v[28:29], v[246:247], v[92:93] op_sel_hi:[1,0,1]
    v_pk_mul_f32 v[94:95], v[94:95], v[244:245] op_sel_hi:[1,0]
    s_nop 0
    v_pk_fma_f32 v[94:95], v[30:31], v[246:247], v[94:95] op_sel_hi:[1,0,1]
    v_cvt_pk_bf16_f32 v88, v88, v89
    v_cvt_pk_bf16_f32 v89, v90, v91
    v_cvt_pk_bf16_f32 v90, v92, v93
    v_cvt_pk_bf16_f32 v91, v94, v95
    buffer_store_dwordx4 v[88:91], v230, s[20:23], s53 offen offset:1536 sc1
    v_pk_mul_f32 v[96:97], v[96:97], v[244:245] op_sel_hi:[1,0]
    s_waitcnt lgkmcnt(7)
    v_pk_fma_f32 v[96:97], v[32:33], v[246:247], v[96:97] op_sel_hi:[1,0,1]
    v_pk_mul_f32 v[98:99], v[98:99], v[244:245] op_sel_hi:[1,0]
    s_nop 0
    v_pk_fma_f32 v[98:99], v[34:35], v[246:247], v[98:99] op_sel_hi:[1,0,1]
    v_pk_mul_f32 v[100:101], v[100:101], v[244:245] op_sel_hi:[1,0]
    s_waitcnt lgkmcnt(6)
    v_pk_fma_f32 v[100:101], v[36:37], v[246:247], v[100:101] op_sel_hi:[1,0,1]
    v_pk_mul_f32 v[102:103], v[102:103], v[244:245] op_sel_hi:[1,0]
    s_nop 0
    v_pk_fma_f32 v[102:103], v[38:39], v[246:247], v[102:103] op_sel_hi:[1,0,1]
    v_cvt_pk_bf16_f32 v96, v96, v97
    v_cvt_pk_bf16_f32 v97, v98, v99
    v_cvt_pk_bf16_f32 v98, v100, v101
    v_cvt_pk_bf16_f32 v99, v102, v103
    buffer_store_dwordx4 v[96:99], v230, s[20:23], s53 offen offset:2048 sc1
    v_pk_mul_f32 v[104:105], v[104:105], v[244:245] op_sel_hi:[1,0]
    s_waitcnt lgkmcnt(5)
    v_pk_fma_f32 v[104:105], v[40:41], v[246:247], v[104:105] op_sel_hi:[1,0,1]
    v_pk_mul_f32 v[106:107], v[106:107], v[244:245] op_sel_hi:[1,0]
    s_nop 0
    v_pk_fma_f32 v[106:107], v[42:43], v[246:247], v[106:107] op_sel_hi:[1,0,1]
    v_pk_mul_f32 v[108:109], v[108:109], v[244:245] op_sel_hi:[1,0]
    s_waitcnt lgkmcnt(4)
    v_pk_fma_f32 v[108:109], v[44:45], v[246:247], v[108:109] op_sel_hi:[1,0,1]
    v_pk_mul_f32 v[110:111], v[110:111], v[244:245] op_sel_hi:[1,0]
    s_nop 0
    v_pk_fma_f32 v[110:111], v[46:47], v[246:247], v[110:111] op_sel_hi:[1,0,1]
    v_cvt_pk_bf16_f32 v104, v104, v105
    v_cvt_pk_bf16_f32 v105, v106, v107
    v_cvt_pk_bf16_f32 v106, v108, v109
    v_cvt_pk_bf16_f32 v107, v110, v111
    buffer_store_dwordx4 v[104:107], v230, s[20:23], s53 offen offset:2560 sc1
    v_pk_mul_f32 v[112:113], v[112:113], v[244:245] op_sel_hi:[1,0]
    s_waitcnt lgkmcnt(3)
    v_pk_fma_f32 v[112:113], v[48:49], v[246:247], v[112:113] op_sel_hi:[1,0,1]
    v_pk_mul_f32 v[114:115], v[114:115], v[244:245] op_sel_hi:[1,0]
    s_nop 0
    v_pk_fma_f32 v[114:115], v[50:51], v[246:247], v[114:115] op_sel_hi:[1,0,1]
    v_pk_mul_f32 v[116:117], v[116:117], v[244:245] op_sel_hi:[1,0]
    s_waitcnt lgkmcnt(2)
    v_pk_fma_f32 v[116:117], v[52:53], v[246:247], v[116:117] op_sel_hi:[1,0,1]
    v_pk_mul_f32 v[118:119], v[118:119], v[244:245] op_sel_hi:[1,0]
    s_nop 0
    v_pk_fma_f32 v[118:119], v[54:55], v[246:247], v[118:119] op_sel_hi:[1,0,1]
    v_cvt_pk_bf16_f32 v112, v112, v113
    v_cvt_pk_bf16_f32 v113, v114, v115
    v_cvt_pk_bf16_f32 v114, v116, v117
    v_cvt_pk_bf16_f32 v115, v118, v119
    buffer_store_dwordx4 v[112:115], v230, s[20:23], s53 offen offset:3072 sc1
    v_pk_mul_f32 v[120:121], v[120:121], v[244:245] op_sel_hi:[1,0]
    s_waitcnt lgkmcnt(1)
    v_pk_fma_f32 v[120:121], v[56:57], v[246:247], v[120:121] op_sel_hi:[1,0,1]
    v_pk_mul_f32 v[122:123], v[122:123], v[244:245] op_sel_hi:[1,0]
    s_nop 0
    v_pk_fma_f32 v[122:123], v[58:59], v[246:247], v[122:123] op_sel_hi:[1,0,1]
    v_pk_mul_f32 v[124:125], v[124:125], v[244:245] op_sel_hi:[1,0]
    s_waitcnt lgkmcnt(0)
    v_pk_fma_f32 v[124:125], v[60:61], v[246:247], v[124:125] op_sel_hi:[1,0,1]
    v_pk_mul_f32 v[126:127], v[126:127], v[244:245] op_sel_hi:[1,0]
    s_nop 0
    v_pk_fma_f32 v[126:127], v[62:63], v[246:247], v[126:127] op_sel_hi:[1,0,1]
    v_cvt_pk_bf16_f32 v120, v120, v121
    v_cvt_pk_bf16_f32 v121, v122, v123
    v_cvt_pk_bf16_f32 v122, v124, v125
    s_waitcnt vmcnt(7)
    v_readfirstlane_b32 s30, v197
    s_nop 0
    s_cmp_eq_u32 s30, 8
    s_cselect_b32 s30, 0, 0xf0000000
    s_or_b32 s17, s9, s30
    s_add_u32 m0, s46, 131072
    s_nop 0
    buffer_load_dwordx4 v229, s[20:23], s17 offen offset:0 lds
    buffer_load_dwordx4 v229, s[20:23], s17 offen offset:1024 lds
    buffer_load_dwordx4 v229, s[20:23], s17 offen offset:2048 lds
    buffer_load_dwordx4 v229, s[20:23], s17 offen offset:3072 lds
    s_or_b32 s17, s14, s30
    s_add_u32 m0, s46, 98304
    s_nop 0
    buffer_load_dwordx4 v229, s[20:23], s17 offen offset:0 lds
    buffer_load_dwordx4 v229, s[20:23], s17 offen offset:1024 lds
    buffer_load_dwordx4 v229, s[20:23], s17 offen offset:2048 lds
    buffer_load_dwordx4 v229, s[20:23], s17 offen offset:3072 lds
    s_or_b32 s17, s15, s30
    s_add_u32 m0, s46, 114688
    s_nop 0
    buffer_load_dwordx4 v229, s[20:23], s17 offen offset:0 lds
    buffer_load_dwordx4 v229, s[20:23], s17 offen offset:1024 lds
    buffer_load_dwordx4 v229, s[20:23], s17 offen offset:2048 lds
    buffer_load_dwordx4 v229, s[20:23], s17 offen offset:3072 lds
    ds_read_b128 a[80:83], v198 offset:0
    v_cvt_pk_bf16_f32 v123, v126, v127
    ds_read_b128 a[84:87], v198 offset:1024
    ds_read_b128 a[88:91], v198 offset:2048
    ds_read_b128 a[92:95], v198 offset:3072
    ds_read_b128 a[112:115], v198 offset:16384
    buffer_store_dwordx4 v[120:123], v230, s[20:23], s53 offen offset:3584 sc1
    ds_read_b128 a[116:119], v198 offset:17408
    ds_read_b128 a[120:123], v198 offset:18432
    ds_read_b128 a[124:127], v198 offset:19456
    s_branch K2_DONE
K2_M23:
    ds_read_b128 a[0:3], v199 offset:49152
    v_mfma_f32_32x32x16_bf16 v[64:79], a[128:131], v[160:163], v[64:79]
    v_add_f32 v225, v225, v171
    v_cvt_pk_bf16_f32 v169, v170, v171
    v_exp_f32 v173, v173
    v_mfma_f32_32x32x16_bf16 v[80:95], a[132:135], v[160:163], v[80:95]
    s_add_u32 s16, s12, 16384
    buffer_load_dwordx4 a[32:35], v229, s[20:23], s16 offen offset:0
    v_add_f32 v225, v225, v172
    v_exp_f32 v174, v174
    v_add_f32 v225, v225, v173
    v_mfma_f32_32x32x16_bf16 v[96:111], a[136:139], v[160:163], v[96:111]
    ds_read_b128 a[4:7], v199 offset:50176
    v_cvt_pk_bf16_f32 v170, v172, v173
    v_exp_f32 v175, v175
    v_add_f32 v225, v225, v174
    v_mfma_f32_32x32x16_bf16 v[112:127], a[140:143], v[160:163], v[112:127]
    buffer_load_dwordx4 a[36:39], v229, s[20:23], s16 offen offset:1024
    v_exp_f32 v176, v176
    v_add_f32 v225, v225, v175
    v_cvt_pk_bf16_f32 v171, v174, v175
    s_nop 1
    v_mfma_f32_32x32x16_bf16 v[64:79], a[144:147], v[168:171], v[64:79]
    ds_read_b128 a[8:11], v199 offset:51200
    v_exp_f32 v177, v177
    v_add_f32 v225, v225, v176
    v_exp_f32 v178, v178
    v_add_f32 v225, v225, v177
    s_add_u32 s16, s12, 18432
    buffer_load_dwordx4 a[40:43], v229, s[20:23], s16 offen offset:0
    v_cvt_pk_bf16_f32 v176, v176, v177
    v_mfma_f32_32x32x16_bf16 v[80:95], a[148:151], v[168:171], v[80:95]
    v_exp_f32 v179, v179
    v_add_f32 v225, v225, v178
    v_exp_f32 v180, v180
    ds_read_b128 a[12:15], v199 offset:52224
    v_add_f32 v225, v225, v179
    v_cvt_pk_bf16_f32 v177, v178, v179
    v_mfma_f32_32x32x16_bf16 v[96:111], a[152:155], v[168:171], v[96:111]
    v_exp_f32 v181, v181
    buffer_load_dwordx4 a[44:47], v229, s[20:23], s16 offen offset:1024
    v_add_f32 v225, v225, v180
    v_exp_f32 v182, v182
    v_add_f32 v225, v225, v181
    v_cvt_pk_bf16_f32 v178, v180, v181
    ds_read_b128 a[96:99], v199 offset:32768
    v_mfma_f32_32x32x16_bf16 v[112:127], a[156:159], v[168:171], v[112:127]
    v_exp_f32 v183, v183
    v_add_f32 v225, v225, v182
    v_exp_f32 v184, v184
    s_add_u32 s16, s12, 32768
    buffer_load_dwordx4 a[64:67], v229, s[20:23], s16 offen offset:0
    v_add_f32 v225, v225, v183
    v_cvt_pk_bf16_f32 v179, v182, v183
    s_nop 1
    v_mfma_f32_32x32x16_bf16 v[64:79], a[160:163], v[176:179], v[64:79]
    v_exp_f32 v185, v185
    ds_read_b128 a[100:103], v199 offset:33792
    v_add_f32 v225, v225, v184
    v_exp_f32 v186, v186
    v_add_f32 v225, v225, v185
    v_cvt_pk_bf16_f32 v184, v184, v185
    v_mfma_f32_32x32x16_bf16 v[80:95], a[164:167], v[176:179], v[80:95]
    buffer_load_dwordx4 a[68:71], v229, s[20:23], s16 offen offset:1024
    v_exp_f32 v187, v187
    v_add_f32 v225, v225, v186
    v_exp_f32 v188, v188
    v_add_f32 v225, v225, v187
    ds_read_b128 a[104:107], v199 offset:34816
    v_cvt_pk_bf16_f32 v185, v186, v187
    v_mfma_f32_32x32x16_bf16 v[96:111], a[168:171], v[176:179], v[96:111]
    v_exp_f32 v189, v189
    v_add_f32 v225, v225, v188
    s_add_u32 s16, s12, 34816
    buffer_load_dwordx4 a[72:75], v229, s[20:23], s16 offen offset:0
    v_exp_f32 v190, v190
    v_add_f32 v225, v225, v189
    v_cvt_pk_bf16_f32 v186, v188, v189
    v_mfma_f32_32x32x16_bf16 v[112:127], a[172:175], v[176:179], v[112:127]
    ds_read_b128 a[108:111], v199 offset:35840
    v_exp_f32 v191, v191
    v_add_f32 v225, v225, v190
    v_add_f32 v225, v225, v191
    v_cvt_pk_bf16_f32 v187, v190, v191
    buffer_load_dwordx4 a[76:79], v229, s[20:23], s16 offen offset:1024
    s_nop 0
    v_mfma_f32_32x32x16_bf16 v[64:79], a[176:179], v[184:187], v[64:79]
    v_mfma_f32_32x32x16_bf16 v[80:95], a[180:183], v[184:187], v[80:95]
    v_mfma_f32_32x32x16_bf16 v[96:111], a[184:187], v[184:187], v[96:111]
    v_mfma_f32_32x32x16_bf16 v[112:127], a[188:191], v[184:187], v[112:127]
    s_nop 8
    ds_write_b128 v228, v[64:67] offset:0
    ds_write_b128 v228, v[68:71] offset:1024
    ds_write_b128 v228, v[72:75] offset:2048
    ds_write_b128 v228, v[76:79] offset:3072
    ds_write_b128 v228, v[80:83] offset:16384
    ds_write_b128 v228, v[84:87] offset:17408
    ds_write_b128 v228, v[88:91] offset:18432
    ds_write_b128 v228, v[92:95] offset:19456
    ds_write_b128 v228, v[96:99] offset:32768
    ds_write_b128 v228, v[100:103] offset:33792
    ds_write_b128 v228, v[104:107] offset:34816
    ds_write_b128 v228, v[108:111] offset:35840
    ds_write_b128 v228, v[112:115] offset:49152
    ds_write_b128 v228, v[116:119] offset:50176
    ds_write_b128 v228, v[120:123] offset:51200
    ds_write_b128 v228, v[124:127] offset:52224
    v_mov_b32 v209, v225
    ds_write_b64 v226, v[208:209]
    s_waitcnt vmcnt(16)
    v_cmp_gt_u32 vcc, s31, v231
    s_nop 0
    s_cbranch_vccz K3_P1_OK
    v_min_u32 v195, 5, v253
    v_lshlrev_b32 v195, 7, v195
K3_P1:
    s_sleep 4
    buffer_load_dword v231, v195, s[20:23], s63 offen sc1
    s_waitcnt vmcnt(0)
    v_cmp_gt_u32 vcc, s31, v231
    s_nop 0
    s_cbranch_vccz K3_P1_OK
    s_branch K3_P1
K3_P1_OK:
    s_waitcnt lgkmcnt(0)
    s_barrier
    ds_read_b64 v[232:233], v227
    ds_read_b128 v[64:67], v196 offset:0
    ds_read_b128 v[68:71], v196 offset:1024
    ds_read_b128 v[72:75], v196 offset:2048
    ds_read_b128 v[76:79], v196 offset:3072
    ds_read_b128 v[80:83], v196 offset:16384
    ds_read_b128 v[84:87], v196 offset:17408
    ds_read_b128 v[88:91], v196 offset:18432
    ds_read_b128 v[92:95], v196 offset:19456
    ds_read_b128 v[96:99], v196 offset:32768
    ds_read_b128 v[100:103], v196 offset:33792
    ds_read_b128 v[104:107], v196 offset:34816
    ds_read_b128 v[108:111], v196 offset:35840
    ds_read_b128 v[112:115], v196 offset:49152
    ds_read_b128 v[116:119], v196 offset:50176
    ds_read_b128 v[120:123], v196 offset:51200
    ds_read_b128 v[124:127], v196 offset:52224
    s_waitcnt lgkmcnt(15)
    v_min_f32 v234, v192, v232
    v_sub_f32 v244, v234, v192
    v_sub_f32 v246, v234, v232
    v_exp_f32 v244, v244
    v_exp_f32 v246, v246
    v_mul_f32 v224, v224, v244
    v_fmac_f32 v224, v233, v246
    v_mov_b32 v236, v224
    s_nop 1
    v_permlane32_swap_b32 v236, v224
    v_add_f32 v236, v236, v224
    v_rcp_f32 v236, v236
    s_nop 0
    v_mul_f32 v244, v244, v236
    v_mul_f32 v246, v246, v236
    v_pk_mul_f32 v[0:1], v[0:1], v[244:245] op_sel_hi:[1,0]
    s_nop 0
    v_pk_fma_f32 v[0:1], v[64:65], v[246:247], v[0:1] op_sel_hi:[1,0,1]
    v_pk_mul_f32 v[2:3], v[2:3], v[244:245] op_sel_hi:[1,0]
    s_nop 0
    v_pk_fma_f32 v[2:3], v[66:67], v[246:247], v[2:3] op_sel_hi:[1,0,1]
    v_pk_mul_f32 v[4:5], v[4:5], v[244:245] op_sel_hi:[1,0]
    s_waitcnt lgkmcnt(14)
    v_pk_fma_f32 v[4:5], v[68:69], v[246:247], v[4:5] op_sel_hi:[1,0,1]
    v_pk_mul_f32 v[6:7], v[6:7], v[244:245] op_sel_hi:[1,0]
    s_nop 0
    v_pk_fma_f32 v[6:7], v[70:71], v[246:247], v[6:7] op_sel_hi:[1,0,1]
    v_cvt_pk_bf16_f32 v0, v0, v1
    v_cvt_pk_bf16_f32 v1, v2, v3
    buffer_load_dword v197, off, s[20:23], s29 sc1
    v_cvt_pk_bf16_f32 v2, v4, v5
    v_cvt_pk_bf16_f32 v3, v6, v7
    buffer_store_dwordx4 v[0:3], v230, s[20:23], s52 offen offset:0 sc1
    v_pk_mul_f32 v[8:9], v[8:9], v[244:245] op_sel_hi:[1,0]
    s_waitcnt lgkmcnt(13)
    v_pk_fma_f32 v[8:9], v[72:73], v[246:247], v[8:9] op_sel_hi:[1,0,1]
    v_pk_mul_f32 v[10:11], v[10:11], v[244:245] op_sel_hi:[1,0]
    s_nop 0
    v_pk_fma_f32 v[10:11], v[74:75], v[246:247], v[10:11] op_sel_hi:[1,0,1]
    v_pk_mul_f32 v[12:13], v[12:13], v[244:245] op_sel_hi:[1,0]
    s_waitcnt lgkmcnt(12)
    v_pk_fma_f32 v[12:13], v[76:77], v[246:247], v[12:13] op_sel_hi:[1,0,1]
    v_pk_mul_f32 v[14:15], v[14:15], v[244:245] op_sel_hi:[1,0]
    s_nop 0
    v_pk_fma_f32 v[14:15], v[78:79], v[246:247], v[14:15] op_sel_hi:[1,0,1]
    v_cvt_pk_bf16_f32 v8, v8, v9
    v_cvt_pk_bf16_f32 v9, v10, v11
    v_cvt_pk_bf16_f32 v10, v12, v13
    v_cvt_pk_bf16_f32 v11, v14, v15
    buffer_store_dwordx4 v[8:11], v230, s[20:23], s52 offen offset:512 sc1
    v_pk_mul_f32 v[16:17], v[16:17], v[244:245] op_sel_hi:[1,0]
    s_waitcnt lgkmcnt(11)
    v_pk_fma_f32 v[16:17], v[80:81], v[246:247], v[16:17] op_sel_hi:[1,0,1]
    v_pk_mul_f32 v[18:19], v[18:19], v[244:245] op_sel_hi:[1,0]
    s_nop 0
    v_pk_fma_f32 v[18:19], v[82:83], v[246:247], v[18:19] op_sel_hi:[1,0,1]
    v_pk_mul_f32 v[20:21], v[20:21], v[244:245] op_sel_hi:[1,0]
    s_waitcnt lgkmcnt(10)
    v_pk_fma_f32 v[20:21], v[84:85], v[246:247], v[20:21] op_sel_hi:[1,0,1]
    v_pk_mul_f32 v[22:23], v[22:23], v[244:245] op_sel_hi:[1,0]
    s_nop 0
    v_pk_fma_f32 v[22:23], v[86:87], v[246:247], v[22:23] op_sel_hi:[1,0,1]
    v_cvt_pk_bf16_f32 v16, v16, v17
    v_cvt_pk_bf16_f32 v17, v18, v19
    v_cvt_pk_bf16_f32 v18, v20, v21
    v_cvt_pk_bf16_f32 v19, v22, v23
    buffer_store_dwordx4 v[16:19], v230, s[20:23], s52 offen offset:1024 sc1
    v_pk_mul_f32 v[24:25], v[24:25], v[244:245] op_sel_hi:[1,0]
    s_waitcnt lgkmcnt(9)
    v_pk_fma_f32 v[24:25], v[88:89], v[246:247], v[24:25] op_sel_hi:[1,0,1]
    v_pk_mul_f32 v[26:27], v[26:27], v[244:245] op_sel_hi:[1,0]
    s_nop 0
    v_pk_fma_f32 v[26:27], v[90:91], v[246:247], v[26:27] op_sel_hi:[1,0,1]
    v_pk_mul_f32 v[28:29], v[28:29], v[244:245] op_sel_hi:[1,0]
    s_waitcnt lgkmcnt(8)
    v_pk_fma_f32 v[28:29], v[92:93], v[246:247], v[28:29] op_sel_hi:[1,0,1]
    v_pk_mul_f32 v[30:31], v[30:31], v[244:245] op_sel_hi:[1,0]
    s_nop 0
    v_pk_fma_f32 v[30:31], v[94:95], v[246:247], v[30:31] op_sel_hi:[1,0,1]
    v_cvt_pk_bf16_f32 v24, v24, v25
    v_cvt_pk_bf16_f32 v25, v26, v27
    v_cvt_pk_bf16_f32 v26, v28, v29
    v_cvt_pk_bf16_f32 v27, v30, v31
    buffer_store_dwordx4 v[24:27], v230, s[20:23], s52 offen offset:1536 sc1
    v_pk_mul_f32 v[32:33], v[32:33], v[244:245] op_sel_hi:[1,0]
    s_waitcnt lgkmcnt(7)
    v_pk_fma_f32 v[32:33], v[96:97], v[246:247], v[32:33] op_sel_hi:[1,0,1]
    v_pk_mul_f32 v[34:35], v[34:35], v[244:245] op_sel_hi:[1,0]
    s_nop 0
    v_pk_fma_f32 v[34:35], v[98:99], v[246:247], v[34:35] op_sel_hi:[1,0,1]
    v_pk_mul_f32 v[36:37], v[36:37], v[244:245] op_sel_hi:[1,0]
    s_waitcnt lgkmcnt(6)
    v_pk_fma_f32 v[36:37], v[100:101], v[246:247], v[36:37] op_sel_hi:[1,0,1]
    v_pk_mul_f32 v[38:39], v[38:39], v[244:245] op_sel_hi:[1,0]
    s_nop 0
    v_pk_fma_f32 v[38:39], v[102:103], v[246:247], v[38:39] op_sel_hi:[1,0,1]
    v_cvt_pk_bf16_f32 v32, v32, v33
    v_cvt_pk_bf16_f32 v33, v34, v35
    v_cvt_pk_bf16_f32 v34, v36, v37
    v_cvt_pk_bf16_f32 v35, v38, v39
    buffer_store_dwordx4 v[32:35], v230, s[20:23], s52 offen offset:2048 sc1
    v_pk_mul_f32 v[40:41], v[40:41], v[244:245] op_sel_hi:[1,0]
    s_waitcnt lgkmcnt(5)
    v_pk_fma_f32 v[40:41], v[104:105], v[246:247], v[40:41] op_sel_hi:[1,0,1]
    v_pk_mul_f32 v[42:43], v[42:43], v[244:245] op_sel_hi:[1,0]
    s_nop 0
    v_pk_fma_f32 v[42:43], v[106:107], v[246:247], v[42:43] op_sel_hi:[1,0,1]
    v_pk_mul_f32 v[44:45], v[44:45], v[244:245] op_sel_hi:[1,0]
    s_waitcnt lgkmcnt(4)
    v_pk_fma_f32 v[44:45], v[108:109], v[246:247], v[44:45] op_sel_hi:[1,0,1]
    v_pk_mul_f32 v[46:47], v[46:47], v[244:245] op_sel_hi:[1,0]
    s_nop 0
    v_pk_fma_f32 v[46:47], v[110:111], v[246:247], v[46:47] op_sel_hi:[1,0,1]
    v_cvt_pk_bf16_f32 v40, v40, v41
    v_cvt_pk_bf16_f32 v41, v42, v43
    v_cvt_pk_bf16_f32 v42, v44, v45
    v_cvt_pk_bf16_f32 v43, v46, v47
    buffer_store_dwordx4 v[40:43], v230, s[20:23], s52 offen offset:2560 sc1
    v_pk_mul_f32 v[48:49], v[48:49], v[244:245] op_sel_hi:[1,0]
    s_waitcnt lgkmcnt(3)
    v_pk_fma_f32 v[48:49], v[112:113], v[246:247], v[48:49] op_sel_hi:[1,0,1]
    v_pk_mul_f32 v[50:51], v[50:51], v[244:245] op_sel_hi:[1,0]
    s_nop 0
    v_pk_fma_f32 v[50:51], v[114:115], v[246:247], v[50:51] op_sel_hi:[1,0,1]
    v_pk_mul_f32 v[52:53], v[52:53], v[244:245] op_sel_hi:[1,0]
    s_waitcnt lgkmcnt(2)
    v_pk_fma_f32 v[52:53], v[116:117], v[246:247], v[52:53] op_sel_hi:[1,0,1]
    v_pk_mul_f32 v[54:55], v[54:55], v[244:245] op_sel_hi:[1,0]
    s_nop 0
    v_pk_fma_f32 v[54:55], v[118:119], v[246:247], v[54:55] op_sel_hi:[1,0,1]
    v_cvt_pk_bf16_f32 v48, v48, v49
    v_cvt_pk_bf16_f32 v49, v50, v51
    v_cvt_pk_bf16_f32 v50, v52, v53
    v_cvt_pk_bf16_f32 v51, v54, v55
    buffer_store_dwordx4 v[48:51], v230, s[20:23], s52 offen offset:3072 sc1
    v_pk_mul_f32 v[56:57], v[56:57], v[244:245] op_sel_hi:[1,0]
    s_waitcnt lgkmcnt(1)
    v_pk_fma_f32 v[56:57], v[120:121], v[246:247], v[56:57] op_sel_hi:[1,0,1]
    v_pk_mul_f32 v[58:59], v[58:59], v[244:245] op_sel_hi:[1,0]
    s_nop 0
    v_pk_fma_f32 v[58:59], v[122:123], v[246:247], v[58:59] op_sel_hi:[1,0,1]
    v_pk_mul_f32 v[60:61], v[60:61], v[244:245] op_sel_hi:[1,0]
    s_waitcnt lgkmcnt(0)
    v_pk_fma_f32 v[60:61], v[124:125], v[246:247], v[60:61] op_sel_hi:[1,0,1]
    v_pk_mul_f32 v[62:63], v[62:63], v[244:245] op_sel_hi:[1,0]
    s_nop 0
    v_pk_fma_f32 v[62:63], v[126:127], v[246:247], v[62:63] op_sel_hi:[1,0,1]
    v_cvt_pk_bf16_f32 v56, v56, v57
    v_cvt_pk_bf16_f32 v57, v58, v59
    v_cvt_pk_bf16_f32 v58, v60, v61
    s_waitcnt vmcnt(7)
    v_readfirstlane_b32 s30, v197
    s_nop 0
    s_cmp_eq_u32 s30, 8
    s_cselect_b32 s30, 0, 0xf0000000
    s_or_b32 s17, s9, s30
    s_add_u32 m0, s46, 131072
    s_nop 0
    buffer_load_dwordx4 v229, s[20:23], s17 offen offset:0 lds
    buffer_load_dwordx4 v229, s[20:23], s17 offen offset:1024 lds
    buffer_load_dwordx4 v229, s[20:23], s17 offen offset:2048 lds
    buffer_load_dwordx4 v229, s[20:23], s17 offen offset:3072 lds
    s_or_b32 s17, s14, s30
    s_add_u32 m0, s46, 98304
    s_nop 0
    buffer_load_dwordx4 v229, s[20:23], s17 offen offset:0 lds
    buffer_load_dwordx4 v229, s[20:23], s17 offen offset:1024 lds
    buffer_load_dwordx4 v229, s[20:23], s17 offen offset:2048 lds
    buffer_load_dwordx4 v229, s[20:23], s17 offen offset:3072 lds
    s_or_b32 s17, s15, s30
    s_add_u32 m0, s46, 114688
    s_nop 0
    buffer_load_dwordx4 v229, s[20:23], s17 offen offset:0 lds
    buffer_load_dwordx4 v229, s[20:23], s17 offen offset:1024 lds
    buffer_load_dwordx4 v229, s[20:23], s17 offen offset:2048 lds
    buffer_load_dwordx4 v229, s[20:23], s17 offen offset:3072 lds
    ds_read_b128 a[80:83], v198 offset:0
    v_cvt_pk_bf16_f32 v59, v62, v63
    ds_read_b128 a[84:87], v198 offset:1024
    ds_read_b128 a[88:91], v198 offset:2048
    ds_read_b128 a[92:95], v198 offset:3072
    ds_read_b128 a[112:115], v198 offset:16384
    buffer_store_dwordx4 v[56:59], v230, s[20:23], s52 offen offset:3584 sc1
    ds_read_b128 a[116:119], v198 offset:17408
    ds_read_b128 a[120:123], v198 offset:18432
    ds_read_b128 a[124:127], v198 offset:19456
    s_branch K2_DONE
K2_SLOWX:
    v_cmp_lt_f32 vcc, 0x41000000, v226
    s_cmp_lg_u32 s42, s65
    s_cbranch_scc1 K2_NODIAGX
    v_mov_b32 v232, 0xff800000
    v_cndmask_b32 v128, v128, v232, s[10:11]
    v_cndmask_b32 v129, v129, v232, s[12:13]
    v_cndmask_b32 v130, v130, v232, s[14:15]
    v_cndmask_b32 v131, v131, v232, s[16:17]
    v_cndmask_b32 v132, v132, v232, s[18:19]
    v_cndmask_b32 v133, v133, v232, s[24:25]
    v_cndmask_b32 v134, v134, v232, s[26:27]
    v_cndmask_b32 v135, v135, v232, s[28:29]
    v_cndmask_b32 v136, v136, v232, s[30:31]
    v_cndmask_b32 v137, v137, v232, s[32:33]
    v_cndmask_b32 v138, v138, v232, s[34:35]
    v_cndmask_b32 v139, v139, v232, s[36:37]
    v_cndmask_b32 v140, v140, v232, s[38:39]
    v_cndmask_b32 v141, v141, v232, s[56:57]
    v_cndmask_b32 v142, v142, v232, s[58:59]
    v_cndmask_b32 v143, v143, v232, s[60:61]
    v_mov_b64 v[144:145], s[100:101]
    v_mov_b64 v[146:147], s[100:101]
    v_mov_b64 v[148:149], s[100:101]
    v_mov_b64 v[150:151], s[100:101]
    v_mov_b64 v[152:153], s[100:101]
    v_mov_b64 v[154:155], s[100:101]
    v_mov_b64 v[156:157], s[100:101]
    v_mov_b64 v[158:159], s[100:101]
    s_or_b32 s9, vcc_lo, vcc_hi
    s_or_b32 s9, s9, s66
    s_cbranch_scc0 K2_BACKX
    v_max3_f32 v226, v128, v129, v130
    v_max3_f32 v226, v226, v131, v132
    v_max3_f32 v226, v226, v133, v134
    v_max3_f32 v226, v226, v135, v136
    v_max3_f32 v226, v226, v137, v138
    v_max3_f32 v226, v226, v139, v140
    v_max3_f32 v226, v226, v141, v142
    v_max3_f32 v226, v226, v143, v144
    v_max3_f32 v226, v226, v145, v146
    v_max3_f32 v226, v226, v147, v148
    v_max3_f32 v226, v226, v149, v150
    v_max3_f32 v226, v226, v151, v152
    v_max3_f32 v226, v226, v153, v154
    v_max3_f32 v226, v226, v155, v156
    v_max3_f32 v226, v226, v157, v158
    v_max_f32 v226, v226, v159
K2_NODIAGX:
    s_or_b32 s9, vcc_lo, vcc_hi
    s_or_b32 s9, s9, s66
    s_cbranch_scc0 K2_BACKX
    v_mov_b32 v232, v226
    v_mov_b32 v233, 0
    s_nop 0
    v_permlane32_swap_b32 v232, v226
    v_max_f32 v226, v226, v232
    s_cmp_lg_u32 s66, 0
    s_cbranch_scc1 K2_FIRSTX
    v_max_f32 v226, 0, v226
    v_sub_f32 v232, 0, v226
    v_exp_f32 v232, v232
    s_nop 0
    v_mul_f32 v224, v224, v232
    v_pk_mul_f32 v[0:1], v[0:1], v[232:233] op_sel_hi:[1,0]
    v_pk_mul_f32 v[2:3], v[2:3], v[232:233] op_sel_hi:[1,0]
    v_pk_mul_f32 v[4:5], v[4:5], v[232:233] op_sel_hi:[1,0]
    v_pk_mul_f32 v[6:7], v[6:7], v[232:233] op_sel_hi:[1,0]
    v_pk_mul_f32 v[8:9], v[8:9], v[232:233] op_sel_hi:[1,0]
    v_pk_mul_f32 v[10:11], v[10:11], v[232:233] op_sel_hi:[1,0]
    v_pk_mul_f32 v[12:13], v[12:13], v[232:233] op_sel_hi:[1,0]
    v_pk_mul_f32 v[14:15], v[14:15], v[232:233] op_sel_hi:[1,0]
    v_pk_mul_f32 v[16:17], v[16:17], v[232:233] op_sel_hi:[1,0]
    v_pk_mul_f32 v[18:19], v[18:19], v[232:233] op_sel_hi:[1,0]
    v_pk_mul_f32 v[20:21], v[20:21], v[232:233] op_sel_hi:[1,0]
    v_pk_mul_f32 v[22:23], v[22:23], v[232:233] op_sel_hi:[1,0]
    v_pk_mul_f32 v[24:25], v[24:25], v[232:233] op_sel_hi:[1,0]
    v_pk_mul_f32 v[26:27], v[26:27], v[232:233] op_sel_hi:[1,0]
    v_pk_mul_f32 v[28:29], v[28:29], v[232:233] op_sel_hi:[1,0]
    v_pk_mul_f32 v[30:31], v[30:31], v[232:233] op_sel_hi:[1,0]
    v_pk_mul_f32 v[32:33], v[32:33], v[232:233] op_sel_hi:[1,0]
    v_pk_mul_f32 v[34:35], v[34:35], v[232:233] op_sel_hi:[1,0]
    v_pk_mul_f32 v[36:37], v[36:37], v[232:233] op_sel_hi:[1,0]
    v_pk_mul_f32 v[38:39], v[38:39], v[232:233] op_sel_hi:[1,0]
    v_pk_mul_f32 v[40:41], v[40:41], v[232:233] op_sel_hi:[1,0]
    v_pk_mul_f32 v[42:43], v[42:43], v[232:233] op_sel_hi:[1,0]
    v_pk_mul_f32 v[44:45], v[44:45], v[232:233] op_sel_hi:[1,0]
    v_pk_mul_f32 v[46:47], v[46:47], v[232:233] op_sel_hi:[1,0]
    v_pk_mul_f32 v[48:49], v[48:49], v[232:233] op_sel_hi:[1,0]
    v_pk_mul_f32 v[50:51], v[50:51], v[232:233] op_sel_hi:[1,0]
    v_pk_mul_f32 v[52:53], v[52:53], v[232:233] op_sel_hi:[1,0]
    v_pk_mul_f32 v[54:55], v[54:55], v[232:233] op_sel_hi:[1,0]
    v_pk_mul_f32 v[56:57], v[56:57], v[232:233] op_sel_hi:[1,0]
    v_pk_mul_f32 v[58:59], v[58:59], v[232:233] op_sel_hi:[1,0]
    v_pk_mul_f32 v[60:61], v[60:61], v[232:233] op_sel_hi:[1,0]
    v_pk_mul_f32 v[62:63], v[62:63], v[232:233] op_sel_hi:[1,0]
K2_FIRSTX:
    v_sub_f32 v232, 0, v226
    v_pk_add_f32 v[192:193], v[192:193], v[232:233] op_sel_hi:[1,0]
    v_pk_add_f32 v[194:195], v[194:195], v[232:233] op_sel_hi:[1,0]
    v_pk_add_f32 v[196:197], v[196:197], v[232:233] op_sel_hi:[1,0]
    v_pk_add_f32 v[198:199], v[198:199], v[232:233] op_sel_hi:[1,0]
    v_pk_add_f32 v[200:201], v[200:201], v[232:233] op_sel_hi:[1,0]
    v_pk_add_f32 v[202:203], v[202:203], v[232:233] op_sel_hi:[1,0]
    v_pk_add_f32 v[204:205], v[204:205], v[232:233] op_sel_hi:[1,0]
    v_pk_add_f32 v[206:207], v[206:207], v[232:233] op_sel_hi:[1,0]
    v_pk_add_f32 v[128:129], v[128:129], v[232:233] op_sel_hi:[1,0]
    v_pk_add_f32 v[130:131], v[130:131], v[232:233] op_sel_hi:[1,0]
    v_pk_add_f32 v[132:133], v[132:133], v[232:233] op_sel_hi:[1,0]
    v_pk_add_f32 v[134:135], v[134:135], v[232:233] op_sel_hi:[1,0]
    v_pk_add_f32 v[136:137], v[136:137], v[232:233] op_sel_hi:[1,0]
    v_pk_add_f32 v[138:139], v[138:139], v[232:233] op_sel_hi:[1,0]
    v_pk_add_f32 v[140:141], v[140:141], v[232:233] op_sel_hi:[1,0]
    v_pk_add_f32 v[142:143], v[142:143], v[232:233] op_sel_hi:[1,0]
    v_pk_add_f32 v[144:145], v[144:145], v[232:233] op_sel_hi:[1,0]
    v_pk_add_f32 v[146:147], v[146:147], v[232:233] op_sel_hi:[1,0]
    v_pk_add_f32 v[148:149], v[148:149], v[232:233] op_sel_hi:[1,0]
    v_pk_add_f32 v[150:151], v[150:151], v[232:233] op_sel_hi:[1,0]
    v_pk_add_f32 v[152:153], v[152:153], v[232:233] op_sel_hi:[1,0]
    v_pk_add_f32 v[154:155], v[154:155], v[232:233] op_sel_hi:[1,0]
    v_pk_add_f32 v[156:157], v[156:157], v[232:233] op_sel_hi:[1,0]
    v_pk_add_f32 v[158:159], v[158:159], v[232:233] op_sel_hi:[1,0]
    s_cmp_eq_u32 s66, 0
    s_cbranch_scc1 K2_BACKX
    v_lshrrev_b32 v232, 1, v229
    s_lshl_b32 s9, s40, 9
    s_add_u32 s9, s9, 147456
    v_add_u32 v232, s9, v232
    ds_write_b32 v232, v192
    s_branch K2_BACKX
K2_SLOWY:
    v_cmp_lt_f32 vcc, 0x41000000, v227
    s_cmp_lg_u32 s42, s65
    s_cbranch_scc1 K2_NODIAGY
    v_mov_b32 v232, 0xff800000
    v_cndmask_b32 v176, v176, v232, s[10:11]
    v_cndmask_b32 v177, v177, v232, s[12:13]
    v_cndmask_b32 v178, v178, v232, s[14:15]
    v_cndmask_b32 v179, v179, v232, s[16:17]
    v_cndmask_b32 v180, v180, v232, s[18:19]
    v_cndmask_b32 v181, v181, v232, s[24:25]
    v_cndmask_b32 v182, v182, v232, s[26:27]
    v_cndmask_b32 v183, v183, v232, s[28:29]
    v_cndmask_b32 v184, v184, v232, s[30:31]
    v_cndmask_b32 v185, v185, v232, s[32:33]
    v_cndmask_b32 v186, v186, v232, s[34:35]
    v_cndmask_b32 v187, v187, v232, s[36:37]
    v_cndmask_b32 v188, v188, v232, s[38:39]
    v_cndmask_b32 v189, v189, v232, s[56:57]
    v_cndmask_b32 v190, v190, v232, s[58:59]
    v_cndmask_b32 v191, v191, v232, s[60:61]
    s_or_b32 s9, vcc_lo, vcc_hi
    s_or_b32 s9, s9, s66
    s_cbranch_scc0 K2_HOOK
    v_max3_f32 v227, v160, v161, v162
    v_max3_f32 v227, v227, v163, v164
    v_max3_f32 v227, v227, v165, v166
    v_max3_f32 v227, v227, v167, v168
    v_max3_f32 v227, v227, v169, v170
    v_max3_f32 v227, v227, v171, v172
    v_max3_f32 v227, v227, v173, v174
    v_max3_f32 v227, v227, v175, v176
    v_max3_f32 v227, v227, v177, v178
    v_max3_f32 v227, v227, v179, v180
    v_max3_f32 v227, v227, v181, v182
    v_max3_f32 v227, v227, v183, v184
    v_max3_f32 v227, v227, v185, v186
    v_max3_f32 v227, v227, v187, v188
    v_max3_f32 v227, v227, v189, v190
    v_max_f32 v227, v227, v191
K2_NODIAGY:
    s_or_b32 s9, vcc_lo, vcc_hi
    s_or_b32 s9, s9, s66
    s_cbranch_scc0 K2_HOOK
    v_mov_b32 v232, v227
    v_mov_b32 v233, 0
    s_nop 0
    v_permlane32_swap_b32 v232, v227
    v_max_f32 v227, v227, v232
    s_cmp_lg_u32 s66, 0
    s_cbranch_scc1 K2_FIRSTY
    v_max_f32 v227, 0, v227
    v_sub_f32 v232, 0, v227
    v_exp_f32 v232, v232
    s_nop 0
    v_mul_f32 v225, v225, v232
    v_pk_mul_f32 v[64:65], v[64:65], v[232:233] op_sel_hi:[1,0]
    v_pk_mul_f32 v[66:67], v[66:67], v[232:233] op_sel_hi:[1,0]
    v_pk_mul_f32 v[68:69], v[68:69], v[232:233] op_sel_hi:[1,0]
    v_pk_mul_f32 v[70:71], v[70:71], v[232:233] op_sel_hi:[1,0]
    v_pk_mul_f32 v[72:73], v[72:73], v[232:233] op_sel_hi:[1,0]
    v_pk_mul_f32 v[74:75], v[74:75], v[232:233] op_sel_hi:[1,0]
    v_pk_mul_f32 v[76:77], v[76:77], v[232:233] op_sel_hi:[1,0]
    v_pk_mul_f32 v[78:79], v[78:79], v[232:233] op_sel_hi:[1,0]
    v_pk_mul_f32 v[80:81], v[80:81], v[232:233] op_sel_hi:[1,0]
    v_pk_mul_f32 v[82:83], v[82:83], v[232:233] op_sel_hi:[1,0]
    v_pk_mul_f32 v[84:85], v[84:85], v[232:233] op_sel_hi:[1,0]
    v_pk_mul_f32 v[86:87], v[86:87], v[232:233] op_sel_hi:[1,0]
    v_pk_mul_f32 v[88:89], v[88:89], v[232:233] op_sel_hi:[1,0]
    v_pk_mul_f32 v[90:91], v[90:91], v[232:233] op_sel_hi:[1,0]
    v_pk_mul_f32 v[92:93], v[92:93], v[232:233] op_sel_hi:[1,0]
    v_pk_mul_f32 v[94:95], v[94:95], v[232:233] op_sel_hi:[1,0]
    v_pk_mul_f32 v[96:97], v[96:97], v[232:233] op_sel_hi:[1,0]
    v_pk_mul_f32 v[98:99], v[98:99], v[232:233] op_sel_hi:[1,0]
    v_pk_mul_f32 v[100:101], v[100:101], v[232:233] op_sel_hi:[1,0]
    v_pk_mul_f32 v[102:103], v[102:103], v[232:233] op_sel_hi:[1,0]
    v_pk_mul_f32 v[104:105], v[104:105], v[232:233] op_sel_hi:[1,0]
    v_pk_mul_f32 v[106:107], v[106:107], v[232:233] op_sel_hi:[1,0]
    v_pk_mul_f32 v[108:109], v[108:109], v[232:233] op_sel_hi:[1,0]
    v_pk_mul_f32 v[110:111], v[110:111], v[232:233] op_sel_hi:[1,0]
    v_pk_mul_f32 v[112:113], v[112:113], v[232:233] op_sel_hi:[1,0]
    v_pk_mul_f32 v[114:115], v[114:115], v[232:233] op_sel_hi:[1,0]
    v_pk_mul_f32 v[116:117], v[116:117], v[232:233] op_sel_hi:[1,0]
    v_pk_mul_f32 v[118:119], v[118:119], v[232:233] op_sel_hi:[1,0]
    v_pk_mul_f32 v[120:121], v[120:121], v[232:233] op_sel_hi:[1,0]
    v_pk_mul_f32 v[122:123], v[122:123], v[232:233] op_sel_hi:[1,0]
    v_pk_mul_f32 v[124:125], v[124:125], v[232:233] op_sel_hi:[1,0]
    v_pk_mul_f32 v[126:127], v[126:127], v[232:233] op_sel_hi:[1,0]
K2_FIRSTY:
    v_sub_f32 v232, 0, v227
    v_pk_add_f32 v[208:209], v[208:209], v[232:233] op_sel_hi:[1,0]
    v_pk_add_f32 v[210:211], v[210:211], v[232:233] op_sel_hi:[1,0]
    v_pk_add_f32 v[212:213], v[212:213], v[232:233] op_sel_hi:[1,0]
    v_pk_add_f32 v[214:215], v[214:215], v[232:233] op_sel_hi:[1,0]
    v_pk_add_f32 v[216:217], v[216:217], v[232:233] op_sel_hi:[1,0]
    v_pk_add_f32 v[218:219], v[218:219], v[232:233] op_sel_hi:[1,0]
    v_pk_add_f32 v[220:221], v[220:221], v[232:233] op_sel_hi:[1,0]
    v_pk_add_f32 v[222:223], v[222:223], v[232:233] op_sel_hi:[1,0]
    v_pk_add_f32 v[160:161], v[160:161], v[232:233] op_sel_hi:[1,0]
    v_pk_add_f32 v[162:163], v[162:163], v[232:233] op_sel_hi:[1,0]
    v_pk_add_f32 v[164:165], v[164:165], v[232:233] op_sel_hi:[1,0]
    v_pk_add_f32 v[166:167], v[166:167], v[232:233] op_sel_hi:[1,0]
    v_pk_add_f32 v[168:169], v[168:169], v[232:233] op_sel_hi:[1,0]
    v_pk_add_f32 v[170:171], v[170:171], v[232:233] op_sel_hi:[1,0]
    v_pk_add_f32 v[172:173], v[172:173], v[232:233] op_sel_hi:[1,0]
    v_pk_add_f32 v[174:175], v[174:175], v[232:233] op_sel_hi:[1,0]
    v_pk_add_f32 v[176:177], v[176:177], v[232:233] op_sel_hi:[1,0]
    v_pk_add_f32 v[178:179], v[178:179], v[232:233] op_sel_hi:[1,0]
    v_pk_add_f32 v[180:181], v[180:181], v[232:233] op_sel_hi:[1,0]
    v_pk_add_f32 v[182:183], v[182:183], v[232:233] op_sel_hi:[1,0]
    v_pk_add_f32 v[184:185], v[184:185], v[232:233] op_sel_hi:[1,0]
    v_pk_add_f32 v[186:187], v[186:187], v[232:233] op_sel_hi:[1,0]
    v_pk_add_f32 v[188:189], v[188:189], v[232:233] op_sel_hi:[1,0]
    v_pk_add_f32 v[190:191], v[190:191], v[232:233] op_sel_hi:[1,0]
    s_cmp_eq_u32 s66, 0
    s_cbranch_scc1 K2_HOOK
    v_lshrrev_b32 v232, 1, v229
    s_lshl_b32 s9, s40, 9
    s_add_u32 s9, s9, 147460
    v_add_u32 v232, s9, v232
    ds_write_b32 v232, v208
K2_HOOK:
    s_mov_b32 s66, 0
    s_cmp_lg_u32 s42, s96
    s_cbranch_scc1 K2_NOEA
    s_add_u32 s54, s41, s40
    s_lshl_b32 s54, s54, 7
    s_add_u32 s54, s54, s97
    buffer_atomic_add v249, v248, s[20:23], s54 offen sc1
K2_NOEA:
    s_cmp_lg_u32 s42, s62
    s_cbranch_scc1 K2_PL_OK
    s_cmp_eq_u32 s42, 14
    s_cbranch_scc1 K2_PL2
    s_mov_b32 s62, 14
    buffer_load_dword v231, v252, s[20:23], s63 offen sc1
    s_branch K2_PL_OK
K2_PL2:
    s_mov_b32 s62, 99
    v_cmp_gt_u32 vcc, 32, v231
    s_nop 0
    s_cbranch_vccz K2_PL3
K2_PL:
    s_sleep 4
    buffer_load_dword v231, v252, s[20:23], s63 offen sc1
    s_waitcnt vmcnt(0)
    v_cmp_gt_u32 vcc, 32, v231
    s_nop 0
    s_cbranch_vccz K2_PL3
    s_branch K2_PL
K2_PL3:
    buffer_load_dword v231, v252, s[20:23], s63 offen offset:256 sc1
K2_PL_OK:
    s_cmp_lg_u32 s42, s50
    s_cbranch_scc1 K2_HOOKEND
    s_cmp_lg_u32 s42, s41
    s_cbranch_scc1 K2_RPB
    s_add_u32 s50, s50, 1
    s_mov_b32 s55, m0
    s_add_u32 m0, s51, 0
    s_add_u32 s54, s48, 0
    buffer_load_dwordx4 v251, s[92:95], s54 offen offset:0 lds
    s_add_u32 s54, s48, 7168
    buffer_load_dwordx4 v251, s[92:95], s54 offen offset:1024 lds
    s_add_u32 s54, s48, 14336
    buffer_load_dwordx4 v251, s[92:95], s54 offen offset:2048 lds
    s_add_u32 s54, s48, 21504
    buffer_load_dwordx4 v251, s[92:95], s54 offen offset:3072 lds
    s_add_u32 m0, s51, 4096
    s_add_u32 s54, s48, 128
    buffer_load_dwordx4 v251, s[92:95], s54 offen offset:0 lds
    s_add_u32 s54, s48, 7296
    buffer_load_dwordx4 v251, s[92:95], s54 offen offset:1024 lds
    s_add_u32 s54, s48, 14464
    buffer_load_dwordx4 v251, s[92:95], s54 offen offset:2048 lds
    s_add_u32 s54, s48, 21632
    buffer_load_dwordx4 v251, s[92:95], s54 offen offset:3072 lds
    s_add_u32 m0, s51, 20480
    s_add_u32 s54, s87, 0
    buffer_load_dwordx4 v251, s[88:91], s54 offen offset:0 lds
    s_add_u32 s54, s87, 7168
    buffer_load_dwordx4 v251, s[88:91], s54 offen offset:1024 lds
    s_add_u32 s54, s87, 14336
    buffer_load_dwordx4 v251, s[88:91], s54 offen offset:2048 lds
    s_add_u32 s54, s87, 21504
    buffer_load_dwordx4 v251, s[88:91], s54 offen offset:3072 lds
    s_mov_b32 m0, s55
    s_branch K2_HOOKEND
K2_RPC:
    s_mov_b32 s50, 99
    s_lshl_b32 s54, s41, 6
    s_add_u32 s54, s54, 537600
    buffer_atomic_add v249, v248, s[20:23], s54 offen sc1
    s_branch K2_HOOKEND
K2_RPB:
    s_add_u32 s54, s41, 2
    s_cmp_eq_u32 s42, s54
    s_cbranch_scc1 K2_RPC
    s_cmp_eq_u32 s40, 2
    s_cselect_b32 s50, s54, 99
    ds_read_b64_tr_b16 a[196:197], v250 offset:0
    ds_read_b64_tr_b16 a[198:199], v250 offset:1024
    ds_read_b64_tr_b16 a[200:201], v250 offset:32
    ds_read_b64_tr_b16 a[202:203], v250 offset:1056
    ds_read_b64_tr_b16 a[204:205], v250 offset:64
    ds_read_b64_tr_b16 a[206:207], v250 offset:1088
    ds_read_b64_tr_b16 a[208:209], v250 offset:96
    ds_read_b64_tr_b16 a[210:211], v250 offset:1120
    ds_read_b64_tr_b16 a[212:213], v250 offset:4096
    ds_read_b64_tr_b16 a[214:215], v250 offset:5120
    ds_read_b64_tr_b16 a[216:217], v250 offset:4128
    ds_read_b64_tr_b16 a[218:219], v250 offset:5152
    ds_read_b64_tr_b16 a[220:221], v250 offset:4160
    ds_read_b64_tr_b16 a[222:223], v250 offset:5184
    ds_read_b64_tr_b16 a[224:225], v250 offset:4192
    ds_read_b64_tr_b16 a[226:227], v250 offset:5216
    ds_read_b64_tr_b16 a[228:229], v250 offset:20480
    ds_read_b64_tr_b16 a[230:231], v250 offset:21504
    ds_read_b64_tr_b16 a[232:233], v250 offset:20512
    ds_read_b64_tr_b16 a[234:235], v250 offset:21536
    ds_read_b64_tr_b16 a[236:237], v250 offset:20544
    ds_read_b64_tr_b16 a[238:239], v250 offset:21568
    ds_read_b64_tr_b16 a[240:241], v250 offset:20576
    ds_read_b64_tr_b16 a[242:243], v250 offset:21600
    s_add_u32 s54, s49, 524288
    s_waitcnt lgkmcnt(15)
    buffer_store_dwordx4 a[196:199], v229, s[20:23], s49 offen offset:0 sc1
    buffer_store_dwordx4 a[200:203], v229, s[20:23], s49 offen offset:1024 sc1
    s_add_u32 s55, s49, 2048
    buffer_store_dwordx4 a[204:207], v229, s[20:23], s55 offen offset:2048 sc1
    buffer_store_dwordx4 a[208:211], v229, s[20:23], s55 offen offset:3072 sc1
    s_waitcnt lgkmcnt(14)
    buffer_store_dwordx4 a[212:215], v229, s[20:23], s54 offen offset:0 sc1
    s_waitcnt lgkmcnt(12)
    buffer_store_dwordx4 a[216:219], v229, s[20:23], s54 offen offset:1024 sc1
    s_add_u32 s55, s54, 2048
    s_waitcnt lgkmcnt(10)
    buffer_store_dwordx4 a[220:223], v229, s[20:23], s55 offen offset:2048 sc1
    s_waitcnt lgkmcnt(8)
    buffer_store_dwordx4 a[224:227], v229, s[20:23], s55 offen offset:3072 sc1
    s_waitcnt lgkmcnt(6)
    buffer_store_dwordx4 a[228:231], v229, s[20:23], s86 offen offset:0 sc1
    s_waitcnt lgkmcnt(4)
    buffer_store_dwordx4 a[232:235], v229, s[20:23], s86 offen offset:1024 sc1
    s_waitcnt lgkmcnt(2)
    buffer_store_dwordx4 a[236:239], v229, s[20:23], s86 offen offset:2048 sc1
    s_waitcnt lgkmcnt(0)
    buffer_store_dwordx4 a[240:243], v229, s[20:23], s86 offen offset:3072 sc1
K2_HOOKEND:
    s_cmp_gt_u32 s65, s42
    s_cselect_b32 s85, s65, 99
    s_min_u32 s85, s85, s50
    s_min_u32 s85, s85, s62
    s_branch K2_BACKY
K2_DONE:
    s_load_dwordx2 s[4:5], s[0:1], 96
    s_mov_b32 s6, 2097152
    s_load_dwordx2 s[24:25], s[0:1], 0
    s_mov_b32 s26, 2097152
    s_mov_b32 s27, 0x20000
    buffer_load_dword v251, v250, s[20:23], s18 offen sc1
    s_cmp_eq_u32 s30, 0
    s_cbranch_scc1 K3_P2_OK
K3_P2:
    s_sleep 4
    buffer_load_dword v197, off, s[20:23], s29 sc1
    s_waitcnt vmcnt(0)
    v_readfirstlane_b32 s30, v197
    s_nop 0
    s_cmp_lg_u32 s30, 8
    s_cbranch_scc1 K3_P2
    s_add_u32 s17, s9, 0
    s_add_u32 m0, s46, 131072
    s_nop 0
    buffer_load_dwordx4 v229, s[20:23], s17 offen offset:0 lds
    buffer_load_dwordx4 v229, s[20:23], s17 offen offset:1024 lds
    buffer_load_dwordx4 v229, s[20:23], s17 offen offset:2048 lds
    buffer_load_dwordx4 v229, s[20:23], s17 offen offset:3072 lds
    s_add_u32 s17, s14, 0
    s_add_u32 m0, s46, 98304
    s_nop 0
    buffer_load_dwordx4 v229, s[20:23], s17 offen offset:0 lds
    buffer_load_dwordx4 v229, s[20:23], s17 offen offset:1024 lds
    buffer_load_dwordx4 v229, s[20:23], s17 offen offset:2048 lds
    buffer_load_dwordx4 v229, s[20:23], s17 offen offset:3072 lds
    s_add_u32 s17, s15, 0
    s_add_u32 m0, s46, 114688
    s_nop 0
    buffer_load_dwordx4 v229, s[20:23], s17 offen offset:0 lds
    buffer_load_dwordx4 v229, s[20:23], s17 offen offset:1024 lds
    buffer_load_dwordx4 v229, s[20:23], s17 offen offset:2048 lds
    buffer_load_dwordx4 v229, s[20:23], s17 offen offset:3072 lds
    s_waitcnt vmcnt(0)
K3_P2_OK:
    v_mov_b32 v192, v229
    v_add_u32 v193, 0x10000, v229
    v_add_u32 v194, 0x20000, v229
    s_sub_u32 s16, s29, 524288
    s_xor_b32 s16, s16, 3968
    v_mov_b32 v205, s16
    s_lshr_b32 s38, s19, 2
    s_sub_u32 s16, 31, s41
    v_sub_u32 v206, s16, v253
    v_lshlrev_b32 v206, 7, v206
    v_mov_b32 v207, 0x80000000
    v_cmp_gt_u32 vcc, 2, v253
    s_nop 1
    v_cndmask_b32 v206, v207, v206, vcc
    s_cmp_eq_u32 s40, 0
    s_cselect_b32 s36, s97, 0x70000000
    s_add_u32 s16, s12, 65536
    buffer_load_dwordx4 a[128:131], v229, s[20:23], s16 offen offset:0
    buffer_load_dwordx4 a[132:135], v229, s[20:23], s16 offen offset:1024
    s_add_u32 s16, s12, 67584
    buffer_load_dwordx4 a[136:139], v229, s[20:23], s16 offen offset:0
    buffer_load_dwordx4 a[140:143], v229, s[20:23], s16 offen offset:1024
    s_add_u32 s16, s12, 73728
    buffer_load_dwordx4 a[144:147], v229, s[20:23], s16 offen offset:0
    buffer_load_dwordx4 a[148:151], v229, s[20:23], s16 offen offset:1024
    s_add_u32 s16, s12, 75776
    buffer_load_dwordx4 a[152:155], v229, s[20:23], s16 offen offset:0
    buffer_load_dwordx4 a[156:159], v229, s[20:23], s16 offen offset:1024
    s_waitcnt vmcnt(14)
    s_waitcnt lgkmcnt(0)
    s_barrier
    ds_read_b128 v[64:67], v194 offset:0
    ds_read_b128 v[68:71], v193 offset:32768
    ds_read_b128 v[72:75], v194 offset:1024
    ds_read_b128 v[76:79], v193 offset:33792
    ds_read_b128 v[80:83], v194 offset:2048
    ds_read_b128 v[84:87], v193 offset:34816
    ds_read_b128 v[88:91], v194 offset:3072
    ds_read_b128 v[92:95], v193 offset:35840
    s_waitcnt lgkmcnt(7)
    v_mfma_f32_16x16x32_bf16 v[16:19], a[0:3], v[64:67], 0
    ds_read_b128 v[96:99], v194 offset:4096
    s_add_u32 s17, s9, 16384
    s_add_u32 m0, s46, 147456
    v_mfma_f32_16x16x32_bf16 v[20:23], a[4:7], v[64:67], 0
    buffer_load_dwordx4 v229, s[20:23], s17 offen offset:0 lds
    s_waitcnt lgkmcnt(7)
    v_mfma_f32_16x16x32_bf16 v[32:35], a[0:3], v[68:71], 0
    ds_read_b128 v[100:103], v193 offset:36864
    s_lshl_b32 s41, s10, 2
    v_mfma_f32_16x16x32_bf16 v[36:39], a[4:7], v[68:71], 0
    buffer_load_dwordx4 v229, s[20:23], s17 offen offset:1024 lds
    s_waitcnt lgkmcnt(7)
    v_mfma_f32_16x16x32_bf16 v[16:19], a[8:11], v[72:75], v[16:19]
    ds_read_b128 v[104:107], v194 offset:5120
    s_lshr_b32 s28, s11, 1
    v_mfma_f32_16x16x32_bf16 v[20:23], a[12:15], v[72:75], v[20:23]
    buffer_load_dwordx4 v229, s[20:23], s17 offen offset:2048 lds
    s_waitcnt lgkmcnt(7)
    v_mfma_f32_16x16x32_bf16 v[32:35], a[8:11], v[76:79], v[32:35]
    ds_read_b128 v[108:111], v193 offset:37888
    s_add_u32 s41, s41, s28
    v_mfma_f32_16x16x32_bf16 v[36:39], a[12:15], v[76:79], v[36:39]
    buffer_load_dwordx4 v229, s[20:23], s17 offen offset:3072 lds
    s_waitcnt lgkmcnt(7)
    v_mfma_f32_16x16x32_bf16 v[16:19], a[16:19], v[80:83], v[16:19]
    ds_read_b128 v[64:67], v194 offset:6144
    s_add_u32 s16, s12, 81920
    v_mfma_f32_16x16x32_bf16 v[20:23], a[20:23], v[80:83], v[20:23]
    buffer_load_dwordx4 a[160:163], v229, s[20:23], s16 offen offset:0
    s_waitcnt lgkmcnt(7)
    v_mfma_f32_16x16x32_bf16 v[32:35], a[16:19], v[84:87], v[32:35]
    ds_read_b128 v[68:71], v193 offset:38912
    s_mul_i32 s28, s41, 196608
    v_mfma_f32_16x16x32_bf16 v[36:39], a[20:23], v[84:87], v[36:39]
    buffer_load_dwordx4 a[164:167], v229, s[20:23], s16 offen offset:1024
    s_waitcnt vmcnt(15)
    s_waitcnt vmcnt(14)
    v_cmp_gt_u32 vcc, s19, v251
    s_nop 0
    s_cbranch_vccz K3_P3_OK
K3_P3:
    s_sleep 4
    buffer_load_dword v251, v250, s[20:23], s18 offen sc1
    s_waitcnt vmcnt(0)
    v_cmp_gt_u32 vcc, s19, v251
    s_nop 0
    s_cbranch_vccz K3_P3_OK
    s_branch K3_P3
K3_P3_OK:
    s_barrier
    buffer_atomic_add v249, v206, s[20:23], s36 offen sc1
    s_waitcnt lgkmcnt(7)
    v_mfma_f32_16x16x32_bf16 v[16:19], a[24:27], v[88:91], v[16:19]
    ds_read_b128 v[72:75], v194 offset:7168
    s_add_u32 s16, s12, 83968
    v_mfma_f32_16x16x32_bf16 v[20:23], a[28:31], v[88:91], v[20:23]
    buffer_load_dwordx4 a[168:171], v229, s[20:23], s16 offen offset:0
    s_waitcnt lgkmcnt(7)
    v_mfma_f32_16x16x32_bf16 v[32:35], a[24:27], v[92:95], v[32:35]
    ds_read_b128 v[76:79], v193 offset:39936
    s_add_u32 s28, s28, s46
    v_mfma_f32_16x16x32_bf16 v[36:39], a[28:31], v[92:95], v[36:39]
    buffer_load_dwordx4 a[172:175], v229, s[20:23], s16 offen offset:1024
    s_waitcnt lgkmcnt(7)
    v_mfma_f32_16x16x32_bf16 v[16:19], a[32:35], v[96:99], v[16:19]
    ds_read_b128 v[80:83], v194 offset:8192
    s_add_u32 s16, s12, 90112
    v_mfma_f32_16x16x32_bf16 v[20:23], a[36:39], v[96:99], v[20:23]
    buffer_load_dwordx4 a[176:179], v229, s[20:23], s16 offen offset:0
    s_waitcnt lgkmcnt(7)
    v_mfma_f32_16x16x32_bf16 v[32:35], a[32:35], v[100:103], v[32:35]
    ds_read_b128 v[84:87], v193 offset:40960
    s_add_u32 s28, s28, 104857600
    v_mfma_f32_16x16x32_bf16 v[36:39], a[36:39], v[100:103], v[36:39]
    buffer_load_dwordx4 a[180:183], v229, s[20:23], s16 offen offset:1024
    s_waitcnt lgkmcnt(7)
    v_mfma_f32_16x16x32_bf16 v[16:19], a[40:43], v[104:107], v[16:19]
    ds_read_b128 v[88:91], v194 offset:9216
    s_add_u32 s16, s12, 92160
    v_mfma_f32_16x16x32_bf16 v[20:23], a[44:47], v[104:107], v[20:23]
    buffer_load_dwordx4 a[184:187], v229, s[20:23], s16 offen offset:0
    s_waitcnt lgkmcnt(7)
    v_mfma_f32_16x16x32_bf16 v[32:35], a[40:43], v[108:111], v[32:35]
    ds_read_b128 v[92:95], v193 offset:41984
    s_mul_i32 s45, s13, 49152
    v_mfma_f32_16x16x32_bf16 v[36:39], a[44:47], v[108:111], v[36:39]
    buffer_load_dwordx4 a[188:191], v229, s[20:23], s16 offen offset:1024
    s_waitcnt lgkmcnt(7)
    v_mfma_f32_16x16x32_bf16 v[16:19], a[48:51], v[64:67], v[16:19]
    ds_read_b128 v[96:99], v194 offset:10240
    s_add_u32 s17, s14, 16384
    s_add_u32 m0, s46, 65536
    v_mfma_f32_16x16x32_bf16 v[20:23], a[52:55], v[64:67], v[20:23]
    buffer_load_dwordx4 v229, s[20:23], s17 offen offset:0 lds
    s_waitcnt lgkmcnt(7)
    v_mfma_f32_16x16x32_bf16 v[32:35], a[48:51], v[68:71], v[32:35]
    ds_read_b128 v[100:103], v193 offset:43008
    s_add_u32 s45, s45, s28
    v_mfma_f32_16x16x32_bf16 v[36:39], a[52:55], v[68:71], v[36:39]
    buffer_load_dwordx4 v229, s[20:23], s17 offen offset:1024 lds
    s_waitcnt lgkmcnt(7)
    v_mfma_f32_16x16x32_bf16 v[16:19], a[56:59], v[72:75], v[16:19]
    ds_read_b128 v[104:107], v194 offset:11264
    s_add_u32 s42, s13, 1
    v_mfma_f32_16x16x32_bf16 v[20:23], a[60:63], v[72:75], v[20:23]
    buffer_load_dwordx4 v229, s[20:23], s17 offen offset:2048 lds
    s_waitcnt lgkmcnt(7)
    v_mfma_f32_16x16x32_bf16 v[32:35], a[56:59], v[76:79], v[32:35]
    ds_read_b128 v[108:111], v193 offset:44032
    s_and_b32 s42, s42, 3
    v_mfma_f32_16x16x32_bf16 v[36:39], a[60:63], v[76:79], v[36:39]
    buffer_load_dwordx4 v229, s[20:23], s17 offen offset:3072 lds
    s_waitcnt lgkmcnt(7)
    v_mfma_f32_16x16x32_bf16 v[16:19], a[64:67], v[80:83], v[16:19]
    ds_read_b128 v[64:67], v194 offset:12288
    s_add_u32 s16, s12, 98304
    v_mfma_f32_16x16x32_bf16 v[20:23], a[68:71], v[80:83], v[20:23]
    buffer_load_dwordx4 a[192:195], v229, s[20:23], s16 offen offset:0
    s_waitcnt lgkmcnt(7)
    v_mfma_f32_16x16x32_bf16 v[32:35], a[64:67], v[84:87], v[32:35]
    ds_read_b128 v[68:71], v193 offset:45056
    s_mul_i32 s42, s42, 49152
    v_mfma_f32_16x16x32_bf16 v[36:39], a[68:71], v[84:87], v[36:39]
    buffer_load_dwordx4 a[196:199], v229, s[20:23], s16 offen offset:1024
    s_waitcnt lgkmcnt(7)
    v_mfma_f32_16x16x32_bf16 v[16:19], a[72:75], v[88:91], v[16:19]
    ds_read_b128 v[72:75], v194 offset:13312
    s_add_u32 s16, s12, 100352
    v_mfma_f32_16x16x32_bf16 v[20:23], a[76:79], v[88:91], v[20:23]
    buffer_load_dwordx4 a[200:203], v229, s[20:23], s16 offen offset:0
    s_waitcnt lgkmcnt(7)
    v_mfma_f32_16x16x32_bf16 v[32:35], a[72:75], v[92:95], v[32:35]
    ds_read_b128 v[76:79], v193 offset:46080
    s_add_u32 s42, s42, s28
    v_mfma_f32_16x16x32_bf16 v[36:39], a[76:79], v[92:95], v[36:39]
    buffer_load_dwordx4 a[204:207], v229, s[20:23], s16 offen offset:1024
    s_waitcnt lgkmcnt(7)
    v_mfma_f32_16x16x32_bf16 v[16:19], a[80:83], v[96:99], v[16:19]
    ds_read_b128 v[80:83], v194 offset:14336
    s_add_u32 s16, s12, 106496
    v_mfma_f32_16x16x32_bf16 v[20:23], a[84:87], v[96:99], v[20:23]
    buffer_load_dwordx4 a[208:211], v229, s[20:23], s16 offen offset:0
    s_waitcnt lgkmcnt(7)
    v_mfma_f32_16x16x32_bf16 v[32:35], a[80:83], v[100:103], v[32:35]
    ds_read_b128 v[84:87], v193 offset:47104
    s_add_u32 s42, s42, 0
    v_mfma_f32_16x16x32_bf16 v[36:39], a[84:87], v[100:103], v[36:39]
    buffer_load_dwordx4 a[212:215], v229, s[20:23], s16 offen offset:1024
    s_waitcnt lgkmcnt(7)
    v_mfma_f32_16x16x32_bf16 v[16:19], a[88:91], v[104:107], v[16:19]
    ds_read_b128 v[88:91], v194 offset:15360
    s_add_u32 s16, s12, 108544
    v_mfma_f32_16x16x32_bf16 v[20:23], a[92:95], v[104:107], v[20:23]
    buffer_load_dwordx4 a[216:219], v229, s[20:23], s16 offen offset:0
    s_waitcnt lgkmcnt(7)
    v_mfma_f32_16x16x32_bf16 v[32:35], a[88:91], v[108:111], v[32:35]
    ds_read_b128 v[92:95], v193 offset:48128
    s_add_u32 s43, s13, 2
    v_mfma_f32_16x16x32_bf16 v[36:39], a[92:95], v[108:111], v[36:39]
    buffer_load_dwordx4 a[220:223], v229, s[20:23], s16 offen offset:1024
    s_waitcnt vmcnt(21)
    s_barrier
    s_waitcnt lgkmcnt(7)
    v_mfma_f32_16x16x32_bf16 v[16:19], a[96:99], v[64:67], v[16:19]
    ds_read_b128 v[96:99], v193 offset:49152
    buffer_load_dword v195, v205, s[20:23], s18 offen sc1
    s_add_u32 s16, s12, 114688
    v_mfma_f32_16x16x32_bf16 v[20:23], a[100:103], v[64:67], v[20:23]
    buffer_load_dwordx4 a[224:227], v229, s[20:23], s16 offen offset:0
    s_waitcnt lgkmcnt(7)
    v_mfma_f32_16x16x32_bf16 v[32:35], a[96:99], v[68:71], v[32:35]
    ds_read_b128 v[100:103], v194 offset:16384
    s_and_b32 s43, s43, 3
    v_mfma_f32_16x16x32_bf16 v[36:39], a[100:103], v[68:71], v[36:39]
    buffer_load_dwordx4 a[228:231], v229, s[20:23], s16 offen offset:1024
    s_waitcnt lgkmcnt(7)
    v_mfma_f32_16x16x32_bf16 v[16:19], a[104:107], v[72:75], v[16:19]
    ds_read_b128 v[104:107], v193 offset:50176
    s_add_u32 s16, s12, 116736
    v_mfma_f32_16x16x32_bf16 v[20:23], a[108:111], v[72:75], v[20:23]
    buffer_load_dwordx4 a[232:235], v229, s[20:23], s16 offen offset:0
    s_waitcnt lgkmcnt(7)
    v_mfma_f32_16x16x32_bf16 v[32:35], a[104:107], v[76:79], v[32:35]
    ds_read_b128 v[108:111], v194 offset:17408
    s_mul_i32 s43, s43, 49152
    v_mfma_f32_16x16x32_bf16 v[36:39], a[108:111], v[76:79], v[36:39]
    buffer_load_dwordx4 a[236:239], v229, s[20:23], s16 offen offset:1024
    s_waitcnt lgkmcnt(7)
    v_mfma_f32_16x16x32_bf16 v[16:19], a[112:115], v[80:83], v[16:19]
    ds_read_b128 v[64:67], v193 offset:51200
    s_add_u32 s16, s12, 122880
    v_mfma_f32_16x16x32_bf16 v[20:23], a[116:119], v[80:83], v[20:23]
    buffer_load_dwordx4 a[240:243], v229, s[20:23], s16 offen offset:0
    s_waitcnt lgkmcnt(7)
    v_mfma_f32_16x16x32_bf16 v[32:35], a[112:115], v[84:87], v[32:35]
    ds_read_b128 v[68:71], v194 offset:18432
    s_add_u32 s43, s43, s28
    v_mfma_f32_16x16x32_bf16 v[36:39], a[116:119], v[84:87], v[36:39]
    buffer_load_dwordx4 a[244:247], v229, s[20:23], s16 offen offset:1024
    s_waitcnt lgkmcnt(7)
    v_mfma_f32_16x16x32_bf16 v[16:19], a[120:123], v[88:91], v[16:19]
    ds_read_b128 v[72:75], v193 offset:52224
    s_add_u32 s16, s12, 124928
    v_mfma_f32_16x16x32_bf16 v[20:23], a[124:127], v[88:91], v[20:23]
    buffer_load_dwordx4 a[248:251], v229, s[20:23], s16 offen offset:0
    s_waitcnt lgkmcnt(7)
    v_mfma_f32_16x16x32_bf16 v[32:35], a[120:123], v[92:95], v[32:35]
    ds_read_b128 v[76:79], v194 offset:19456
    s_add_u32 s43, s43, 16384
    v_mfma_f32_16x16x32_bf16 v[36:39], a[124:127], v[92:95], v[36:39]
    buffer_load_dwordx4 a[252:255], v229, s[20:23], s16 offen offset:1024
    s_waitcnt lgkmcnt(7)
    v_mfma_f32_16x16x32_bf16 v[48:51], a[0:3], v[96:99], 0
    ds_read_b128 v[80:83], v193 offset:53248
    s_add_u32 s17, s15, 16384
    s_add_u32 m0, s46, 81920
    v_mfma_f32_16x16x32_bf16 v[52:55], a[4:7], v[96:99], 0
    buffer_load_dwordx4 v229, s[20:23], s17 offen offset:0 lds
    s_waitcnt lgkmcnt(7)
    v_mfma_f32_16x16x32_bf16 v[16:19], a[128:131], v[100:103], v[16:19]
    ds_read_b128 v[84:87], v194 offset:20480
    s_add_u32 s44, s13, 3
    v_mfma_f32_16x16x32_bf16 v[20:23], a[132:135], v[100:103], v[20:23]
    s_and_b32 s44, s44, 3
    s_waitcnt lgkmcnt(7)
    v_mfma_f32_16x16x32_bf16 v[48:51], a[8:11], v[104:107], v[48:51]
    ds_read_b128 v[88:91], v193 offset:54272
    s_mul_i32 s44, s44, 49152
    v_mfma_f32_16x16x32_bf16 v[52:55], a[12:15], v[104:107], v[52:55]
    buffer_load_dwordx4 v229, s[20:23], s17 offen offset:1024 lds
    s_waitcnt lgkmcnt(7)
    v_mfma_f32_16x16x32_bf16 v[16:19], a[136:139], v[108:111], v[16:19]
    ds_read_b128 v[92:95], v194 offset:21504
    s_add_u32 s44, s44, s28
    v_mfma_f32_16x16x32_bf16 v[20:23], a[140:143], v[108:111], v[20:23]
    s_add_u32 s44, s44, 32768
    s_waitcnt lgkmcnt(7)
    v_mfma_f32_16x16x32_bf16 v[48:51], a[16:19], v[64:67], v[48:51]
    ds_read_b128 v[96:99], v193 offset:55296
    s_add_u32 s41, s41, 192
    v_mfma_f32_16x16x32_bf16 v[52:55], a[20:23], v[64:67], v[52:55]
    buffer_load_dwordx4 v229, s[20:23], s17 offen offset:2048 lds
    s_waitcnt lgkmcnt(7)
    v_mfma_f32_16x16x32_bf16 v[16:19], a[144:147], v[68:71], v[16:19]
    ds_read_b128 v[100:103], v194 offset:22528
    s_lshl_b32 s41, s41, 8
    v_mfma_f32_16x16x32_bf16 v[20:23], a[148:151], v[68:71], v[20:23]
    v_mov_b32 v204, s41
    s_waitcnt lgkmcnt(7)
    v_mfma_f32_16x16x32_bf16 v[48:51], a[24:27], v[72:75], v[48:51]
    ds_read_b128 v[104:107], v193 offset:56320
    s_add_u32 s41, s41, 524288
    v_mfma_f32_16x16x32_bf16 v[52:55], a[28:31], v[72:75], v[52:55]
    buffer_load_dwordx4 v229, s[20:23], s17 offen offset:3072 lds
    s_waitcnt lgkmcnt(7)
    v_mfma_f32_16x16x32_bf16 v[16:19], a[152:155], v[76:79], v[16:19]
    ds_read_b128 v[108:111], v194 offset:23552
    s_cmp_eq_u32 s40, 0
    s_cselect_b32 s41, s41, 0x70000000
    v_mfma_f32_16x16x32_bf16 v[20:23], a[156:159], v[76:79], v[20:23]
    v_mov_b32 v250, v204
    s_waitcnt vmcnt(12)
    v_cmp_gt_u32 vcc, s38, v195
    s_nop 0
    s_cbranch_vccz K3_PL_OK
K3_PL:
    s_sleep 2
    buffer_load_dword v195, v205, s[20:23], s18 offen sc1
    s_waitcnt vmcnt(0)
    v_cmp_gt_u32 vcc, s38, v195
    s_nop 0
    s_cbranch_vccz K3_PL_OK
    s_branch K3_PL
K3_PL_OK:
    s_barrier
    s_waitcnt lgkmcnt(7)
    v_mfma_f32_16x16x32_bf16 v[48:51], a[32:35], v[80:83], v[48:51]
    ds_read_b128 v[64:67], v193 offset:57344
    s_add_u32 s17, s9, s39
    s_add_u32 m0, s46, 0
    v_mfma_f32_16x16x32_bf16 v[52:55], a[36:39], v[80:83], v[52:55]
    buffer_load_dwordx4 v229, s[20:23], s17 offen offset:0 lds
    s_waitcnt lgkmcnt(7)
    v_mfma_f32_16x16x32_bf16 v[16:19], a[160:163], v[84:87], v[16:19]
    ds_read_b128 v[68:71], v194 offset:24576
    s_lshr_b32 s19, s19, 3
    v_mfma_f32_16x16x32_bf16 v[20:23], a[164:167], v[84:87], v[20:23]
    s_and_b32 s49, s2, 1
    s_waitcnt lgkmcnt(7)
    v_mfma_f32_16x16x32_bf16 v[48:51], a[40:43], v[88:91], v[48:51]
    ds_read_b128 v[72:75], v193 offset:58368
    s_mul_i32 s49, s49, 30
    v_mfma_f32_16x16x32_bf16 v[52:55], a[44:47], v[88:91], v[52:55]
    buffer_load_dwordx4 v229, s[20:23], s17 offen offset:1024 lds
    s_waitcnt lgkmcnt(7)
    v_mfma_f32_16x16x32_bf16 v[16:19], a[168:171], v[92:95], v[16:19]
    ds_read_b128 v[76:79], v194 offset:25600
    s_lshr_b32 s50, s2, 3
    v_mfma_f32_16x16x32_bf16 v[20:23], a[172:175], v[92:95], v[20:23]
    s_add_u32 s49, s49, s50
    s_waitcnt lgkmcnt(7)
    v_mfma_f32_16x16x32_bf16 v[48:51], a[48:51], v[96:99], v[48:51]
    ds_read_b128 v[80:83], v193 offset:59392
    s_lshr_b32 s48, s49, 2
    v_mfma_f32_16x16x32_bf16 v[52:55], a[52:55], v[96:99], v[52:55]
    buffer_load_dwordx4 v229, s[20:23], s17 offen offset:2048 lds
    s_waitcnt lgkmcnt(7)
    v_mfma_f32_16x16x32_bf16 v[16:19], a[176:179], v[100:103], v[16:19]
    ds_read_b128 v[84:87], v194 offset:26624
    s_and_b32 s47, s49, 1
    v_mfma_f32_16x16x32_bf16 v[20:23], a[180:183], v[100:103], v[20:23]
    s_and_b32 s49, s49, 2
    s_waitcnt lgkmcnt(7)
    v_mfma_f32_16x16x32_bf16 v[48:51], a[56:59], v[104:107], v[48:51]
    ds_read_b128 v[88:91], v193 offset:60416
    s_lshl_b32 s49, s49, 2
    v_mfma_f32_16x16x32_bf16 v[52:55], a[60:63], v[104:107], v[52:55]
    buffer_load_dwordx4 v229, s[20:23], s17 offen offset:3072 lds
    s_waitcnt lgkmcnt(7)
    v_mfma_f32_16x16x32_bf16 v[16:19], a[184:187], v[108:111], v[16:19]
    ds_read_b128 v[92:95], v194 offset:27648
    s_add_u32 s47, s47, s49
    v_mfma_f32_16x16x32_bf16 v[20:23], a[188:191], v[108:111], v[20:23]
    s_and_b32 s50, s2, 6
    s_waitcnt lgkmcnt(7)
    v_mfma_f32_16x16x32_bf16 v[48:51], a[64:67], v[64:67], v[48:51]
    ds_read_b128 v[96:99], v193 offset:61440
    s_add_u32 s17, s9, s39
    s_add_u32 s17, s17, 16384
    s_add_u32 m0, s46, 16384
    v_mfma_f32_16x16x32_bf16 v[52:55], a[68:71], v[64:67], v[52:55]
    buffer_load_dwordx4 v229, s[20:23], s17 offen offset:0 lds
    s_waitcnt lgkmcnt(7)
    v_mfma_f32_16x16x32_bf16 v[16:19], a[192:195], v[68:71], v[16:19]
    ds_read_b128 v[100:103], v194 offset:28672
    s_add_u32 s47, s47, s50
    v_mfma_f32_16x16x32_bf16 v[20:23], a[196:199], v[68:71], v[20:23]
    s_lshl_b32 s67, s47, 7
    s_waitcnt lgkmcnt(7)
    v_mfma_f32_16x16x32_bf16 v[48:51], a[72:75], v[72:75], v[48:51]
    ds_read_b128 v[104:107], v193 offset:62464
    s_mul_i32 s59, s67, 3
    v_mfma_f32_16x16x32_bf16 v[52:55], a[76:79], v[72:75], v[52:55]
    buffer_load_dwordx4 v229, s[20:23], s17 offen offset:1024 lds
    s_waitcnt lgkmcnt(7)
    v_mfma_f32_16x16x32_bf16 v[16:19], a[200:203], v[76:79], v[16:19]
    ds_read_b128 v[108:111], v194 offset:29696
    s_add_u32 s59, s59, 540672
    v_mfma_f32_16x16x32_bf16 v[20:23], a[204:207], v[76:79], v[20:23]
    s_add_u32 s67, s67, 538624
    s_waitcnt lgkmcnt(7)
    v_mfma_f32_16x16x32_bf16 v[48:51], a[80:83], v[80:83], v[48:51]
    ds_read_b128 v[64:67], v193 offset:63488
    s_cmp_eq_u32 s40, 0
    s_cselect_b32 s59, s59, 0xf0000000
    v_mfma_f32_16x16x32_bf16 v[52:55], a[84:87], v[80:83], v[52:55]
    buffer_load_dwordx4 v229, s[20:23], s17 offen offset:2048 lds
    s_waitcnt lgkmcnt(7)
    v_mfma_f32_16x16x32_bf16 v[16:19], a[208:211], v[84:87], v[16:19]
    ds_read_b128 v[68:71], v194 offset:30720
    s_cmp_eq_u32 s40, 1
    s_cselect_b32 s67, s67, 0xf0000000
    s_cselect_b32 s66, 16, 0
    v_mfma_f32_16x16x32_bf16 v[20:23], a[212:215], v[84:87], v[20:23]
    s_lshl_b32 s47, s47, 2
    s_waitcnt lgkmcnt(7)
    v_mfma_f32_16x16x32_bf16 v[48:51], a[88:91], v[88:91], v[48:51]
    ds_read_b128 v[72:75], v193 offset:64512
    s_add_u32 s47, s47, s40
    v_mfma_f32_16x16x32_bf16 v[52:55], a[92:95], v[88:91], v[52:55]
    buffer_load_dwordx4 v229, s[20:23], s17 offen offset:3072 lds
    s_waitcnt lgkmcnt(7)
    v_mfma_f32_16x16x32_bf16 v[16:19], a[216:219], v[92:95], v[16:19]
    ds_read_b128 v[76:79], v194 offset:31744
    s_lshl_b32 s52, s47, 15
    v_mfma_f32_16x16x32_bf16 v[20:23], a[220:223], v[92:95], v[20:23]
    s_add_u32 s52, s52, 67108864
    s_waitcnt vmcnt(8)
    s_barrier
    s_waitcnt lgkmcnt(7)
    v_mfma_f32_16x16x32_bf16 v[48:51], a[96:99], v[96:99], v[48:51]
    ds_read_b128 v[80:83], v193 offset:0
    s_add_u32 s17, s14, s39
    s_add_u32 m0, s46, 32768
    v_mfma_f32_16x16x32_bf16 v[52:55], a[100:103], v[96:99], v[52:55]
    buffer_load_dwordx4 v229, s[20:23], s17 offen offset:0 lds
    s_waitcnt lgkmcnt(7)
    v_mfma_f32_16x16x32_bf16 v[16:19], a[224:227], v[100:103], v[16:19]
    ds_read_b128 v[84:87], v193 offset:16384
    s_mul_i32 s51, s48, 196608
    v_mfma_f32_16x16x32_bf16 v[20:23], a[228:231], v[100:103], v[20:23]
    s_add_u32 s51, s51, s46
    s_waitcnt lgkmcnt(7)
    v_mfma_f32_16x16x32_bf16 v[48:51], a[104:107], v[104:107], v[48:51]
    ds_read_b128 v[88:91], v193 offset:1024
    s_add_u32 s51, s51, 83886080
    v_mfma_f32_16x16x32_bf16 v[52:55], a[108:111], v[104:107], v[52:55]
    s_cmp_ge_u32 s2, 240
    s_cselect_b32 s51, 0xf0000000, s51
    s_waitcnt lgkmcnt(7)
    v_mfma_f32_16x16x32_bf16 v[16:19], a[232:235], v[108:111], v[16:19]
    ds_read_b128 v[92:95], v193 offset:17408
    s_cmp_ge_u32 s48, 14
    s_cselect_b32 s56, 0xf0000000, s51
    v_mfma_f32_16x16x32_bf16 v[20:23], a[236:239], v[108:111], v[20:23]
    s_lshl_b32 s57, s47, 8
    s_waitcnt lgkmcnt(7)
    v_mfma_f32_16x16x32_bf16 v[48:51], a[112:115], v[64:67], v[48:51]
    ds_read_b128 v[96:99], v193 offset:2048
    s_add_u32 s57, s57, 69206016
    v_mfma_f32_16x16x32_bf16 v[52:55], a[116:119], v[64:67], v[52:55]
    buffer_load_dwordx4 v229, s[20:23], s17 offen offset:1024 lds
    s_waitcnt lgkmcnt(7)
    v_mfma_f32_16x16x32_bf16 v[16:19], a[240:243], v[68:71], v[16:19]
    ds_read_b128 v[100:103], v193 offset:18432
    s_mul_i32 s58, s48, 384
    v_mfma_f32_16x16x32_bf16 v[20:23], a[244:247], v[68:71], v[20:23]
    s_add_u32 s58, s58, 262144
    s_waitcnt lgkmcnt(7)
    v_mfma_f32_16x16x32_bf16 v[48:51], a[120:123], v[72:75], v[48:51]
    ds_read_b128 v[104:107], v193 offset:3072
    s_mul_i32 s53, s47, 92160
    v_mfma_f32_16x16x32_bf16 v[52:55], a[124:127], v[72:75], v[52:55]
    s_mul_i32 s49, s48, 3072
    s_waitcnt lgkmcnt(7)
    v_mfma_f32_16x16x32_bf16 v[16:19], a[248:251], v[76:79], v[16:19]
    ds_read_b128 v[108:111], v193 offset:19456
    s_add_u32 s53, s53, s49
    v_mfma_f32_16x16x32_bf16 v[20:23], a[252:255], v[76:79], v[20:23]
    s_add_u32 s53, s53, 71303168
    s_waitcnt lgkmcnt(7)
    v_mfma_f32_16x16x32_bf16 v[32:35], a[128:131], v[80:83], v[32:35]
    ds_read_b128 v[64:67], v193 offset:4096
    v_and_b32 v184, 31, v253
    v_mfma_f32_16x16x32_bf16 v[36:39], a[132:135], v[80:83], v[36:39]
    buffer_load_dwordx4 v229, s[20:23], s17 offen offset:2048 lds
    s_waitcnt lgkmcnt(7)
    v_mfma_f32_16x16x32_bf16 v[48:51], a[128:131], v[84:87], v[48:51]
    ds_read_b128 v[68:71], v193 offset:20480
    v_lshlrev_b32 v179, 3, v184
    v_mfma_f32_16x16x32_bf16 v[52:55], a[132:135], v[84:87], v[52:55]
    v_lshrrev_b32 v185, 5, v253
    s_waitcnt lgkmcnt(7)
    v_mfma_f32_16x16x32_bf16 v[32:35], a[136:139], v[88:91], v[32:35]
    ds_read_b128 v[72:75], v193 offset:5120
    v_mul_u32_u24 v185, 11264, v185
    v_mfma_f32_16x16x32_bf16 v[36:39], a[140:143], v[88:91], v[36:39]
    buffer_store_dwordx4 v[16:19], v229, s[20:23], s42 offen offset:0 sc1
    s_waitcnt lgkmcnt(7)
    v_mfma_f32_16x16x32_bf16 v[48:51], a[136:139], v[92:95], v[48:51]
    ds_read_b128 v[76:79], v193 offset:21504
    v_lshl_add_u32 v185, v184, 2, v185
    v_mfma_f32_16x16x32_bf16 v[52:55], a[140:143], v[92:95], v[52:55]
    s_add_u32 s54, s58, 0
    s_waitcnt lgkmcnt(7)
    v_mfma_f32_16x16x32_bf16 v[32:35], a[144:147], v[96:99], v[32:35]
    ds_read_b128 v[80:83], v193 offset:6144
    v_mfma_f32_16x16x32_bf16 v[36:39], a[148:151], v[96:99], v[36:39]
    buffer_store_dwordx4 v[20:23], v229, s[20:23], s42 offen offset:1024 sc1
    s_waitcnt lgkmcnt(7)
    v_mfma_f32_16x16x32_bf16 v[48:51], a[144:147], v[100:103], v[48:51]
    ds_read_b128 v[84:87], v193 offset:22528
    v_mfma_f32_16x16x32_bf16 v[52:55], a[148:151], v[100:103], v[52:55]
    buffer_load_dwordx4 v229, s[20:23], s17 offen offset:3072 lds
    s_waitcnt lgkmcnt(7)
    v_mfma_f32_16x16x32_bf16 v[32:35], a[152:155], v[104:107], v[32:35]
    ds_read_b128 v[88:91], v193 offset:7168
    v_mfma_f32_16x16x32_bf16 v[36:39], a[156:159], v[104:107], v[36:39]
    buffer_load_dword v144, v185, s[20:23], s54 offen offset:0
    s_waitcnt lgkmcnt(7)
    v_mfma_f32_16x16x32_bf16 v[48:51], a[152:155], v[108:111], v[48:51]
    ds_read_b128 v[92:95], v193 offset:23552
    v_mfma_f32_16x16x32_bf16 v[52:55], a[156:159], v[108:111], v[52:55]
    buffer_load_dword v152, v185, s[20:23], s54 offen offset:128
    s_waitcnt lgkmcnt(7)
    v_mfma_f32_16x16x32_bf16 v[32:35], a[160:163], v[64:67], v[32:35]
    ds_read_b128 v[96:99], v193 offset:8192
    v_mfma_f32_16x16x32_bf16 v[36:39], a[164:167], v[64:67], v[36:39]
    buffer_load_dword v160, v185, s[20:23], s54 offen offset:256
    s_waitcnt lgkmcnt(7)
    v_mfma_f32_16x16x32_bf16 v[48:51], a[160:163], v[68:71], v[48:51]
    ds_read_b128 v[100:103], v193 offset:24576
    s_add_u32 s17, s14, s39
    s_add_u32 s17, s17, 16384
    s_add_u32 m0, s46, 49152
    v_mfma_f32_16x16x32_bf16 v[52:55], a[164:167], v[68:71], v[52:55]
    buffer_load_dwordx4 v229, s[20:23], s17 offen offset:0 lds
    s_waitcnt lgkmcnt(7)
    v_mfma_f32_16x16x32_bf16 v[32:35], a[168:171], v[72:75], v[32:35]
    ds_read_b128 v[104:107], v193 offset:9216
    s_add_u32 s54, s58, 5632
    v_mfma_f32_16x16x32_bf16 v[36:39], a[172:175], v[72:75], v[36:39]
    buffer_load_dword v148, v185, s[20:23], s54 offen offset:0
    s_waitcnt lgkmcnt(7)
    v_mfma_f32_16x16x32_bf16 v[48:51], a[168:171], v[76:79], v[48:51]
    ds_read_b128 v[108:111], v193 offset:25600
    v_mfma_f32_16x16x32_bf16 v[52:55], a[172:175], v[76:79], v[52:55]
    buffer_load_dword v156, v185, s[20:23], s54 offen offset:128
    s_waitcnt lgkmcnt(7)
    v_mfma_f32_16x16x32_bf16 v[32:35], a[176:179], v[80:83], v[32:35]
    ds_read_b128 v[64:67], v193 offset:10240
    v_mfma_f32_16x16x32_bf16 v[36:39], a[180:183], v[80:83], v[36:39]
    buffer_load_dword v164, v185, s[20:23], s54 offen offset:256
    s_waitcnt lgkmcnt(7)
    v_mfma_f32_16x16x32_bf16 v[48:51], a[176:179], v[84:87], v[48:51]
    ds_read_b128 v[68:71], v193 offset:26624
    s_add_u32 s54, s58, 22528
    v_mfma_f32_16x16x32_bf16 v[52:55], a[180:183], v[84:87], v[52:55]
    buffer_load_dwordx4 v229, s[20:23], s17 offen offset:1024 lds
    s_waitcnt lgkmcnt(7)
    v_mfma_f32_16x16x32_bf16 v[32:35], a[184:187], v[88:91], v[32:35]
    ds_read_b128 v[72:75], v193 offset:11264
    v_mfma_f32_16x16x32_bf16 v[36:39], a[188:191], v[88:91], v[36:39]
    buffer_load_dword v145, v185, s[20:23], s54 offen offset:0
    s_waitcnt lgkmcnt(7)
    v_mfma_f32_16x16x32_bf16 v[48:51], a[184:187], v[92:95], v[48:51]
    ds_read_b128 v[76:79], v193 offset:27648
    v_mfma_f32_16x16x32_bf16 v[52:55], a[188:191], v[92:95], v[52:55]
    buffer_load_dword v153, v185, s[20:23], s54 offen offset:128
    s_waitcnt lgkmcnt(7)
    v_mfma_f32_16x16x32_bf16 v[32:35], a[192:195], v[96:99], v[32:35]
    ds_read_b128 v[80:83], v193 offset:12288
    v_mfma_f32_16x16x32_bf16 v[36:39], a[196:199], v[96:99], v[36:39]
    buffer_load_dword v161, v185, s[20:23], s54 offen offset:256
    s_waitcnt lgkmcnt(7)
    v_mfma_f32_16x16x32_bf16 v[48:51], a[192:195], v[100:103], v[48:51]
    ds_read_b128 v[84:87], v193 offset:28672
    s_add_u32 s54, s58, 28160
    v_mfma_f32_16x16x32_bf16 v[52:55], a[196:199], v[100:103], v[52:55]
    buffer_load_dwordx4 v229, s[20:23], s17 offen offset:2048 lds
    s_waitcnt lgkmcnt(7)
    v_mfma_f32_16x16x32_bf16 v[32:35], a[200:203], v[104:107], v[32:35]
    ds_read_b128 v[88:91], v193 offset:13312
    v_mfma_f32_16x16x32_bf16 v[36:39], a[204:207], v[104:107], v[36:39]
    buffer_load_dword v149, v185, s[20:23], s54 offen offset:0
    s_waitcnt lgkmcnt(7)
    v_mfma_f32_16x16x32_bf16 v[48:51], a[200:203], v[108:111], v[48:51]
    ds_read_b128 v[92:95], v193 offset:29696
    v_mfma_f32_16x16x32_bf16 v[52:55], a[204:207], v[108:111], v[52:55]
    buffer_load_dword v157, v185, s[20:23], s54 offen offset:128
    s_waitcnt lgkmcnt(7)
    v_mfma_f32_16x16x32_bf16 v[32:35], a[208:211], v[64:67], v[32:35]
    ds_read_b128 v[96:99], v193 offset:14336
    v_mfma_f32_16x16x32_bf16 v[36:39], a[212:215], v[64:67], v[36:39]
    buffer_load_dword v165, v185, s[20:23], s54 offen offset:256
    s_waitcnt lgkmcnt(7)
    v_mfma_f32_16x16x32_bf16 v[48:51], a[208:211], v[68:71], v[48:51]
    ds_read_b128 v[100:103], v193 offset:30720
    s_add_u32 s54, s58, 45056
    v_mfma_f32_16x16x32_bf16 v[52:55], a[212:215], v[68:71], v[52:55]
    buffer_load_dwordx4 v229, s[20:23], s17 offen offset:3072 lds
    s_waitcnt lgkmcnt(7)
    v_mfma_f32_16x16x32_bf16 v[32:35], a[216:219], v[72:75], v[32:35]
    ds_read_b128 v[104:107], v193 offset:15360
    v_mfma_f32_16x16x32_bf16 v[36:39], a[220:223], v[72:75], v[36:39]
    buffer_load_dword v146, v185, s[20:23], s54 offen offset:0
    s_waitcnt lgkmcnt(7)
    v_mfma_f32_16x16x32_bf16 v[48:51], a[216:219], v[76:79], v[48:51]
    ds_read_b128 v[108:111], v193 offset:31744
    v_mfma_f32_16x16x32_bf16 v[52:55], a[220:223], v[76:79], v[52:55]
    buffer_load_dword v154, v185, s[20:23], s54 offen offset:128
    s_waitcnt vmcnt(24)
    s_barrier
    s_waitcnt lgkmcnt(7)
    v_mfma_f32_16x16x32_bf16 v[32:35], a[224:227], v[80:83], v[32:35]
    ds_read_b128 v[64:67], v192 offset:0
    v_mfma_f32_16x16x32_bf16 v[36:39], a[228:231], v[80:83], v[36:39]
    buffer_load_dword v162, v185, s[20:23], s54 offen offset:256
    s_waitcnt lgkmcnt(7)
    v_mfma_f32_16x16x32_bf16 v[48:51], a[224:227], v[84:87], v[48:51]
    ds_read_b128 v[68:71], v192 offset:16384
    s_add_u32 s17, s15, s39
    s_add_u32 m0, s46, 131072
    v_mfma_f32_16x16x32_bf16 v[52:55], a[228:231], v[84:87], v[52:55]
    buffer_load_dwordx4 v229, s[20:23], s17 offen offset:0 lds
    s_waitcnt lgkmcnt(7)
    v_mfma_f32_16x16x32_bf16 v[32:35], a[232:235], v[88:91], v[32:35]
    ds_read_b128 v[72:75], v192 offset:1024
    s_add_u32 s54, s58, 50688
    v_mfma_f32_16x16x32_bf16 v[36:39], a[236:239], v[88:91], v[36:39]
    buffer_load_dword v150, v185, s[20:23], s54 offen offset:0
    s_waitcnt lgkmcnt(7)
    v_mfma_f32_16x16x32_bf16 v[48:51], a[232:235], v[92:95], v[48:51]
    ds_read_b128 v[76:79], v192 offset:17408
    v_mfma_f32_16x16x32_bf16 v[52:55], a[236:239], v[92:95], v[52:55]
    buffer_load_dword v158, v185, s[20:23], s54 offen offset:128
    s_waitcnt lgkmcnt(7)
    v_mfma_f32_16x16x32_bf16 v[32:35], a[240:243], v[96:99], v[32:35]
    ds_read_b128 v[80:83], v192 offset:2048
    v_mfma_f32_16x16x32_bf16 v[36:39], a[244:247], v[96:99], v[36:39]
    buffer_load_dword v166, v185, s[20:23], s54 offen offset:256
    s_waitcnt lgkmcnt(7)
    v_mfma_f32_16x16x32_bf16 v[48:51], a[240:243], v[100:103], v[48:51]
    ds_read_b128 v[84:87], v192 offset:18432
    s_add_u32 s54, s58, 67584
    v_mfma_f32_16x16x32_bf16 v[52:55], a[244:247], v[100:103], v[52:55]
    buffer_load_dwordx4 v229, s[20:23], s17 offen offset:1024 lds
    s_waitcnt lgkmcnt(7)
    v_mfma_f32_16x16x32_bf16 v[32:35], a[248:251], v[104:107], v[32:35]
    ds_read_b128 v[88:91], v192 offset:3072
    v_mfma_f32_16x16x32_bf16 v[36:39], a[252:255], v[104:107], v[36:39]
    buffer_load_dword v147, v185, s[20:23], s54 offen offset:0
    s_waitcnt lgkmcnt(7)
    v_mfma_f32_16x16x32_bf16 v[48:51], a[248:251], v[108:111], v[48:51]
    ds_read_b128 v[92:95], v192 offset:19456
    v_mfma_f32_16x16x32_bf16 v[52:55], a[252:255], v[108:111], v[52:55]
    buffer_load_dword v155, v185, s[20:23], s54 offen offset:128
    s_waitcnt lgkmcnt(7)
    v_mfma_f32_16x16x32_bf16 v[24:27], a[0:3], v[64:67], 0
    ds_read_b128 v[96:99], v192 offset:4096
    v_mfma_f32_16x16x32_bf16 v[28:31], a[4:7], v[64:67], 0
    buffer_load_dword v163, v185, s[20:23], s54 offen offset:256
    s_waitcnt lgkmcnt(7)
    v_mfma_f32_16x16x32_bf16 v[24:27], a[128:131], v[68:71], v[24:27]
    ds_read_b128 v[100:103], v192 offset:20480
    s_add_u32 s54, s58, 73216
    v_mfma_f32_16x16x32_bf16 v[28:31], a[132:135], v[68:71], v[28:31]
    buffer_store_dwordx4 v[32:35], v229, s[20:23], s43 offen offset:0 sc1
    s_waitcnt lgkmcnt(7)
    v_mfma_f32_16x16x32_bf16 v[24:27], a[8:11], v[72:75], v[24:27]
    ds_read_b128 v[104:107], v192 offset:5120
    v_mfma_f32_16x16x32_bf16 v[28:31], a[12:15], v[72:75], v[28:31]
    buffer_load_dwordx4 v229, s[20:23], s17 offen offset:2048 lds
    s_waitcnt lgkmcnt(7)
    v_mfma_f32_16x16x32_bf16 v[24:27], a[136:139], v[76:79], v[24:27]
    ds_read_b128 v[108:111], v192 offset:21504
    v_mfma_f32_16x16x32_bf16 v[28:31], a[140:143], v[76:79], v[28:31]
    buffer_store_dwordx4 v[36:39], v229, s[20:23], s43 offen offset:1024 sc1
    s_waitcnt lgkmcnt(7)
    v_mfma_f32_16x16x32_bf16 v[24:27], a[16:19], v[80:83], v[24:27]
    ds_read_b128 v[64:67], v192 offset:6144
    v_mfma_f32_16x16x32_bf16 v[28:31], a[20:23], v[80:83], v[28:31]
    buffer_load_dword v151, v185, s[20:23], s54 offen offset:0
    s_waitcnt lgkmcnt(7)
    v_mfma_f32_16x16x32_bf16 v[24:27], a[144:147], v[84:87], v[24:27]
    ds_read_b128 v[68:71], v192 offset:22528
    v_mfma_f32_16x16x32_bf16 v[28:31], a[148:151], v[84:87], v[28:31]
    buffer_store_dwordx4 v[48:51], v229, s[20:23], s44 offen offset:0 sc1
    s_waitcnt lgkmcnt(7)
    v_mfma_f32_16x16x32_bf16 v[24:27], a[24:27], v[88:91], v[24:27]
    ds_read_b128 v[72:75], v192 offset:7168
    v_mfma_f32_16x16x32_bf16 v[28:31], a[28:31], v[88:91], v[28:31]
    buffer_load_dwordx4 v229, s[20:23], s17 offen offset:3072 lds
    s_waitcnt lgkmcnt(7)
    v_mfma_f32_16x16x32_bf16 v[24:27], a[152:155], v[92:95], v[24:27]
    ds_read_b128 v[76:79], v192 offset:23552
    v_mfma_f32_16x16x32_bf16 v[28:31], a[156:159], v[92:95], v[28:31]
    buffer_store_dwordx4 v[52:55], v229, s[20:23], s44 offen offset:1024 sc1
    s_waitcnt lgkmcnt(7)
    v_mfma_f32_16x16x32_bf16 v[24:27], a[32:35], v[96:99], v[24:27]
    ds_read_b128 v[80:83], v192 offset:8192
    v_mfma_f32_16x16x32_bf16 v[28:31], a[36:39], v[96:99], v[28:31]
    buffer_load_dword v159, v185, s[20:23], s54 offen offset:128
    s_waitcnt lgkmcnt(7)
    v_mfma_f32_16x16x32_bf16 v[24:27], a[160:163], v[100:103], v[24:27]
    ds_read_b128 v[84:87], v192 offset:24576
    v_mfma_f32_16x16x32_bf16 v[28:31], a[164:167], v[100:103], v[28:31]
    buffer_load_dword v167, v185, s[20:23], s54 offen offset:256
    s_waitcnt lgkmcnt(7)
    v_mfma_f32_16x16x32_bf16 v[24:27], a[40:43], v[104:107], v[24:27]
    ds_read_b128 v[88:91], v192 offset:9216
    s_add_u32 s17, s15, s39
    s_add_u32 s17, s17, 16384
    s_add_u32 m0, s46, 98304
    v_mfma_f32_16x16x32_bf16 v[28:31], a[44:47], v[104:107], v[28:31]
    buffer_load_dwordx4 v229, s[20:23], s17 offen offset:0 lds
    s_waitcnt lgkmcnt(7)
    v_mfma_f32_16x16x32_bf16 v[24:27], a[168:171], v[108:111], v[24:27]
    ds_read_b128 v[92:95], v192 offset:25600
    v_mov_b32 v170, v229
    v_mfma_f32_16x16x32_bf16 v[28:31], a[172:175], v[108:111], v[28:31]
    v_add_u32 v171, 0x10000, v229
    s_waitcnt lgkmcnt(7)
    v_mfma_f32_16x16x32_bf16 v[24:27], a[48:51], v[64:67], v[24:27]
    ds_read_b128 v[96:99], v192 offset:10240
    v_add_u32 v172, 0x20000, v229
    v_mfma_f32_16x16x32_bf16 v[28:31], a[52:55], v[64:67], v[28:31]
    v_bfe_u32 v184, v253, 4, 1
    s_waitcnt lgkmcnt(7)
    v_mfma_f32_16x16x32_bf16 v[24:27], a[176:179], v[68:71], v[24:27]
    ds_read_b128 v[100:103], v192 offset:26624
    v_mul_u32_u24 v175, 46080, v184
    v_mfma_f32_16x16x32_bf16 v[28:31], a[180:183], v[68:71], v[28:31]
    v_lshrrev_b32 v184, 5, v253
    s_waitcnt lgkmcnt(7)
    v_mfma_f32_16x16x32_bf16 v[24:27], a[56:59], v[72:75], v[24:27]
    ds_read_b128 v[104:107], v192 offset:11264
    v_lshl_add_u32 v175, v184, 8, v175
    v_mfma_f32_16x16x32_bf16 v[28:31], a[60:63], v[72:75], v[28:31]
    buffer_load_dwordx4 v229, s[20:23], s17 offen offset:1024 lds
    s_waitcnt lgkmcnt(7)
    v_mfma_f32_16x16x32_bf16 v[24:27], a[184:187], v[76:79], v[24:27]
    ds_read_b128 v[108:111], v192 offset:27648
    v_and_b32 v184, 15, v253
    v_mfma_f32_16x16x32_bf16 v[28:31], a[188:191], v[76:79], v[28:31]
    v_lshl_add_u32 v175, v184, 4, v175
    s_waitcnt lgkmcnt(7)
    v_mfma_f32_16x16x32_bf16 v[24:27], a[64:67], v[80:83], v[24:27]
    ds_read_b128 v[64:67], v192 offset:12288
    s_mov_b32 s55, 0xbdd2d3e8
    v_mfma_f32_16x16x32_bf16 v[28:31], a[68:71], v[80:83], v[28:31]
    v_mov_b32 v178, 0xc0135761
    s_waitcnt lgkmcnt(7)
    v_mfma_f32_16x16x32_bf16 v[24:27], a[192:195], v[84:87], v[24:27]
    ds_read_b128 v[68:71], v192 offset:28672
    s_lshl_b32 s30, s10, 2
    v_mfma_f32_16x16x32_bf16 v[28:31], a[196:199], v[84:87], v[28:31]
    s_add_u32 s30, s30, s13
    s_waitcnt lgkmcnt(7)
    v_mfma_f32_16x16x32_bf16 v[24:27], a[72:75], v[88:91], v[24:27]
    ds_read_b128 v[72:75], v192 offset:13312
    s_lshl_b32 s30, s30, 1
    v_mfma_f32_16x16x32_bf16 v[28:31], a[76:79], v[88:91], v[28:31]
    buffer_load_dwordx4 v229, s[20:23], s17 offen offset:2048 lds
    s_waitcnt lgkmcnt(7)
    v_mfma_f32_16x16x32_bf16 v[24:27], a[200:203], v[92:95], v[24:27]
    ds_read_b128 v[76:79], v192 offset:29696
    s_and_b32 s28, s40, 1
    v_mfma_f32_16x16x32_bf16 v[28:31], a[204:207], v[92:95], v[28:31]
    s_add_u32 s30, s30, s28
    s_waitcnt lgkmcnt(7)
    v_mfma_f32_16x16x32_bf16 v[24:27], a[80:83], v[96:99], v[24:27]
    ds_read_b128 v[80:83], v192 offset:14336
    s_lshl_b32 s30, s30, 1
    v_mfma_f32_16x16x32_bf16 v[28:31], a[84:87], v[96:99], v[28:31]
    v_lshrrev_b32 v206, 3, v253
    s_waitcnt lgkmcnt(7)
    v_mfma_f32_16x16x32_bf16 v[24:27], a[208:211], v[100:103], v[24:27]
    ds_read_b128 v[84:87], v192 offset:30720
    v_and_b32 v207, 7, v253
    v_mfma_f32_16x16x32_bf16 v[28:31], a[212:215], v[100:103], v[28:31]
    v_lshlrev_b32 v201, 10, v206
    s_waitcnt lgkmcnt(7)
    v_mfma_f32_16x16x32_bf16 v[24:27], a[88:91], v[104:107], v[24:27]
    ds_read_b128 v[88:91], v192 offset:15360
    v_lshl_add_u32 v201, v207, 4, v201
    v_mfma_f32_16x16x32_bf16 v[28:31], a[92:95], v[104:107], v[28:31]
    buffer_load_dwordx4 v229, s[20:23], s17 offen offset:3072 lds
    s_waitcnt lgkmcnt(7)
    v_mfma_f32_16x16x32_bf16 v[24:27], a[216:219], v[108:111], v[24:27]
    ds_read_b128 v[92:95], v192 offset:31744
    v_lshlrev_b32 v202, 5, v207
    v_mfma_f32_16x16x32_bf16 v[28:31], a[220:223], v[108:111], v[28:31]
    v_lshlrev_b32 v203, 4, v206
    s_waitcnt vmcnt(24)
    s_barrier
    s_waitcnt lgkmcnt(7)
    v_mfma_f32_16x16x32_bf16 v[24:27], a[96:99], v[64:67], v[24:27]
    ds_read_b128 v[96:99], v192 offset:32768
    v_lshl_add_u32 v204, v207, 9, v203
    v_mfma_f32_16x16x32_bf16 v[28:31], a[100:103], v[64:67], v[28:31]
    v_xor_b32 v200, v206, v207
    s_waitcnt lgkmcnt(7)
    v_mfma_f32_16x16x32_bf16 v[24:27], a[224:227], v[68:71], v[24:27]
    ds_read_b128 v[100:103], v192 offset:49152
    v_lshlrev_b32 v200, 4, v200
    v_mfma_f32_16x16x32_bf16 v[28:31], a[228:231], v[68:71], v[28:31]
    v_lshl_add_u32 v200, v206, 8, v200
    s_waitcnt lgkmcnt(7)
    v_mfma_f32_16x16x32_bf16 v[24:27], a[104:107], v[72:75], v[24:27]
    ds_read_b128 v[104:107], v192 offset:33792
    s_add_u32 s17, s8, 0
    s_add_u32 m0, s46, 114688
    v_mfma_f32_16x16x32_bf16 v[28:31], a[108:111], v[72:75], v[28:31]
    buffer_load_dwordx4 v229, s[20:23], s17 offen offset:0 lds
    s_waitcnt lgkmcnt(7)
    v_mfma_f32_16x16x32_bf16 v[24:27], a[232:235], v[76:79], v[24:27]
    ds_read_b128 v[108:111], v192 offset:50176
    s_add_u32 s28, s46, 98304
    v_mfma_f32_16x16x32_bf16 v[28:31], a[236:239], v[76:79], v[28:31]
    v_add_u32 v200, s28, v200
    s_waitcnt lgkmcnt(7)
    v_mfma_f32_16x16x32_bf16 v[24:27], a[112:115], v[80:83], v[24:27]
    ds_read_b128 v[64:67], v192 offset:34816
    s_and_b32 s31, s40, 1
    v_mfma_f32_16x16x32_bf16 v[28:31], a[116:119], v[80:83], v[28:31]
    s_mul_i32 s31, s31, 31
    s_waitcnt lgkmcnt(7)
    v_mfma_f32_16x16x32_bf16 v[24:27], a[240:243], v[84:87], v[24:27]
    ds_read_b128 v[68:71], v192 offset:51200
    s_xor_b32 s31, s31, s10
    v_mfma_f32_16x16x32_bf16 v[28:31], a[244:247], v[84:87], v[28:31]
    s_lshl_b32 s31, s31, 2
    s_waitcnt lgkmcnt(7)
    v_mfma_f32_16x16x32_bf16 v[24:27], a[120:123], v[88:91], v[24:27]
    ds_read_b128 v[72:75], v192 offset:35840
    s_add_u32 s31, s31, s13
    v_mfma_f32_16x16x32_bf16 v[28:31], a[124:127], v[88:91], v[28:31]
    buffer_load_dwordx4 v229, s[20:23], s17 offen offset:1024 lds
    s_waitcnt lgkmcnt(7)
    v_mfma_f32_16x16x32_bf16 v[24:27], a[248:251], v[92:95], v[24:27]
    ds_read_b128 v[76:79], v192 offset:52224
    s_lshl_b32 s31, s31, 14
    v_mfma_f32_16x16x32_bf16 v[28:31], a[252:255], v[92:95], v[28:31]
    s_lshl_b32 s33, s11, 7
    s_waitcnt lgkmcnt(7)
    v_mfma_f32_16x16x32_bf16 v[40:43], a[0:3], v[96:99], 0
    ds_read_b128 v[80:83], v192 offset:36864
    s_add_u32 s31, s31, s33
    v_mfma_f32_16x16x32_bf16 v[44:47], a[4:7], v[96:99], 0
    s_add_u32 s32, s31, 62914560
    s_waitcnt lgkmcnt(7)
    v_mfma_f32_16x16x32_bf16 v[40:43], a[128:131], v[100:103], v[40:43]
    ds_read_b128 v[84:87], v192 offset:53248
    s_lshl_b32 s33, s11, 8
    v_mfma_f32_16x16x32_bf16 v[44:47], a[132:135], v[100:103], v[44:47]
    s_add_u32 s33, s33, 135168
    s_waitcnt lgkmcnt(7)
    v_mfma_f32_16x16x32_bf16 v[40:43], a[8:11], v[104:107], v[40:43]
    ds_read_b128 v[88:91], v192 offset:37888
    v_mfma_f32_16x16x32_bf16 v[44:47], a[12:15], v[104:107], v[44:47]
    buffer_store_dwordx4 v[24:27], v229, s[20:23], s42 offen offset:2048 sc1
    s_waitcnt lgkmcnt(7)
    v_mfma_f32_16x16x32_bf16 v[40:43], a[136:139], v[108:111], v[40:43]
    ds_read_b128 v[92:95], v192 offset:54272
    v_mfma_f32_16x16x32_bf16 v[44:47], a[140:143], v[108:111], v[44:47]
    buffer_load_dwordx4 v229, s[20:23], s17 offen offset:2048 lds
    s_waitcnt lgkmcnt(7)
    v_mfma_f32_16x16x32_bf16 v[40:43], a[16:19], v[64:67], v[40:43]
    ds_read_b128 v[96:99], v192 offset:38912
    v_mfma_f32_16x16x32_bf16 v[44:47], a[20:23], v[64:67], v[44:47]
    buffer_store_dwordx4 v[28:31], v229, s[20:23], s42 offen offset:3072 sc1
    s_waitcnt lgkmcnt(7)
    v_mfma_f32_16x16x32_bf16 v[40:43], a[144:147], v[68:71], v[40:43]
    ds_read_b128 v[100:103], v192 offset:55296
    v_mfma_f32_16x16x32_bf16 v[44:47], a[148:151], v[68:71], v[44:47]
    buffer_load_dwordx4 v[208:211], v201, s[24:27], s31 offen
    s_waitcnt lgkmcnt(7)
    v_mfma_f32_16x16x32_bf16 v[40:43], a[24:27], v[72:75], v[40:43]
    ds_read_b128 v[104:107], v192 offset:39936
    s_add_u32 s31, s31, 8192
    v_mfma_f32_16x16x32_bf16 v[44:47], a[28:31], v[72:75], v[44:47]
    buffer_load_dwordx4 v[212:215], v201, s[24:27], s31 offen
    s_waitcnt lgkmcnt(7)
    v_mfma_f32_16x16x32_bf16 v[40:43], a[152:155], v[76:79], v[40:43]
    ds_read_b128 v[108:111], v192 offset:56320
    v_mfma_f32_16x16x32_bf16 v[44:47], a[156:159], v[76:79], v[44:47]
    buffer_load_dwordx4 v229, s[20:23], s17 offen offset:3072 lds
    s_waitcnt lgkmcnt(7)
    v_mfma_f32_16x16x32_bf16 v[40:43], a[32:35], v[80:83], v[40:43]
    ds_read_b128 v[64:67], v192 offset:40960
    v_mfma_f32_16x16x32_bf16 v[44:47], a[36:39], v[80:83], v[44:47]
    buffer_load_dwordx4 v[216:219], v202, s[20:23], s33 offen offset:0
    s_waitcnt lgkmcnt(7)
    v_mfma_f32_16x16x32_bf16 v[40:43], a[160:163], v[84:87], v[40:43]
    ds_read_b128 v[68:71], v192 offset:57344
    v_mfma_f32_16x16x32_bf16 v[44:47], a[164:167], v[84:87], v[44:47]
    buffer_load_dwordx4 v[220:223], v202, s[20:23], s33 offen offset:16
    s_waitcnt lgkmcnt(7)
    v_mfma_f32_16x16x32_bf16 v[40:43], a[40:43], v[88:91], v[40:43]
    ds_read_b128 v[72:75], v192 offset:41984
    s_add_u32 s33, s33, 4096
    v_mfma_f32_16x16x32_bf16 v[44:47], a[44:47], v[88:91], v[44:47]
    buffer_load_dwordx4 v[232:235], v202, s[20:23], s33 offen offset:0
    s_waitcnt lgkmcnt(7)
    v_mfma_f32_16x16x32_bf16 v[40:43], a[168:171], v[92:95], v[40:43]
    ds_read_b128 v[76:79], v192 offset:58368
    s_add_u32 s17, s8, s39
    s_add_u32 m0, s46, 147456
    v_mfma_f32_16x16x32_bf16 v[44:47], a[172:175], v[92:95], v[44:47]
    buffer_load_dwordx4 v229, s[20:23], s17 offen offset:0 lds
    s_waitcnt lgkmcnt(7)
    v_mfma_f32_16x16x32_bf16 v[40:43], a[48:51], v[96:99], v[40:43]
    ds_read_b128 v[80:83], v192 offset:43008
    v_mfma_f32_16x16x32_bf16 v[44:47], a[52:55], v[96:99], v[44:47]
    buffer_load_dwordx4 v[236:239], v202, s[20:23], s33 offen offset:16
    s_waitcnt lgkmcnt(7)
    v_mfma_f32_16x16x32_bf16 v[40:43], a[176:179], v[100:103], v[40:43]
    ds_read_b128 v[84:87], v192 offset:59392
    v_lshrrev_b32 v206, 5, v253
    v_mfma_f32_16x16x32_bf16 v[44:47], a[180:183], v[100:103], v[44:47]
    v_xor_b32 v206, v206, v207
    s_waitcnt lgkmcnt(7)
    v_mfma_f32_16x16x32_bf16 v[40:43], a[56:59], v[104:107], v[40:43]
    ds_read_b128 v[88:91], v192 offset:44032
    s_lshl_b32 s28, s40, 2
    v_mfma_f32_16x16x32_bf16 v[44:47], a[60:63], v[104:107], v[44:47]
    s_and_b32 s28, s28, 4
    s_waitcnt lgkmcnt(7)
    v_mfma_f32_16x16x32_bf16 v[40:43], a[184:187], v[108:111], v[40:43]
    ds_read_b128 v[92:95], v192 offset:60416
    v_xor_b32 v206, s28, v206
    v_mfma_f32_16x16x32_bf16 v[44:47], a[188:191], v[108:111], v[44:47]
    buffer_load_dwordx4 v229, s[20:23], s17 offen offset:1024 lds
    s_waitcnt lgkmcnt(7)
    v_mfma_f32_16x16x32_bf16 v[40:43], a[64:67], v[64:67], v[40:43]
    ds_read_b128 v[96:99], v192 offset:45056
    v_lshlrev_b32 v206, 4, v206
    v_mfma_f32_16x16x32_bf16 v[44:47], a[68:71], v[64:67], v[44:47]
    v_and_b32 v207, 15, v253
    s_waitcnt lgkmcnt(7)
    v_mfma_f32_16x16x32_bf16 v[40:43], a[192:195], v[68:71], v[40:43]
    ds_read_b128 v[100:103], v192 offset:61440
    v_lshl_add_u32 v206, v207, 8, v206
    v_mfma_f32_16x16x32_bf16 v[44:47], a[196:199], v[68:71], v[44:47]
    v_bfe_u32 v207, v253, 4, 1
    s_waitcnt lgkmcnt(7)
    v_mfma_f32_16x16x32_bf16 v[40:43], a[72:75], v[72:75], v[40:43]
    ds_read_b128 v[104:107], v192 offset:46080
    v_lshl_add_u32 v206, v207, 7, v206
    v_mfma_f32_16x16x32_bf16 v[44:47], a[76:79], v[72:75], v[44:47]
    s_and_b32 s28, s46, 8192
    s_waitcnt lgkmcnt(7)
    v_mfma_f32_16x16x32_bf16 v[40:43], a[200:203], v[76:79], v[40:43]
    ds_read_b128 v[108:111], v192 offset:62464
    s_add_u32 s28, s28, 98304
    v_mfma_f32_16x16x32_bf16 v[44:47], a[204:207], v[76:79], v[44:47]
    buffer_load_dwordx4 v229, s[20:23], s17 offen offset:2048 lds
    s_waitcnt lgkmcnt(7)
    v_mfma_f32_16x16x32_bf16 v[40:43], a[80:83], v[80:83], v[40:43]
    ds_read_b128 v[64:67], v192 offset:47104
    v_add_u32 v196, s28, v206
    v_mfma_f32_16x16x32_bf16 v[44:47], a[84:87], v[80:83], v[44:47]
    v_xor_b32 v197, 32, v196
    s_waitcnt lgkmcnt(7)
    v_mfma_f32_16x16x32_bf16 v[40:43], a[208:211], v[84:87], v[40:43]
    ds_read_b128 v[68:71], v192 offset:63488
    s_lshr_b32 s34, s30, 2
    v_mfma_f32_16x16x32_bf16 v[44:47], a[212:215], v[84:87], v[44:47]
    s_lshl_b32 s34, s34, 15
    s_waitcnt lgkmcnt(7)
    v_mfma_f32_16x16x32_bf16 v[40:43], a[88:91], v[88:91], v[40:43]
    ds_read_b128 v[72:75], v192 offset:48128
    s_and_b32 s28, s30, 3
    v_mfma_f32_16x16x32_bf16 v[44:47], a[92:95], v[88:91], v[44:47]
    s_lshl_b32 s28, s28, 7
    s_waitcnt lgkmcnt(7)
    v_mfma_f32_16x16x32_bf16 v[40:43], a[216:219], v[92:95], v[40:43]
    ds_read_b128 v[76:79], v192 offset:64512
    s_add_u32 s34, s34, s28
    v_mfma_f32_16x16x32_bf16 v[44:47], a[220:223], v[92:95], v[44:47]
    buffer_load_dwordx4 v229, s[20:23], s17 offen offset:3072 lds
    s_waitcnt vmcnt(16)
    s_barrier
    s_waitcnt lgkmcnt(7)
    v_mfma_f32_16x16x32_bf16 v[40:43], a[96:99], v[96:99], v[40:43]
    ds_read_b128 v[80:83], v194 offset:0
    s_lshl_b32 s28, s11, 12
    v_mfma_f32_16x16x32_bf16 v[44:47], a[100:103], v[96:99], v[44:47]
    s_add_u32 s34, s34, s28
    s_waitcnt lgkmcnt(7)
    v_mfma_f32_16x16x32_bf16 v[40:43], a[224:227], v[100:103], v[40:43]
    ds_read_b128 v[84:87], v193 offset:32768
    s_add_u32 s34, s34, 67108864
    v_mfma_f32_16x16x32_bf16 v[44:47], a[228:231], v[100:103], v[44:47]
    s_lshl_b32 s35, s30, 6
    s_waitcnt lgkmcnt(7)
    v_mfma_f32_16x16x32_bf16 v[40:43], a[104:107], v[104:107], v[40:43]
    ds_read_b128 v[88:91], v194 offset:1024
    s_lshl_b32 s28, s11, 14
    v_mfma_f32_16x16x32_bf16 v[44:47], a[108:111], v[104:107], v[44:47]
    s_add_u32 s35, s35, s28
    s_waitcnt lgkmcnt(7)
    v_mfma_f32_16x16x32_bf16 v[40:43], a[232:235], v[108:111], v[40:43]
    ds_read_b128 v[92:95], v193 offset:33792
    s_add_u32 s17, s8, 16384
    s_add_u32 m0, s46, 65536
    v_mfma_f32_16x16x32_bf16 v[44:47], a[236:239], v[108:111], v[44:47]
    buffer_load_dwordx4 v229, s[20:23], s17 offen offset:0 lds
    s_waitcnt lgkmcnt(7)
    v_mfma_f32_16x16x32_bf16 v[40:43], a[112:115], v[64:67], v[40:43]
    ds_read_b128 v[96:99], v194 offset:2048
    s_add_u32 s35, s35, 69206016
    v_mfma_f32_16x16x32_bf16 v[44:47], a[116:119], v[64:67], v[44:47]
    v_lshrrev_b32 v203, 1, v203
    s_waitcnt lgkmcnt(7)
    v_mfma_f32_16x16x32_bf16 v[40:43], a[240:243], v[68:71], v[40:43]
    ds_read_b128 v[100:103], v193 offset:34816
    v_and_b32 v206, 4, v253
    v_mfma_f32_16x16x32_bf16 v[44:47], a[244:247], v[68:71], v[44:47]
    v_lshl_add_u32 v203, v206, 4, v203
    s_waitcnt lgkmcnt(7)
    v_mfma_f32_16x16x32_bf16 v[40:43], a[120:123], v[72:75], v[40:43]
    ds_read_b128 v[104:107], v194 offset:3072
    v_cmp_ne_u32 s[36:37], 0, v206
    v_mfma_f32_16x16x32_bf16 v[44:47], a[124:127], v[72:75], v[44:47]
    s_lshl_b32 s29, s10, 7
    s_waitcnt lgkmcnt(7)
    v_mfma_f32_16x16x32_bf16 v[40:43], a[248:251], v[76:79], v[40:43]
    ds_read_b128 v[108:111], v193 offset:35840
    s_add_u32 s29, s29, 538624
    v_mfma_f32_16x16x32_bf16 v[44:47], a[252:255], v[76:79], v[44:47]
    buffer_load_dwordx4 v229, s[20:23], s17 offen offset:1024 lds
    s_waitcnt lgkmcnt(7)
    v_mfma_f32_16x16x32_bf16 v[56:59], a[0:3], v[80:83], 0
    ds_read_b128 v[64:67], v194 offset:4096
    s_cmp_eq_u32 s40, 0
    s_cselect_b32 s29, s29, 0x70000000
    v_mfma_f32_16x16x32_bf16 v[60:63], a[4:7], v[80:83], 0
    s_waitcnt lgkmcnt(7)
    v_mfma_f32_16x16x32_bf16 v[56:59], a[128:131], v[84:87], v[56:59]
    ds_read_b128 v[68:71], v193 offset:36864
    v_mfma_f32_16x16x32_bf16 v[60:63], a[132:135], v[84:87], v[60:63]
    s_waitcnt lgkmcnt(7)
    v_mfma_f32_16x16x32_bf16 v[56:59], a[8:11], v[88:91], v[56:59]
    ds_read_b128 v[72:75], v194 offset:5120
    v_mfma_f32_16x16x32_bf16 v[60:63], a[12:15], v[88:91], v[60:63]
    buffer_store_dwordx4 v[40:43], v229, s[20:23], s43 offen offset:2048 sc1
    s_waitcnt lgkmcnt(7)
    v_mfma_f32_16x16x32_bf16 v[56:59], a[136:139], v[92:95], v[56:59]
    ds_read_b128 v[76:79], v193 offset:37888
    v_mfma_f32_16x16x32_bf16 v[60:63], a[140:143], v[92:95], v[60:63]
    buffer_load_dwordx4 v229, s[20:23], s17 offen offset:2048 lds
    s_waitcnt lgkmcnt(7)
    v_mfma_f32_16x16x32_bf16 v[56:59], a[16:19], v[96:99], v[56:59]
    ds_read_b128 v[80:83], v194 offset:6144
    v_mfma_f32_16x16x32_bf16 v[60:63], a[20:23], v[96:99], v[60:63]
    buffer_store_dwordx4 v[44:47], v229, s[20:23], s43 offen offset:3072 sc1
    s_waitcnt lgkmcnt(7)
    v_mfma_f32_16x16x32_bf16 v[56:59], a[144:147], v[100:103], v[56:59]
    ds_read_b128 v[84:87], v193 offset:38912
    v_mfma_f32_16x16x32_bf16 v[60:63], a[148:151], v[100:103], v[60:63]
    s_waitcnt lgkmcnt(7)
    v_mfma_f32_16x16x32_bf16 v[56:59], a[24:27], v[104:107], v[56:59]
    ds_read_b128 v[88:91], v194 offset:7168
    v_mfma_f32_16x16x32_bf16 v[60:63], a[28:31], v[104:107], v[60:63]
    s_waitcnt lgkmcnt(7)
    v_mfma_f32_16x16x32_bf16 v[56:59], a[152:155], v[108:111], v[56:59]
    ds_read_b128 v[92:95], v193 offset:39936
    v_mfma_f32_16x16x32_bf16 v[60:63], a[156:159], v[108:111], v[60:63]
    buffer_load_dwordx4 v229, s[20:23], s17 offen offset:3072 lds
    s_waitcnt lgkmcnt(7)
    v_mfma_f32_16x16x32_bf16 v[56:59], a[32:35], v[64:67], v[56:59]
    ds_read_b128 v[96:99], v194 offset:8192
    v_mfma_f32_16x16x32_bf16 v[60:63], a[36:39], v[64:67], v[60:63]
    s_waitcnt lgkmcnt(7)
    v_mfma_f32_16x16x32_bf16 v[56:59], a[160:163], v[68:71], v[56:59]
    ds_read_b128 v[100:103], v193 offset:40960
    v_mfma_f32_16x16x32_bf16 v[60:63], a[164:167], v[68:71], v[60:63]
    s_waitcnt lgkmcnt(7)
    v_mfma_f32_16x16x32_bf16 v[56:59], a[40:43], v[72:75], v[56:59]
    ds_read_b128 v[104:107], v194 offset:9216
    v_mfma_f32_16x16x32_bf16 v[60:63], a[44:47], v[72:75], v[60:63]
    s_waitcnt lgkmcnt(7)
    v_mfma_f32_16x16x32_bf16 v[56:59], a[168:171], v[76:79], v[56:59]
    ds_read_b128 v[108:111], v193 offset:41984
    s_add_u32 s17, s8, s39
    s_add_u32 s17, s17, 16384
    s_add_u32 m0, s46, 81920
    v_mfma_f32_16x16x32_bf16 v[60:63], a[172:175], v[76:79], v[60:63]
    buffer_load_dwordx4 v229, s[20:23], s17 offen offset:0 lds
    s_waitcnt lgkmcnt(7)
    v_mfma_f32_16x16x32_bf16 v[56:59], a[48:51], v[80:83], v[56:59]
    ds_read_b128 v[64:67], v194 offset:10240
    v_mfma_f32_16x16x32_bf16 v[60:63], a[52:55], v[80:83], v[60:63]
    s_waitcnt lgkmcnt(7)
    v_mfma_f32_16x16x32_bf16 v[56:59], a[176:179], v[84:87], v[56:59]
    ds_read_b128 v[68:71], v193 offset:43008
    v_mfma_f32_16x16x32_bf16 v[60:63], a[180:183], v[84:87], v[60:63]
    s_waitcnt lgkmcnt(7)
    v_mfma_f32_16x16x32_bf16 v[56:59], a[56:59], v[88:91], v[56:59]
    ds_read_b128 v[72:75], v194 offset:11264
    v_mfma_f32_16x16x32_bf16 v[60:63], a[60:63], v[88:91], v[60:63]
    s_waitcnt lgkmcnt(7)
    v_mfma_f32_16x16x32_bf16 v[56:59], a[184:187], v[92:95], v[56:59]
    ds_read_b128 v[76:79], v193 offset:44032
    v_mfma_f32_16x16x32_bf16 v[60:63], a[188:191], v[92:95], v[60:63]
    buffer_load_dwordx4 v229, s[20:23], s17 offen offset:1024 lds
    s_waitcnt lgkmcnt(7)
    v_mfma_f32_16x16x32_bf16 v[56:59], a[64:67], v[96:99], v[56:59]
    ds_read_b128 v[80:83], v194 offset:12288
    v_mfma_f32_16x16x32_bf16 v[60:63], a[68:71], v[96:99], v[60:63]
    s_waitcnt lgkmcnt(7)
    v_mfma_f32_16x16x32_bf16 v[56:59], a[192:195], v[100:103], v[56:59]
    ds_read_b128 v[84:87], v193 offset:45056
    v_mfma_f32_16x16x32_bf16 v[60:63], a[196:199], v[100:103], v[60:63]
    s_waitcnt lgkmcnt(7)
    v_mfma_f32_16x16x32_bf16 v[56:59], a[72:75], v[104:107], v[56:59]
    ds_read_b128 v[88:91], v194 offset:13312
    v_mfma_f32_16x16x32_bf16 v[60:63], a[76:79], v[104:107], v[60:63]
    s_waitcnt lgkmcnt(7)
    v_mfma_f32_16x16x32_bf16 v[56:59], a[200:203], v[108:111], v[56:59]
    ds_read_b128 v[92:95], v193 offset:46080
    v_mfma_f32_16x16x32_bf16 v[60:63], a[204:207], v[108:111], v[60:63]
    buffer_load_dwordx4 v229, s[20:23], s17 offen offset:2048 lds
    s_waitcnt lgkmcnt(7)
    v_mfma_f32_16x16x32_bf16 v[56:59], a[80:83], v[64:67], v[56:59]
    ds_read_b128 v[96:99], v194 offset:14336
    v_mfma_f32_16x16x32_bf16 v[60:63], a[84:87], v[64:67], v[60:63]
    s_waitcnt lgkmcnt(7)
    v_mfma_f32_16x16x32_bf16 v[56:59], a[208:211], v[68:71], v[56:59]
    ds_read_b128 v[100:103], v193 offset:47104
    v_mfma_f32_16x16x32_bf16 v[60:63], a[212:215], v[68:71], v[60:63]
    s_waitcnt lgkmcnt(7)
    v_mfma_f32_16x16x32_bf16 v[56:59], a[88:91], v[72:75], v[56:59]
    ds_read_b128 v[104:107], v194 offset:15360
    v_mfma_f32_16x16x32_bf16 v[60:63], a[92:95], v[72:75], v[60:63]
    s_waitcnt lgkmcnt(7)
    v_mfma_f32_16x16x32_bf16 v[56:59], a[216:219], v[76:79], v[56:59]
    ds_read_b128 v[108:111], v193 offset:48128
    v_mfma_f32_16x16x32_bf16 v[60:63], a[220:223], v[76:79], v[60:63]
    buffer_load_dwordx4 v229, s[20:23], s17 offen offset:3072 lds
    s_waitcnt vmcnt(21)
    s_waitcnt vmcnt(10)
    s_barrier
    s_waitcnt lgkmcnt(7)
    v_mfma_f32_16x16x32_bf16 v[56:59], a[96:99], v[80:83], v[56:59]
    ds_read_b128 v[64:67], v193 offset:49152
    buffer_atomic_add v249, v248, s[20:23], s41 offen offset:128 sc1
    v_mfma_f32_16x16x32_bf16 v[60:63], a[100:103], v[80:83], v[60:63]
    s_waitcnt lgkmcnt(7)
    v_mfma_f32_16x16x32_bf16 v[56:59], a[224:227], v[84:87], v[56:59]
    ds_read_b128 v[68:71], v194 offset:16384
    v_mfma_f32_16x16x32_bf16 v[60:63], a[228:231], v[84:87], v[60:63]
    s_waitcnt lgkmcnt(7)
    v_mfma_f32_16x16x32_bf16 v[56:59], a[104:107], v[88:91], v[56:59]
    ds_read_b128 v[72:75], v193 offset:50176
    v_mfma_f32_16x16x32_bf16 v[60:63], a[108:111], v[88:91], v[60:63]
    s_waitcnt lgkmcnt(7)
    v_mfma_f32_16x16x32_bf16 v[56:59], a[232:235], v[92:95], v[56:59]
    ds_read_b128 v[76:79], v194 offset:17408
    s_add_u32 s49, s51, 0
    s_add_u32 m0, s46, 0
    v_mfma_f32_16x16x32_bf16 v[60:63], a[236:239], v[92:95], v[60:63]
    buffer_load_dwordx4 v229, s[20:23], s49 offen offset:0 lds
    s_waitcnt lgkmcnt(7)
    v_mfma_f32_16x16x32_bf16 v[56:59], a[112:115], v[96:99], v[56:59]
    ds_read_b128 v[80:83], v193 offset:51200
    v_mfma_f32_16x16x32_bf16 v[60:63], a[116:119], v[96:99], v[60:63]
    s_waitcnt lgkmcnt(7)
    v_mfma_f32_16x16x32_bf16 v[56:59], a[240:243], v[100:103], v[56:59]
    ds_read_b128 v[84:87], v194 offset:18432
    v_mfma_f32_16x16x32_bf16 v[60:63], a[244:247], v[100:103], v[60:63]
    buffer_load_dwordx4 v229, s[20:23], s49 offen offset:1024 lds
    s_waitcnt lgkmcnt(7)
    v_mfma_f32_16x16x32_bf16 v[56:59], a[120:123], v[104:107], v[56:59]
    ds_read_b128 v[88:91], v193 offset:52224
    v_mfma_f32_16x16x32_bf16 v[60:63], a[124:127], v[104:107], v[60:63]
    s_waitcnt lgkmcnt(7)
    v_mfma_f32_16x16x32_bf16 v[56:59], a[248:251], v[108:111], v[56:59]
    ds_read_b128 v[92:95], v194 offset:19456
    v_mfma_f32_16x16x32_bf16 v[60:63], a[252:255], v[108:111], v[60:63]
    buffer_load_dwordx4 v229, s[20:23], s49 offen offset:2048 lds
    s_waitcnt lgkmcnt(7)
    v_mfma_f32_16x16x32_bf16 v[0:3], a[0:3], v[64:67], 0
    ds_read_b128 v[96:99], v193 offset:53248
    v_mfma_f32_16x16x32_bf16 v[4:7], a[4:7], v[64:67], 0
    s_waitcnt lgkmcnt(7)
    v_mfma_f32_16x16x32_bf16 v[8:11], a[0:3], v[68:71], 0
    ds_read_b128 v[100:103], v194 offset:20480
    v_mfma_f32_16x16x32_bf16 v[12:15], a[4:7], v[68:71], 0
    buffer_load_dwordx4 v229, s[20:23], s49 offen offset:3072 lds
    s_waitcnt lgkmcnt(7)
    v_mfma_f32_16x16x32_bf16 v[0:3], a[8:11], v[72:75], v[0:3]
    ds_read_b128 v[104:107], v193 offset:54272
    v_mfma_f32_16x16x32_bf16 v[4:7], a[12:15], v[72:75], v[4:7]
    buffer_store_dwordx4 v[56:59], v229, s[20:23], s44 offen offset:2048 sc1
    s_waitcnt lgkmcnt(7)
    v_mfma_f32_16x16x32_bf16 v[8:11], a[8:11], v[76:79], v[8:11]
    ds_read_b128 v[108:111], v194 offset:21504
    s_add_u32 s49, s56, 65536
    s_add_u32 m0, s46, 16384
    v_mfma_f32_16x16x32_bf16 v[12:15], a[12:15], v[76:79], v[12:15]
    buffer_load_dwordx4 v229, s[20:23], s49 offen offset:0 lds
    s_waitcnt lgkmcnt(7)
    v_mfma_f32_16x16x32_bf16 v[0:3], a[16:19], v[80:83], v[0:3]
    ds_read_b128 v[64:67], v193 offset:55296
    v_mfma_f32_16x16x32_bf16 v[4:7], a[20:23], v[80:83], v[4:7]
    buffer_store_dwordx4 v[60:63], v229, s[20:23], s44 offen offset:3072 sc1
    s_waitcnt lgkmcnt(7)
    v_mfma_f32_16x16x32_bf16 v[8:11], a[16:19], v[84:87], v[8:11]
    ds_read_b128 v[68:71], v194 offset:22528
    v_mfma_f32_16x16x32_bf16 v[12:15], a[20:23], v[84:87], v[12:15]
    buffer_load_dwordx4 v229, s[20:23], s49 offen offset:1024 lds
    s_waitcnt lgkmcnt(7)
    v_mfma_f32_16x16x32_bf16 v[0:3], a[24:27], v[88:91], v[0:3]
    ds_read_b128 v[72:75], v193 offset:56320
    v_mfma_f32_16x16x32_bf16 v[4:7], a[28:31], v[88:91], v[4:7]
    s_waitcnt lgkmcnt(7)
    v_mfma_f32_16x16x32_bf16 v[8:11], a[24:27], v[92:95], v[8:11]
    ds_read_b128 v[76:79], v194 offset:23552
    v_mfma_f32_16x16x32_bf16 v[12:15], a[28:31], v[92:95], v[12:15]
    buffer_load_dwordx4 v229, s[20:23], s49 offen offset:2048 lds
    s_waitcnt lgkmcnt(7)
    v_mfma_f32_16x16x32_bf16 v[0:3], a[32:35], v[96:99], v[0:3]
    ds_read_b128 v[80:83], v193 offset:57344
    v_mfma_f32_16x16x32_bf16 v[4:7], a[36:39], v[96:99], v[4:7]
    s_waitcnt lgkmcnt(7)
    v_mfma_f32_16x16x32_bf16 v[8:11], a[32:35], v[100:103], v[8:11]
    ds_read_b128 v[84:87], v194 offset:24576
    v_mfma_f32_16x16x32_bf16 v[12:15], a[36:39], v[100:103], v[12:15]
    buffer_load_dwordx4 v229, s[20:23], s49 offen offset:3072 lds
    s_waitcnt lgkmcnt(7)
    v_mfma_f32_16x16x32_bf16 v[0:3], a[40:43], v[104:107], v[0:3]
    ds_read_b128 v[88:91], v193 offset:58368
    v_mfma_f32_16x16x32_bf16 v[4:7], a[44:47], v[104:107], v[4:7]
    s_waitcnt lgkmcnt(7)
    v_mfma_f32_16x16x32_bf16 v[8:11], a[40:43], v[108:111], v[8:11]
    ds_read_b128 v[92:95], v194 offset:25600
    v_mfma_f32_16x16x32_bf16 v[12:15], a[44:47], v[108:111], v[12:15]
    s_waitcnt lgkmcnt(7)
    v_mfma_f32_16x16x32_bf16 v[0:3], a[48:51], v[64:67], v[0:3]
    ds_read_b128 v[96:99], v193 offset:59392
    v_mfma_f32_16x16x32_bf16 v[4:7], a[52:55], v[64:67], v[4:7]
    s_waitcnt lgkmcnt(7)
    v_mfma_f32_16x16x32_bf16 v[8:11], a[48:51], v[68:71], v[8:11]
    ds_read_b128 v[100:103], v194 offset:26624
    v_mfma_f32_16x16x32_bf16 v[12:15], a[52:55], v[68:71], v[12:15]
    s_waitcnt lgkmcnt(7)
    v_mfma_f32_16x16x32_bf16 v[0:3], a[56:59], v[72:75], v[0:3]
    ds_read_b128 v[104:107], v193 offset:60416
    v_mfma_f32_16x16x32_bf16 v[4:7], a[60:63], v[72:75], v[4:7]
    s_waitcnt lgkmcnt(7)
    v_mfma_f32_16x16x32_bf16 v[8:11], a[56:59], v[76:79], v[8:11]
    ds_read_b128 v[108:111], v194 offset:27648
    v_mfma_f32_16x16x32_bf16 v[12:15], a[60:63], v[76:79], v[12:15]
    s_waitcnt lgkmcnt(7)
    v_mfma_f32_16x16x32_bf16 v[0:3], a[64:67], v[80:83], v[0:3]
    ds_read_b128 v[64:67], v193 offset:61440
    v_mfma_f32_16x16x32_bf16 v[4:7], a[68:71], v[80:83], v[4:7]
    s_waitcnt lgkmcnt(7)
    v_mfma_f32_16x16x32_bf16 v[8:11], a[64:67], v[84:87], v[8:11]
    ds_read_b128 v[68:71], v194 offset:28672
    v_mfma_f32_16x16x32_bf16 v[12:15], a[68:71], v[84:87], v[12:15]
    s_waitcnt lgkmcnt(7)
    v_mfma_f32_16x16x32_bf16 v[0:3], a[72:75], v[88:91], v[0:3]
    ds_read_b128 v[72:75], v193 offset:62464
    v_mfma_f32_16x16x32_bf16 v[4:7], a[76:79], v[88:91], v[4:7]
    s_waitcnt lgkmcnt(7)
    v_mfma_f32_16x16x32_bf16 v[8:11], a[72:75], v[92:95], v[8:11]
    ds_read_b128 v[76:79], v194 offset:29696
    v_mfma_f32_16x16x32_bf16 v[12:15], a[76:79], v[92:95], v[12:15]
    s_waitcnt lgkmcnt(7)
    v_mfma_f32_16x16x32_bf16 v[0:3], a[80:83], v[96:99], v[0:3]
    ds_read_b128 v[80:83], v193 offset:63488
    buffer_load_dword v251, v250, s[20:23], s18 offen offset:128 sc1
    v_mfma_f32_16x16x32_bf16 v[4:7], a[84:87], v[96:99], v[4:7]
    s_waitcnt lgkmcnt(7)
    v_mfma_f32_16x16x32_bf16 v[8:11], a[80:83], v[100:103], v[8:11]
    ds_read_b128 v[84:87], v194 offset:30720
    v_mfma_f32_16x16x32_bf16 v[12:15], a[84:87], v[100:103], v[12:15]
    s_waitcnt lgkmcnt(7)
    v_mfma_f32_16x16x32_bf16 v[0:3], a[88:91], v[104:107], v[0:3]
    ds_read_b128 v[88:91], v193 offset:64512
    v_mfma_f32_16x16x32_bf16 v[4:7], a[92:95], v[104:107], v[4:7]
    s_waitcnt lgkmcnt(7)
    v_mfma_f32_16x16x32_bf16 v[8:11], a[88:91], v[108:111], v[8:11]
    ds_read_b128 v[92:95], v194 offset:31744
    v_mfma_f32_16x16x32_bf16 v[12:15], a[92:95], v[108:111], v[12:15]
    s_waitcnt vmcnt(12)
    s_barrier
    s_waitcnt lgkmcnt(7)
    v_mfma_f32_16x16x32_bf16 v[0:3], a[96:99], v[64:67], v[0:3]
    ds_read_b128 v[96:99], v193 offset:0
    v_mfma_f32_16x16x32_bf16 v[4:7], a[100:103], v[64:67], v[4:7]
    s_waitcnt lgkmcnt(7)
    v_mfma_f32_16x16x32_bf16 v[8:11], a[96:99], v[68:71], v[8:11]
    ds_read_b128 v[100:103], v193 offset:16384
    v_mfma_f32_16x16x32_bf16 v[12:15], a[100:103], v[68:71], v[12:15]
    s_waitcnt lgkmcnt(7)
    v_mfma_f32_16x16x32_bf16 v[0:3], a[104:107], v[72:75], v[0:3]
    ds_read_b128 v[104:107], v193 offset:1024
    v_mfma_f32_16x16x32_bf16 v[4:7], a[108:111], v[72:75], v[4:7]
    s_waitcnt lgkmcnt(7)
    v_mfma_f32_16x16x32_bf16 v[8:11], a[104:107], v[76:79], v[8:11]
    ds_read_b128 v[108:111], v193 offset:17408
    v_mfma_f32_16x16x32_bf16 v[12:15], a[108:111], v[76:79], v[12:15]
    s_waitcnt lgkmcnt(7)
    v_mfma_f32_16x16x32_bf16 v[0:3], a[112:115], v[80:83], v[0:3]
    ds_read_b128 v[64:67], v193 offset:2048
    v_mfma_f32_16x16x32_bf16 v[4:7], a[116:119], v[80:83], v[4:7]
    s_waitcnt lgkmcnt(7)
    v_mfma_f32_16x16x32_bf16 v[8:11], a[112:115], v[84:87], v[8:11]
    ds_read_b128 v[68:71], v193 offset:18432
    v_mfma_f32_16x16x32_bf16 v[12:15], a[116:119], v[84:87], v[12:15]
    s_waitcnt lgkmcnt(7)
    v_mfma_f32_16x16x32_bf16 v[0:3], a[120:123], v[88:91], v[0:3]
    ds_read_b128 v[72:75], v193 offset:3072
    v_mfma_f32_16x16x32_bf16 v[4:7], a[124:127], v[88:91], v[4:7]
    s_waitcnt lgkmcnt(7)
    v_mfma_f32_16x16x32_bf16 v[8:11], a[120:123], v[92:95], v[8:11]
    ds_read_b128 v[76:79], v193 offset:19456
    v_mfma_f32_16x16x32_bf16 v[12:15], a[124:127], v[92:95], v[12:15]
    s_waitcnt vmcnt(4)
    s_barrier
    s_waitcnt lgkmcnt(7)
    v_mfma_f32_16x16x32_bf16 v[0:3], a[128:131], v[96:99], v[0:3]
    ds_read_b128 v[80:83], v193 offset:4096
    v_mfma_f32_16x16x32_bf16 v[4:7], a[132:135], v[96:99], v[4:7]
    buffer_atomic_add v249, v248, s[20:23], s41 offen sc1
    s_waitcnt lgkmcnt(7)
    v_mfma_f32_16x16x32_bf16 v[8:11], a[128:131], v[100:103], v[8:11]
    ds_read_b128 v[84:87], v193 offset:20480
    v_mfma_f32_16x16x32_bf16 v[12:15], a[132:135], v[100:103], v[12:15]
    s_waitcnt lgkmcnt(7)
    v_mfma_f32_16x16x32_bf16 v[0:3], a[136:139], v[104:107], v[0:3]
    ds_read_b128 v[88:91], v193 offset:5120
    v_mfma_f32_16x16x32_bf16 v[4:7], a[140:143], v[104:107], v[4:7]
    s_waitcnt lgkmcnt(7)
    v_mfma_f32_16x16x32_bf16 v[8:11], a[136:139], v[108:111], v[8:11]
    ds_read_b128 v[92:95], v193 offset:21504
    v_mfma_f32_16x16x32_bf16 v[12:15], a[140:143], v[108:111], v[12:15]
    s_waitcnt lgkmcnt(7)
    v_mfma_f32_16x16x32_bf16 v[0:3], a[144:147], v[64:67], v[0:3]
    ds_read_b128 v[96:99], v193 offset:6144
    v_mfma_f32_16x16x32_bf16 v[4:7], a[148:151], v[64:67], v[4:7]
    s_waitcnt lgkmcnt(7)
    v_mfma_f32_16x16x32_bf16 v[8:11], a[144:147], v[68:71], v[8:11]
    ds_read_b128 v[100:103], v193 offset:22528
    v_mfma_f32_16x16x32_bf16 v[12:15], a[148:151], v[68:71], v[12:15]
    s_waitcnt lgkmcnt(7)
    v_mfma_f32_16x16x32_bf16 v[0:3], a[152:155], v[72:75], v[0:3]
    ds_read_b128 v[104:107], v193 offset:7168
    v_mfma_f32_16x16x32_bf16 v[4:7], a[156:159], v[72:75], v[4:7]
    s_waitcnt lgkmcnt(7)
    v_mfma_f32_16x16x32_bf16 v[8:11], a[152:155], v[76:79], v[8:11]
    ds_read_b128 v[108:111], v193 offset:23552
    v_mfma_f32_16x16x32_bf16 v[12:15], a[156:159], v[76:79], v[12:15]
    s_waitcnt vmcnt(1)
    v_cmp_gt_u32 vcc, s19, v251
    s_nop 0
    s_cbranch_vccz K3_PA_OK
K3_PA:
    s_sleep 4
    buffer_load_dword v251, v250, s[20:23], s18 offen offset:128 sc1
    s_waitcnt vmcnt(0)
    v_cmp_gt_u32 vcc, s19, v251
    s_nop 0
    s_cbranch_vccz K3_PA_OK
    s_branch K3_PA
K3_PA_OK:
    s_barrier
    s_waitcnt lgkmcnt(7)
    v_mfma_f32_16x16x32_bf16 v[0:3], a[160:163], v[80:83], v[0:3]
    ds_read_b128 v[64:67], v193 offset:8192
    v_mfma_f32_16x16x32_bf16 v[4:7], a[164:167], v[80:83], v[4:7]
    buffer_load_dwordx4 v[16:19], v229, s[20:23], s45 offen offset:0
    s_waitcnt lgkmcnt(7)
    v_mfma_f32_16x16x32_bf16 v[8:11], a[160:163], v[84:87], v[8:11]
    ds_read_b128 v[68:71], v193 offset:24576
    v_mfma_f32_16x16x32_bf16 v[12:15], a[164:167], v[84:87], v[12:15]
    s_waitcnt lgkmcnt(7)
    v_mfma_f32_16x16x32_bf16 v[0:3], a[168:171], v[88:91], v[0:3]
    ds_read_b128 v[72:75], v193 offset:9216
    v_mfma_f32_16x16x32_bf16 v[4:7], a[172:175], v[88:91], v[4:7]
    buffer_load_dwordx4 v[20:23], v229, s[20:23], s45 offen offset:1024
    s_waitcnt lgkmcnt(7)
    v_mfma_f32_16x16x32_bf16 v[8:11], a[168:171], v[92:95], v[8:11]
    ds_read_b128 v[76:79], v193 offset:25600
    v_mfma_f32_16x16x32_bf16 v[12:15], a[172:175], v[92:95], v[12:15]
    s_waitcnt lgkmcnt(7)
    v_mfma_f32_16x16x32_bf16 v[0:3], a[176:179], v[96:99], v[0:3]
    ds_read_b128 v[80:83], v193 offset:10240
    v_mfma_f32_16x16x32_bf16 v[4:7], a[180:183], v[96:99], v[4:7]
    buffer_load_dwordx4 v[24:27], v229, s[20:23], s45 offen offset:2048
    s_waitcnt lgkmcnt(7)
    v_mfma_f32_16x16x32_bf16 v[8:11], a[176:179], v[100:103], v[8:11]
    ds_read_b128 v[84:87], v193 offset:26624
    v_mfma_f32_16x16x32_bf16 v[12:15], a[180:183], v[100:103], v[12:15]
    s_waitcnt lgkmcnt(7)
    v_mfma_f32_16x16x32_bf16 v[0:3], a[184:187], v[104:107], v[0:3]
    ds_read_b128 v[88:91], v193 offset:11264
    v_mfma_f32_16x16x32_bf16 v[4:7], a[188:191], v[104:107], v[4:7]
    buffer_load_dwordx4 v[28:31], v229, s[20:23], s45 offen offset:3072
    s_add_u32 s45, s45, 16384
    s_waitcnt lgkmcnt(7)
    v_mfma_f32_16x16x32_bf16 v[8:11], a[184:187], v[108:111], v[8:11]
    ds_read_b128 v[92:95], v193 offset:27648
    v_mfma_f32_16x16x32_bf16 v[12:15], a[188:191], v[108:111], v[12:15]
    s_waitcnt lgkmcnt(7)
    v_mfma_f32_16x16x32_bf16 v[0:3], a[192:195], v[64:67], v[0:3]
    ds_read_b128 v[96:99], v193 offset:12288
    v_mfma_f32_16x16x32_bf16 v[4:7], a[196:199], v[64:67], v[4:7]
    buffer_load_dwordx4 v[32:35], v229, s[20:23], s45 offen offset:0
    s_waitcnt lgkmcnt(7)
    v_mfma_f32_16x16x32_bf16 v[8:11], a[192:195], v[68:71], v[8:11]
    ds_read_b128 v[100:103], v193 offset:28672
    v_mfma_f32_16x16x32_bf16 v[12:15], a[196:199], v[68:71], v[12:15]
    s_waitcnt lgkmcnt(7)
    v_mfma_f32_16x16x32_bf16 v[0:3], a[200:203], v[72:75], v[0:3]
    ds_read_b128 v[104:107], v193 offset:13312
    v_mfma_f32_16x16x32_bf16 v[4:7], a[204:207], v[72:75], v[4:7]
    buffer_load_dwordx4 v[36:39], v229, s[20:23], s45 offen offset:1024
    s_add_u32 s45, s45, 16384
    s_waitcnt lgkmcnt(7)
    v_mfma_f32_16x16x32_bf16 v[8:11], a[200:203], v[76:79], v[8:11]
    ds_read_b128 v[108:111], v193 offset:29696
    v_mfma_f32_16x16x32_bf16 v[12:15], a[204:207], v[76:79], v[12:15]
    s_waitcnt lgkmcnt(7)
    v_mfma_f32_16x16x32_bf16 v[0:3], a[208:211], v[80:83], v[0:3]
    ds_read_b128 v[64:67], v193 offset:14336
    v_mfma_f32_16x16x32_bf16 v[4:7], a[212:215], v[80:83], v[4:7]
    buffer_load_dwordx4 v[48:51], v229, s[20:23], s45 offen offset:0
    s_waitcnt lgkmcnt(7)
    v_mfma_f32_16x16x32_bf16 v[8:11], a[208:211], v[84:87], v[8:11]
    ds_read_b128 v[68:71], v193 offset:30720
    v_mfma_f32_16x16x32_bf16 v[12:15], a[212:215], v[84:87], v[12:15]
    s_waitcnt lgkmcnt(7)
    v_mfma_f32_16x16x32_bf16 v[0:3], a[216:219], v[88:91], v[0:3]
    ds_read_b128 v[72:75], v193 offset:15360
    v_mfma_f32_16x16x32_bf16 v[4:7], a[220:223], v[88:91], v[4:7]
    buffer_load_dwordx4 v[52:55], v229, s[20:23], s45 offen offset:1024
    s_waitcnt lgkmcnt(7)
    v_mfma_f32_16x16x32_bf16 v[8:11], a[216:219], v[92:95], v[8:11]
    ds_read_b128 v[76:79], v193 offset:31744
    v_mfma_f32_16x16x32_bf16 v[12:15], a[220:223], v[92:95], v[12:15]
    s_waitcnt lgkmcnt(7)
    v_mfma_f32_16x16x32_bf16 v[0:3], a[224:227], v[96:99], v[0:3]
    v_mfma_f32_16x16x32_bf16 v[4:7], a[228:231], v[96:99], v[4:7]
    s_waitcnt lgkmcnt(6)
    v_mfma_f32_16x16x32_bf16 v[8:11], a[224:227], v[100:103], v[8:11]
    v_mfma_f32_16x16x32_bf16 v[12:15], a[228:231], v[100:103], v[12:15]
    s_waitcnt lgkmcnt(5)
    v_mfma_f32_16x16x32_bf16 v[0:3], a[232:235], v[104:107], v[0:3]
    buffer_load_dword v251, v250, s[20:23], s18 offen sc1
    v_mfma_f32_16x16x32_bf16 v[4:7], a[236:239], v[104:107], v[4:7]
    s_waitcnt lgkmcnt(4)
    v_mfma_f32_16x16x32_bf16 v[8:11], a[232:235], v[108:111], v[8:11]
    v_mfma_f32_16x16x32_bf16 v[12:15], a[236:239], v[108:111], v[12:15]
    s_waitcnt lgkmcnt(3)
    v_mfma_f32_16x16x32_bf16 v[0:3], a[240:243], v[64:67], v[0:3]
    v_mfma_f32_16x16x32_bf16 v[4:7], a[244:247], v[64:67], v[4:7]
    s_waitcnt lgkmcnt(2)
    v_mfma_f32_16x16x32_bf16 v[8:11], a[240:243], v[68:71], v[8:11]
    v_mfma_f32_16x16x32_bf16 v[12:15], a[244:247], v[68:71], v[12:15]
    s_waitcnt lgkmcnt(1)
    v_mfma_f32_16x16x32_bf16 v[0:3], a[248:251], v[72:75], v[0:3]
    v_mfma_f32_16x16x32_bf16 v[4:7], a[252:255], v[72:75], v[4:7]
    s_waitcnt lgkmcnt(0)
    v_mfma_f32_16x16x32_bf16 v[8:11], a[248:251], v[76:79], v[8:11]
    v_mfma_f32_16x16x32_bf16 v[12:15], a[252:255], v[76:79], v[12:15]
    s_waitcnt vmcnt(0)
    v_cmp_gt_u32 vcc, s19, v251
    s_nop 0
    s_cbranch_vccz K3_PX_OK
K3_PX:
    s_sleep 4
    buffer_load_dword v251, v250, s[20:23], s18 offen sc1
    s_waitcnt vmcnt(0)
    v_cmp_gt_u32 vcc, s19, v251
    s_nop 0
    s_cbranch_vccz K3_PX_OK
    s_branch K3_PX
K3_PX_OK:
    s_barrier
    buffer_load_dwordx4 v[56:59], v229, s[20:23], s45 offen offset:2048
    buffer_load_dwordx4 v[60:63], v229, s[20:23], s45 offen offset:3072
    s_sub_u32 s45, s45, 16384
    buffer_load_dwordx4 v[40:43], v229, s[20:23], s45 offen offset:2048
    buffer_load_dwordx4 v[44:47], v229, s[20:23], s45 offen offset:3072
    v_add_f32 v144, v144, v145
    v_add_f32 v146, v146, v147
    v_add_f32 v144, v144, v146
    v_cvt_pk_bf16_f32 v145, v144, v144
    v_and_b32 v145, 0xffff0000, v145
    v_sub_f32 v144, v144, v145
    v_cvt_pk_bf16_f32 v144, v145, v144
    v_mov_b32 v145, 0
    v_mov_b64 v[146:147], 0
    v_add_f32 v148, v148, v149
    v_add_f32 v150, v150, v151
    v_add_f32 v148, v148, v150
    v_cvt_pk_bf16_f32 v149, v148, v148
    v_and_b32 v149, 0xffff0000, v149
    v_sub_f32 v148, v148, v149
    v_cvt_pk_bf16_f32 v148, v149, v148
    v_mov_b32 v149, 0
    v_mov_b64 v[150:151], 0
    v_add_f32 v152, v152, v153
    v_add_f32 v154, v154, v155
    v_add_f32 v152, v152, v154
    v_cvt_pk_bf16_f32 v153, v152, v152
    v_and_b32 v153, 0xffff0000, v153
    v_sub_f32 v152, v152, v153
    v_cvt_pk_bf16_f32 v152, v153, v152
    v_mov_b32 v153, 0
    v_mov_b64 v[154:155], 0
    v_add_f32 v156, v156, v157
    v_add_f32 v158, v158, v159
    v_add_f32 v156, v156, v158
    v_cvt_pk_bf16_f32 v157, v156, v156
    v_and_b32 v157, 0xffff0000, v157
    v_sub_f32 v156, v156, v157
    v_cvt_pk_bf16_f32 v156, v157, v156
    v_mov_b32 v157, 0
    v_mov_b64 v[158:159], 0
    v_add_f32 v160, v160, v161
    v_add_f32 v162, v162, v163
    v_add_f32 v160, v160, v162
    v_cvt_pk_bf16_f32 v161, v160, v160
    v_and_b32 v161, 0xffff0000, v161
    v_sub_f32 v160, v160, v161
    v_cvt_pk_bf16_f32 v160, v161, v160
    v_mov_b32 v161, 0
    v_mov_b64 v[162:163], 0
    v_add_f32 v164, v164, v165
    v_add_f32 v166, v166, v167
    v_add_f32 v164, v164, v166
    v_cvt_pk_bf16_f32 v165, v164, v164
    v_and_b32 v165, 0xffff0000, v165
    v_sub_f32 v164, v164, v165
    v_cvt_pk_bf16_f32 v164, v165, v164
    v_mov_b32 v165, 0
    v_mov_b64 v[166:167], 0
    v_add_f32 v232, 1.0, v232
    v_add_f32 v233, 1.0, v233
    v_cvt_pk_bf16_f32 v244, v232, v233
    v_lshlrev_b32 v232, 16, v244
    v_and_b32 v233, 0xffff0000, v244
    v_add_f32 v234, 1.0, v234
    v_add_f32 v235, 1.0, v235
    v_cvt_pk_bf16_f32 v244, v234, v235
    v_lshlrev_b32 v234, 16, v244
    v_and_b32 v235, 0xffff0000, v244
    v_add_f32 v236, 1.0, v236
    v_add_f32 v237, 1.0, v237
    v_cvt_pk_bf16_f32 v244, v236, v237
    v_lshlrev_b32 v236, 16, v244
    v_and_b32 v237, 0xffff0000, v244
    v_add_f32 v238, 1.0, v238
    v_add_f32 v239, 1.0, v239
    v_cvt_pk_bf16_f32 v244, v238, v239
    v_lshlrev_b32 v238, 16, v244
    v_and_b32 v239, 0xffff0000, v244
    v_lshlrev_b32 v112, 16, v208
    v_and_b32 v113, 0xffff0000, v208
    v_lshlrev_b32 v114, 16, v209
    v_and_b32 v115, 0xffff0000, v209
    v_lshlrev_b32 v116, 16, v210
    v_and_b32 v117, 0xffff0000, v210
    v_lshlrev_b32 v118, 16, v211
    v_and_b32 v119, 0xffff0000, v211
    v_lshlrev_b32 v120, 16, v212
    v_and_b32 v121, 0xffff0000, v212
    v_lshlrev_b32 v122, 16, v213
    v_and_b32 v123, 0xffff0000, v213
    v_lshlrev_b32 v124, 16, v214
    v_and_b32 v125, 0xffff0000, v214
    v_lshlrev_b32 v126, 16, v215
    v_and_b32 v127, 0xffff0000, v215
    v_add_f32 v0, v0, v16
    v_add_f32 v1, v1, v17
    v_add_f32 v2, v2, v18
    v_add_f32 v3, v3, v19
    v_add_f32 v4, v4, v20
    v_add_f32 v5, v5, v21
    v_add_f32 v6, v6, v22
    v_add_f32 v7, v7, v23
    v_add_f32 v0, v0, v32
    v_add_f32 v1, v1, v33
    v_add_f32 v2, v2, v34
    v_add_f32 v3, v3, v35
    v_add_f32 v4, v4, v36
    v_add_f32 v5, v5, v37
    v_add_f32 v6, v6, v38
    v_add_f32 v7, v7, v39
    v_add_f32 v0, v0, v48
    v_add_f32 v1, v1, v49
    v_add_f32 v2, v2, v50
    v_add_f32 v3, v3, v51
    ds_write_b128 v196, v[0:3] offset:0
    v_add_f32 v4, v4, v52
    v_add_f32 v5, v5, v53
    v_add_f32 v6, v6, v54
    v_add_f32 v7, v7, v55
    ds_write_b128 v197, v[4:7] offset:0
    v_add_f32 v8, v8, v24
    v_add_f32 v9, v9, v25
    v_add_f32 v10, v10, v26
    v_add_f32 v11, v11, v27
    v_add_f32 v12, v12, v28
    v_add_f32 v13, v13, v29
    v_add_f32 v14, v14, v30
    v_add_f32 v15, v15, v31
    s_waitcnt vmcnt(1)
    v_add_f32 v8, v8, v40
    v_add_f32 v9, v9, v41
    v_add_f32 v10, v10, v42
    v_add_f32 v11, v11, v43
    s_waitcnt vmcnt(0)
    v_add_f32 v12, v12, v44
    v_add_f32 v13, v13, v45
    v_add_f32 v14, v14, v46
    v_add_f32 v15, v15, v47
    v_add_f32 v8, v8, v56
    v_add_f32 v9, v9, v57
    v_add_f32 v10, v10, v58
    v_add_f32 v11, v11, v59
    ds_write_b128 v196, v[8:11] offset:4096
    v_add_f32 v12, v12, v60
    v_add_f32 v13, v13, v61
    v_add_f32 v14, v14, v62
    v_add_f32 v15, v15, v63
    ds_write_b128 v197, v[12:15] offset:4096
    s_waitcnt lgkmcnt(0)
    s_barrier
    ds_read_b128 v[0:3], v200 offset:0
    ds_read_b128 v[4:7], v200 offset:128
    ds_read_b128 v[32:35], v200 offset:2048
    ds_read_b128 v[36:39], v200 offset:2176
    s_waitcnt lgkmcnt(3)
    v_cvt_pk_bf16_f32 v244, v0, v1
    v_lshlrev_b32 v0, 16, v244
    v_and_b32 v1, 0xffff0000, v244
    v_mul_f32 v0, v0, v216
    v_mul_f32 v1, v1, v217
    v_cvt_pk_bf16_f32 v244, v0, v1
    v_lshlrev_b32 v0, 16, v244
    v_and_b32 v1, 0xffff0000, v244
    v_add_f32 v0, v0, v112
    v_add_f32 v1, v1, v113
    v_cvt_pk_bf16_f32 v16, v0, v1
    v_cvt_pk_bf16_f32 v244, v2, v3
    v_lshlrev_b32 v2, 16, v244
    v_and_b32 v3, 0xffff0000, v244
    v_mul_f32 v2, v2, v218
    v_mul_f32 v3, v3, v219
    v_cvt_pk_bf16_f32 v244, v2, v3
    v_lshlrev_b32 v2, 16, v244
    v_and_b32 v3, 0xffff0000, v244
    v_add_f32 v2, v2, v114
    v_add_f32 v3, v3, v115
    v_cvt_pk_bf16_f32 v17, v2, v3
    s_waitcnt lgkmcnt(2)
    v_cvt_pk_bf16_f32 v244, v4, v5
    v_lshlrev_b32 v4, 16, v244
    v_and_b32 v5, 0xffff0000, v244
    v_mul_f32 v4, v4, v220
    v_mul_f32 v5, v5, v221
    v_cvt_pk_bf16_f32 v244, v4, v5
    v_lshlrev_b32 v4, 16, v244
    v_and_b32 v5, 0xffff0000, v244
    v_add_f32 v4, v4, v116
    v_add_f32 v5, v5, v117
    v_cvt_pk_bf16_f32 v18, v4, v5
    v_cvt_pk_bf16_f32 v244, v6, v7
    v_lshlrev_b32 v6, 16, v244
    v_and_b32 v7, 0xffff0000, v244
    v_mul_f32 v6, v6, v222
    v_mul_f32 v7, v7, v223
    v_cvt_pk_bf16_f32 v244, v6, v7
    v_lshlrev_b32 v6, 16, v244
    v_and_b32 v7, 0xffff0000, v244
    v_add_f32 v6, v6, v118
    v_add_f32 v7, v7, v119
    v_cvt_pk_bf16_f32 v19, v6, v7
    buffer_store_dwordx4 v[16:19], v201, s[20:23], s32 offen sc1
    s_add_u32 s32, s32, 8192
    v_lshlrev_b32 v0, 16, v16
    v_and_b32 v1, 0xffff0000, v16
    v_lshlrev_b32 v2, 16, v17
    v_and_b32 v3, 0xffff0000, v17
    v_lshlrev_b32 v4, 16, v18
    v_and_b32 v5, 0xffff0000, v18
    v_lshlrev_b32 v6, 16, v19
    v_and_b32 v7, 0xffff0000, v19
    v_mul_f32 v8, v0, v232
    v_mul_f32 v9, v1, v233
    v_cvt_pk_bf16_f32 v20, v8, v9
    v_mul_f32 v8, v2, v234
    v_mul_f32 v9, v3, v235
    v_cvt_pk_bf16_f32 v21, v8, v9
    v_mul_f32 v8, v4, v236
    v_mul_f32 v9, v5, v237
    v_cvt_pk_bf16_f32 v22, v8, v9
    v_mul_f32 v8, v6, v238
    v_mul_f32 v9, v7, v239
    v_cvt_pk_bf16_f32 v23, v8, v9
    buffer_store_dwordx4 v[20:23], v204, s[20:23], s34 offen offset:0 sc1
    s_waitcnt lgkmcnt(1)
    v_cvt_pk_bf16_f32 v244, v32, v33
    v_lshlrev_b32 v32, 16, v244
    v_and_b32 v33, 0xffff0000, v244
    v_mul_f32 v32, v32, v216
    v_mul_f32 v33, v33, v217
    v_cvt_pk_bf16_f32 v244, v32, v33
    v_lshlrev_b32 v32, 16, v244
    v_and_b32 v33, 0xffff0000, v244
    v_add_f32 v32, v32, v120
    v_add_f32 v33, v33, v121
    v_cvt_pk_bf16_f32 v48, v32, v33
    v_cvt_pk_bf16_f32 v244, v34, v35
    v_lshlrev_b32 v34, 16, v244
    v_and_b32 v35, 0xffff0000, v244
    v_mul_f32 v34, v34, v218
    v_mul_f32 v35, v35, v219
    v_cvt_pk_bf16_f32 v244, v34, v35
    v_lshlrev_b32 v34, 16, v244
    v_and_b32 v35, 0xffff0000, v244
    v_add_f32 v34, v34, v122
    v_add_f32 v35, v35, v123
    v_cvt_pk_bf16_f32 v49, v34, v35
    s_waitcnt lgkmcnt(0)
    v_cvt_pk_bf16_f32 v244, v36, v37
    v_lshlrev_b32 v36, 16, v244
    v_and_b32 v37, 0xffff0000, v244
    v_mul_f32 v36, v36, v220
    v_mul_f32 v37, v37, v221
    v_cvt_pk_bf16_f32 v244, v36, v37
    v_lshlrev_b32 v36, 16, v244
    v_and_b32 v37, 0xffff0000, v244
    v_add_f32 v36, v36, v124
    v_add_f32 v37, v37, v125
    v_cvt_pk_bf16_f32 v50, v36, v37
    v_cvt_pk_bf16_f32 v244, v38, v39
    v_lshlrev_b32 v38, 16, v244
    v_and_b32 v39, 0xffff0000, v244
    v_mul_f32 v38, v38, v222
    v_mul_f32 v39, v39, v223
    v_cvt_pk_bf16_f32 v244, v38, v39
    v_lshlrev_b32 v38, 16, v244
    v_and_b32 v39, 0xffff0000, v244
    v_add_f32 v38, v38, v126
    v_add_f32 v39, v39, v127
    v_cvt_pk_bf16_f32 v51, v38, v39
    buffer_store_dwordx4 v[48:51], v201, s[20:23], s32 offen sc1
    v_lshlrev_b32 v32, 16, v48
    v_and_b32 v33, 0xffff0000, v48
    v_lshlrev_b32 v34, 16, v49
    v_and_b32 v35, 0xffff0000, v49
    v_lshlrev_b32 v36, 16, v50
    v_and_b32 v37, 0xffff0000, v50
    v_lshlrev_b32 v38, 16, v51
    v_and_b32 v39, 0xffff0000, v51
    v_mul_f32 v40, v32, v232
    v_mul_f32 v41, v33, v233
    v_cvt_pk_bf16_f32 v52, v40, v41
    v_mul_f32 v40, v34, v234
    v_mul_f32 v41, v35, v235
    v_cvt_pk_bf16_f32 v53, v40, v41
    v_mul_f32 v40, v36, v236
    v_mul_f32 v41, v37, v237
    v_cvt_pk_bf16_f32 v54, v40, v41
    v_mul_f32 v40, v38, v238
    v_mul_f32 v41, v39, v239
    v_cvt_pk_bf16_f32 v55, v40, v41
    buffer_store_dwordx4 v[52:55], v204, s[20:23], s34 offen offset:128 sc1
    v_add_f32 v24, v0, v1
    v_add_f32 v56, v32, v33
    v_add_f32 v24, v24, v2
    v_add_f32 v56, v56, v34
    v_add_f32 v24, v24, v3
    v_add_f32 v56, v56, v35
    v_add_f32 v24, v24, v4
    v_add_f32 v56, v56, v36
    v_add_f32 v24, v24, v5
    v_add_f32 v56, v56, v37
    v_add_f32 v24, v24, v6
    v_add_f32 v56, v56, v38
    v_add_f32 v24, v24, v7
    v_add_f32 v56, v56, v39
    s_nop 0
    v_add_f32_dpp v24, v24, v24 quad_perm:[1,0,3,2] row_mask:0xf bank_mask:0xf
    v_add_f32_dpp v56, v56, v56 quad_perm:[1,0,3,2] row_mask:0xf bank_mask:0xf
    s_nop 0
    v_add_f32_dpp v24, v24, v24 quad_perm:[2,3,0,1] row_mask:0xf bank_mask:0xf
    v_add_f32_dpp v56, v56, v56 quad_perm:[2,3,0,1] row_mask:0xf bank_mask:0xf
    s_nop 0
    v_add_f32_dpp v24, v24, v24 row_half_mirror row_mask:0xf bank_mask:0xf
    v_add_f32_dpp v56, v56, v56 row_half_mirror row_mask:0xf bank_mask:0xf
    v_mul_f32 v26, 0x3c800000, v24
    v_mul_f32 v58, 0x3c800000, v56
    v_sub_f32 v27, v0, v26
    v_sub_f32 v59, v32, v58
    v_mul_f32 v25, v27, v27
    v_mul_f32 v57, v59, v59
    v_sub_f32 v27, v1, v26
    v_sub_f32 v59, v33, v58
    v_fmac_f32 v25, v27, v27
    v_fmac_f32 v57, v59, v59
    v_sub_f32 v27, v2, v26
    v_sub_f32 v59, v34, v58
    v_fmac_f32 v25, v27, v27
    v_fmac_f32 v57, v59, v59
    v_sub_f32 v27, v3, v26
    v_sub_f32 v59, v35, v58
    v_fmac_f32 v25, v27, v27
    v_fmac_f32 v57, v59, v59
    v_sub_f32 v27, v4, v26
    v_sub_f32 v59, v36, v58
    v_fmac_f32 v25, v27, v27
    v_fmac_f32 v57, v59, v59
    v_sub_f32 v27, v5, v26
    v_sub_f32 v59, v37, v58
    v_fmac_f32 v25, v27, v27
    v_fmac_f32 v57, v59, v59
    v_sub_f32 v27, v6, v26
    v_sub_f32 v59, v38, v58
    v_fmac_f32 v25, v27, v27
    v_fmac_f32 v57, v59, v59
    v_sub_f32 v27, v7, v26
    v_sub_f32 v59, v39, v58
    v_fmac_f32 v25, v27, v27
    v_fmac_f32 v57, v59, v59
    s_nop 0
    v_add_f32_dpp v25, v25, v25 quad_perm:[1,0,3,2] row_mask:0xf bank_mask:0xf
    v_add_f32_dpp v57, v57, v57 quad_perm:[1,0,3,2] row_mask:0xf bank_mask:0xf
    s_nop 0
    v_add_f32_dpp v25, v25, v25 quad_perm:[2,3,0,1] row_mask:0xf bank_mask:0xf
    v_add_f32_dpp v57, v57, v57 quad_perm:[2,3,0,1] row_mask:0xf bank_mask:0xf
    s_nop 0
    v_add_f32_dpp v25, v25, v25 row_half_mirror row_mask:0xf bank_mask:0xf
    v_add_f32_dpp v57, v57, v57 row_half_mirror row_mask:0xf bank_mask:0xf
    v_cndmask_b32 v24, v24, v56, s[36:37]
    v_cndmask_b32 v25, v25, v57, s[36:37]
    buffer_store_dwordx2 v[24:25], v203, s[20:23], s35 offen sc1
    s_waitcnt vmcnt(0)
    s_barrier
    buffer_atomic_add v249, v248, s[20:23], s29 offen sc1
    s_cmp_ge_u32 s2, 240
    s_cbranch_scc1 K45_IDLE
    s_add_u32 s49, s51, 16384
    s_add_u32 m0, s46, 32768
    s_nop 0
    buffer_load_dwordx4 v229, s[20:23], s49 offen offset:0 lds
    buffer_load_dwordx4 v229, s[20:23], s49 offen offset:1024 lds
    buffer_load_dwordx4 v229, s[20:23], s49 offen offset:2048 lds
    buffer_load_dwordx4 v229, s[20:23], s49 offen offset:3072 lds
    s_add_u32 s49, s56, 81920
    s_add_u32 m0, s46, 49152
    s_nop 0
    buffer_load_dwordx4 v229, s[20:23], s49 offen offset:0 lds
    buffer_load_dwordx4 v229, s[20:23], s49 offen offset:1024 lds
    buffer_load_dwordx4 v229, s[20:23], s49 offen offset:2048 lds
    buffer_load_dwordx4 v229, s[20:23], s49 offen offset:3072 lds
    s_add_u32 s49, s51, 32768
    s_add_u32 m0, s46, 65536
    s_nop 0
    buffer_load_dwordx4 v229, s[20:23], s49 offen offset:0 lds
    buffer_load_dwordx4 v229, s[20:23], s49 offen offset:1024 lds
    buffer_load_dwordx4 v229, s[20:23], s49 offen offset:2048 lds
    buffer_load_dwordx4 v229, s[20:23], s49 offen offset:3072 lds
    s_add_u32 s49, s51, 49152
    s_add_u32 m0, s46, 81920
    s_nop 0
    buffer_load_dwordx4 v229, s[20:23], s49 offen offset:0 lds
    buffer_load_dwordx4 v229, s[20:23], s49 offen offset:1024 lds
    buffer_load_dwordx4 v229, s[20:23], s49 offen offset:2048 lds
    buffer_load_dwordx4 v229, s[20:23], s49 offen offset:3072 lds
    buffer_load_dword v222, off, s[20:23], s67 sc1
    s_add_u32 s49, s56, 98304
    s_add_u32 m0, s46, 98304
    s_nop 0
    buffer_load_dwordx4 v229, s[20:23], s49 offen offset:0 lds
    buffer_load_dwordx4 v229, s[20:23], s49 offen offset:1024 lds
    buffer_load_dwordx4 v229, s[20:23], s49 offen offset:2048 lds
    buffer_load_dwordx4 v229, s[20:23], s49 offen offset:3072 lds
    s_add_u32 s49, s56, 114688
    s_add_u32 m0, s46, 114688
    s_nop 0
    buffer_load_dwordx4 v229, s[20:23], s49 offen offset:0 lds
    buffer_load_dwordx4 v229, s[20:23], s49 offen offset:1024 lds
    buffer_load_dwordx4 v229, s[20:23], s49 offen offset:2048 lds
    buffer_load_dwordx4 v229, s[20:23], s49 offen offset:3072 lds
    s_add_u32 s49, s56, 131072
    s_add_u32 m0, s46, 131072
    s_nop 0
    buffer_load_dwordx4 v229, s[20:23], s49 offen offset:0 lds
    buffer_load_dwordx4 v229, s[20:23], s49 offen offset:1024 lds
    buffer_load_dwordx4 v229, s[20:23], s49 offen offset:2048 lds
    buffer_load_dwordx4 v229, s[20:23], s49 offen offset:3072 lds
    s_add_u32 s49, s56, 147456
    s_add_u32 m0, s46, 147456
    s_nop 0
    buffer_load_dwordx4 v229, s[20:23], s49 offen offset:0 lds
    buffer_load_dwordx4 v229, s[20:23], s49 offen offset:1024 lds
    buffer_load_dwordx4 v229, s[20:23], s49 offen offset:2048 lds
    buffer_load_dwordx4 v229, s[20:23], s49 offen offset:3072 lds
    s_waitcnt vmcnt(16)
    v_cmp_gt_u32 vcc, s66, v222
    s_nop 0
    s_cbranch_vccz K4_PY_OK
K4_PY:
    s_sleep 4
    buffer_load_dword v222, off, s[20:23], s67 sc1
    s_waitcnt vmcnt(0)
    v_cmp_gt_u32 vcc, s66, v222
    s_nop 0
    s_cbranch_vccz K4_PY_OK
    s_branch K4_PY
K4_PY_OK:
    s_barrier
    s_add_u32 s50, s52, 0
    buffer_load_dwordx4 a[0:3], v229, s[20:23], s50 offen offset:0
    buffer_load_dwordx4 a[4:7], v229, s[20:23], s50 offen offset:1024
    buffer_load_dwordx4 a[8:11], v229, s[20:23], s50 offen offset:2048
    buffer_load_dwordx4 a[12:15], v229, s[20:23], s50 offen offset:3072
    s_add_u32 s50, s52, 4096
    buffer_load_dwordx4 a[16:19], v229, s[20:23], s50 offen offset:0
    buffer_load_dwordx4 a[20:23], v229, s[20:23], s50 offen offset:1024
    buffer_load_dwordx4 a[24:27], v229, s[20:23], s50 offen offset:2048
    buffer_load_dwordx4 a[28:31], v229, s[20:23], s50 offen offset:3072
    s_add_u32 s50, s52, 8192
    buffer_load_dwordx4 a[32:35], v229, s[20:23], s50 offen offset:0
    buffer_load_dwordx4 a[36:39], v229, s[20:23], s50 offen offset:1024
    buffer_load_dwordx4 a[40:43], v229, s[20:23], s50 offen offset:2048
    buffer_load_dwordx4 a[44:47], v229, s[20:23], s50 offen offset:3072
    s_add_u32 s50, s52, 12288
    buffer_load_dwordx4 a[48:51], v229, s[20:23], s50 offen offset:0
    buffer_load_dwordx4 a[52:55], v229, s[20:23], s50 offen offset:1024
    buffer_load_dwordx4 a[56:59], v229, s[20:23], s50 offen offset:2048
    buffer_load_dwordx4 a[60:63], v229, s[20:23], s50 offen offset:3072
    ds_read_b128 v[96:99], v170 offset:0
    ds_read_b128 v[100:103], v170 offset:1024
    ds_read_b128 v[104:107], v170 offset:2048
    ds_read_b128 v[108:111], v170 offset:3072
    ds_read_b128 v[112:115], v170 offset:4096
    ds_read_b128 v[116:119], v170 offset:5120
    s_waitcnt vmcnt(15) lgkmcnt(5)
    v_mfma_f32_32x32x16_bf16 v[0:15], v[96:99], a[0:3], 0
    ds_read_b128 v[120:123], v170 offset:6144
    s_add_u32 s50, s52, 16384
    s_waitcnt lgkmcnt(5)
    v_mfma_f32_32x32x16_bf16 v[16:31], v[100:103], a[0:3], 0
    ds_read_b128 v[124:127], v170 offset:7168
    buffer_load_dwordx4 a[64:67], v229, s[20:23], s50 offen offset:0
    s_waitcnt vmcnt(15) lgkmcnt(5)
    v_mfma_f32_32x32x16_bf16 v[0:15], v[104:107], a[4:7], v[0:15]
    ds_read_b128 v[96:99], v170 offset:8192
    s_waitcnt lgkmcnt(5)
    v_mfma_f32_32x32x16_bf16 v[16:31], v[108:111], a[4:7], v[16:31]
    ds_read_b128 v[100:103], v170 offset:9216
    buffer_load_dwordx4 a[68:71], v229, s[20:23], s50 offen offset:1024
    s_waitcnt vmcnt(15) lgkmcnt(5)
    v_mfma_f32_32x32x16_bf16 v[0:15], v[112:115], a[8:11], v[0:15]
    ds_read_b128 v[104:107], v170 offset:10240
    s_waitcnt lgkmcnt(5)
    v_mfma_f32_32x32x16_bf16 v[16:31], v[116:119], a[8:11], v[16:31]
    ds_read_b128 v[108:111], v170 offset:11264
    buffer_load_dwordx4 a[72:75], v229, s[20:23], s50 offen offset:2048
    s_waitcnt lgkmcnt(4)
    s_waitcnt vmcnt(15)
    v_mfma_f32_32x32x16_bf16 v[0:15], v[120:123], a[12:15], v[0:15]
    ds_read_b128 v[112:115], v170 offset:12288
    v_mfma_f32_32x32x16_bf16 v[16:31], v[124:127], a[12:15], v[16:31]
    ds_read_b128 v[116:119], v170 offset:13312
    buffer_load_dwordx4 a[76:79], v229, s[20:23], s50 offen offset:3072
    s_waitcnt lgkmcnt(4)
    s_barrier
    s_waitcnt vmcnt(15)
    v_mfma_f32_32x32x16_bf16 v[0:15], v[96:99], a[16:19], v[0:15]
    ds_read_b128 v[120:123], v170 offset:14336
    s_add_u32 s50, s52, 20480
    v_mfma_f32_32x32x16_bf16 v[16:31], v[100:103], a[16:19], v[16:31]
    ds_read_b128 v[124:127], v170 offset:15360
    buffer_load_dwordx4 a[80:83], v229, s[20:23], s50 offen offset:0
    s_waitcnt lgkmcnt(4)
    s_waitcnt vmcnt(15)
    v_mfma_f32_32x32x16_bf16 v[0:15], v[104:107], a[20:23], v[0:15]
    ds_read_b128 v[96:99], v170 offset:16384
    v_mfma_f32_32x32x16_bf16 v[16:31], v[108:111], a[20:23], v[16:31]
    ds_read_b128 v[100:103], v170 offset:17408
    buffer_load_dwordx4 a[84:87], v229, s[20:23], s50 offen offset:1024
    s_waitcnt lgkmcnt(4)
    s_waitcnt vmcnt(15)
    v_mfma_f32_32x32x16_bf16 v[0:15], v[112:115], a[24:27], v[0:15]
    ds_read_b128 v[104:107], v170 offset:18432
    v_mfma_f32_32x32x16_bf16 v[16:31], v[116:119], a[24:27], v[16:31]
    ds_read_b128 v[108:111], v170 offset:19456
    buffer_load_dwordx4 a[88:91], v229, s[20:23], s50 offen offset:2048
    s_waitcnt lgkmcnt(4)
    s_waitcnt vmcnt(15)
    v_mfma_f32_32x32x16_bf16 v[0:15], v[120:123], a[28:31], v[0:15]
    ds_read_b128 v[112:115], v170 offset:20480
    v_mfma_f32_32x32x16_bf16 v[16:31], v[124:127], a[28:31], v[16:31]
    ds_read_b128 v[116:119], v170 offset:21504
    buffer_load_dwordx4 a[92:95], v229, s[20:23], s50 offen offset:3072
    s_waitcnt lgkmcnt(4)
    v_mfma_f32_32x32x16_bf16 v[32:47], v[96:99], a[0:3], 0
    ds_read_b128 v[120:123], v170 offset:22528
    s_add_u32 s50, s52, 24576
    v_mfma_f32_32x32x16_bf16 v[48:63], v[100:103], a[0:3], 0
    ds_read_b128 v[124:127], v170 offset:23552
    buffer_load_dwordx4 a[96:99], v229, s[20:23], s50 offen offset:0
    s_waitcnt lgkmcnt(4)
    v_mfma_f32_32x32x16_bf16 v[32:47], v[104:107], a[4:7], v[32:47]
    ds_read_b128 v[96:99], v170 offset:24576
    v_mfma_f32_32x32x16_bf16 v[48:63], v[108:111], a[4:7], v[48:63]
    ds_read_b128 v[100:103], v170 offset:25600
    buffer_load_dwordx4 a[100:103], v229, s[20:23], s50 offen offset:1024
    s_waitcnt lgkmcnt(4)
    v_mfma_f32_32x32x16_bf16 v[32:47], v[112:115], a[8:11], v[32:47]
    ds_read_b128 v[104:107], v170 offset:26624
    v_mfma_f32_32x32x16_bf16 v[48:63], v[116:119], a[8:11], v[48:63]
    ds_read_b128 v[108:111], v170 offset:27648
    buffer_load_dwordx4 a[104:107], v229, s[20:23], s50 offen offset:2048
    s_waitcnt lgkmcnt(4)
    v_mfma_f32_32x32x16_bf16 v[32:47], v[120:123], a[12:15], v[32:47]
    ds_read_b128 v[112:115], v170 offset:28672
    v_mfma_f32_32x32x16_bf16 v[48:63], v[124:127], a[12:15], v[48:63]
    ds_read_b128 v[116:119], v170 offset:29696
    buffer_load_dwordx4 a[108:111], v229, s[20:23], s50 offen offset:3072
    s_waitcnt lgkmcnt(4)
    s_barrier
    v_mfma_f32_32x32x16_bf16 v[32:47], v[96:99], a[16:19], v[32:47]
    ds_read_b128 v[120:123], v170 offset:30720
    s_add_u32 s50, s52, 28672
    v_mfma_f32_32x32x16_bf16 v[48:63], v[100:103], a[16:19], v[48:63]
    ds_read_b128 v[124:127], v170 offset:31744
    buffer_load_dwordx4 a[112:115], v229, s[20:23], s50 offen offset:0
    s_waitcnt lgkmcnt(4)
    v_mfma_f32_32x32x16_bf16 v[32:47], v[104:107], a[20:23], v[32:47]
    ds_read_b128 v[96:99], v170 offset:32768
    v_mfma_f32_32x32x16_bf16 v[48:63], v[108:111], a[20:23], v[48:63]
    ds_read_b128 v[100:103], v170 offset:33792
    buffer_load_dwordx4 a[116:119], v229, s[20:23], s50 offen offset:1024
    s_waitcnt lgkmcnt(4)
    v_mfma_f32_32x32x16_bf16 v[32:47], v[112:115], a[24:27], v[32:47]
    ds_read_b128 v[104:107], v170 offset:34816
    v_mfma_f32_32x32x16_bf16 v[48:63], v[116:119], a[24:27], v[48:63]
    ds_read_b128 v[108:111], v170 offset:35840
    buffer_load_dwordx4 a[120:123], v229, s[20:23], s50 offen offset:2048
    s_waitcnt lgkmcnt(4)
    v_mfma_f32_32x32x16_bf16 v[32:47], v[120:123], a[28:31], v[32:47]
    ds_read_b128 v[112:115], v170 offset:36864
    v_mfma_f32_32x32x16_bf16 v[48:63], v[124:127], a[28:31], v[48:63]
    ds_read_b128 v[116:119], v170 offset:37888
    buffer_load_dwordx4 a[124:127], v229, s[20:23], s50 offen offset:3072
    s_waitcnt lgkmcnt(4)
    s_waitcnt vmcnt(23)
    v_mfma_f32_32x32x16_bf16 v[0:15], v[96:99], a[32:35], v[0:15]
    ds_read_b128 v[120:123], v170 offset:38912
    v_mfma_f32_32x32x16_bf16 v[16:31], v[100:103], a[32:35], v[16:31]
    ds_read_b128 v[124:127], v170 offset:39936
    buffer_load_dwordx2 v[128:129], v179, s[20:23], s57 offen
    s_add_u32 s57, s57, 16384
    s_waitcnt lgkmcnt(4)
    s_waitcnt vmcnt(23)
    v_mfma_f32_32x32x16_bf16 v[0:15], v[104:107], a[36:39], v[0:15]
    ds_read_b128 v[96:99], v170 offset:40960
    buffer_load_dwordx2 v[130:131], v179, s[20:23], s57 offen
    s_add_u32 s57, s57, 16384
    v_mfma_f32_32x32x16_bf16 v[16:31], v[108:111], a[36:39], v[16:31]
    ds_read_b128 v[100:103], v170 offset:41984
    buffer_load_dwordx2 v[132:133], v179, s[20:23], s57 offen
    s_add_u32 s57, s57, 16384
    s_waitcnt lgkmcnt(4)
    s_waitcnt vmcnt(24)
    v_mfma_f32_32x32x16_bf16 v[0:15], v[112:115], a[40:43], v[0:15]
    ds_read_b128 v[104:107], v170 offset:43008
    buffer_load_dwordx2 v[134:135], v179, s[20:23], s57 offen
    s_add_u32 s57, s57, 16384
    v_mfma_f32_32x32x16_bf16 v[16:31], v[116:119], a[40:43], v[16:31]
    ds_read_b128 v[108:111], v170 offset:44032
    buffer_load_dwordx2 v[136:137], v179, s[20:23], s57 offen
    s_add_u32 s57, s57, 16384
    s_waitcnt lgkmcnt(4)
    s_waitcnt vmcnt(25)
    v_mfma_f32_32x32x16_bf16 v[0:15], v[120:123], a[44:47], v[0:15]
    ds_read_b128 v[112:115], v170 offset:45056
    buffer_load_dwordx2 v[138:139], v179, s[20:23], s57 offen
    s_add_u32 s57, s57, 16384
    v_mfma_f32_32x32x16_bf16 v[16:31], v[124:127], a[44:47], v[16:31]
    ds_read_b128 v[116:119], v170 offset:46080
    buffer_load_dwordx2 v[140:141], v179, s[20:23], s57 offen
    s_add_u32 s57, s57, 16384
    s_waitcnt lgkmcnt(4)
    s_barrier
    s_waitcnt vmcnt(26)
    v_mfma_f32_32x32x16_bf16 v[0:15], v[96:99], a[48:51], v[0:15]
    ds_read_b128 v[120:123], v170 offset:47104
    buffer_load_dwordx2 v[142:143], v179, s[20:23], s57 offen
    s_add_u32 s57, s57, 16384
    s_add_u32 s49, s56, 163840
    s_add_u32 m0, s46, 0
    v_mfma_f32_32x32x16_bf16 v[16:31], v[100:103], a[48:51], v[16:31]
    ds_read_b128 v[124:127], v170 offset:48128
    buffer_load_dwordx4 v229, s[20:23], s49 offen offset:0 lds
    s_waitcnt lgkmcnt(4)
    s_waitcnt vmcnt(27)
    v_mfma_f32_32x32x16_bf16 v[0:15], v[104:107], a[52:55], v[0:15]
    ds_read_b128 v[96:99], v170 offset:49152
    v_mfma_f32_32x32x16_bf16 v[16:31], v[108:111], a[52:55], v[16:31]
    ds_read_b128 v[100:103], v170 offset:50176
    s_waitcnt lgkmcnt(4)
    s_waitcnt vmcnt(26)
    v_mfma_f32_32x32x16_bf16 v[0:15], v[112:115], a[56:59], v[0:15]
    ds_read_b128 v[104:107], v170 offset:51200
    buffer_load_dwordx4 v229, s[20:23], s49 offen offset:1024 lds
    v_mfma_f32_32x32x16_bf16 v[16:31], v[116:119], a[56:59], v[16:31]
    ds_read_b128 v[108:111], v170 offset:52224
    s_waitcnt lgkmcnt(4)
    s_waitcnt vmcnt(26)
    v_mfma_f32_32x32x16_bf16 v[0:15], v[120:123], a[60:63], v[0:15]
    ds_read_b128 v[112:115], v170 offset:53248
    v_mfma_f32_32x32x16_bf16 v[16:31], v[124:127], a[60:63], v[16:31]
    ds_read_b128 v[116:119], v170 offset:54272
    buffer_load_dwordx4 v229, s[20:23], s49 offen offset:2048 lds
    s_waitcnt lgkmcnt(4)
    v_mfma_f32_32x32x16_bf16 v[32:47], v[96:99], a[32:35], v[32:47]
    ds_read_b128 v[120:123], v170 offset:55296
    s_and_b32 s64, s2, 6
    s_bfe_u32 s65, s2, 0x10006
    s_add_u32 s64, s64, s65
    s_lshr_b32 s65, s2, 7
    s_lshl_b32 s65, s65, 3
    s_add_u32 s64, s64, s65
    s_mul_i32 s60, s64, 384
    v_mfma_f32_32x32x16_bf16 v[48:63], v[100:103], a[32:35], v[48:63]
    ds_read_b128 v[124:127], v170 offset:56320
    s_add_u32 s60, s60, 540672
    s_cmp_eq_u32 s40, 1
    s_cselect_b32 s60, s60, 0xf0000000
    s_cselect_b32 s66, 15, 0
    s_and_b32 s63, s40, 1
    s_mul_i32 s63, s63, 62
    s_waitcnt lgkmcnt(4)
    v_mfma_f32_32x32x16_bf16 v[32:47], v[104:107], a[36:39], v[32:47]
    ds_read_b128 v[96:99], v170 offset:57344
    buffer_load_dwordx4 v229, s[20:23], s49 offen offset:3072 lds
    s_lshl_b32 s64, s64, 1
    s_bfe_u32 s65, s2, 0x10005
    s_add_u32 s64, s64, s65
    s_mul_i32 s62, s64, 184320
    s_mul_i32 s65, s40, 3072
    v_mfma_f32_32x32x16_bf16 v[48:63], v[108:111], a[36:39], v[48:63]
    ds_read_b128 v[100:103], v170 offset:58368
    s_add_u32 s62, s62, s65
    s_add_u32 s62, s62, 71303168
    s_xor_b32 s63, s63, s64
    s_lshl_b32 s63, s63, 15
    s_lshr_b32 s65, s40, 1
    s_lshl_b32 s65, s65, 14
    s_waitcnt lgkmcnt(4)
    v_mfma_f32_32x32x16_bf16 v[32:47], v[112:115], a[40:43], v[32:47]
    ds_read_b128 v[104:107], v170 offset:59392
    s_lshr_b32 s49, s2, 3
    s_lshl_b32 s49, s49, 2
    s_add_u32 s49, s49, s40
    s_mul_i32 s49, s49, 52
    v_min_u32 v210, 51, v253
    v_add_u32 v210, s49, v210
    v_min_u32 v210, 6143, v210
    v_lshlrev_b32 v210, 7, v210
    s_and_b32 s49, s2, 1
    s_mul_i32 s49, s49, 786432
    s_add_u32 s49, s49, 88080384
    v_mfma_f32_32x32x16_bf16 v[48:63], v[116:119], a[40:43], v[48:63]
    ds_read_b128 v[108:111], v170 offset:60416
    buffer_load_dword v211, v210, s[20:23], s49 offen
    s_waitcnt vmcnt(11)
    v_add_f32 v184, v128, v130
    s_waitcnt vmcnt(10)
    v_add_f32 v184, v184, v132
    s_waitcnt vmcnt(9)
    v_add_f32 v184, v184, v134
    s_add_u32 s63, s63, s65
    s_waitcnt lgkmcnt(4)
    v_mfma_f32_32x32x16_bf16 v[32:47], v[120:123], a[44:47], v[32:47]
    ds_read_b128 v[112:115], v170 offset:61440
    s_waitcnt vmcnt(8)
    v_add_f32 v184, v184, v136
    s_waitcnt vmcnt(7)
    v_add_f32 v184, v184, v138
    s_waitcnt vmcnt(6)
    v_add_f32 v184, v184, v140
    s_waitcnt vmcnt(5)
    v_add_f32 v184, v184, v142
    v_mul_f32 v184, 0x3b000000, v184
    v_add_f32 v185, v129, v131
    s_bfe_u32 s64, s2, 0x20003
    v_mfma_f32_32x32x16_bf16 v[48:63], v[124:127], a[44:47], v[48:63]
    ds_read_b128 v[116:119], v170 offset:62464
    s_add_u32 s49, s56, 180224
    s_add_u32 m0, s46, 16384
    v_add_f32 v185, v185, v133
    v_add_f32 v185, v185, v135
    v_add_f32 v185, v185, v137
    s_and_b32 s65, s2, 1
    s_waitcnt lgkmcnt(4)
    s_barrier
    v_mfma_f32_32x32x16_bf16 v[32:47], v[96:99], a[48:51], v[32:47]
    ds_read_b128 v[120:123], v170 offset:63488
    buffer_load_dwordx4 v229, s[20:23], s49 offen offset:0 lds
    v_add_f32 v185, v185, v139
    v_add_f32 v185, v185, v141
    v_add_f32 v185, v185, v143
    v_mov_b32 v187, 0x3c800000
    s_lshl_b32 s65, s65, 2
    v_mfma_f32_32x32x16_bf16 v[48:63], v[100:103], a[48:51], v[48:63]
    ds_read_b128 v[124:127], v170 offset:64512
    v_mov_b32 v188, 0
    v_fma_f32 v186, v128, v187, -v184
    v_fmac_f32 v188, v186, v186
    v_fma_f32 v186, v130, v187, -v184
    v_fmac_f32 v188, v186, v186
    s_add_u32 s64, s64, s65
    s_waitcnt lgkmcnt(4)
    v_mfma_f32_32x32x16_bf16 v[32:47], v[104:107], a[52:55], v[32:47]
    ds_read_b128 v[96:99], v171 offset:0
    v_fma_f32 v186, v132, v187, -v184
    v_fmac_f32 v188, v186, v186
    v_fma_f32 v186, v134, v187, -v184
    v_fmac_f32 v188, v186, v186
    v_fma_f32 v186, v136, v187, -v184
    v_fmac_f32 v188, v186, v186
    s_lshl_b32 s64, s64, 7
    v_mfma_f32_32x32x16_bf16 v[48:63], v[108:111], a[52:55], v[48:63]
    ds_read_b128 v[100:103], v171 offset:1024
    buffer_load_dwordx4 v229, s[20:23], s49 offen offset:1024 lds
    v_fma_f32 v186, v138, v187, -v184
    v_fmac_f32 v188, v186, v186
    v_fma_f32 v186, v140, v187, -v184
    s_add_u32 s63, s63, s64
    s_waitcnt lgkmcnt(4)
    v_mfma_f32_32x32x16_bf16 v[32:47], v[112:115], a[56:59], v[32:47]
    ds_read_b128 v[104:107], v171 offset:2048
    v_fmac_f32 v188, v186, v186
    v_fma_f32 v186, v142, v187, -v184
    v_fmac_f32 v188, v186, v186
    v_mul_f32 v188, 0x42800000, v188
    v_add_f32 v185, v185, v188
    v_mul_f32 v185, 0x3b000000, v185
    s_mul_i32 s61, s40, 12288
    v_mfma_f32_32x32x16_bf16 v[48:63], v[116:119], a[56:59], v[48:63]
    ds_read_b128 v[108:111], v171 offset:3072
    v_cvt_pk_bf16_f32 v185, v185, v185
    v_and_b32 v185, 0xffff0000, v185
    v_add_f32 v185, 0x3727c5ac, v185
    v_cvt_pk_bf16_f32 v185, v185, v185
    v_and_b32 v185, 0xffff0000, v185
    s_mul_i32 s65, s64, 1536
    s_waitcnt lgkmcnt(4)
    v_mfma_f32_32x32x16_bf16 v[32:47], v[120:123], a[60:63], v[32:47]
    ds_read_b128 v[112:115], v171 offset:4096
    buffer_load_dwordx4 v229, s[20:23], s49 offen offset:2048 lds
    v_sqrt_f32 v185, v185
    v_sub_f32 v184, 0, v184
    v_cvt_pk_bf16_f32 v181, v185, v185
    s_add_u32 s61, s61, s65
    v_mfma_f32_32x32x16_bf16 v[48:63], v[124:127], a[60:63], v[48:63]
    ds_read_b128 v[116:119], v171 offset:5120
    v_cvt_pk_bf16_f32 v180, v184, v184
    v_and_b32 v176, 0xffff0000, v181
    v_rcp_f32 v177, v176
    v_cmp_gt_u32 vcc, 32, v253
    s_add_u32 s61, s61, 88080384
    s_waitcnt lgkmcnt(4)
    v_mfma_f32_32x32x16_bf16 v[0:15], v[96:99], a[64:67], v[0:15]
    ds_read_b128 v[120:123], v171 offset:6144
    v_mov_b32 v182, 0
    v_mov_b32 v183, 0
    v_cndmask_b32 v180, v181, v180, vcc
    v_mov_b32 v181, 0
    v_lshrrev_b32 v230, 3, v253
    v_and_b32 v231, 7, v253
    v_lshlrev_b32 v174, 10, v230
    v_mfma_f32_32x32x16_bf16 v[16:31], v[100:103], a[64:67], v[16:31]
    ds_read_b128 v[124:127], v171 offset:7168
    buffer_load_dwordx4 v229, s[20:23], s49 offen offset:3072 lds
    v_xor_b32 v228, v230, v231
    v_lshlrev_b32 v228, 4, v228
    v_lshl_add_u32 v228, v230, 8, v228
    s_lshl_b32 s65, s40, 14
    s_waitcnt lgkmcnt(4)
    v_mfma_f32_32x32x16_bf16 v[0:15], v[104:107], a[68:71], v[0:15]
    ds_read_b128 v[96:99], v171 offset:8192
    s_add_u32 s65, s65, 65536
    v_add_u32 v228, s65, v228
    v_lshl_add_u32 v174, v231, 4, v174
    v_lshlrev_b32 v231, 5, v231
    s_lshl_b32 s64, s64, 1
    s_add_u32 s64, s64, 141312
    buffer_load_dwordx4 v[240:243], v231, s[20:23], s64 offen
    v_mfma_f32_32x32x16_bf16 v[16:31], v[108:111], a[68:71], v[16:31]
    ds_read_b128 v[100:103], v171 offset:9216
    buffer_load_dwordx4 v[244:247], v231, s[20:23], s64 offen offset:16
    s_waitcnt lgkmcnt(4)
    v_mfma_f32_32x32x16_bf16 v[0:15], v[112:115], a[72:75], v[0:15]
    ds_read_b128 v[104:107], v171 offset:10240
    v_add_u32 v217, 0, v229
    v_add_u32 v218, 46080, v229
    v_add_u32 v219, 92160, v229
    v_add_u32 v220, 138240, v229
    v_min_u32 v221, 1, v253
    v_lshlrev_b32 v221, 31, v221
    v_lshrrev_b32 v230, 5, v253
    v_mfma_f32_32x32x16_bf16 v[16:31], v[116:119], a[72:75], v[16:31]
    ds_read_b128 v[108:111], v171 offset:11264
    v_add_u32 v212, s46, v229
    v_and_b32 v223, 7, v253
    v_xor_b32 v230, v230, v223
    v_lshlrev_b32 v230, 4, v230
    v_and_b32 v223, 15, v253
    v_lshl_add_u32 v230, v223, 8, v230
    s_waitcnt lgkmcnt(4)
    v_mfma_f32_32x32x16_bf16 v[0:15], v[120:123], a[76:79], v[0:15]
    ds_read_b128 v[112:115], v171 offset:12288
    v_bfe_u32 v223, v253, 4, 1
    v_lshl_add_u32 v230, v223, 7, v230
    s_add_u32 s65, s46, 65536
    v_add_u32 v224, s65, v230
    v_xor_b32 v225, 32, v224
    v_xor_b32 v226, 64, v224
    v_xor_b32 v227, 96, v224
    v_mfma_f32_32x32x16_bf16 v[16:31], v[124:127], a[76:79], v[16:31]
    ds_read_b128 v[116:119], v171 offset:13312
    v_mov_b32 v223, 1
    s_waitcnt lgkmcnt(4)
    s_barrier
    v_mfma_f32_32x32x16_bf16 v[0:15], v[96:99], a[80:83], v[0:15]
    ds_read_b128 v[120:123], v171 offset:14336
    v_mfma_f32_32x32x16_bf16 v[16:31], v[100:103], a[80:83], v[16:31]
    ds_read_b128 v[124:127], v171 offset:15360
    s_waitcnt lgkmcnt(4)
    v_mfma_f32_32x32x16_bf16 v[0:15], v[104:107], a[84:87], v[0:15]
    ds_read_b128 v[96:99], v171 offset:16384
    v_mfma_f32_32x32x16_bf16 v[16:31], v[108:111], a[84:87], v[16:31]
    ds_read_b128 v[100:103], v171 offset:17408
    s_waitcnt lgkmcnt(4)
    v_mfma_f32_32x32x16_bf16 v[0:15], v[112:115], a[88:91], v[0:15]
    ds_read_b128 v[104:107], v171 offset:18432
    v_mfma_f32_32x32x16_bf16 v[16:31], v[116:119], a[88:91], v[16:31]
    ds_read_b128 v[108:111], v171 offset:19456
    s_waitcnt lgkmcnt(4)
    v_mfma_f32_32x32x16_bf16 v[0:15], v[120:123], a[92:95], v[0:15]
    ds_read_b128 v[112:115], v171 offset:20480
    v_mfma_f32_32x32x16_bf16 v[16:31], v[124:127], a[92:95], v[16:31]
    ds_read_b128 v[116:119], v171 offset:21504
    s_waitcnt lgkmcnt(4)
    v_mfma_f32_32x32x16_bf16 v[0:15], v[96:99], a[96:99], v[0:15]
    ds_read_b128 v[120:123], v171 offset:22528
    v_mfma_f32_32x32x16_bf16 v[16:31], v[100:103], a[96:99], v[16:31]
    ds_read_b128 v[124:127], v171 offset:23552
    s_waitcnt lgkmcnt(4)
    v_mfma_f32_32x32x16_bf16 v[0:15], v[104:107], a[100:103], v[0:15]
    ds_read_b128 v[96:99], v171 offset:24576
    v_mfma_f32_32x32x16_bf16 v[16:31], v[108:111], a[100:103], v[16:31]
    ds_read_b128 v[100:103], v171 offset:25600
    s_waitcnt lgkmcnt(4)
    v_mfma_f32_32x32x16_bf16 v[0:15], v[112:115], a[104:107], v[0:15]
    ds_read_b128 v[104:107], v171 offset:26624
    v_mfma_f32_32x32x16_bf16 v[16:31], v[116:119], a[104:107], v[16:31]
    ds_read_b128 v[108:111], v171 offset:27648
    s_waitcnt lgkmcnt(4)
    v_mfma_f32_32x32x16_bf16 v[0:15], v[120:123], a[108:111], v[0:15]
    ds_read_b128 v[112:115], v171 offset:28672
    v_mfma_f32_32x32x16_bf16 v[16:31], v[124:127], a[108:111], v[16:31]
    ds_read_b128 v[116:119], v171 offset:29696
    s_waitcnt lgkmcnt(4)
    s_barrier
    v_mfma_f32_32x32x16_bf16 v[0:15], v[96:99], a[112:115], v[0:15]
    ds_read_b128 v[120:123], v171 offset:30720
    v_mfma_f32_32x32x16_bf16 v[16:31], v[100:103], a[112:115], v[16:31]
    ds_read_b128 v[124:127], v171 offset:31744
    s_add_u32 m0, s46, 32768
    s_add_u32 s64, s61, 0
    s_waitcnt lgkmcnt(4)
    v_mfma_f32_32x32x16_bf16 v[0:15], v[104:107], a[116:119], v[0:15]
    ds_read_b128 v[96:99], v171 offset:32768
    buffer_load_dwordx4 v229, s[20:23], s64 offen offset:0 lds
    v_mfma_f32_32x32x16_bf16 v[16:31], v[108:111], a[116:119], v[16:31]
    ds_read_b128 v[100:103], v171 offset:33792
    s_waitcnt lgkmcnt(4)
    v_mfma_f32_32x32x16_bf16 v[0:15], v[112:115], a[120:123], v[0:15]
    ds_read_b128 v[104:107], v171 offset:34816
    v_mfma_f32_32x32x16_bf16 v[16:31], v[116:119], a[120:123], v[16:31]
    ds_read_b128 v[108:111], v171 offset:35840
    buffer_load_dwordx4 v229, s[20:23], s64 offen offset:1024 lds
    s_waitcnt lgkmcnt(4)
    v_mfma_f32_32x32x16_bf16 v[0:15], v[120:123], a[124:127], v[0:15]
    ds_read_b128 v[112:115], v171 offset:36864
    v_mfma_f32_32x32x16_bf16 v[16:31], v[124:127], a[124:127], v[16:31]
    ds_read_b128 v[116:119], v171 offset:37888
    v_mfma_f32_32x32x16_bf16 v[0:15], v[144:147], v[180:183], v[0:15]
    buffer_load_dwordx4 v229, s[20:23], s64 offen offset:2048 lds
    v_mfma_f32_32x32x16_bf16 v[16:31], v[148:151], v[180:183], v[16:31]
    s_waitcnt lgkmcnt(4)
    v_mfma_f32_32x32x16_bf16 v[32:47], v[96:99], a[64:67], v[32:47]
    ds_read_b128 v[120:123], v171 offset:38912
    v_mfma_f32_32x32x16_bf16 v[48:63], v[100:103], a[64:67], v[48:63]
    ds_read_b128 v[124:127], v171 offset:39936
    buffer_load_dwordx4 v229, s[20:23], s64 offen offset:3072 lds
    s_waitcnt lgkmcnt(4)
    v_mfma_f32_32x32x16_bf16 v[32:47], v[104:107], a[68:71], v[32:47]
    ds_read_b128 v[96:99], v171 offset:40960
    s_nop 0
    v_mul_f32 v0, v0, v177
    v_mul_f32 v1, v1, v177
    v_mul_f32 v2, v2, v177
    v_mul_f32 v3, v3, v177
    v_mul_f32 v192, v0, v0
    v_mfma_f32_32x32x16_bf16 v[48:63], v[108:111], a[68:71], v[48:63]
    ds_read_b128 v[100:103], v171 offset:41984
    s_add_u32 m0, s46, 49152
    s_add_u32 s64, s61, 49152
    v_mul_f32 v193, v1, v1
    v_mul_f32 v194, v2, v2
    s_waitcnt lgkmcnt(4)
    v_mfma_f32_32x32x16_bf16 v[32:47], v[112:115], a[72:75], v[32:47]
    ds_read_b128 v[104:107], v171 offset:43008
    buffer_load_dwordx4 v229, s[20:23], s64 offen offset:0 lds
    v_mul_f32 v195, v3, v3
    v_fma_f32 v192, v192, s55, v178
    v_fma_f32 v193, v193, s55, v178
    v_mfma_f32_32x32x16_bf16 v[48:63], v[116:119], a[72:75], v[48:63]
    ds_read_b128 v[108:111], v171 offset:44032
    v_fma_f32 v194, v194, s55, v178
    v_fma_f32 v195, v195, s55, v178
    v_mul_f32 v192, v192, v0
    v_mul_f32 v193, v193, v1
    s_waitcnt lgkmcnt(4)
    v_mfma_f32_32x32x16_bf16 v[32:47], v[120:123], a[76:79], v[32:47]
    ds_read_b128 v[112:115], v171 offset:45056
    v_mul_f32 v194, v194, v2
    v_mul_f32 v195, v195, v3
    v_exp_f32 v192, v192
    v_mfma_f32_32x32x16_bf16 v[48:63], v[124:127], a[76:79], v[48:63]
    ds_read_b128 v[116:119], v171 offset:46080
    buffer_load_dwordx4 v229, s[20:23], s64 offen offset:1024 lds
    v_exp_f32 v193, v193
    s_waitcnt lgkmcnt(4)
    s_barrier
    v_mfma_f32_32x32x16_bf16 v[32:47], v[96:99], a[80:83], v[32:47]
    ds_read_b128 v[120:123], v171 offset:47104
    v_exp_f32 v194, v194
    v_exp_f32 v195, v195
    v_mul_f32 v16, v16, v0
    v_mfma_f32_32x32x16_bf16 v[48:63], v[100:103], a[80:83], v[48:63]
    ds_read_b128 v[124:127], v171 offset:48128
    v_mul_f32 v17, v17, v1
    v_mul_f32 v18, v18, v2
    v_mul_f32 v19, v19, v3
    v_fma_f32 v192, v192, v176, v176
    s_waitcnt lgkmcnt(4)
    v_mfma_f32_32x32x16_bf16 v[32:47], v[104:107], a[84:87], v[32:47]
    ds_read_b128 v[96:99], v171 offset:49152
    buffer_load_dwordx4 v229, s[20:23], s64 offen offset:2048 lds
    v_fma_f32 v193, v193, v176, v176
    v_fma_f32 v194, v194, v176, v176
    v_fma_f32 v195, v195, v176, v176
    v_mfma_f32_32x32x16_bf16 v[48:63], v[108:111], a[84:87], v[48:63]
    ds_read_b128 v[100:103], v171 offset:50176
    v_rcp_f32 v192, v192
    v_rcp_f32 v193, v193
    s_waitcnt lgkmcnt(4)
    v_mfma_f32_32x32x16_bf16 v[32:47], v[112:115], a[88:91], v[32:47]
    ds_read_b128 v[104:107], v171 offset:51200
    v_rcp_f32 v194, v194
    v_rcp_f32 v195, v195
    v_mul_f32 v16, v16, v192
    v_mfma_f32_32x32x16_bf16 v[48:63], v[116:119], a[88:91], v[48:63]
    ds_read_b128 v[108:111], v171 offset:52224
    buffer_load_dwordx4 v229, s[20:23], s64 offen offset:3072 lds
    v_mul_f32 v17, v17, v193
    v_mul_f32 v18, v18, v194
    s_waitcnt lgkmcnt(4)
    v_mfma_f32_32x32x16_bf16 v[32:47], v[120:123], a[92:95], v[32:47]
    ds_read_b128 v[112:115], v171 offset:53248
    v_mul_f32 v19, v19, v195
    v_cvt_pk_bf16_f32 v0, v16, v17
    v_cvt_pk_bf16_f32 v1, v18, v19
    v_mul_f32 v4, v4, v177
    v_mul_f32 v5, v5, v177
    v_mfma_f32_32x32x16_bf16 v[48:63], v[124:127], a[92:95], v[48:63]
    ds_read_b128 v[116:119], v171 offset:54272
    s_add_u32 m0, s46, 65536
    s_add_u32 s64, s61, 98304
    v_mul_f32 v6, v6, v177
    v_mul_f32 v7, v7, v177
    s_waitcnt lgkmcnt(4)
    v_mfma_f32_32x32x16_bf16 v[32:47], v[96:99], a[96:99], v[32:47]
    ds_read_b128 v[120:123], v171 offset:55296
    buffer_load_dwordx4 v229, s[20:23], s64 offen offset:0 lds
    v_mul_f32 v192, v4, v4
    v_mul_f32 v193, v5, v5
    v_mul_f32 v194, v6, v6
    v_mfma_f32_32x32x16_bf16 v[48:63], v[100:103], a[96:99], v[48:63]
    ds_read_b128 v[124:127], v171 offset:56320
    v_mul_f32 v195, v7, v7
    v_fma_f32 v192, v192, s55, v178
    v_fma_f32 v193, v193, s55, v178
    v_fma_f32 v194, v194, s55, v178
    s_waitcnt lgkmcnt(4)
    v_mfma_f32_32x32x16_bf16 v[32:47], v[104:107], a[100:103], v[32:47]
    ds_read_b128 v[96:99], v171 offset:57344
    v_fma_f32 v195, v195, s55, v178
    v_mul_f32 v192, v192, v4
    v_mul_f32 v193, v193, v5
    v_mul_f32 v194, v194, v6
    v_mul_f32 v195, v195, v7
    v_mfma_f32_32x32x16_bf16 v[48:63], v[108:111], a[100:103], v[48:63]
    ds_read_b128 v[100:103], v171 offset:58368
    buffer_load_dwordx4 v229, s[20:23], s64 offen offset:1024 lds
    v_exp_f32 v192, v192
    s_waitcnt lgkmcnt(4)
    v_mfma_f32_32x32x16_bf16 v[32:47], v[112:115], a[104:107], v[32:47]
    ds_read_b128 v[104:107], v171 offset:59392
    v_exp_f32 v193, v193
    v_exp_f32 v194, v194
    v_mfma_f32_32x32x16_bf16 v[48:63], v[116:119], a[104:107], v[48:63]
    ds_read_b128 v[108:111], v171 offset:60416
    v_exp_f32 v195, v195
    v_mul_f32 v20, v20, v4
    v_mul_f32 v21, v21, v5
    s_waitcnt lgkmcnt(4)
    v_mfma_f32_32x32x16_bf16 v[32:47], v[120:123], a[108:111], v[32:47]
    ds_read_b128 v[112:115], v171 offset:61440
    buffer_load_dwordx4 v229, s[20:23], s64 offen offset:2048 lds
    v_mul_f32 v22, v22, v6
    v_mul_f32 v23, v23, v7
    v_fma_f32 v192, v192, v176, v176
    v_mfma_f32_32x32x16_bf16 v[48:63], v[124:127], a[108:111], v[48:63]
    ds_read_b128 v[116:119], v171 offset:62464
    v_fma_f32 v193, v193, v176, v176
    v_fma_f32 v194, v194, v176, v176
    v_fma_f32 v195, v195, v176, v176
    s_waitcnt lgkmcnt(4)
    s_barrier
    v_mfma_f32_32x32x16_bf16 v[32:47], v[96:99], a[112:115], v[32:47]
    ds_read_b128 v[120:123], v171 offset:63488
    v_rcp_f32 v192, v192
    v_rcp_f32 v193, v193
    v_mfma_f32_32x32x16_bf16 v[48:63], v[100:103], a[112:115], v[48:63]
    ds_read_b128 v[124:127], v171 offset:64512
    buffer_load_dwordx4 v229, s[20:23], s64 offen offset:3072 lds
    v_rcp_f32 v194, v194
    s_waitcnt lgkmcnt(4)
    v_mfma_f32_32x32x16_bf16 v[32:47], v[104:107], a[116:119], v[32:47]
    ds_read_b128 v[96:99], v172 offset:0
    v_rcp_f32 v195, v195
    v_mul_f32 v20, v20, v192
    v_mul_f32 v21, v21, v193
    v_mul_f32 v22, v22, v194
    v_mfma_f32_32x32x16_bf16 v[48:63], v[108:111], a[116:119], v[48:63]
    ds_read_b128 v[100:103], v172 offset:1024
    s_add_u32 m0, s46, 81920
    s_add_u32 s64, s61, 147456
    v_mul_f32 v23, v23, v195
    v_cvt_pk_bf16_f32 v2, v20, v21
    s_waitcnt lgkmcnt(4)
    v_mfma_f32_32x32x16_bf16 v[32:47], v[112:115], a[120:123], v[32:47]
    ds_read_b128 v[104:107], v172 offset:2048
    buffer_load_dwordx4 v229, s[20:23], s64 offen offset:0 lds
    v_cvt_pk_bf16_f32 v3, v22, v23
    buffer_store_dwordx4 v[0:3], v175, s[20:23], s53 offen offset:0 sc1
    v_mul_f32 v8, v8, v177
    v_mfma_f32_32x32x16_bf16 v[48:63], v[116:119], a[120:123], v[48:63]
    ds_read_b128 v[108:111], v172 offset:3072
    v_mul_f32 v9, v9, v177
    v_mul_f32 v10, v10, v177
    v_mul_f32 v11, v11, v177
    v_mul_f32 v192, v8, v8
    s_waitcnt lgkmcnt(4)
    v_mfma_f32_32x32x16_bf16 v[32:47], v[120:123], a[124:127], v[32:47]
    ds_read_b128 v[112:115], v172 offset:4096
    v_mul_f32 v193, v9, v9
    v_mul_f32 v194, v10, v10
    v_mul_f32 v195, v11, v11
    v_fma_f32 v192, v192, s55, v178
    v_fma_f32 v193, v193, s55, v178
    v_mfma_f32_32x32x16_bf16 v[48:63], v[124:127], a[124:127], v[48:63]
    ds_read_b128 v[116:119], v172 offset:5120
    buffer_load_dwordx4 v229, s[20:23], s64 offen offset:1024 lds
    v_fma_f32 v194, v194, s55, v178
    v_fma_f32 v195, v195, s55, v178
    v_mul_f32 v192, v192, v8
    v_mfma_f32_32x32x16_bf16 v[32:47], v[152:155], v[180:183], v[32:47]
    v_mul_f32 v193, v193, v9
    v_mul_f32 v194, v194, v10
    v_mul_f32 v195, v195, v11
    v_exp_f32 v192, v192
    v_mfma_f32_32x32x16_bf16 v[48:63], v[156:159], v[180:183], v[48:63]
    v_exp_f32 v193, v193
    v_exp_f32 v194, v194
    s_waitcnt lgkmcnt(4)
    v_mfma_f32_32x32x16_bf16 v[64:79], v[96:99], a[0:3], 0
    ds_read_b128 v[120:123], v172 offset:6144
    buffer_load_dwordx4 v229, s[20:23], s64 offen offset:2048 lds
    v_exp_f32 v195, v195
    v_mul_f32 v24, v24, v8
    v_mfma_f32_32x32x16_bf16 v[80:95], v[100:103], a[0:3], 0
    ds_read_b128 v[124:127], v172 offset:7168
    v_mul_f32 v25, v25, v9
    v_mul_f32 v26, v26, v10
    v_mul_f32 v27, v27, v11
    v_fma_f32 v192, v192, v176, v176
    s_waitcnt lgkmcnt(4)
    v_mfma_f32_32x32x16_bf16 v[64:79], v[104:107], a[4:7], v[64:79]
    ds_read_b128 v[96:99], v172 offset:8192
    v_fma_f32 v193, v193, v176, v176
    v_fma_f32 v194, v194, v176, v176
    v_fma_f32 v195, v195, v176, v176
    v_rcp_f32 v192, v192
    v_mfma_f32_32x32x16_bf16 v[80:95], v[108:111], a[4:7], v[80:95]
    ds_read_b128 v[100:103], v172 offset:9216
    buffer_load_dwordx4 v229, s[20:23], s64 offen offset:3072 lds
    v_rcp_f32 v193, v193
    s_waitcnt lgkmcnt(4)
    v_mfma_f32_32x32x16_bf16 v[64:79], v[112:115], a[8:11], v[64:79]
    ds_read_b128 v[104:107], v172 offset:10240
    v_rcp_f32 v194, v194
    v_rcp_f32 v195, v195
    v_mul_f32 v24, v24, v192
    v_mfma_f32_32x32x16_bf16 v[80:95], v[116:119], a[8:11], v[80:95]
    ds_read_b128 v[108:111], v172 offset:11264
    s_add_u32 m0, s46, 98304
    s_add_u32 s64, s61, 4096
    v_mul_f32 v25, v25, v193
    v_mul_f32 v26, v26, v194
    s_waitcnt lgkmcnt(4)
    v_mfma_f32_32x32x16_bf16 v[64:79], v[120:123], a[12:15], v[64:79]
    ds_read_b128 v[112:115], v172 offset:12288
    buffer_load_dwordx4 v229, s[20:23], s64 offen offset:0 lds
    v_mul_f32 v27, v27, v195
    v_cvt_pk_bf16_f32 v4, v24, v25
    v_cvt_pk_bf16_f32 v5, v26, v27
    v_mfma_f32_32x32x16_bf16 v[80:95], v[124:127], a[12:15], v[80:95]
    ds_read_b128 v[116:119], v172 offset:13312
    v_mul_f32 v12, v12, v177
    v_mul_f32 v13, v13, v177
    v_mul_f32 v14, v14, v177
    v_mul_f32 v15, v15, v177
    s_waitcnt lgkmcnt(4)
    s_barrier
    v_mfma_f32_32x32x16_bf16 v[64:79], v[96:99], a[16:19], v[64:79]
    ds_read_b128 v[120:123], v172 offset:14336
    v_mul_f32 v192, v12, v12
    v_mul_f32 v193, v13, v13
    v_mul_f32 v194, v14, v14
    v_mul_f32 v195, v15, v15
    v_fma_f32 v192, v192, s55, v178
    v_mfma_f32_32x32x16_bf16 v[80:95], v[100:103], a[16:19], v[80:95]
    ds_read_b128 v[124:127], v172 offset:15360
    buffer_load_dwordx4 v229, s[20:23], s64 offen offset:1024 lds
    v_fma_f32 v193, v193, s55, v178
    v_fma_f32 v194, v194, s55, v178
    s_waitcnt lgkmcnt(4)
    v_mfma_f32_32x32x16_bf16 v[64:79], v[104:107], a[20:23], v[64:79]
    ds_read_b128 v[96:99], v172 offset:16384
    v_fma_f32 v195, v195, s55, v178
    v_mul_f32 v192, v192, v12
    v_mul_f32 v193, v193, v13
    v_mul_f32 v194, v194, v14
    v_mul_f32 v195, v195, v15
    v_mfma_f32_32x32x16_bf16 v[80:95], v[108:111], a[20:23], v[80:95]
    ds_read_b128 v[100:103], v172 offset:17408
    v_exp_f32 v192, v192
    v_exp_f32 v193, v193
    s_waitcnt lgkmcnt(4)
    v_mfma_f32_32x32x16_bf16 v[64:79], v[112:115], a[24:27], v[64:79]
    ds_read_b128 v[104:107], v172 offset:18432
    buffer_load_dwordx4 v229, s[20:23], s64 offen offset:2048 lds
    v_exp_f32 v194, v194
    v_mfma_f32_32x32x16_bf16 v[80:95], v[116:119], a[24:27], v[80:95]
    ds_read_b128 v[108:111], v172 offset:19456
    v_exp_f32 v195, v195
    v_mul_f32 v28, v28, v12
    v_mul_f32 v29, v29, v13
    s_waitcnt lgkmcnt(4)
    v_mfma_f32_32x32x16_bf16 v[64:79], v[120:123], a[28:31], v[64:79]
    ds_read_b128 v[112:115], v172 offset:20480
    v_mul_f32 v30, v30, v14
    v_mul_f32 v31, v31, v15
    v_fma_f32 v192, v192, v176, v176
    v_fma_f32 v193, v193, v176, v176
    v_fma_f32 v194, v194, v176, v176
    v_mfma_f32_32x32x16_bf16 v[80:95], v[124:127], a[28:31], v[80:95]
    ds_read_b128 v[116:119], v172 offset:21504
    buffer_load_dwordx4 v229, s[20:23], s64 offen offset:3072 lds
    v_fma_f32 v195, v195, v176, v176
    s_waitcnt lgkmcnt(4)
    v_mfma_f32_32x32x16_bf16 v[64:79], v[96:99], a[32:35], v[64:79]
    ds_read_b128 v[120:123], v172 offset:22528
    v_rcp_f32 v192, v192
    v_rcp_f32 v193, v193
    v_mfma_f32_32x32x16_bf16 v[80:95], v[100:103], a[32:35], v[80:95]
    ds_read_b128 v[124:127], v172 offset:23552
    s_add_u32 m0, s46, 114688
    s_add_u32 s64, s61, 53248
    v_rcp_f32 v194, v194
    s_waitcnt lgkmcnt(4)
    v_mfma_f32_32x32x16_bf16 v[64:79], v[104:107], a[36:39], v[64:79]
    ds_read_b128 v[96:99], v172 offset:24576
    buffer_load_dwordx4 v229, s[20:23], s64 offen offset:0 lds
    v_rcp_f32 v195, v195
    v_mul_f32 v28, v28, v192
    v_mfma_f32_32x32x16_bf16 v[80:95], v[108:111], a[36:39], v[80:95]
    ds_read_b128 v[100:103], v172 offset:25600
    v_mul_f32 v29, v29, v193
    v_mul_f32 v30, v30, v194
    v_mul_f32 v31, v31, v195
    v_cvt_pk_bf16_f32 v6, v28, v29
    s_waitcnt lgkmcnt(4)
    v_mfma_f32_32x32x16_bf16 v[64:79], v[112:115], a[40:43], v[64:79]
    ds_read_b128 v[104:107], v172 offset:26624
    v_cvt_pk_bf16_f32 v7, v30, v31
    buffer_store_dwordx4 v[4:7], v175, s[20:23], s53 offen offset:512 sc1
    v_mul_f32 v32, v32, v177
    v_mul_f32 v33, v33, v177
    v_mul_f32 v34, v34, v177
    v_mfma_f32_32x32x16_bf16 v[80:95], v[116:119], a[40:43], v[80:95]
    ds_read_b128 v[108:111], v172 offset:27648
    buffer_load_dwordx4 v229, s[20:23], s64 offen offset:1024 lds
    v_mul_f32 v35, v35, v177
    v_mul_f32 v192, v32, v32
    s_waitcnt lgkmcnt(4)
    v_mfma_f32_32x32x16_bf16 v[64:79], v[120:123], a[44:47], v[64:79]
    ds_read_b128 v[112:115], v172 offset:28672
    v_mul_f32 v193, v33, v33
    v_mul_f32 v194, v34, v34
    v_mul_f32 v195, v35, v35
    v_fma_f32 v192, v192, s55, v178
    v_fma_f32 v193, v193, s55, v178
    v_mfma_f32_32x32x16_bf16 v[80:95], v[124:127], a[44:47], v[80:95]
    ds_read_b128 v[116:119], v172 offset:29696
    v_fma_f32 v194, v194, s55, v178
    v_fma_f32 v195, v195, s55, v178
    v_mul_f32 v192, v192, v32
    v_mul_f32 v193, v193, v33
    s_waitcnt lgkmcnt(4)
    s_waitcnt vmcnt(31)
    s_barrier
    v_mfma_f32_32x32x16_bf16 v[64:79], v[96:99], a[48:51], v[64:79]
    ds_read_b128 v[120:123], v172 offset:30720
    buffer_load_dwordx4 v229, s[20:23], s64 offen offset:2048 lds
    v_mul_f32 v194, v194, v34
    v_mul_f32 v195, v195, v35
    v_mfma_f32_32x32x16_bf16 v[80:95], v[100:103], a[48:51], v[80:95]
    ds_read_b128 v[124:127], v172 offset:31744
    v_exp_f32 v192, v192
    v_exp_f32 v193, v193
    s_waitcnt lgkmcnt(4)
    v_mfma_f32_32x32x16_bf16 v[64:79], v[104:107], a[52:55], v[64:79]
    ds_read_b128 v[96:99], v170 offset:0
    v_exp_f32 v194, v194
    v_exp_f32 v195, v195
    v_mul_f32 v48, v48, v32
    v_mfma_f32_32x32x16_bf16 v[80:95], v[108:111], a[52:55], v[80:95]
    ds_read_b128 v[100:103], v170 offset:1024
    buffer_load_dwordx4 v229, s[20:23], s64 offen offset:3072 lds
    v_mul_f32 v49, v49, v33
    v_mul_f32 v50, v50, v34
    s_waitcnt lgkmcnt(4)
    v_mfma_f32_32x32x16_bf16 v[64:79], v[112:115], a[56:59], v[64:79]
    ds_read_b128 v[104:107], v170 offset:2048
    v_mul_f32 v51, v51, v35
    v_fma_f32 v192, v192, v176, v176
    v_fma_f32 v193, v193, v176, v176
    v_fma_f32 v194, v194, v176, v176
    v_fma_f32 v195, v195, v176, v176
    v_mfma_f32_32x32x16_bf16 v[80:95], v[116:119], a[56:59], v[80:95]
    ds_read_b128 v[108:111], v170 offset:3072
    s_add_u32 m0, s46, 131072
    s_add_u32 s64, s61, 102400
    v_rcp_f32 v192, v192
    s_waitcnt lgkmcnt(4)
    v_mfma_f32_32x32x16_bf16 v[64:79], v[120:123], a[60:63], v[64:79]
    ds_read_b128 v[112:115], v170 offset:4096
    buffer_load_dwordx4 v229, s[20:23], s64 offen offset:0 lds
    v_rcp_f32 v193, v193
    v_mfma_f32_32x32x16_bf16 v[80:95], v[124:127], a[60:63], v[80:95]
    ds_read_b128 v[116:119], v170 offset:5120
    v_rcp_f32 v194, v194
    v_rcp_f32 v195, v195
    s_waitcnt lgkmcnt(4)
    v_mfma_f32_32x32x16_bf16 v[64:79], v[96:99], a[64:67], v[64:79]
    ds_read_b128 v[120:123], v170 offset:6144
    v_mul_f32 v48, v48, v192
    v_mul_f32 v49, v49, v193
    v_mul_f32 v50, v50, v194
    v_mul_f32 v51, v51, v195
    v_cvt_pk_bf16_f32 v32, v48, v49
    v_mfma_f32_32x32x16_bf16 v[80:95], v[100:103], a[64:67], v[80:95]
    ds_read_b128 v[124:127], v170 offset:7168
    buffer_load_dwordx4 v229, s[20:23], s64 offen offset:1024 lds
    v_cvt_pk_bf16_f32 v33, v50, v51
    v_mul_f32 v36, v36, v177
    s_waitcnt lgkmcnt(4)
    v_mfma_f32_32x32x16_bf16 v[64:79], v[104:107], a[68:71], v[64:79]
    ds_read_b128 v[96:99], v170 offset:8192
    v_mul_f32 v37, v37, v177
    v_mul_f32 v38, v38, v177
    v_mul_f32 v39, v39, v177
    v_mul_f32 v192, v36, v36
    v_mul_f32 v193, v37, v37
    v_mfma_f32_32x32x16_bf16 v[80:95], v[108:111], a[68:71], v[80:95]
    ds_read_b128 v[100:103], v170 offset:9216
    v_mul_f32 v194, v38, v38
    v_mul_f32 v195, v39, v39
    v_fma_f32 v192, v192, s55, v178
    v_fma_f32 v193, v193, s55, v178
    s_waitcnt lgkmcnt(4)
    v_mfma_f32_32x32x16_bf16 v[64:79], v[112:115], a[72:75], v[64:79]
    ds_read_b128 v[104:107], v170 offset:10240
    buffer_load_dwordx4 v229, s[20:23], s64 offen offset:2048 lds
    v_fma_f32 v194, v194, s55, v178
    v_fma_f32 v195, v195, s55, v178
    v_mul_f32 v192, v192, v36
    v_mfma_f32_32x32x16_bf16 v[80:95], v[116:119], a[72:75], v[80:95]
    ds_read_b128 v[108:111], v170 offset:11264
    v_mul_f32 v193, v193, v37
    v_mul_f32 v194, v194, v38
    v_mul_f32 v195, v195, v39
    s_waitcnt lgkmcnt(4)
    v_mfma_f32_32x32x16_bf16 v[64:79], v[120:123], a[76:79], v[64:79]
    ds_read_b128 v[112:115], v170 offset:12288
    v_exp_f32 v192, v192
    v_exp_f32 v193, v193
    v_mfma_f32_32x32x16_bf16 v[80:95], v[124:127], a[76:79], v[80:95]
    ds_read_b128 v[116:119], v170 offset:13312
    buffer_load_dwordx4 v229, s[20:23], s64 offen offset:3072 lds
    v_exp_f32 v194, v194
    s_waitcnt lgkmcnt(4)
    s_waitcnt vmcnt(32)
    s_barrier
    v_mfma_f32_32x32x16_bf16 v[64:79], v[96:99], a[80:83], v[64:79]
    ds_read_b128 v[120:123], v170 offset:14336
    v_exp_f32 v195, v195
    v_mul_f32 v52, v52, v36
    v_mul_f32 v53, v53, v37
    v_mul_f32 v54, v54, v38
    v_mfma_f32_32x32x16_bf16 v[80:95], v[100:103], a[80:83], v[80:95]
    ds_read_b128 v[124:127], v170 offset:15360
    s_add_u32 m0, s46, 147456
    s_add_u32 s64, s61, 151552
    v_mul_f32 v55, v55, v39
    v_fma_f32 v192, v192, v176, v176
    s_waitcnt lgkmcnt(4)
    v_mfma_f32_32x32x16_bf16 v[64:79], v[104:107], a[84:87], v[64:79]
    ds_read_b128 v[96:99], v170 offset:16384
    buffer_load_dwordx4 v229, s[20:23], s64 offen offset:0 lds
    v_fma_f32 v193, v193, v176, v176
    v_fma_f32 v194, v194, v176, v176
    v_fma_f32 v195, v195, v176, v176
    v_mfma_f32_32x32x16_bf16 v[80:95], v[108:111], a[84:87], v[80:95]
    ds_read_b128 v[100:103], v170 offset:17408
    v_rcp_f32 v192, v192
    v_rcp_f32 v193, v193
    s_waitcnt lgkmcnt(4)
    v_mfma_f32_32x32x16_bf16 v[64:79], v[112:115], a[88:91], v[64:79]
    ds_read_b128 v[104:107], v170 offset:18432
    v_rcp_f32 v194, v194
    v_rcp_f32 v195, v195
    v_mul_f32 v52, v52, v192
    v_mfma_f32_32x32x16_bf16 v[80:95], v[116:119], a[88:91], v[80:95]
    ds_read_b128 v[108:111], v170 offset:19456
    buffer_load_dwordx4 v229, s[20:23], s64 offen offset:1024 lds
    v_mul_f32 v53, v53, v193
    v_mul_f32 v54, v54, v194
    s_waitcnt lgkmcnt(4)
    v_mfma_f32_32x32x16_bf16 v[64:79], v[120:123], a[92:95], v[64:79]
    ds_read_b128 v[112:115], v170 offset:20480
    v_mul_f32 v55, v55, v195
    v_cvt_pk_bf16_f32 v34, v52, v53
    v_cvt_pk_bf16_f32 v35, v54, v55
    buffer_store_dwordx4 v[32:35], v175, s[20:23], s53 offen offset:1024 sc1
    v_mul_f32 v40, v40, v177
    v_mfma_f32_32x32x16_bf16 v[80:95], v[124:127], a[92:95], v[80:95]
    ds_read_b128 v[116:119], v170 offset:21504
    v_mul_f32 v41, v41, v177
    v_mul_f32 v42, v42, v177
    v_mul_f32 v43, v43, v177
    v_mul_f32 v192, v40, v40
    s_waitcnt lgkmcnt(4)
    v_mfma_f32_32x32x16_bf16 v[64:79], v[96:99], a[96:99], v[64:79]
    ds_read_b128 v[120:123], v170 offset:22528
    buffer_load_dwordx4 v229, s[20:23], s64 offen offset:2048 lds
    v_mul_f32 v193, v41, v41
    v_mul_f32 v194, v42, v42
    v_mul_f32 v195, v43, v43
    v_mfma_f32_32x32x16_bf16 v[80:95], v[100:103], a[96:99], v[80:95]
    ds_read_b128 v[124:127], v170 offset:23552
    v_fma_f32 v192, v192, s55, v178
    v_fma_f32 v193, v193, s55, v178
    v_fma_f32 v194, v194, s55, v178
    v_fma_f32 v195, v195, s55, v178
    s_waitcnt lgkmcnt(4)
    v_mfma_f32_32x32x16_bf16 v[64:79], v[104:107], a[100:103], v[64:79]
    ds_read_b128 v[96:99], v170 offset:24576
    v_mul_f32 v192, v192, v40
    v_mul_f32 v193, v193, v41
    v_mul_f32 v194, v194, v42
    v_mul_f32 v195, v195, v43
    v_mfma_f32_32x32x16_bf16 v[80:95], v[108:111], a[100:103], v[80:95]
    ds_read_b128 v[100:103], v170 offset:25600
    buffer_load_dwordx4 v229, s[20:23], s64 offen offset:3072 lds
    v_exp_f32 v192, v192
    s_waitcnt lgkmcnt(4)
    v_mfma_f32_32x32x16_bf16 v[64:79], v[112:115], a[104:107], v[64:79]
    ds_read_b128 v[104:107], v170 offset:26624
    v_exp_f32 v193, v193
    v_exp_f32 v194, v194
    v_mfma_f32_32x32x16_bf16 v[80:95], v[116:119], a[104:107], v[80:95]
    ds_read_b128 v[108:111], v170 offset:27648
    v_exp_f32 v195, v195
    v_mul_f32 v56, v56, v40
    v_mul_f32 v57, v57, v41
    s_waitcnt lgkmcnt(4)
    v_mfma_f32_32x32x16_bf16 v[64:79], v[120:123], a[108:111], v[64:79]
    ds_read_b128 v[112:115], v170 offset:28672
    v_mul_f32 v58, v58, v42
    v_mul_f32 v59, v59, v43
    v_fma_f32 v192, v192, v176, v176
    v_fma_f32 v193, v193, v176, v176
    v_fma_f32 v194, v194, v176, v176
    v_mfma_f32_32x32x16_bf16 v[80:95], v[124:127], a[108:111], v[80:95]
    ds_read_b128 v[116:119], v170 offset:29696
    v_fma_f32 v195, v195, v176, v176
    v_rcp_f32 v192, v192
    s_waitcnt lgkmcnt(4)
    s_barrier
    v_mfma_f32_32x32x16_bf16 v[64:79], v[96:99], a[112:115], v[64:79]
    ds_read_b128 v[120:123], v170 offset:30720
    v_rcp_f32 v193, v193
    v_rcp_f32 v194, v194
    v_mfma_f32_32x32x16_bf16 v[80:95], v[100:103], a[112:115], v[80:95]
    ds_read_b128 v[124:127], v170 offset:31744
    v_rcp_f32 v195, v195
    v_mul_f32 v56, v56, v192
    v_mul_f32 v57, v57, v193
    s_waitcnt lgkmcnt(4)
    v_mfma_f32_32x32x16_bf16 v[64:79], v[104:107], a[116:119], v[64:79]
    v_mul_f32 v58, v58, v194
    v_mul_f32 v59, v59, v195
    v_cvt_pk_bf16_f32 v36, v56, v57
    v_cvt_pk_bf16_f32 v37, v58, v59
    v_mul_f32 v44, v44, v177
    v_mul_f32 v45, v45, v177
    v_mfma_f32_32x32x16_bf16 v[80:95], v[108:111], a[116:119], v[80:95]
    v_mul_f32 v46, v46, v177
    v_mul_f32 v47, v47, v177
    v_mul_f32 v192, v44, v44
    v_mul_f32 v193, v45, v45
    v_mul_f32 v194, v46, v46
    s_waitcnt lgkmcnt(2)
    v_mfma_f32_32x32x16_bf16 v[64:79], v[112:115], a[120:123], v[64:79]
    v_mul_f32 v195, v47, v47
    v_fma_f32 v192, v192, s55, v178
    v_fma_f32 v193, v193, s55, v178
    v_fma_f32 v194, v194, s55, v178
    v_fma_f32 v195, v195, s55, v178
    v_mul_f32 v192, v192, v44
    v_mfma_f32_32x32x16_bf16 v[80:95], v[116:119], a[120:123], v[80:95]
    v_mul_f32 v193, v193, v45
    v_mul_f32 v194, v194, v46
    v_mul_f32 v195, v195, v47
    v_exp_f32 v192, v192
    s_waitcnt lgkmcnt(0)
    v_mfma_f32_32x32x16_bf16 v[64:79], v[120:123], a[124:127], v[64:79]
    v_exp_f32 v193, v193
    v_exp_f32 v194, v194
    v_exp_f32 v195, v195
    v_mfma_f32_32x32x16_bf16 v[80:95], v[124:127], a[124:127], v[80:95]
    v_mul_f32 v60, v60, v44
    v_mul_f32 v61, v61, v45
    v_mul_f32 v62, v62, v46
    v_mul_f32 v63, v63, v47
    v_fma_f32 v192, v192, v176, v176
    v_fma_f32 v193, v193, v176, v176
    v_mfma_f32_32x32x16_bf16 v[64:79], v[160:163], v[180:183], v[64:79]
    v_fma_f32 v194, v194, v176, v176
    v_fma_f32 v195, v195, v176, v176
    v_rcp_f32 v192, v192
    v_rcp_f32 v193, v193
    v_mfma_f32_32x32x16_bf16 v[80:95], v[164:167], v[180:183], v[80:95]
    v_rcp_f32 v194, v194
    v_rcp_f32 v195, v195
    v_mul_f32 v60, v60, v192
    v_mul_f32 v61, v61, v193
    v_mul_f32 v62, v62, v194
    v_mul_f32 v63, v63, v195
    v_cvt_pk_bf16_f32 v38, v60, v61
    v_cvt_pk_bf16_f32 v39, v62, v63
    buffer_store_dwordx4 v[36:39], v175, s[20:23], s53 offen offset:1536 sc1
    s_waitcnt vmcnt(0)
    s_barrier
    buffer_atomic_add v223, v221, s[20:23], s59 offen offset:0 sc1
    s_add_u32 m0, s46, 0
    s_add_u32 s64, s61, 8192
    buffer_load_dwordx4 v229, s[20:23], s64 offen offset:0 lds
    v_mul_f32 v64, v64, v177
    v_mul_f32 v65, v65, v177
    v_mul_f32 v66, v66, v177
    v_mul_f32 v67, v67, v177
    v_mul_f32 v192, v64, v64
    v_mul_f32 v193, v65, v65
    v_mul_f32 v194, v66, v66
    v_mul_f32 v195, v67, v67
    buffer_load_dwordx4 v229, s[20:23], s64 offen offset:1024 lds
    v_fma_f32 v192, v192, s55, v178
    v_fma_f32 v193, v193, s55, v178
    v_fma_f32 v194, v194, s55, v178
    v_fma_f32 v195, v195, s55, v178
    v_mul_f32 v192, v192, v64
    v_mul_f32 v193, v193, v65
    v_mul_f32 v194, v194, v66
    buffer_load_dwordx4 v229, s[20:23], s64 offen offset:2048 lds
    v_mul_f32 v195, v195, v67
    v_exp_f32 v192, v192
    v_exp_f32 v193, v193
    v_exp_f32 v194, v194
    v_exp_f32 v195, v195
    v_mul_f32 v80, v80, v64
    v_mul_f32 v81, v81, v65
    v_mul_f32 v82, v82, v66
    buffer_load_dwordx4 v229, s[20:23], s64 offen offset:3072 lds
    v_mul_f32 v83, v83, v67
    v_fma_f32 v192, v192, v176, v176
    v_fma_f32 v193, v193, v176, v176
    v_fma_f32 v194, v194, v176, v176
    v_fma_f32 v195, v195, v176, v176
    v_rcp_f32 v192, v192
    v_rcp_f32 v193, v193
    s_add_u32 m0, s46, 16384
    s_add_u32 s64, s61, 57344
    buffer_load_dwordx4 v229, s[20:23], s64 offen offset:0 lds
    v_rcp_f32 v194, v194
    v_rcp_f32 v195, v195
    v_mul_f32 v80, v80, v192
    v_mul_f32 v81, v81, v193
    v_mul_f32 v82, v82, v194
    v_mul_f32 v83, v83, v195
    v_cvt_pk_bf16_f32 v64, v80, v81
    v_cvt_pk_bf16_f32 v65, v82, v83
    buffer_load_dwordx4 v229, s[20:23], s64 offen offset:1024 lds
    v_mul_f32 v68, v68, v177
    v_mul_f32 v69, v69, v177
    v_mul_f32 v70, v70, v177
    v_mul_f32 v71, v71, v177
    v_mul_f32 v192, v68, v68
    v_mul_f32 v193, v69, v69
    v_mul_f32 v194, v70, v70
    buffer_load_dwordx4 v229, s[20:23], s64 offen offset:2048 lds
    v_mul_f32 v195, v71, v71
    v_fma_f32 v192, v192, s55, v178
    v_fma_f32 v193, v193, s55, v178
    v_fma_f32 v194, v194, s55, v178
    v_fma_f32 v195, v195, s55, v178
    v_mul_f32 v192, v192, v68
    v_mul_f32 v193, v193, v69
    v_mul_f32 v194, v194, v70
    buffer_load_dwordx4 v229, s[20:23], s64 offen offset:3072 lds
    v_mul_f32 v195, v195, v71
    v_exp_f32 v192, v192
    v_exp_f32 v193, v193
    v_exp_f32 v194, v194
    v_exp_f32 v195, v195
    v_mul_f32 v84, v84, v68
    v_mul_f32 v85, v85, v69
    v_mul_f32 v86, v86, v70
    v_mul_f32 v87, v87, v71
    v_fma_f32 v192, v192, v176, v176
    v_fma_f32 v193, v193, v176, v176
    v_fma_f32 v194, v194, v176, v176
    v_fma_f32 v195, v195, v176, v176
    v_rcp_f32 v192, v192
    v_rcp_f32 v193, v193
    v_rcp_f32 v194, v194
    v_rcp_f32 v195, v195
    v_mul_f32 v84, v84, v192
    v_mul_f32 v85, v85, v193
    v_mul_f32 v86, v86, v194
    v_mul_f32 v87, v87, v195
    v_cvt_pk_bf16_f32 v66, v84, v85
    v_cvt_pk_bf16_f32 v67, v86, v87
    buffer_store_dwordx4 v[64:67], v175, s[20:23], s53 offen offset:2048 sc1
    v_mul_f32 v72, v72, v177
    v_mul_f32 v73, v73, v177
    v_mul_f32 v74, v74, v177
    v_mul_f32 v75, v75, v177
    v_mul_f32 v192, v72, v72
    v_mul_f32 v193, v73, v73
    v_mul_f32 v194, v74, v74
    v_mul_f32 v195, v75, v75
    v_fma_f32 v192, v192, s55, v178
    v_fma_f32 v193, v193, s55, v178
    v_fma_f32 v194, v194, s55, v178
    v_fma_f32 v195, v195, s55, v178
    v_mul_f32 v192, v192, v72
    v_mul_f32 v193, v193, v73
    v_mul_f32 v194, v194, v74
    v_mul_f32 v195, v195, v75
    v_exp_f32 v192, v192
    v_exp_f32 v193, v193
    v_exp_f32 v194, v194
    v_exp_f32 v195, v195
    v_mul_f32 v88, v88, v72
    v_mul_f32 v89, v89, v73
    v_mul_f32 v90, v90, v74
    v_mul_f32 v91, v91, v75
    v_fma_f32 v192, v192, v176, v176
    v_fma_f32 v193, v193, v176, v176
    v_fma_f32 v194, v194, v176, v176
    v_fma_f32 v195, v195, v176, v176
    v_rcp_f32 v192, v192
    v_rcp_f32 v193, v193
    v_rcp_f32 v194, v194
    v_rcp_f32 v195, v195
    v_mul_f32 v88, v88, v192
    v_mul_f32 v89, v89, v193
    v_mul_f32 v90, v90, v194
    v_mul_f32 v91, v91, v195
    v_cvt_pk_bf16_f32 v68, v88, v89
    v_cvt_pk_bf16_f32 v69, v90, v91
    v_mul_f32 v76, v76, v177
    v_mul_f32 v77, v77, v177
    v_mul_f32 v78, v78, v177
    v_mul_f32 v79, v79, v177
    v_mul_f32 v192, v76, v76
    v_mul_f32 v193, v77, v77
    v_mul_f32 v194, v78, v78
    v_mul_f32 v195, v79, v79
    v_fma_f32 v192, v192, s55, v178
    v_fma_f32 v193, v193, s55, v178
    v_fma_f32 v194, v194, s55, v178
    v_fma_f32 v195, v195, s55, v178
    v_mul_f32 v192, v192, v76
    v_mul_f32 v193, v193, v77
    v_mul_f32 v194, v194, v78
    v_mul_f32 v195, v195, v79
    v_exp_f32 v192, v192
    v_exp_f32 v193, v193
    v_exp_f32 v194, v194
    v_exp_f32 v195, v195
    v_mul_f32 v92, v92, v76
    v_mul_f32 v93, v93, v77
    v_mul_f32 v94, v94, v78
    v_mul_f32 v95, v95, v79
    v_fma_f32 v192, v192, v176, v176
    v_fma_f32 v193, v193, v176, v176
    v_fma_f32 v194, v194, v176, v176
    v_fma_f32 v195, v195, v176, v176
    v_rcp_f32 v192, v192
    v_rcp_f32 v193, v193
    v_rcp_f32 v194, v194
    v_rcp_f32 v195, v195
    v_mul_f32 v92, v92, v192
    v_mul_f32 v93, v93, v193
    v_mul_f32 v94, v94, v194
    v_mul_f32 v95, v95, v195
    v_cvt_pk_bf16_f32 v70, v92, v93
    v_cvt_pk_bf16_f32 v71, v94, v95
    buffer_store_dwordx4 v[68:71], v175, s[20:23], s53 offen offset:2560 sc1
    buffer_load_dword v222, off, s[20:23], s60 offset:0 sc1
    s_waitcnt vmcnt(1)
    s_barrier
    buffer_atomic_add v223, v221, s[20:23], s59 offen offset:128 sc1
    s_waitcnt vmcnt(1)
    v_cmp_gt_u32 vcc, s66, v222
    s_nop 0
    s_cbranch_vccz K45_P0_OK
K45_P0:
    s_sleep 4
    buffer_load_dword v222, off, s[20:23], s60 offset:0 sc1
    s_waitcnt vmcnt(0)
    v_cmp_gt_u32 vcc, s66, v222
    s_nop 0
    s_cbranch_vccz K45_P0_OK
    s_branch K45_P0
K45_P0_OK:
    s_barrier
K45_JOIN:
    s_add_u32 s65, s62, 0
    buffer_load_dwordx4 a[128:131], v217, s[20:23], s65 offen
    buffer_load_dwordx4 a[132:135], v218, s[20:23], s65 offen
    buffer_load_dwordx4 a[136:139], v219, s[20:23], s65 offen
    buffer_load_dwordx4 a[140:143], v220, s[20:23], s65 offen
    s_add_u32 s65, s62, 12288
    buffer_load_dwordx4 a[144:147], v217, s[20:23], s65 offen
    buffer_load_dwordx4 a[148:151], v218, s[20:23], s65 offen
    buffer_load_dwordx4 a[152:155], v219, s[20:23], s65 offen
    buffer_load_dwordx4 a[156:159], v220, s[20:23], s65 offen
    s_add_u32 s65, s62, 24576
    buffer_load_dwordx4 a[160:163], v217, s[20:23], s65 offen
    buffer_load_dwordx4 a[164:167], v218, s[20:23], s65 offen
    buffer_load_dwordx4 a[168:171], v219, s[20:23], s65 offen
    buffer_load_dwordx4 a[172:175], v220, s[20:23], s65 offen
    s_add_u32 s65, s62, 36864
    s_cmp_ge_u32 s40, 3
    s_cselect_b32 s65, 0xf0000000, s65
    buffer_load_dwordx4 a[176:179], v217, s[20:23], s65 offen
    buffer_load_dwordx4 a[180:183], v218, s[20:23], s65 offen
    buffer_load_dwordx4 a[184:187], v219, s[20:23], s65 offen
    buffer_load_dwordx4 a[188:191], v220, s[20:23], s65 offen
    ds_read_b128 v[96:99], v212 offset:32768
    ds_read_b128 v[100:103], v212 offset:33792
    ds_read_b128 v[104:107], v212 offset:34816
    ds_read_b128 v[108:111], v212 offset:35840
    s_waitcnt vmcnt(15) lgkmcnt(3)
    v_mfma_f32_16x16x32_bf16 v[0:3], v[96:99], a[128:131], 0
    s_waitcnt vmcnt(14)
    v_mfma_f32_16x16x32_bf16 v[16:19], v[96:99], a[132:135], 0
    ds_read_b128 v[112:115], v212 offset:49152
    s_add_u32 s65, s62, 1024
    s_waitcnt vmcnt(13)
    v_mfma_f32_16x16x32_bf16 v[32:35], v[96:99], a[136:139], 0
    buffer_load_dwordx4 a[192:195], v217, s[20:23], s65 offen
    s_waitcnt vmcnt(13)
    v_mfma_f32_16x16x32_bf16 v[48:51], v[96:99], a[140:143], 0
    ds_read_b128 v[116:119], v212 offset:50176
    s_waitcnt lgkmcnt(4)
    v_mfma_f32_16x16x32_bf16 v[4:7], v[100:103], a[128:131], 0
    buffer_load_dwordx4 a[196:199], v218, s[20:23], s65 offen
    v_mfma_f32_16x16x32_bf16 v[20:23], v[100:103], a[132:135], 0
    ds_read_b128 v[120:123], v212 offset:51200
    v_mfma_f32_16x16x32_bf16 v[36:39], v[100:103], a[136:139], 0
    buffer_load_dwordx4 a[200:203], v219, s[20:23], s65 offen
    v_mfma_f32_16x16x32_bf16 v[52:55], v[100:103], a[140:143], 0
    ds_read_b128 v[124:127], v212 offset:52224
    s_waitcnt lgkmcnt(5)
    v_mfma_f32_16x16x32_bf16 v[8:11], v[104:107], a[128:131], 0
    buffer_load_dwordx4 a[204:207], v220, s[20:23], s65 offen
    v_mfma_f32_16x16x32_bf16 v[24:27], v[104:107], a[132:135], 0
    s_add_u32 s65, s62, 13312
    v_mfma_f32_16x16x32_bf16 v[40:43], v[104:107], a[136:139], 0
    buffer_load_dwordx4 a[208:211], v217, s[20:23], s65 offen
    v_mfma_f32_16x16x32_bf16 v[56:59], v[104:107], a[140:143], 0
    s_waitcnt lgkmcnt(4)
    v_mfma_f32_16x16x32_bf16 v[12:15], v[108:111], a[128:131], 0
    buffer_load_dwordx4 a[212:215], v218, s[20:23], s65 offen
    v_mfma_f32_16x16x32_bf16 v[28:31], v[108:111], a[132:135], 0
    v_mfma_f32_16x16x32_bf16 v[44:47], v[108:111], a[136:139], 0
    buffer_load_dwordx4 a[216:219], v219, s[20:23], s65 offen
    v_mfma_f32_16x16x32_bf16 v[60:63], v[108:111], a[140:143], 0
    v_add_u32 v212, 65536, v212
    s_waitcnt vmcnt(18) lgkmcnt(3)
    v_mfma_f32_16x16x32_bf16 v[0:3], v[112:115], a[144:147], v[0:3]
    buffer_load_dwordx4 a[220:223], v220, s[20:23], s65 offen
    s_waitcnt vmcnt(18)
    v_mfma_f32_16x16x32_bf16 v[16:19], v[112:115], a[148:151], v[16:19]
    ds_read_b128 v[96:99], v212 offset:0
    s_add_u32 s65, s62, 25600
    s_waitcnt vmcnt(17)
    v_mfma_f32_16x16x32_bf16 v[32:35], v[112:115], a[152:155], v[32:35]
    buffer_load_dwordx4 a[224:227], v217, s[20:23], s65 offen
    s_waitcnt vmcnt(17)
    v_mfma_f32_16x16x32_bf16 v[48:51], v[112:115], a[156:159], v[48:51]
    ds_read_b128 v[100:103], v212 offset:1024
    s_waitcnt lgkmcnt(4)
    v_mfma_f32_16x16x32_bf16 v[4:7], v[116:119], a[144:147], v[4:7]
    buffer_load_dwordx4 a[228:231], v218, s[20:23], s65 offen
    v_mfma_f32_16x16x32_bf16 v[20:23], v[116:119], a[148:151], v[20:23]
    ds_read_b128 v[104:107], v212 offset:2048
    v_mfma_f32_16x16x32_bf16 v[36:39], v[116:119], a[152:155], v[36:39]
    buffer_load_dwordx4 a[232:235], v219, s[20:23], s65 offen
    v_mfma_f32_16x16x32_bf16 v[52:55], v[116:119], a[156:159], v[52:55]
    ds_read_b128 v[108:111], v212 offset:3072
    s_waitcnt lgkmcnt(5)
    v_mfma_f32_16x16x32_bf16 v[8:11], v[120:123], a[144:147], v[8:11]
    buffer_load_dwordx4 a[236:239], v220, s[20:23], s65 offen
    v_mfma_f32_16x16x32_bf16 v[24:27], v[120:123], a[148:151], v[24:27]
    s_add_u32 s65, s62, 37888
    s_cmp_ge_u32 s40, 2
    s_cselect_b32 s65, 0xf0000000, s65
    v_mfma_f32_16x16x32_bf16 v[40:43], v[120:123], a[152:155], v[40:43]
    buffer_load_dwordx4 a[240:243], v217, s[20:23], s65 offen
    v_mfma_f32_16x16x32_bf16 v[56:59], v[120:123], a[156:159], v[56:59]
    s_waitcnt lgkmcnt(4)
    v_mfma_f32_16x16x32_bf16 v[12:15], v[124:127], a[144:147], v[12:15]
    buffer_load_dwordx4 a[244:247], v218, s[20:23], s65 offen
    v_mfma_f32_16x16x32_bf16 v[28:31], v[124:127], a[148:151], v[28:31]
    v_mfma_f32_16x16x32_bf16 v[44:47], v[124:127], a[152:155], v[44:47]
    buffer_load_dwordx4 a[248:251], v219, s[20:23], s65 offen
    v_mfma_f32_16x16x32_bf16 v[60:63], v[124:127], a[156:159], v[60:63]
    s_waitcnt vmcnt(22) lgkmcnt(3)
    v_mfma_f32_16x16x32_bf16 v[0:3], v[96:99], a[160:163], v[0:3]
    buffer_load_dwordx4 a[252:255], v220, s[20:23], s65 offen
    buffer_load_dword v222, off, s[20:23], s60 offset:128 sc1
    s_waitcnt vmcnt(23)
    v_mfma_f32_16x16x32_bf16 v[16:19], v[96:99], a[164:167], v[16:19]
    ds_read_b128 v[112:115], v212 offset:16384
    s_waitcnt vmcnt(22)
    v_mfma_f32_16x16x32_bf16 v[32:35], v[96:99], a[168:171], v[32:35]
    s_add_u32 m0, s46, 32768
    s_add_u32 s64, s61, 106496
    s_waitcnt vmcnt(21)
    v_mfma_f32_16x16x32_bf16 v[48:51], v[96:99], a[172:175], v[48:51]
    ds_read_b128 v[116:119], v212 offset:17408
    buffer_load_dwordx4 v229, s[20:23], s64 offen offset:0 lds
    s_waitcnt lgkmcnt(4)
    v_mfma_f32_16x16x32_bf16 v[4:7], v[100:103], a[160:163], v[4:7]
    v_mfma_f32_16x16x32_bf16 v[20:23], v[100:103], a[164:167], v[20:23]
    ds_read_b128 v[120:123], v212 offset:18432
    buffer_load_dwordx4 v229, s[20:23], s64 offen offset:1024 lds
    v_mfma_f32_16x16x32_bf16 v[36:39], v[100:103], a[168:171], v[36:39]
    v_mfma_f32_16x16x32_bf16 v[52:55], v[100:103], a[172:175], v[52:55]
    ds_read_b128 v[124:127], v212 offset:19456
    buffer_load_dwordx4 v229, s[20:23], s64 offen offset:2048 lds
    s_waitcnt lgkmcnt(5)
    v_mfma_f32_16x16x32_bf16 v[8:11], v[104:107], a[160:163], v[8:11]
    v_mfma_f32_16x16x32_bf16 v[24:27], v[104:107], a[164:167], v[24:27]
    buffer_load_dwordx4 v229, s[20:23], s64 offen offset:3072 lds
    v_mfma_f32_16x16x32_bf16 v[40:43], v[104:107], a[168:171], v[40:43]
    s_add_u32 m0, s46, 49152
    s_add_u32 s64, s61, 155648
    v_mfma_f32_16x16x32_bf16 v[56:59], v[104:107], a[172:175], v[56:59]
    buffer_load_dwordx4 v229, s[20:23], s64 offen offset:0 lds
    s_waitcnt lgkmcnt(4)
    v_mfma_f32_16x16x32_bf16 v[12:15], v[108:111], a[160:163], v[12:15]
    v_mfma_f32_16x16x32_bf16 v[28:31], v[108:111], a[164:167], v[28:31]
    buffer_load_dwordx4 v229, s[20:23], s64 offen offset:1024 lds
    v_mfma_f32_16x16x32_bf16 v[44:47], v[108:111], a[168:171], v[44:47]
    v_mfma_f32_16x16x32_bf16 v[60:63], v[108:111], a[172:175], v[60:63]
    buffer_load_dwordx4 v229, s[20:23], s64 offen offset:2048 lds
    s_waitcnt vmcnt(27) lgkmcnt(3)
    v_mfma_f32_16x16x32_bf16 v[0:3], v[112:115], a[176:179], v[0:3]
    s_waitcnt vmcnt(26)
    v_mfma_f32_16x16x32_bf16 v[16:19], v[112:115], a[180:183], v[16:19]
    ds_read_b128 v[96:99], v212 offset:32768
    buffer_load_dwordx4 v229, s[20:23], s64 offen offset:3072 lds
    s_waitcnt vmcnt(26)
    v_mfma_f32_16x16x32_bf16 v[32:35], v[112:115], a[184:187], v[32:35]
    s_waitcnt vmcnt(25)
    v_mfma_f32_16x16x32_bf16 v[48:51], v[112:115], a[188:191], v[48:51]
    ds_read_b128 v[100:103], v212 offset:33792
    s_waitcnt lgkmcnt(4)
    v_mfma_f32_16x16x32_bf16 v[4:7], v[116:119], a[176:179], v[4:7]
    v_mfma_f32_16x16x32_bf16 v[20:23], v[116:119], a[180:183], v[20:23]
    ds_read_b128 v[104:107], v212 offset:34816
    v_mfma_f32_16x16x32_bf16 v[36:39], v[116:119], a[184:187], v[36:39]
    v_mfma_f32_16x16x32_bf16 v[52:55], v[116:119], a[188:191], v[52:55]
    ds_read_b128 v[108:111], v212 offset:35840
    s_waitcnt vmcnt(8)
    v_cmp_gt_u32 vcc, s66, v222
    s_nop 0
    s_cbranch_vccz K45_P2_OK
K45_P2:
    s_sleep 4
    buffer_load_dword v222, off, s[20:23], s60 offset:128 sc1
    s_waitcnt vmcnt(0)
    v_cmp_gt_u32 vcc, s66, v222
    s_nop 0
    s_cbranch_vccz K45_P2_OK
    s_branch K45_P2
K45_P2_OK:
    s_barrier
    s_waitcnt lgkmcnt(5)
    v_mfma_f32_16x16x32_bf16 v[8:11], v[120:123], a[176:179], v[8:11]
    s_add_u32 s65, s62, 2048
    v_mfma_f32_16x16x32_bf16 v[24:27], v[120:123], a[180:183], v[24:27]
    buffer_load_dwordx4 a[0:3], v217, s[20:23], s65 offen
    v_mfma_f32_16x16x32_bf16 v[40:43], v[120:123], a[184:187], v[40:43]
    buffer_load_dwordx4 a[4:7], v218, s[20:23], s65 offen
    v_mfma_f32_16x16x32_bf16 v[56:59], v[120:123], a[188:191], v[56:59]
    buffer_load_dwordx4 a[8:11], v219, s[20:23], s65 offen
    s_waitcnt lgkmcnt(4)
    v_mfma_f32_16x16x32_bf16 v[12:15], v[124:127], a[176:179], v[12:15]
    buffer_load_dwordx4 a[12:15], v220, s[20:23], s65 offen
    s_add_u32 s65, s62, 14336
    v_mfma_f32_16x16x32_bf16 v[28:31], v[124:127], a[180:183], v[28:31]
    buffer_load_dwordx4 a[16:19], v217, s[20:23], s65 offen
    v_mfma_f32_16x16x32_bf16 v[44:47], v[124:127], a[184:187], v[44:47]
    buffer_load_dwordx4 a[20:23], v218, s[20:23], s65 offen
    v_mfma_f32_16x16x32_bf16 v[60:63], v[124:127], a[188:191], v[60:63]
    buffer_load_dwordx4 a[24:27], v219, s[20:23], s65 offen
    s_waitcnt lgkmcnt(3)
    v_mfma_f32_16x16x32_bf16 v[0:3], v[96:99], a[192:195], v[0:3]
    buffer_load_dwordx4 a[28:31], v220, s[20:23], s65 offen
    s_add_u32 s65, s62, 26624
    v_mfma_f32_16x16x32_bf16 v[16:19], v[96:99], a[196:199], v[16:19]
    ds_read_b128 v[112:115], v212 offset:49152
    buffer_load_dwordx4 a[32:35], v217, s[20:23], s65 offen
    v_mfma_f32_16x16x32_bf16 v[32:35], v[96:99], a[200:203], v[32:35]
    buffer_load_dwordx4 a[36:39], v218, s[20:23], s65 offen
    v_mfma_f32_16x16x32_bf16 v[48:51], v[96:99], a[204:207], v[48:51]
    ds_read_b128 v[116:119], v212 offset:50176
    buffer_load_dwordx4 a[40:43], v219, s[20:23], s65 offen
    s_waitcnt lgkmcnt(4)
    v_mfma_f32_16x16x32_bf16 v[4:7], v[100:103], a[192:195], v[4:7]
    buffer_load_dwordx4 a[44:47], v220, s[20:23], s65 offen
    s_add_u32 s65, s62, 38912
    s_cmp_ge_u32 s40, 2
    s_cselect_b32 s65, 0xf0000000, s65
    v_mfma_f32_16x16x32_bf16 v[20:23], v[100:103], a[196:199], v[20:23]
    ds_read_b128 v[120:123], v212 offset:51200
    buffer_load_dwordx4 a[48:51], v217, s[20:23], s65 offen
    v_mfma_f32_16x16x32_bf16 v[36:39], v[100:103], a[200:203], v[36:39]
    buffer_load_dwordx4 a[52:55], v218, s[20:23], s65 offen
    v_mfma_f32_16x16x32_bf16 v[52:55], v[100:103], a[204:207], v[52:55]
    ds_read_b128 v[124:127], v212 offset:52224
    buffer_load_dwordx4 a[56:59], v219, s[20:23], s65 offen
    s_waitcnt lgkmcnt(5)
    v_mfma_f32_16x16x32_bf16 v[8:11], v[104:107], a[192:195], v[8:11]
    buffer_load_dwordx4 a[60:63], v220, s[20:23], s65 offen
    s_add_u32 s65, s63, 62914560
    v_mfma_f32_16x16x32_bf16 v[24:27], v[104:107], a[196:199], v[24:27]
    buffer_load_dwordx4 v[232:235], v174, s[20:23], s65 offen
    s_add_u32 s65, s65, 8192
    v_mfma_f32_16x16x32_bf16 v[40:43], v[104:107], a[200:203], v[40:43]
    buffer_load_dwordx4 v[236:239], v174, s[20:23], s65 offen
    v_mfma_f32_16x16x32_bf16 v[56:59], v[104:107], a[204:207], v[56:59]
    s_waitcnt lgkmcnt(4)
    v_mfma_f32_16x16x32_bf16 v[12:15], v[108:111], a[192:195], v[12:15]
    v_mfma_f32_16x16x32_bf16 v[28:31], v[108:111], a[196:199], v[28:31]
    v_mfma_f32_16x16x32_bf16 v[44:47], v[108:111], a[200:203], v[44:47]
    v_mfma_f32_16x16x32_bf16 v[60:63], v[108:111], a[204:207], v[60:63]
    v_add_u32 v212, 65536, v212
    s_waitcnt lgkmcnt(3)
    v_mfma_f32_16x16x32_bf16 v[0:3], v[112:115], a[208:211], v[0:3]
    v_mfma_f32_16x16x32_bf16 v[16:19], v[112:115], a[212:215], v[16:19]
    ds_read_b128 v[96:99], v212 offset:0
    v_mfma_f32_16x16x32_bf16 v[32:35], v[112:115], a[216:219], v[32:35]
    v_mfma_f32_16x16x32_bf16 v[48:51], v[112:115], a[220:223], v[48:51]
    ds_read_b128 v[100:103], v212 offset:1024
    s_waitcnt lgkmcnt(4)
    v_mfma_f32_16x16x32_bf16 v[4:7], v[116:119], a[208:211], v[4:7]
    v_mfma_f32_16x16x32_bf16 v[20:23], v[116:119], a[212:215], v[20:23]
    ds_read_b128 v[104:107], v212 offset:2048
    v_mfma_f32_16x16x32_bf16 v[36:39], v[116:119], a[216:219], v[36:39]
    v_mfma_f32_16x16x32_bf16 v[52:55], v[116:119], a[220:223], v[52:55]
    ds_read_b128 v[108:111], v212 offset:3072
    s_waitcnt lgkmcnt(5)
    v_mfma_f32_16x16x32_bf16 v[8:11], v[120:123], a[208:211], v[8:11]
    v_mfma_f32_16x16x32_bf16 v[24:27], v[120:123], a[212:215], v[24:27]
    v_mfma_f32_16x16x32_bf16 v[40:43], v[120:123], a[216:219], v[40:43]
    v_mfma_f32_16x16x32_bf16 v[56:59], v[120:123], a[220:223], v[56:59]
    s_waitcnt lgkmcnt(4)
    v_mfma_f32_16x16x32_bf16 v[12:15], v[124:127], a[208:211], v[12:15]
    v_mfma_f32_16x16x32_bf16 v[28:31], v[124:127], a[212:215], v[28:31]
    v_mfma_f32_16x16x32_bf16 v[44:47], v[124:127], a[216:219], v[44:47]
    v_mfma_f32_16x16x32_bf16 v[60:63], v[124:127], a[220:223], v[60:63]
    s_waitcnt lgkmcnt(3)
    v_mfma_f32_16x16x32_bf16 v[0:3], v[96:99], a[224:227], v[0:3]
    v_mfma_f32_16x16x32_bf16 v[16:19], v[96:99], a[228:231], v[16:19]
    ds_read_b128 v[112:115], v212 offset:16384
    v_mfma_f32_16x16x32_bf16 v[32:35], v[96:99], a[232:235], v[32:35]
    v_mfma_f32_16x16x32_bf16 v[48:51], v[96:99], a[236:239], v[48:51]
    ds_read_b128 v[116:119], v212 offset:17408
    s_waitcnt lgkmcnt(4)
    v_mfma_f32_16x16x32_bf16 v[4:7], v[100:103], a[224:227], v[4:7]
    v_mfma_f32_16x16x32_bf16 v[20:23], v[100:103], a[228:231], v[20:23]
    ds_read_b128 v[120:123], v212 offset:18432
    v_mfma_f32_16x16x32_bf16 v[36:39], v[100:103], a[232:235], v[36:39]
    v_mfma_f32_16x16x32_bf16 v[52:55], v[100:103], a[236:239], v[52:55]
    ds_read_b128 v[124:127], v212 offset:19456
    s_waitcnt lgkmcnt(5)
    v_mfma_f32_16x16x32_bf16 v[8:11], v[104:107], a[224:227], v[8:11]
    v_mfma_f32_16x16x32_bf16 v[24:27], v[104:107], a[228:231], v[24:27]
    v_mfma_f32_16x16x32_bf16 v[40:43], v[104:107], a[232:235], v[40:43]
    v_mfma_f32_16x16x32_bf16 v[56:59], v[104:107], a[236:239], v[56:59]
    s_waitcnt lgkmcnt(4)
    v_mfma_f32_16x16x32_bf16 v[12:15], v[108:111], a[224:227], v[12:15]
    v_mfma_f32_16x16x32_bf16 v[28:31], v[108:111], a[228:231], v[28:31]
    v_mfma_f32_16x16x32_bf16 v[44:47], v[108:111], a[232:235], v[44:47]
    v_mfma_f32_16x16x32_bf16 v[60:63], v[108:111], a[236:239], v[60:63]
    v_add_u32 v212, 4294836224, v212
    s_waitcnt lgkmcnt(3)
    v_mfma_f32_16x16x32_bf16 v[0:3], v[112:115], a[240:243], v[0:3]
    v_mfma_f32_16x16x32_bf16 v[16:19], v[112:115], a[244:247], v[16:19]
    ds_read_b128 v[96:99], v212 offset:0
    v_mfma_f32_16x16x32_bf16 v[32:35], v[112:115], a[248:251], v[32:35]
    v_mfma_f32_16x16x32_bf16 v[48:51], v[112:115], a[252:255], v[48:51]
    ds_read_b128 v[100:103], v212 offset:1024
    s_waitcnt lgkmcnt(4)
    v_mfma_f32_16x16x32_bf16 v[4:7], v[116:119], a[240:243], v[4:7]
    v_mfma_f32_16x16x32_bf16 v[20:23], v[116:119], a[244:247], v[20:23]
    ds_read_b128 v[104:107], v212 offset:2048
    v_mfma_f32_16x16x32_bf16 v[36:39], v[116:119], a[248:251], v[36:39]
    v_mfma_f32_16x16x32_bf16 v[52:55], v[116:119], a[252:255], v[52:55]
    ds_read_b128 v[108:111], v212 offset:3072
    s_waitcnt lgkmcnt(5)
    v_mfma_f32_16x16x32_bf16 v[8:11], v[120:123], a[240:243], v[8:11]
    v_mfma_f32_16x16x32_bf16 v[24:27], v[120:123], a[244:247], v[24:27]
    v_mfma_f32_16x16x32_bf16 v[40:43], v[120:123], a[248:251], v[40:43]
    v_mfma_f32_16x16x32_bf16 v[56:59], v[120:123], a[252:255], v[56:59]
    s_waitcnt lgkmcnt(4)
    v_mfma_f32_16x16x32_bf16 v[12:15], v[124:127], a[240:243], v[12:15]
    v_mfma_f32_16x16x32_bf16 v[28:31], v[124:127], a[244:247], v[28:31]
    v_mfma_f32_16x16x32_bf16 v[44:47], v[124:127], a[248:251], v[44:47]
    v_mfma_f32_16x16x32_bf16 v[60:63], v[124:127], a[252:255], v[60:63]
    s_waitcnt vmcnt(17) lgkmcnt(3)
    v_mfma_f32_16x16x32_bf16 v[0:3], v[96:99], a[0:3], v[0:3]
    s_waitcnt vmcnt(16)
    v_mfma_f32_16x16x32_bf16 v[16:19], v[96:99], a[4:7], v[16:19]
    ds_read_b128 v[112:115], v212 offset:16384
    s_waitcnt vmcnt(15)
    v_mfma_f32_16x16x32_bf16 v[32:35], v[96:99], a[8:11], v[32:35]
    s_waitcnt vmcnt(14)
    v_mfma_f32_16x16x32_bf16 v[48:51], v[96:99], a[12:15], v[48:51]
    ds_read_b128 v[116:119], v212 offset:17408
    s_waitcnt lgkmcnt(4)
    v_mfma_f32_16x16x32_bf16 v[4:7], v[100:103], a[0:3], v[4:7]
    v_mfma_f32_16x16x32_bf16 v[20:23], v[100:103], a[4:7], v[20:23]
    ds_read_b128 v[120:123], v212 offset:18432
    v_mfma_f32_16x16x32_bf16 v[36:39], v[100:103], a[8:11], v[36:39]
    v_mfma_f32_16x16x32_bf16 v[52:55], v[100:103], a[12:15], v[52:55]
    ds_read_b128 v[124:127], v212 offset:19456
    s_waitcnt lgkmcnt(5)
    v_mfma_f32_16x16x32_bf16 v[8:11], v[104:107], a[0:3], v[8:11]
    v_mfma_f32_16x16x32_bf16 v[24:27], v[104:107], a[4:7], v[24:27]
    v_mfma_f32_16x16x32_bf16 v[40:43], v[104:107], a[8:11], v[40:43]
    v_mfma_f32_16x16x32_bf16 v[56:59], v[104:107], a[12:15], v[56:59]
    s_waitcnt lgkmcnt(4)
    v_mfma_f32_16x16x32_bf16 v[12:15], v[108:111], a[0:3], v[12:15]
    v_mfma_f32_16x16x32_bf16 v[28:31], v[108:111], a[4:7], v[28:31]
    v_mfma_f32_16x16x32_bf16 v[44:47], v[108:111], a[8:11], v[44:47]
    v_mfma_f32_16x16x32_bf16 v[60:63], v[108:111], a[12:15], v[60:63]
    s_waitcnt vmcnt(13) lgkmcnt(3)
    v_mfma_f32_16x16x32_bf16 v[0:3], v[112:115], a[16:19], v[0:3]
    s_waitcnt vmcnt(12)
    v_mfma_f32_16x16x32_bf16 v[16:19], v[112:115], a[20:23], v[16:19]
    ds_read_b128 v[96:99], v212 offset:32768
    s_waitcnt vmcnt(11)
    v_mfma_f32_16x16x32_bf16 v[32:35], v[112:115], a[24:27], v[32:35]
    s_waitcnt vmcnt(10)
    v_mfma_f32_16x16x32_bf16 v[48:51], v[112:115], a[28:31], v[48:51]
    ds_read_b128 v[100:103], v212 offset:33792
    s_waitcnt lgkmcnt(4)
    v_mfma_f32_16x16x32_bf16 v[4:7], v[116:119], a[16:19], v[4:7]
    v_mfma_f32_16x16x32_bf16 v[20:23], v[116:119], a[20:23], v[20:23]
    ds_read_b128 v[104:107], v212 offset:34816
    v_mfma_f32_16x16x32_bf16 v[36:39], v[116:119], a[24:27], v[36:39]
    v_mfma_f32_16x16x32_bf16 v[52:55], v[116:119], a[28:31], v[52:55]
    ds_read_b128 v[108:111], v212 offset:35840
    s_waitcnt lgkmcnt(5)
    v_mfma_f32_16x16x32_bf16 v[8:11], v[120:123], a[16:19], v[8:11]
    v_mfma_f32_16x16x32_bf16 v[24:27], v[120:123], a[20:23], v[24:27]
    v_mfma_f32_16x16x32_bf16 v[40:43], v[120:123], a[24:27], v[40:43]
    v_mfma_f32_16x16x32_bf16 v[56:59], v[120:123], a[28:31], v[56:59]
    s_waitcnt lgkmcnt(4)
    v_mfma_f32_16x16x32_bf16 v[12:15], v[124:127], a[16:19], v[12:15]
    v_mfma_f32_16x16x32_bf16 v[28:31], v[124:127], a[20:23], v[28:31]
    v_mfma_f32_16x16x32_bf16 v[44:47], v[124:127], a[24:27], v[44:47]
    v_mfma_f32_16x16x32_bf16 v[60:63], v[124:127], a[28:31], v[60:63]
    s_waitcnt vmcnt(9) lgkmcnt(3)
    v_mfma_f32_16x16x32_bf16 v[0:3], v[96:99], a[32:35], v[0:3]
    s_waitcnt vmcnt(1)
    v_lshlrev_b32 v64, 16, v232
    v_and_b32 v65, 0xffff0000, v232
    v_mfma_f32_16x16x32_bf16 v[16:19], v[96:99], a[36:39], v[16:19]
    ds_read_b128 v[112:115], v212 offset:49152
    v_lshlrev_b32 v66, 16, v233
    v_mfma_f32_16x16x32_bf16 v[32:35], v[96:99], a[40:43], v[32:35]
    v_and_b32 v67, 0xffff0000, v233
    v_lshlrev_b32 v68, 16, v234
    v_mfma_f32_16x16x32_bf16 v[48:51], v[96:99], a[44:47], v[48:51]
    ds_read_b128 v[116:119], v212 offset:50176
    v_and_b32 v69, 0xffff0000, v234
    s_waitcnt lgkmcnt(4)
    v_mfma_f32_16x16x32_bf16 v[4:7], v[100:103], a[32:35], v[4:7]
    v_lshlrev_b32 v70, 16, v235
    v_and_b32 v71, 0xffff0000, v235
    v_mfma_f32_16x16x32_bf16 v[20:23], v[100:103], a[36:39], v[20:23]
    ds_read_b128 v[120:123], v212 offset:51200
    s_waitcnt vmcnt(0)
    v_lshlrev_b32 v72, 16, v236
    v_mfma_f32_16x16x32_bf16 v[36:39], v[100:103], a[40:43], v[36:39]
    v_and_b32 v73, 0xffff0000, v236
    v_lshlrev_b32 v74, 16, v237
    v_mfma_f32_16x16x32_bf16 v[52:55], v[100:103], a[44:47], v[52:55]
    ds_read_b128 v[124:127], v212 offset:52224
    v_and_b32 v75, 0xffff0000, v237
    s_waitcnt lgkmcnt(5)
    v_mfma_f32_16x16x32_bf16 v[8:11], v[104:107], a[32:35], v[8:11]
    v_lshlrev_b32 v76, 16, v238
    v_and_b32 v77, 0xffff0000, v238
    v_mfma_f32_16x16x32_bf16 v[24:27], v[104:107], a[36:39], v[24:27]
    v_lshlrev_b32 v78, 16, v239
    v_and_b32 v79, 0xffff0000, v239
    v_mfma_f32_16x16x32_bf16 v[40:43], v[104:107], a[40:43], v[40:43]
    v_mfma_f32_16x16x32_bf16 v[56:59], v[104:107], a[44:47], v[56:59]
    s_waitcnt lgkmcnt(4)
    v_mfma_f32_16x16x32_bf16 v[12:15], v[108:111], a[32:35], v[12:15]
    v_mfma_f32_16x16x32_bf16 v[28:31], v[108:111], a[36:39], v[28:31]
    v_mfma_f32_16x16x32_bf16 v[44:47], v[108:111], a[40:43], v[44:47]
    v_mfma_f32_16x16x32_bf16 v[60:63], v[108:111], a[44:47], v[60:63]
    s_waitcnt lgkmcnt(3)
    v_mfma_f32_16x16x32_bf16 v[0:3], v[112:115], a[48:51], v[0:3]
    v_mfma_f32_16x16x32_bf16 v[16:19], v[112:115], a[52:55], v[16:19]
    v_mfma_f32_16x16x32_bf16 v[32:35], v[112:115], a[56:59], v[32:35]
    v_mfma_f32_16x16x32_bf16 v[48:51], v[112:115], a[60:63], v[48:51]
    s_nop 4
    ds_write_b128 v224, v[0:3] offset:0
    s_waitcnt lgkmcnt(3)
    v_mfma_f32_16x16x32_bf16 v[4:7], v[116:119], a[48:51], v[4:7]
    ds_write_b128 v224, v[16:19] offset:16384
    v_mfma_f32_16x16x32_bf16 v[20:23], v[116:119], a[52:55], v[20:23]
    ds_write_b128 v224, v[32:35] offset:32768
    v_mfma_f32_16x16x32_bf16 v[36:39], v[116:119], a[56:59], v[36:39]
    ds_write_b128 v224, v[48:51] offset:49152
    v_mfma_f32_16x16x32_bf16 v[52:55], v[116:119], a[60:63], v[52:55]
    s_nop 1
    ds_write_b128 v225, v[4:7] offset:0
    s_waitcnt lgkmcnt(6)
    v_mfma_f32_16x16x32_bf16 v[8:11], v[120:123], a[48:51], v[8:11]
    ds_write_b128 v225, v[20:23] offset:16384
    v_mfma_f32_16x16x32_bf16 v[24:27], v[120:123], a[52:55], v[24:27]
    ds_write_b128 v225, v[36:39] offset:32768
    v_mfma_f32_16x16x32_bf16 v[40:43], v[120:123], a[56:59], v[40:43]
    ds_write_b128 v225, v[52:55] offset:49152
    v_mfma_f32_16x16x32_bf16 v[56:59], v[120:123], a[60:63], v[56:59]
    s_nop 1
    ds_write_b128 v226, v[8:11] offset:0
    s_waitcnt lgkmcnt(9)
    v_mfma_f32_16x16x32_bf16 v[12:15], v[124:127], a[48:51], v[12:15]
    ds_write_b128 v226, v[24:27] offset:16384
    v_mfma_f32_16x16x32_bf16 v[28:31], v[124:127], a[52:55], v[28:31]
    ds_write_b128 v226, v[40:43] offset:32768
    v_mfma_f32_16x16x32_bf16 v[44:47], v[124:127], a[56:59], v[44:47]
    ds_write_b128 v226, v[56:59] offset:49152
    v_mfma_f32_16x16x32_bf16 v[60:63], v[124:127], a[60:63], v[60:63]
    s_nop 1
    ds_write_b128 v227, v[12:15] offset:0
    s_nop 0
    ds_write_b128 v227, v[28:31] offset:16384
    s_nop 0
    ds_write_b128 v227, v[44:47] offset:32768
    s_nop 0
    ds_write_b128 v227, v[60:63] offset:49152
    s_waitcnt lgkmcnt(0)
    s_barrier
    ds_read_b128 v[0:3], v228 offset:0
    ds_read_b128 v[8:11], v228 offset:4096
    ds_read_b128 v[16:19], v228 offset:8192
    ds_read_b128 v[24:27], v228 offset:12288
    ds_read_b128 v[4:7], v228 offset:128
    ds_read_b128 v[12:15], v228 offset:4224
    ds_read_b128 v[20:23], v228 offset:8320
    ds_read_b128 v[28:31], v228 offset:12416
    ds_read_b128 v[32:35], v228 offset:2048
    ds_read_b128 v[40:43], v228 offset:6144
    ds_read_b128 v[48:51], v228 offset:10240
    ds_read_b128 v[56:59], v228 offset:14336
    ds_read_b128 v[36:39], v228 offset:2176
    ds_read_b128 v[44:47], v228 offset:6272
    ds_read_b128 v[52:55], v228 offset:10368
    ds_read_b128 v[60:63], v228 offset:14464
    s_waitcnt lgkmcnt(14)
    v_add_f32 v0, v0, v8
    v_add_f32 v1, v1, v9
    v_add_f32 v2, v2, v10
    v_add_f32 v3, v3, v11
    s_waitcnt lgkmcnt(12)
    v_add_f32 v16, v16, v24
    v_add_f32 v17, v17, v25
    v_add_f32 v18, v18, v26
    v_add_f32 v19, v19, v27
    v_add_f32 v0, v0, v16
    v_add_f32 v1, v1, v17
    v_add_f32 v2, v2, v18
    v_add_f32 v3, v3, v19
    s_waitcnt lgkmcnt(10)
    v_add_f32 v4, v4, v12
    v_add_f32 v5, v5, v13
    v_add_f32 v6, v6, v14
    v_add_f32 v7, v7, v15
    s_waitcnt lgkmcnt(8)
    v_add_f32 v20, v20, v28
    v_add_f32 v21, v21, v29
    v_add_f32 v22, v22, v30
    v_add_f32 v23, v23, v31
    v_add_f32 v4, v4, v20
    v_add_f32 v5, v5, v21
    v_add_f32 v6, v6, v22
    v_add_f32 v7, v7, v23
    v_cvt_pk_bf16_f32 v230, v0, v1
    v_lshlrev_b32 v0, 16, v230
    v_and_b32 v1, 0xffff0000, v230
    v_mul_f32 v0, v0, v240
    v_mul_f32 v1, v1, v241
    v_cvt_pk_bf16_f32 v230, v0, v1
    v_lshlrev_b32 v0, 16, v230
    v_and_b32 v1, 0xffff0000, v230
    v_add_f32 v0, v0, v64
    v_add_f32 v1, v1, v65
    v_cvt_pk_bf16_f32 v16, v0, v1
    v_cvt_pk_bf16_f32 v230, v2, v3
    v_lshlrev_b32 v2, 16, v230
    v_and_b32 v3, 0xffff0000, v230
    v_mul_f32 v2, v2, v242
    v_mul_f32 v3, v3, v243
    v_cvt_pk_bf16_f32 v230, v2, v3
    v_lshlrev_b32 v2, 16, v230
    v_and_b32 v3, 0xffff0000, v230
    v_add_f32 v2, v2, v66
    v_add_f32 v3, v3, v67
    v_cvt_pk_bf16_f32 v17, v2, v3
    v_cvt_pk_bf16_f32 v230, v4, v5
    v_lshlrev_b32 v4, 16, v230
    v_and_b32 v5, 0xffff0000, v230
    v_mul_f32 v4, v4, v244
    v_mul_f32 v5, v5, v245
    v_cvt_pk_bf16_f32 v230, v4, v5
    v_lshlrev_b32 v4, 16, v230
    v_and_b32 v5, 0xffff0000, v230
    v_add_f32 v4, v4, v68
    v_add_f32 v5, v5, v69
    v_cvt_pk_bf16_f32 v18, v4, v5
    v_cvt_pk_bf16_f32 v230, v6, v7
    v_lshlrev_b32 v6, 16, v230
    v_and_b32 v7, 0xffff0000, v230
    v_mul_f32 v6, v6, v246
    v_mul_f32 v7, v7, v247
    v_cvt_pk_bf16_f32 v230, v6, v7
    v_lshlrev_b32 v6, 16, v230
    v_and_b32 v7, 0xffff0000, v230
    v_add_f32 v6, v6, v70
    v_add_f32 v7, v7, v71
    v_cvt_pk_bf16_f32 v19, v6, v7
    buffer_store_dwordx4 v[16:19], v174, s[4:7], s63 offen sc1
    s_add_u32 s63, s63, 8192
    s_waitcnt lgkmcnt(6)
    v_add_f32 v32, v32, v40
    v_add_f32 v33, v33, v41
    v_add_f32 v34, v34, v42
    v_add_f32 v35, v35, v43
    s_waitcnt lgkmcnt(4)
    v_add_f32 v48, v48, v56
    v_add_f32 v49, v49, v57
    v_add_f32 v50, v50, v58
    v_add_f32 v51, v51, v59
    v_add_f32 v32, v32, v48
    v_add_f32 v33, v33, v49
    v_add_f32 v34, v34, v50
    v_add_f32 v35, v35, v51
    s_waitcnt lgkmcnt(2)
    v_add_f32 v36, v36, v44
    v_add_f32 v37, v37, v45
    v_add_f32 v38, v38, v46
    v_add_f32 v39, v39, v47
    s_waitcnt lgkmcnt(0)
    v_add_f32 v52, v52, v60
    v_add_f32 v53, v53, v61
    v_add_f32 v54, v54, v62
    v_add_f32 v55, v55, v63
    v_add_f32 v36, v36, v52
    v_add_f32 v37, v37, v53
    v_add_f32 v38, v38, v54
    v_add_f32 v39, v39, v55
    v_cvt_pk_bf16_f32 v230, v32, v33
    v_lshlrev_b32 v32, 16, v230
    v_and_b32 v33, 0xffff0000, v230
    v_mul_f32 v32, v32, v240
    v_mul_f32 v33, v33, v241
    v_cvt_pk_bf16_f32 v230, v32, v33
    v_lshlrev_b32 v32, 16, v230
    v_and_b32 v33, 0xffff0000, v230
    v_add_f32 v32, v32, v72
    v_add_f32 v33, v33, v73
    v_cvt_pk_bf16_f32 v48, v32, v33
    v_cvt_pk_bf16_f32 v230, v34, v35
    v_lshlrev_b32 v34, 16, v230
    v_and_b32 v35, 0xffff0000, v230
    v_mul_f32 v34, v34, v242
    v_mul_f32 v35, v35, v243
    v_cvt_pk_bf16_f32 v230, v34, v35
    v_lshlrev_b32 v34, 16, v230
    v_and_b32 v35, 0xffff0000, v230
    v_add_f32 v34, v34, v74
    v_add_f32 v35, v35, v75
    v_cvt_pk_bf16_f32 v49, v34, v35
    v_cvt_pk_bf16_f32 v230, v36, v37
    v_lshlrev_b32 v36, 16, v230
    v_and_b32 v37, 0xffff0000, v230
    v_mul_f32 v36, v36, v244
    v_mul_f32 v37, v37, v245
    v_cvt_pk_bf16_f32 v230, v36, v37
    v_lshlrev_b32 v36, 16, v230
    v_and_b32 v37, 0xffff0000, v230
    v_add_f32 v36, v36, v76
    v_add_f32 v37, v37, v77
    v_cvt_pk_bf16_f32 v50, v36, v37
    v_cvt_pk_bf16_f32 v230, v38, v39
    v_lshlrev_b32 v38, 16, v230
    v_and_b32 v39, 0xffff0000, v230
    v_mul_f32 v38, v38, v246
    v_mul_f32 v39, v39, v247
    v_cvt_pk_bf16_f32 v230, v38, v39
    v_lshlrev_b32 v38, 16, v230
    v_and_b32 v39, 0xffff0000, v230
    v_add_f32 v38, v38, v78
    v_add_f32 v39, v39, v79
    v_cvt_pk_bf16_f32 v51, v38, v39
    buffer_store_dwordx4 v[48:51], v174, s[4:7], s63 offen sc1
    s_branch K5_FIN
K45_IDLE:
    s_and_b32 s64, s2, 6
    s_bfe_u32 s65, s2, 0x10006
    s_add_u32 s64, s64, s65
    s_lshr_b32 s65, s2, 7
    s_lshl_b32 s65, s65, 3
    s_add_u32 s64, s64, s65
    s_mul_i32 s60, s64, 384
    s_add_u32 s60, s60, 540672
    s_cmp_eq_u32 s40, 1
    s_cselect_b32 s60, s60, 0xf0000000
    s_cselect_b32 s66, 15, 0
    s_and_b32 s63, s40, 1
    s_mul_i32 s63, s63, 62
    s_lshl_b32 s64, s64, 1
    s_bfe_u32 s65, s2, 0x10005
    s_add_u32 s64, s64, s65
    s_mul_i32 s62, s64, 184320
    s_mul_i32 s65, s40, 3072
    s_add_u32 s62, s62, s65
    s_add_u32 s62, s62, 71303168
    s_xor_b32 s63, s63, s64
    s_lshl_b32 s63, s63, 15
    s_lshr_b32 s65, s40, 1
    s_lshl_b32 s65, s65, 14
    s_add_u32 s63, s63, s65
    s_bfe_u32 s64, s2, 0x20003
    s_and_b32 s65, s2, 1
    s_lshl_b32 s65, s65, 2
    s_add_u32 s64, s64, s65
    s_lshl_b32 s64, s64, 7
    s_add_u32 s63, s63, s64
    s_mul_i32 s61, s40, 12288
    s_mul_i32 s65, s64, 1536
    s_add_u32 s61, s61, s65
    s_add_u32 s61, s61, 88080384
    v_lshrrev_b32 v230, 3, v253
    v_and_b32 v231, 7, v253
    v_lshlrev_b32 v174, 10, v230
    v_xor_b32 v228, v230, v231
    v_lshlrev_b32 v228, 4, v228
    v_lshl_add_u32 v228, v230, 8, v228
    s_lshl_b32 s65, s40, 14
    s_add_u32 s65, s65, 65536
    v_add_u32 v228, s65, v228
    v_lshl_add_u32 v174, v231, 4, v174
    v_lshlrev_b32 v231, 5, v231
    s_lshl_b32 s64, s64, 1
    s_add_u32 s64, s64, 141312
    buffer_load_dwordx4 v[240:243], v231, s[20:23], s64 offen
    buffer_load_dwordx4 v[244:247], v231, s[20:23], s64 offen offset:16
    v_add_u32 v217, 0, v229
    v_add_u32 v218, 46080, v229
    v_add_u32 v219, 92160, v229
    v_add_u32 v220, 138240, v229
    v_min_u32 v221, 1, v253
    v_lshlrev_b32 v221, 31, v221
    v_lshrrev_b32 v230, 5, v253
    v_add_u32 v212, s46, v229
    v_and_b32 v223, 7, v253
    v_xor_b32 v230, v230, v223
    v_lshlrev_b32 v230, 4, v230
    v_and_b32 v223, 15, v253
    v_lshl_add_u32 v230, v223, 8, v230
    v_bfe_u32 v223, v253, 4, 1
    v_lshl_add_u32 v230, v223, 7, v230
    s_add_u32 s65, s46, 65536
    v_add_u32 v224, s65, v230
    v_xor_b32 v225, 32, v224
    v_xor_b32 v226, 64, v224
    v_xor_b32 v227, 96, v224
    v_mov_b32 v223, 1
    s_add_u32 m0, s46, 32768
    s_add_u32 s64, s61, 0
    buffer_load_dwordx4 v229, s[20:23], s64 offen offset:0 lds
    buffer_load_dwordx4 v229, s[20:23], s64 offen offset:1024 lds
    buffer_load_dwordx4 v229, s[20:23], s64 offen offset:2048 lds
    buffer_load_dwordx4 v229, s[20:23], s64 offen offset:3072 lds
    s_add_u32 m0, s46, 49152
    s_add_u32 s64, s61, 49152
    buffer_load_dwordx4 v229, s[20:23], s64 offen offset:0 lds
    buffer_load_dwordx4 v229, s[20:23], s64 offen offset:1024 lds
    buffer_load_dwordx4 v229, s[20:23], s64 offen offset:2048 lds
    buffer_load_dwordx4 v229, s[20:23], s64 offen offset:3072 lds
    s_add_u32 m0, s46, 65536
    s_add_u32 s64, s61, 98304
    buffer_load_dwordx4 v229, s[20:23], s64 offen offset:0 lds
    buffer_load_dwordx4 v229, s[20:23], s64 offen offset:1024 lds
    buffer_load_dwordx4 v229, s[20:23], s64 offen offset:2048 lds
    buffer_load_dwordx4 v229, s[20:23], s64 offen offset:3072 lds
    s_add_u32 m0, s46, 81920
    s_add_u32 s64, s61, 147456
    buffer_load_dwordx4 v229, s[20:23], s64 offen offset:0 lds
    buffer_load_dwordx4 v229, s[20:23], s64 offen offset:1024 lds
    buffer_load_dwordx4 v229, s[20:23], s64 offen offset:2048 lds
    buffer_load_dwordx4 v229, s[20:23], s64 offen offset:3072 lds
    s_add_u32 m0, s46, 98304
    s_add_u32 s64, s61, 4096
    buffer_load_dwordx4 v229, s[20:23], s64 offen offset:0 lds
    buffer_load_dwordx4 v229, s[20:23], s64 offen offset:1024 lds
    buffer_load_dwordx4 v229, s[20:23], s64 offen offset:2048 lds
    buffer_load_dwordx4 v229, s[20:23], s64 offen offset:3072 lds
    s_add_u32 m0, s46, 114688
    s_add_u32 s64, s61, 53248
    buffer_load_dwordx4 v229, s[20:23], s64 offen offset:0 lds
    buffer_load_dwordx4 v229, s[20:23], s64 offen offset:1024 lds
    buffer_load_dwordx4 v229, s[20:23], s64 offen offset:2048 lds
    buffer_load_dwordx4 v229, s[20:23], s64 offen offset:3072 lds
    s_add_u32 m0, s46, 131072
    s_add_u32 s64, s61, 102400
    buffer_load_dwordx4 v229, s[20:23], s64 offen offset:0 lds
    buffer_load_dwordx4 v229, s[20:23], s64 offen offset:1024 lds
    buffer_load_dwordx4 v229, s[20:23], s64 offen offset:2048 lds
    buffer_load_dwordx4 v229, s[20:23], s64 offen offset:3072 lds
    s_add_u32 m0, s46, 147456
    s_add_u32 s64, s61, 151552
    buffer_load_dwordx4 v229, s[20:23], s64 offen offset:0 lds
    buffer_load_dwordx4 v229, s[20:23], s64 offen offset:1024 lds
    buffer_load_dwordx4 v229, s[20:23], s64 offen offset:2048 lds
    buffer_load_dwordx4 v229, s[20:23], s64 offen offset:3072 lds
    s_add_u32 m0, s46, 0
    s_add_u32 s64, s61, 8192
    buffer_load_dwordx4 v229, s[20:23], s64 offen offset:0 lds
    buffer_load_dwordx4 v229, s[20:23], s64 offen offset:1024 lds
    buffer_load_dwordx4 v229, s[20:23], s64 offen offset:2048 lds
    buffer_load_dwordx4 v229, s[20:23], s64 offen offset:3072 lds
    s_add_u32 m0, s46, 16384
    s_add_u32 s64, s61, 57344
    buffer_load_dwordx4 v229, s[20:23], s64 offen offset:0 lds
    buffer_load_dwordx4 v229, s[20:23], s64 offen offset:1024 lds
    buffer_load_dwordx4 v229, s[20:23], s64 offen offset:2048 lds
    buffer_load_dwordx4 v229, s[20:23], s64 offen offset:3072 lds
    buffer_load_dword v222, off, s[20:23], s60 offset:0 sc1
    s_waitcnt vmcnt(0)
    v_cmp_gt_u32 vcc, s66, v222
    s_nop 0
    s_cbranch_vccz K45_PI_OK
K45_PI:
    s_sleep 16
    buffer_load_dword v222, off, s[20:23], s60 offset:0 sc1
    s_waitcnt vmcnt(0)
    v_cmp_gt_u32 vcc, s66, v222
    s_nop 0
    s_cbranch_vccz K45_PI_OK
    s_branch K45_PI
K45_PI_OK:
    s_barrier
    s_branch K45_JOIN
K5_FIN:
K5_END:
K1_EXIT:
    s_endpgm

.section .rodata,"a"
.p2align 6
.amdhsa_kernel block_kernel
  .amdhsa_next_free_vgpr 512
  .amdhsa_next_free_sgpr 102
  .amdhsa_accum_offset 256
  .amdhsa_group_segment_fixed_size 0
  .amdhsa_kernarg_size 120
  .amdhsa_user_sgpr_count 2
  .amdhsa_user_sgpr_kernarg_segment_ptr 1
  .amdhsa_system_sgpr_workgroup_id_x 1
  .amdhsa_float_denorm_mode_32 3
  .amdhsa_float_denorm_mode_16_64 3
.end_amdhsa_kernel
```
